```python
import torch

def _softmax(x, axis=-1):
    return torch.softmax(x, dim=axis)

def _gelu(x):
    return torch.nn.functional.gelu(x, approximate='tanh')

def _silu(x):
    return torch.nn.functional.silu(x)

def _sigmoid(x):
    return torch.sigmoid(x)

def _layernorm(x, axis=-1, eps=1e-05):
    m = x.mean(dim=axis, keepdim=True)
    v = x.var(dim=axis, keepdim=True, unbiased=False)
    return (x - m) / torch.sqrt(v + eps)

def _scatter_add(tgt, idx, src, axis=0):
    return tgt.clone().index_add_(axis, idx, src)

def _segment_sum(src, seg, n):
    out = torch.zeros((n,) + src.shape[1:], dtype=src.dtype)
    return out.index_add_(0, seg, src)

def _pad(x, pw):
    flat = tuple((v for pair in reversed(pw) for v in pair))
    return torch.nn.functional.pad(x, flat)
kernel_name = 'adaLN_cond__gqa_block_cached__moe_arch_mod__prompt'

def setup_inputs():

    _w = lambda a: (lambda t: t.to(torch.bfloat16) if t.is_floating_point() else t)(torch.as_tensor(a))

    def _A_setup():
        B, Sq, D = (1, 2048, 576)
        Hq, Hkv, Sk, Dh = (32, 16, 2048, 128)
        assert Hq % Hkv == 0, (Hq, Hkv)
        return {'x': _w((lambda *s: torch.randn(*s, dtype=torch.bfloat16) * 0.05)(B, Sq, D)), 'k_cache': _w((lambda *s: torch.randn(*s, dtype=torch.bfloat16) * 3.2)(B, Hkv, Sk, Dh)), 'v_cache': _w((lambda *s: torch.randn(*s, dtype=torch.bfloat16) * 0.4)(B, Hkv, Sk, Dh)), 'wq': _w((lambda *s: torch.randn(*s, dtype=torch.bfloat16) * 3.2)(D, Hq * Dh) * D ** (-0.5)), 'wo': _w((lambda *s: torch.randn(*s, dtype=torch.bfloat16) * 0.4)(Hq * Dh, D) * (Hq * Dh) ** (-0.5))}
    _A_in = _A_setup()

    def _B_setup():
        B, S, D, F, C = (1, 2048, 576, 4608, 8)
        return {'x': _w((lambda *s: torch.randn(*s, dtype=torch.bfloat16) * 0.05)(B, S, D)), 'w_r': _w((lambda *s: torch.randn(*s, dtype=torch.bfloat16) * 0.05)(D)), 'w_gate': _w((lambda *s: torch.randn(*s, dtype=torch.bfloat16) * 0.05)(D, F)), 'w_up': _w((lambda *s: torch.randn(*s, dtype=torch.bfloat16) * 0.05)(D, F)), 'w_down': _w((lambda *s: torch.randn(*s, dtype=torch.bfloat16) * 0.05)(F, D))}
    _B_in = _B_setup()
    return {'A_x': _A_in['x'], 'A_k_cache': _A_in['k_cache'], 'A_v_cache': _A_in['v_cache'], 'A_wq': _A_in['wq'], 'A_wo': _A_in['wo'], 'B_x': _B_in['x'], 'B_w_r': _B_in['w_r'], 'B_w_gate': _B_in['w_gate'], 'B_w_up': _B_in['w_up'], 'B_w_down': _B_in['w_down'], 'c': _w((lambda *s: torch.randn(*s, dtype=torch.bfloat16) * 0.1)(1, 576) * 8.0), 'w_mod': _w((lambda *s: torch.randn(*s, dtype=torch.bfloat16) * 0.1)(576, 6 * 576) * 576 ** (-0.5) * 8.0)}

def reference(A_x, A_k_cache, A_v_cache, A_wq, A_wo, B_x, B_w_r, B_w_gate, B_w_up, B_w_down, c, w_mod):

    def _A_ref(x, k_cache, v_cache, wq, wo):
        B, Sq, D = x.shape
        Hq, Dh = (32, 128)
        Hkv = k_cache.shape[1]
        rep = Hq // Hkv
        q = (lambda x, *d: x.permute(*d))((x @ wq).reshape(B, Sq, Hq, Dh), 0, 2, 1, 3)
        k = (lambda x, n, axis: torch.repeat_interleave(x, n, dim=axis))(k_cache, rep, axis=1)
        v = (lambda x, n, axis: torch.repeat_interleave(x, n, dim=axis))(v_cache, rep, axis=1)
        scores = torch.einsum('bhqd,bhkd->bhqk', q, k) * Dh ** (-0.5)
        p = _softmax(scores, axis=-1)
        o = torch.einsum('bhqk,bhkd->bhqd', p, v)
        return (lambda x, *d: x.permute(*d))(o, 0, 2, 1, 3).reshape(B, Sq, Hq * Dh) @ wo

    def _B_ref(x, w_r, w_gate, w_up, w_down):
        B, S, D = x.shape
        C = 8
        r = x @ w_r
        idx = torch.argsort(-r, axis=-1)[:, :C]
        idx_e = (lambda x, n, axis: torch.repeat_interleave(x, n, dim=axis))(idx.reshape(B, C, 1), D, axis=2)
        x_sel = (lambda x, i, axis: torch.take_along_dim(x, i, dim=axis))(x, idx_e, axis=1)
        g = _silu(x_sel @ w_gate)
        u = x_sel @ w_up
        y = g * u @ w_down
        r_sel = _sigmoid((lambda x, i, axis: torch.take_along_dim(x, i, dim=axis))(r, idx, axis=1))
        y = y * r_sel.reshape(B, C, 1)
        b_off = (torch.arange(B) * S).reshape(B, 1)
        flat_idx = (idx + b_off).reshape(B * C)
        zero = (x * 0.0).reshape(B * S, D)
        upd = _scatter_add(zero, flat_idx, y.reshape(B * C, D), axis=0)
        return x + upd.reshape(B, S, D)
    x = A_x
    mod = (_silu(c) @ w_mod).reshape(c.shape[0], 6, 1, -1)
    sa, ca, ga, sb, cb, gb = (mod[:, 0].clone(), mod[:, 1].clone(), mod[:, 2].clone(), mod[:, 3].clone(), mod[:, 4].clone(), mod[:, 5].clone())
    h = _layernorm(x, axis=-1) * (1 + ca) + sa
    x = x + ga * _A_ref(h, A_k_cache, A_v_cache, A_wq, A_wo)
    h = _layernorm(x, axis=-1) * (1 + cb) + sb
    x = x + gb * _B_ref(h, B_w_r, B_w_gate, B_w_up, B_w_down)
    return x
```

```asm
; @launch grid=(256,1,1) block=(256,1,1) lds=163840
.amdgcn_target "amdgcn-amd-amdhsa--gfx950"
.text
    .globl adaLN_cond__gqa_block_cached__moe_arch_mod__prompt_kernel
    .p2align 8
    .type adaLN_cond__gqa_block_cached__moe_arch_mod__prompt_kernel,@function
adaLN_cond__gqa_block_cached__moe_arch_mod__prompt_kernel:
    s_cmp_ge_u32 s2, 256
    s_cbranch_scc1 K2_END
    s_load_dwordx2 s[56:57], s[0:1], 88
    s_load_dwordx2 s[48:49], s[0:1], 80
    s_load_dwordx2 s[44:45], s[0:1], 0
    s_load_dwordx2 s[24:25], s[0:1], 112
    s_load_dwordx2 s[16:17], s[0:1], 24
    s_load_dwordx2 s[20:21], s[0:1], 32
    s_load_dwordx2 s[8:9], s[0:1], 8
    s_load_dwordx2 s[12:13], s[0:1], 16
    s_load_dwordx4 s[4:7], s[0:1], 56
    s_load_dwordx2 s[60:61], s[0:1], 72
    s_load_dwordx2 s[36:37], s[0:1], 104
    s_memrealtime s[30:31]
    v_and_b32 v1, 63, v0
    s_lshr_b32 s42, s2, 3
    s_lshl_b32 s42, s42, 4
    v_add_u32 v2, s42, v1
    v_cmp_gt_u32 vcc, 48, v1
    v_mov_b32 v223, v0
    v_mov_b32 v4, 0
    s_nop 0
    v_cndmask_b32 v2, v2, v1, vcc
    s_getpc_b64 s[62:63]
TC27_F_START:
    s_add_u32 s62, s62, F_START-TC27_F_START
    s_addc_u32 s63, s63, 0
    v_min_u32 v3, (BACK_T29_0-F_START-1)/128, v2
    v_lshlrev_b32 v3, 7, v3
    global_load_dword a140, v3, s[62:63]
F_START:
    s_and_b32 s41, s2, 7
    s_lshl_b32 s41, s41, 1
    s_bfe_u32 s42, s2, 0x10003
    s_add_u32 s41, s41, s42
    s_lshr_b32 s42, s2, 4
    s_lshl_b32 s52, s42, 4
    s_add_u32 s52, s52, s41
    v_lshlrev_b32 v225, 4, v1
    v_lshrrev_b32 v1, 6, v0
    s_nop 0
    v_readfirstlane_b32 s40, v1
    s_waitcnt lgkmcnt(0)
    s_or_b32 s43, s2, s40
    s_cmp_lg_u32 s43, 0
    s_cbranch_scc1 F_NOTAG
    s_or_b32 s30, s30, 1
    v_mov_b32 v2, 0
    v_mov_b32 v3, s30
    s_mov_b64 exec, 1
    global_store_dword v2, v3, s[36:37] sc1
    s_mov_b64 exec, -1
F_NOTAG:
    s_and_b32 s57, s57, 0xffff
    s_mov_b32 s58, 0x3cc000
    s_mov_b32 s59, 0x00020000
    s_and_b32 s49, s49, 0xffff
    s_mov_b32 s50, 0x480
    s_mov_b32 s51, 0x00020000
    s_and_b32 s25, s25, 0xffff
    s_mov_b32 s26, 0x3080000
    s_mov_b32 s27, 0x00020000
    s_and_b32 s45, s45, 0xffff
    s_mov_b32 s46, 0x240000
    s_mov_b32 s47, 0x00020000
    s_cmp_lt_u32 s40, 3
    s_cbranch_scc1 F_NOWT
    v_and_b32 v2, 63, v223
    v_min_u32 v2, 53, v2
    v_mul_u32_u24 v3, 21846, v2
    v_lshrrev_b32 v3, 16, v3
    v_mul_u32_u24 v4, 3840, v3
    v_lshl_add_u32 v4, v2, 10, v4
    s_lshr_b32 s43, s2, 3
    s_mul_i32 s43, s43, 124416
    s_and_b32 s30, s2, 7
    s_lshl_b32 s30, s30, 7
    s_add_u32 s43, s43, s30
    buffer_load_dword a140, v4, s[56:59], s43 offen
F_NOWT:
    s_cmp_ge_u32 s52, 108
    s_cbranch_scc1 F_NOMOD0
    v_and_b32 v1, 3, v223
    v_lshrrev_b32 v2, 2, v223
    v_mul_u32_u24 v3, 6912, v2
    v_lshl_add_u32 v3, v1, 4, v3
    s_lshl_b32 s30, s52, 6
    v_lshlrev_b32 v4, 1, v2
    buffer_load_dwordx4 v[20:23], v3, s[56:59], s30 offen
    s_add_u32 s30, s30, 442368
    buffer_load_ushort v8, v4, s[48:51], 0 offen offset:0
    buffer_load_ushort v9, v4, s[48:51], 0 offen offset:128
    buffer_load_ushort v10, v4, s[48:51], 0 offen offset:256
    buffer_load_ushort v11, v4, s[48:51], 0 offen offset:384
    buffer_load_ushort v12, v4, s[48:51], 0 offen offset:512
    buffer_load_ushort v13, v4, s[48:51], 0 offen offset:640
    buffer_load_ushort v14, v4, s[48:51], 0 offen offset:768
    buffer_load_ushort v15, v4, s[48:51], 0 offen offset:896
    buffer_load_ushort v16, v4, s[48:51], 0 offen offset:1024
    buffer_load_dwordx4 v[24:27], v3, s[56:59], s30 offen
    s_add_u32 s30, s30, 442368
    buffer_load_dwordx4 v[28:31], v3, s[56:59], s30 offen
    s_add_u32 s30, s30, 442368
    buffer_load_dwordx4 v[32:35], v3, s[56:59], s30 offen
    s_add_u32 s30, s30, 442368
    buffer_load_dwordx4 v[36:39], v3, s[56:59], s30 offen
    s_add_u32 s30, s30, 442368
    buffer_load_dwordx4 v[40:43], v3, s[56:59], s30 offen
    s_add_u32 s30, s30, 442368
    buffer_load_dwordx4 v[44:47], v3, s[56:59], s30 offen
    s_add_u32 s30, s30, 442368
    buffer_load_dwordx4 v[48:51], v3, s[56:59], s30 offen
    s_add_u32 s30, s30, 442368
    buffer_load_dwordx4 v[52:55], v3, s[56:59], s30 offen
    s_mul_i32 s29, s52, 3641
    s_lshr_b32 s29, s29, 16
    s_mul_i32 s30, s29, 18
    s_sub_u32 s30, s52, s30
    s_lshl_b32 s30, s30, 5
    v_add_u32 v6, s30, v223
    v_lshrrev_b32 v7, 2, v6
    v_lshlrev_b32 v7, 5, v7
    v_and_b32 v6, 3, v6
    v_lshlrev_b32 v18, 2, v223
    v_lshl_add_u32 v19, v6, 1, v7
    v_lshrrev_b32 v5, 4, v223
    v_lshlrev_b32 v5, 7, v5
    v_lshl_add_u32 v5, v1, 5, v5
    v_add_u32 v5, 139264, v5
    v_lshlrev_b32 v7, 2, v223
    v_add_u32 v7, 139264, v7
    s_cmp_eq_u32 s29, 1
    s_cselect_b32 s31, 1.0, 0
    s_cmp_eq_u32 s29, 4
    s_cselect_b32 s31, 1.0, s31
    s_waitcnt vmcnt(8)
    v_mov_b32 v127, 0
    global_load_dword v126, v127, s[36:37] sc1
    v_lshlrev_b32 v8, 16, v8
    v_lshlrev_b32 v9, 16, v9
    v_lshlrev_b32 v10, 16, v10
    v_lshlrev_b32 v11, 16, v11
    v_lshlrev_b32 v12, 16, v12
    v_lshlrev_b32 v13, 16, v13
    v_lshlrev_b32 v14, 16, v14
    v_lshlrev_b32 v15, 16, v15
    v_lshlrev_b32 v16, 16, v16
    v_mul_f32 v60, 0xbfb8aa3b, v8
    v_mul_f32 v61, 0xbfb8aa3b, v9
    v_mul_f32 v62, 0xbfb8aa3b, v10
    v_mul_f32 v63, 0xbfb8aa3b, v11
    v_mul_f32 v64, 0xbfb8aa3b, v12
    v_mul_f32 v65, 0xbfb8aa3b, v13
    v_mul_f32 v66, 0xbfb8aa3b, v14
    v_mul_f32 v67, 0xbfb8aa3b, v15
    v_mul_f32 v68, 0xbfb8aa3b, v16
    v_exp_f32 v60, v60
    v_exp_f32 v61, v61
    v_exp_f32 v62, v62
    v_exp_f32 v63, v63
    v_exp_f32 v64, v64
    v_exp_f32 v65, v65
    v_exp_f32 v66, v66
    v_exp_f32 v67, v67
    v_exp_f32 v68, v68
    v_add_f32 v60, 1.0, v60
    v_add_f32 v61, 1.0, v61
    v_add_f32 v62, 1.0, v62
    v_add_f32 v63, 1.0, v63
    v_add_f32 v64, 1.0, v64
    v_add_f32 v65, 1.0, v65
    v_add_f32 v66, 1.0, v66
    v_add_f32 v67, 1.0, v67
    v_add_f32 v68, 1.0, v68
    v_rcp_f32 v60, v60
    v_rcp_f32 v61, v61
    v_rcp_f32 v62, v62
    v_rcp_f32 v63, v63
    v_rcp_f32 v64, v64
    v_rcp_f32 v65, v65
    v_rcp_f32 v66, v66
    v_rcp_f32 v67, v67
    v_rcp_f32 v68, v68
    v_mul_f32 v8, v8, v60
    v_mul_f32 v9, v9, v61
    v_mul_f32 v10, v10, v62
    v_mul_f32 v11, v11, v63
    v_mul_f32 v12, v12, v64
    v_mul_f32 v13, v13, v65
    v_mul_f32 v14, v14, v66
    v_mul_f32 v15, v15, v67
    v_mul_f32 v16, v16, v68
    v_cvt_pk_bf16_f32 v8, v8, v8
    v_and_b32 v8, 0xffff0000, v8
    v_cvt_pk_bf16_f32 v9, v9, v9
    v_and_b32 v9, 0xffff0000, v9
    v_cvt_pk_bf16_f32 v10, v10, v10
    v_and_b32 v10, 0xffff0000, v10
    v_cvt_pk_bf16_f32 v11, v11, v11
    v_and_b32 v11, 0xffff0000, v11
    v_cvt_pk_bf16_f32 v12, v12, v12
    v_and_b32 v12, 0xffff0000, v12
    v_cvt_pk_bf16_f32 v13, v13, v13
    v_and_b32 v13, 0xffff0000, v13
    v_cvt_pk_bf16_f32 v14, v14, v14
    v_and_b32 v14, 0xffff0000, v14
    v_cvt_pk_bf16_f32 v15, v15, v15
    v_and_b32 v15, 0xffff0000, v15
    v_cvt_pk_bf16_f32 v16, v16, v16
    v_and_b32 v16, 0xffff0000, v16
    v_lshlrev_b32 v60, 16, v20
    v_and_b32 v61, 0xffff0000, v20
    v_mul_f32 v80, v60, v8
    v_mul_f32 v81, v61, v8
    v_lshlrev_b32 v60, 16, v21
    v_and_b32 v61, 0xffff0000, v21
    v_mul_f32 v82, v60, v8
    v_mul_f32 v83, v61, v8
    v_lshlrev_b32 v60, 16, v22
    v_and_b32 v61, 0xffff0000, v22
    v_mul_f32 v84, v60, v8
    v_mul_f32 v85, v61, v8
    v_lshlrev_b32 v60, 16, v23
    v_and_b32 v61, 0xffff0000, v23
    v_mul_f32 v86, v60, v8
    v_mul_f32 v87, v61, v8
    s_waitcnt vmcnt(8)
    v_lshlrev_b32 v60, 16, v24
    v_and_b32 v61, 0xffff0000, v24
    v_fmac_f32 v80, v60, v9
    v_fmac_f32 v81, v61, v9
    v_lshlrev_b32 v60, 16, v25
    v_and_b32 v61, 0xffff0000, v25
    v_fmac_f32 v82, v60, v9
    v_fmac_f32 v83, v61, v9
    v_lshlrev_b32 v60, 16, v26
    v_and_b32 v61, 0xffff0000, v26
    v_fmac_f32 v84, v60, v9
    v_fmac_f32 v85, v61, v9
    v_lshlrev_b32 v60, 16, v27
    v_and_b32 v61, 0xffff0000, v27
    v_fmac_f32 v86, v60, v9
    v_fmac_f32 v87, v61, v9
    s_waitcnt vmcnt(7)
    v_lshlrev_b32 v60, 16, v28
    v_and_b32 v61, 0xffff0000, v28
    v_fmac_f32 v80, v60, v10
    v_fmac_f32 v81, v61, v10
    v_lshlrev_b32 v60, 16, v29
    v_and_b32 v61, 0xffff0000, v29
    v_fmac_f32 v82, v60, v10
    v_fmac_f32 v83, v61, v10
    v_lshlrev_b32 v60, 16, v30
    v_and_b32 v61, 0xffff0000, v30
    v_fmac_f32 v84, v60, v10
    v_fmac_f32 v85, v61, v10
    v_lshlrev_b32 v60, 16, v31
    v_and_b32 v61, 0xffff0000, v31
    v_fmac_f32 v86, v60, v10
    v_fmac_f32 v87, v61, v10
    s_waitcnt vmcnt(6)
    v_lshlrev_b32 v60, 16, v32
    v_and_b32 v61, 0xffff0000, v32
    v_fmac_f32 v80, v60, v11
    v_fmac_f32 v81, v61, v11
    v_lshlrev_b32 v60, 16, v33
    v_and_b32 v61, 0xffff0000, v33
    v_fmac_f32 v82, v60, v11
    v_fmac_f32 v83, v61, v11
    v_lshlrev_b32 v60, 16, v34
    v_and_b32 v61, 0xffff0000, v34
    v_fmac_f32 v84, v60, v11
    v_fmac_f32 v85, v61, v11
    v_lshlrev_b32 v60, 16, v35
    v_and_b32 v61, 0xffff0000, v35
    v_fmac_f32 v86, v60, v11
    v_fmac_f32 v87, v61, v11
    s_waitcnt vmcnt(5)
    v_lshlrev_b32 v60, 16, v36
    v_and_b32 v61, 0xffff0000, v36
    v_fmac_f32 v80, v60, v12
    v_fmac_f32 v81, v61, v12
    v_lshlrev_b32 v60, 16, v37
    v_and_b32 v61, 0xffff0000, v37
    v_fmac_f32 v82, v60, v12
    v_fmac_f32 v83, v61, v12
    v_lshlrev_b32 v60, 16, v38
    v_and_b32 v61, 0xffff0000, v38
    v_fmac_f32 v84, v60, v12
    v_fmac_f32 v85, v61, v12
    v_lshlrev_b32 v60, 16, v39
    v_and_b32 v61, 0xffff0000, v39
    v_fmac_f32 v86, v60, v12
    v_fmac_f32 v87, v61, v12
    s_waitcnt vmcnt(4)
    v_lshlrev_b32 v60, 16, v40
    v_and_b32 v61, 0xffff0000, v40
    v_fmac_f32 v80, v60, v13
    v_fmac_f32 v81, v61, v13
    v_lshlrev_b32 v60, 16, v41
    v_and_b32 v61, 0xffff0000, v41
    v_fmac_f32 v82, v60, v13
    v_fmac_f32 v83, v61, v13
    v_lshlrev_b32 v60, 16, v42
    v_and_b32 v61, 0xffff0000, v42
    v_fmac_f32 v84, v60, v13
    v_fmac_f32 v85, v61, v13
    v_lshlrev_b32 v60, 16, v43
    v_and_b32 v61, 0xffff0000, v43
    v_fmac_f32 v86, v60, v13
    v_fmac_f32 v87, v61, v13
    s_waitcnt vmcnt(3)
    v_lshlrev_b32 v60, 16, v44
    v_and_b32 v61, 0xffff0000, v44
    v_fmac_f32 v80, v60, v14
    v_fmac_f32 v81, v61, v14
    v_lshlrev_b32 v60, 16, v45
    v_and_b32 v61, 0xffff0000, v45
    v_fmac_f32 v82, v60, v14
    v_fmac_f32 v83, v61, v14
    v_lshlrev_b32 v60, 16, v46
    v_and_b32 v61, 0xffff0000, v46
    v_fmac_f32 v84, v60, v14
    v_fmac_f32 v85, v61, v14
    v_lshlrev_b32 v60, 16, v47
    v_and_b32 v61, 0xffff0000, v47
    v_fmac_f32 v86, v60, v14
    v_fmac_f32 v87, v61, v14
    s_waitcnt vmcnt(2)
    v_lshlrev_b32 v60, 16, v48
    v_and_b32 v61, 0xffff0000, v48
    v_fmac_f32 v80, v60, v15
    v_fmac_f32 v81, v61, v15
    v_lshlrev_b32 v60, 16, v49
    v_and_b32 v61, 0xffff0000, v49
    v_fmac_f32 v82, v60, v15
    v_fmac_f32 v83, v61, v15
    v_lshlrev_b32 v60, 16, v50
    v_and_b32 v61, 0xffff0000, v50
    v_fmac_f32 v84, v60, v15
    v_fmac_f32 v85, v61, v15
    v_lshlrev_b32 v60, 16, v51
    v_and_b32 v61, 0xffff0000, v51
    v_fmac_f32 v86, v60, v15
    v_fmac_f32 v87, v61, v15
    s_waitcnt vmcnt(1)
    v_lshlrev_b32 v60, 16, v52
    v_and_b32 v61, 0xffff0000, v52
    v_fmac_f32 v80, v60, v16
    v_fmac_f32 v81, v61, v16
    v_lshlrev_b32 v60, 16, v53
    v_and_b32 v61, 0xffff0000, v53
    v_fmac_f32 v82, v60, v16
    v_fmac_f32 v83, v61, v16
    v_lshlrev_b32 v60, 16, v54
    v_and_b32 v61, 0xffff0000, v54
    v_fmac_f32 v84, v60, v16
    v_fmac_f32 v85, v61, v16
    v_lshlrev_b32 v60, 16, v55
    v_and_b32 v61, 0xffff0000, v55
    v_fmac_f32 v86, v60, v16
    v_fmac_f32 v87, v61, v16
    v_add_f32_dpp v80, v80, v80 row_ror:4 row_mask:0xf bank_mask:0xf
    v_add_f32_dpp v81, v81, v81 row_ror:4 row_mask:0xf bank_mask:0xf
    v_add_f32_dpp v82, v82, v82 row_ror:4 row_mask:0xf bank_mask:0xf
    v_add_f32_dpp v83, v83, v83 row_ror:4 row_mask:0xf bank_mask:0xf
    v_add_f32_dpp v84, v84, v84 row_ror:4 row_mask:0xf bank_mask:0xf
    v_add_f32_dpp v85, v85, v85 row_ror:4 row_mask:0xf bank_mask:0xf
    v_add_f32_dpp v86, v86, v86 row_ror:4 row_mask:0xf bank_mask:0xf
    v_add_f32_dpp v87, v87, v87 row_ror:4 row_mask:0xf bank_mask:0xf
    v_add_f32_dpp v80, v80, v80 row_ror:8 row_mask:0xf bank_mask:0xf
    v_add_f32_dpp v81, v81, v81 row_ror:8 row_mask:0xf bank_mask:0xf
    v_add_f32_dpp v82, v82, v82 row_ror:8 row_mask:0xf bank_mask:0xf
    v_add_f32_dpp v83, v83, v83 row_ror:8 row_mask:0xf bank_mask:0xf
    v_add_f32_dpp v84, v84, v84 row_ror:8 row_mask:0xf bank_mask:0xf
    v_add_f32_dpp v85, v85, v85 row_ror:8 row_mask:0xf bank_mask:0xf
    v_add_f32_dpp v86, v86, v86 row_ror:8 row_mask:0xf bank_mask:0xf
    v_add_f32_dpp v87, v87, v87 row_ror:8 row_mask:0xf bank_mask:0xf
    ds_write_b128 v5, v[80:83]
    ds_write_b128 v5, v[84:87] offset:16
    s_waitcnt vmcnt(0)
    s_mov_b32 s101, 200000
F_TAG385:
    v_readfirstlane_b32 s54, v126
    s_cmp_lg_u32 s54, 0
    s_cbranch_scc1 F_TAG385X
    global_load_dword v126, v127, s[36:37] sc1
    s_sub_u32 s101, s101, 1
    s_waitcnt vmcnt(0)
    s_cbranch_scc0 F_TAG385
F_TAG385X:
    s_waitcnt lgkmcnt(0)
    s_barrier
    s_cmp_lg_u32 s40, 0
    s_cbranch_scc1 F_MODX
    s_mov_b32 exec_hi, 0
    ds_read_b32 v20, v7 offset:0
    ds_read_b32 v21, v7 offset:128
    ds_read_b32 v22, v7 offset:256
    ds_read_b32 v23, v7 offset:384
    ds_read_b32 v24, v7 offset:512
    ds_read_b32 v25, v7 offset:640
    ds_read_b32 v26, v7 offset:768
    ds_read_b32 v27, v7 offset:896
    ds_read_b32 v28, v7 offset:1024
    ds_read_b32 v29, v7 offset:1152
    ds_read_b32 v30, v7 offset:1280
    ds_read_b32 v31, v7 offset:1408
    ds_read_b32 v32, v7 offset:1536
    ds_read_b32 v33, v7 offset:1664
    ds_read_b32 v34, v7 offset:1792
    ds_read_b32 v35, v7 offset:1920
    s_waitcnt lgkmcnt(0)
    v_add_f32 v20, v20, v28
    v_add_f32 v21, v21, v29
    v_add_f32 v22, v22, v30
    v_add_f32 v23, v23, v31
    v_add_f32 v24, v24, v32
    v_add_f32 v25, v25, v33
    v_add_f32 v26, v26, v34
    v_add_f32 v27, v27, v35
    v_add_f32 v20, v20, v24
    v_add_f32 v21, v21, v25
    v_add_f32 v22, v22, v26
    v_add_f32 v23, v23, v27
    v_add_f32 v20, v20, v22
    v_add_f32 v21, v21, v23
    v_add_f32 v20, v20, v21
    v_cvt_pk_bf16_f32 v20, v20, v20
    v_and_b32 v20, 0xffff0000, v20
    v_add_f32 v20, s31, v20
    v_cvt_pk_bf16_f32 v20, v20, v20
    v_and_b32 v20, 0xffff0000, v20
    s_cmp_ge_u32 s29, 2
    s_cbranch_scc1 F_G
    v_mov_b32_dpp v21, v20 quad_perm:[1,0,3,2] row_mask:0xf bank_mask:0xf
    v_lshrrev_b32 v20, 16, v20
    v_or_b32 v20, v20, v21
    v_mov_b32 v21, s54
    s_lshl_b32 s31, s52, 7
    s_mov_b32 exec_lo, 0x55555555
    buffer_store_dwordx2 v[20:21], v18, s[24:27], s31 offen sc1
    s_mov_b64 exec, -1
    s_branch F_MODX
F_G:
    s_lshl_b32 s31, s29, 3
    s_add_u32 s31, s31, 53232
    buffer_store_short_d16_hi v20, v19, s[24:27], s31 offen sc1
    s_mov_b64 exec, -1
F_MODX:
    s_barrier
    s_branch F_SETUP
F_NOMOD0:
    s_sub_u32 s43, s2, 112
    s_cmp_ge_u32 s43, 128
    s_cbranch_scc1 F_SETUP
    s_sub_u32 s30, s2, 112
    s_lshl_b32 s30, s30, 4
    v_lshrrev_b32 v1, 4, v223
    v_add_u32 v1, s30, v1
    v_and_b32 v2, 15, v223
    v_mul_u32_u24 v3, 1152, v1
    v_lshl_add_u32 v3, v2, 3, v3
    buffer_load_dwordx2 v[8:9], v3, s[44:47], 0 offen offset:0
    buffer_load_dwordx2 v[10:11], v3, s[44:47], 0 offen offset:128
    buffer_load_dwordx2 v[12:13], v3, s[44:47], 0 offen offset:256
    buffer_load_dwordx2 v[14:15], v3, s[44:47], 0 offen offset:384
    buffer_load_dwordx2 v[16:17], v3, s[44:47], 0 offen offset:512
    buffer_load_dwordx2 v[18:19], v3, s[44:47], 0 offen offset:640
    buffer_load_dwordx2 v[20:21], v3, s[44:47], 0 offen offset:768
    buffer_load_dwordx2 v[22:23], v3, s[44:47], 0 offen offset:896
    buffer_load_dwordx2 v[24:25], v3, s[44:47], 0 offen offset:1024
F_SETUP:
    s_lshl_b32 s28, s40, 12
    s_lshl_b32 s43, s41, 9
    s_add_u32 s16, s16, s43
    s_addc_u32 s17, s17, 0
    s_sub_u32 s43, 4718592, s43
    s_and_b32 s17, s17, 0xffff
    s_mov_b32 s18, s43
    s_mov_b32 s19, 0x00020000
    v_bfe_u32 v113, v223, 2, 3
    v_lshlrev_b32 v113, 13, v113
    v_and_b32 v112, 3, v223
    v_lshl_add_u32 v113, v112, 7, v113
    s_lshl_b32 s43, s42, 16
    buffer_load_dword a140, v113, s[16:19], s43 offen
    v_lshrrev_b32 v125, 2, v223
    v_min_u32 v125, 55, v125
    v_lshlrev_b32 v125, 13, v125
    v_lshl_add_u32 v125, v112, 7, v125
    v_bfe_u32 v218, v225, 8, 2
    v_bfe_u32 v219, v225, 4, 4
    v_lshlrev_b32 v220, 1, v218
    v_xor_b32 v219, v219, v220
    s_lshl_b32 s43, s40, 4
    v_add_u32 v218, s43, v218
    v_mul_u32_u24 v218, 8192, v218
    v_lshl_add_u32 v242, v219, 4, v218
    v_add_u32 v243, 31744, v242
    v_xor_b32 v219, 8, v219
    v_lshl_add_u32 v244, v219, 4, v218
    v_add_u32 v244, 63488, v244
    v_add_u32 v245, 31744, v244
    s_lshl_b32 s55, s42, 2
    s_add_u32 s55, s55, s40
    s_mul_i32 s38, s55, 36864
    s_add_u32 s38, s38, 65536
    s_lshl_b32 s43, s41, 19
    s_add_u32 s8, s8, s43
    s_addc_u32 s9, s9, 0
    s_and_b32 s9, s9, 0xffff
    s_mov_b32 s10, 0x80000
    s_mov_b32 s11, 0x00020000
    s_add_u32 s12, s12, s43
    s_addc_u32 s13, s13, 0
    s_and_b32 s13, s13, 0xffff
    s_mov_b32 s14, 0x80000
    s_mov_b32 s15, 0x00020000
    s_and_b32 s43, s41, 14
    s_mul_i32 s43, s43, 294912
    s_add_u32 s20, s20, s43
    s_addc_u32 s21, s21, 0
    s_and_b32 s21, s21, 0xffff
    s_mov_b32 s22, 0x90000
    s_mov_b32 s23, 0x00020000
    s_and_b32 s62, s2, 7
    s_lshr_b32 s63, s2, 3
    s_mul_i32 s35, s63, 165888
    s_mul_i32 s43, s62, 1152
    s_add_u32 s35, s35, s43
    s_mov_b32 s3, 9216
    s_cmp_eq_u32 s40, 1
    s_cselect_b32 s4, s6, s4
    s_cselect_b32 s5, s7, s5
    s_mul_i32 s62, s62, 663552
    s_mul_i32 s63, s63, 20736
    s_add_u32 s62, s62, s63
    s_cmp_eq_u32 s40, 2
    s_cselect_b32 s4, s60, s4
    s_cselect_b32 s5, s61, s5
    s_cselect_b32 s35, s62, s35
    s_and_b32 s43, s41, 1
    s_lshl_b32 s43, s43, 4
    s_add_u32 s43, s43, s42
    s_mul_i32 s43, s43, 18432
    s_mov_b32 s53, 5308416
    s_cmp_eq_u32 s40, 3
    s_cselect_b32 s4, s20, s4
    s_cselect_b32 s5, s21, s5
    s_cselect_b32 s53, 589824, s53
    s_cselect_b32 s35, s43, s35
    s_cmp_ge_u32 s40, 2
    s_cselect_b32 s3, 1152, s3
    s_mov_b32 s56, s4
    s_and_b32 s57, s5, 0xffff
    s_mov_b32 s58, s53
    s_mov_b32 s59, 0x00020000
    s_mul_i32 s39, s55, 294912
    s_lshr_b32 s43, s41, 1
    s_mul_i32 s43, s43, 9216
    s_add_u32 s39, s39, s43
    s_add_u32 s39, s39, 12582912
    v_lshrrev_b32 v113, 8, v225
    v_bfe_u32 v112, v225, 4, 4
    s_lshl_b32 s43, s40, 4
    v_add_u32 v114, s43, v113
    v_lshlrev_b32 v114, 8, v114
    v_add_u32 v115, 0, v113
    v_xor_b32 v124, v115, v112
    v_lshl_add_u32 v250, v124, 4, v114
    v_lshlrev_b32 v115, 1, v115
    v_xor_b32 v124, v115, v112
    v_lshl_add_u32 v254, v124, 4, v114
    v_add_u32 v115, 4, v113
    v_xor_b32 v124, v115, v112
    v_lshl_add_u32 v251, v124, 4, v114
    v_lshlrev_b32 v115, 1, v115
    v_xor_b32 v124, v115, v112
    v_lshl_add_u32 v255, v124, 4, v114
    v_add_u32 v115, 8, v113
    v_xor_b32 v124, v115, v112
    v_lshl_add_u32 v252, v124, 4, v114
    v_add_u32 v115, 12, v113
    v_xor_b32 v124, v115, v112
    v_lshl_add_u32 v253, v124, 4, v114
    v_lshlrev_b32 v114, 8, v112
    v_add_u32 v115, 0, v113
    v_xor_b32 v115, v115, v112
    v_lshl_add_u32 v246, v115, 4, v114
    v_add_u32 v115, 4, v113
    v_xor_b32 v115, v115, v112
    v_lshl_add_u32 v247, v115, 4, v114
    v_add_u32 v115, 8, v113
    v_xor_b32 v115, v115, v112
    v_lshl_add_u32 v248, v115, 4, v114
    v_add_u32 v115, 12, v113
    v_xor_b32 v115, v115, v112
    v_lshl_add_u32 v249, v115, 4, v114
    v_lshrrev_b32 v218, 6, v225
    v_lshlrev_b32 v219, 8, v218
    v_and_b32 v218, 7, v218
    v_bfe_u32 v220, v225, 4, 1
    v_lshl_add_u32 v219, v220, 4, v219
    v_bfe_u32 v220, v225, 5, 1
    v_lshl_add_u32 v219, v220, 3, v219
    v_add_u32 v219, 0x10000, v219
    v_lshrrev_b32 v220, 8, v225
    v_lshl_add_u32 v219, v220, 10, v219
    v_xor_b32 v220, 0, v218
    v_lshl_add_u32 v234, v220, 5, v219
    v_and_b32 v226, 0xffff, v234
    v_xor_b32 v220, 1, v218
    v_lshl_add_u32 v235, v220, 5, v219
    v_and_b32 v227, 0xffff, v235
    v_xor_b32 v220, 2, v218
    v_lshl_add_u32 v236, v220, 5, v219
    v_and_b32 v228, 0xffff, v236
    v_xor_b32 v220, 3, v218
    v_lshl_add_u32 v237, v220, 5, v219
    v_and_b32 v229, 0xffff, v237
    v_xor_b32 v220, 4, v218
    v_lshl_add_u32 v238, v220, 5, v219
    v_and_b32 v230, 0xffff, v238
    v_xor_b32 v220, 5, v218
    v_lshl_add_u32 v239, v220, 5, v219
    v_and_b32 v231, 0xffff, v239
    v_xor_b32 v220, 6, v218
    v_lshl_add_u32 v240, v220, 5, v219
    v_and_b32 v232, 0xffff, v240
    v_xor_b32 v220, 7, v218
    v_lshl_add_u32 v241, v220, 5, v219
    v_and_b32 v233, 0xffff, v241
    v_lshlrev_b32 v224, 6, v113
    v_add_u32 v224, 131072, v224
    s_and_b32 s62, s2, 7
    s_mul_i32 s62, s62, 18
    s_lshr_b32 s63, s2, 3
    s_add_u32 s100, s62, s63
    s_mul_i32 s60, s100, 18432
    s_mul_i32 s63, s40, 4608
    s_add_u32 s60, s60, s63
    s_add_u32 s60, s60, 7143424
    s_cmp_lt_u32 s2, 144
    s_cselect_b32 s60, s60, 50855936
    s_lshl_b32 s62, s42, 4
    s_add_u32 s62, s62, s41
    s_lshl_b32 s62, s62, 2
    s_add_u32 s62, s62, s40
    s_mul_i32 s62, s62, 2304
    s_add_u32 s62, s62, 4784128
    v_accvgpr_write_b32 a0, 0
    v_accvgpr_write_b32 a1, 0
    v_accvgpr_write_b32 a2, 0
    v_accvgpr_write_b32 a3, 0
    v_accvgpr_write_b32 a4, 0
    v_accvgpr_write_b32 a5, 0
    v_accvgpr_write_b32 a6, 0
    v_accvgpr_write_b32 a7, 0
    v_accvgpr_write_b32 a8, 0
    v_accvgpr_write_b32 a9, 0
    v_accvgpr_write_b32 a10, 0
    v_accvgpr_write_b32 a11, 0
    v_accvgpr_write_b32 a12, 0
    v_accvgpr_write_b32 a13, 0
    v_accvgpr_write_b32 a14, 0
    v_accvgpr_write_b32 a15, 0
    v_accvgpr_write_b32 a16, 0
    v_accvgpr_write_b32 a17, 0
    v_accvgpr_write_b32 a18, 0
    v_accvgpr_write_b32 a19, 0
    v_accvgpr_write_b32 a20, 0
    v_accvgpr_write_b32 a21, 0
    v_accvgpr_write_b32 a22, 0
    v_accvgpr_write_b32 a23, 0
    v_accvgpr_write_b32 a24, 0
    v_accvgpr_write_b32 a25, 0
    v_accvgpr_write_b32 a26, 0
    v_accvgpr_write_b32 a27, 0
    v_accvgpr_write_b32 a28, 0
    v_accvgpr_write_b32 a29, 0
    v_accvgpr_write_b32 a30, 0
    v_accvgpr_write_b32 a31, 0
    v_accvgpr_write_b32 a32, 0
    v_accvgpr_write_b32 a33, 0
    v_accvgpr_write_b32 a34, 0
    v_accvgpr_write_b32 a35, 0
    v_accvgpr_write_b32 a36, 0
    v_accvgpr_write_b32 a37, 0
    v_accvgpr_write_b32 a38, 0
    v_accvgpr_write_b32 a39, 0
    v_accvgpr_write_b32 a40, 0
    v_accvgpr_write_b32 a41, 0
    v_accvgpr_write_b32 a42, 0
    v_accvgpr_write_b32 a43, 0
    v_accvgpr_write_b32 a44, 0
    v_accvgpr_write_b32 a45, 0
    v_accvgpr_write_b32 a46, 0
    v_accvgpr_write_b32 a47, 0
    v_accvgpr_write_b32 a48, 0
    v_accvgpr_write_b32 a49, 0
    v_accvgpr_write_b32 a50, 0
    v_accvgpr_write_b32 a51, 0
    v_accvgpr_write_b32 a52, 0
    v_accvgpr_write_b32 a53, 0
    v_accvgpr_write_b32 a54, 0
    v_accvgpr_write_b32 a55, 0
    v_accvgpr_write_b32 a56, 0
    v_accvgpr_write_b32 a57, 0
    v_accvgpr_write_b32 a58, 0
    v_accvgpr_write_b32 a59, 0
    v_accvgpr_write_b32 a60, 0
    v_accvgpr_write_b32 a61, 0
    v_accvgpr_write_b32 a62, 0
    v_accvgpr_write_b32 a63, 0
    v_accvgpr_write_b32 a64, 0
    v_accvgpr_write_b32 a65, 0
    v_accvgpr_write_b32 a66, 0
    v_accvgpr_write_b32 a67, 0
    v_accvgpr_write_b32 a68, 0
    v_accvgpr_write_b32 a69, 0
    v_accvgpr_write_b32 a70, 0
    v_accvgpr_write_b32 a71, 0
    v_accvgpr_write_b32 a72, 0
    v_accvgpr_write_b32 a73, 0
    v_accvgpr_write_b32 a74, 0
    v_accvgpr_write_b32 a75, 0
    v_accvgpr_write_b32 a76, 0
    v_accvgpr_write_b32 a77, 0
    v_accvgpr_write_b32 a78, 0
    v_accvgpr_write_b32 a79, 0
    v_accvgpr_write_b32 a80, 0
    v_accvgpr_write_b32 a81, 0
    v_accvgpr_write_b32 a82, 0
    v_accvgpr_write_b32 a83, 0
    v_accvgpr_write_b32 a84, 0
    v_accvgpr_write_b32 a85, 0
    v_accvgpr_write_b32 a86, 0
    v_accvgpr_write_b32 a87, 0
    v_accvgpr_write_b32 a88, 0
    v_accvgpr_write_b32 a89, 0
    v_accvgpr_write_b32 a90, 0
    v_accvgpr_write_b32 a91, 0
    v_accvgpr_write_b32 a92, 0
    v_accvgpr_write_b32 a93, 0
    v_accvgpr_write_b32 a94, 0
    v_accvgpr_write_b32 a95, 0
    v_accvgpr_write_b32 a96, 0
    v_accvgpr_write_b32 a97, 0
    v_accvgpr_write_b32 a98, 0
    v_accvgpr_write_b32 a99, 0
    v_accvgpr_write_b32 a100, 0
    v_accvgpr_write_b32 a101, 0
    v_accvgpr_write_b32 a102, 0
    v_accvgpr_write_b32 a103, 0
    v_accvgpr_write_b32 a104, 0
    v_accvgpr_write_b32 a105, 0
    v_accvgpr_write_b32 a106, 0
    v_accvgpr_write_b32 a107, 0
    v_accvgpr_write_b32 a108, 0
    v_accvgpr_write_b32 a109, 0
    v_accvgpr_write_b32 a110, 0
    v_accvgpr_write_b32 a111, 0
    v_accvgpr_write_b32 a112, 0
    v_accvgpr_write_b32 a113, 0
    v_accvgpr_write_b32 a114, 0
    v_accvgpr_write_b32 a115, 0
    v_accvgpr_write_b32 a116, 0
    v_accvgpr_write_b32 a117, 0
    v_accvgpr_write_b32 a118, 0
    v_accvgpr_write_b32 a119, 0
    v_accvgpr_write_b32 a120, 0
    v_accvgpr_write_b32 a121, 0
    v_accvgpr_write_b32 a122, 0
    v_accvgpr_write_b32 a123, 0
    v_accvgpr_write_b32 a124, 0
    v_accvgpr_write_b32 a125, 0
    v_accvgpr_write_b32 a126, 0
    v_accvgpr_write_b32 a127, 0
    v_and_b32 v112, 16, v225
    v_lshlrev_b32 v112, 3, v112
    v_lshlrev_b32 v116, 4, v223
    v_and_b32 v117, 31, v223
    v_lshlrev_b32 v118, 5, v117
    v_add_u32 v118, 134656, v118
    v_lshlrev_b32 v117, 4, v117
    v_lshlrev_b32 v119, 5, v223
    v_add_u32 v120, 131088, v119
    v_cmp_gt_u32 vcc, 144, v223
    v_add_u32 v119, 126464, v119
    v_mov_b32 v127, 0
    global_load_dword v126, v127, s[36:37] sc1
    v_cndmask_b32 v119, v119, v120, vcc
    v_add_u32 v119, 131072, v116
    v_add_u32 v118, 135168, v117
    s_cmp_ge_u32 s52, 108
    s_cbranch_scc1 F_NOMOD1
    s_branch F_COMMON
F_NOMOD1:
    s_sub_u32 s43, s2, 112
    s_cmp_ge_u32 s43, 128
    s_cbranch_scc1 F_NOLN1
    v_lshrrev_b32 v4, 5, v1
    v_mul_u32_u24 v4, 36864, v4
    v_lshrrev_b32 v5, 3, v2
    v_lshl_add_u32 v4, v5, 11, v4
    v_bfe_u32 v5, v1, 4, 1
    v_lshl_add_u32 v4, v5, 10, v4
    v_bfe_u32 v5, v2, 1, 2
    v_lshl_add_u32 v4, v5, 8, v4
    v_and_b32 v5, 15, v1
    v_lshl_add_u32 v4, v5, 4, v4
    v_and_b32 v5, 1, v2
    v_lshl_add_u32 v4, v5, 3, v4
    s_waitcnt vmcnt(10)
    v_lshlrev_b32 v32, 16, v8
    v_and_b32 v33, 0xffff0000, v8
    v_lshlrev_b32 v34, 16, v9
    v_and_b32 v35, 0xffff0000, v9
    v_mul_f32 v71, v32, v32
    v_add_f32 v70, v32, v33
    v_fmac_f32 v71, v33, v33
    v_add_f32 v70, v70, v34
    v_fmac_f32 v71, v34, v34
    v_add_f32 v70, v70, v35
    v_fmac_f32 v71, v35, v35
    s_waitcnt vmcnt(9)
    v_lshlrev_b32 v36, 16, v10
    v_and_b32 v37, 0xffff0000, v10
    v_lshlrev_b32 v38, 16, v11
    v_and_b32 v39, 0xffff0000, v11
    v_add_f32 v70, v70, v36
    v_fmac_f32 v71, v36, v36
    v_add_f32 v70, v70, v37
    v_fmac_f32 v71, v37, v37
    v_add_f32 v70, v70, v38
    v_fmac_f32 v71, v38, v38
    v_add_f32 v70, v70, v39
    v_fmac_f32 v71, v39, v39
    s_waitcnt vmcnt(8)
    v_lshlrev_b32 v40, 16, v12
    v_and_b32 v41, 0xffff0000, v12
    v_lshlrev_b32 v42, 16, v13
    v_and_b32 v43, 0xffff0000, v13
    v_add_f32 v70, v70, v40
    v_fmac_f32 v71, v40, v40
    v_add_f32 v70, v70, v41
    v_fmac_f32 v71, v41, v41
    v_add_f32 v70, v70, v42
    v_fmac_f32 v71, v42, v42
    v_add_f32 v70, v70, v43
    v_fmac_f32 v71, v43, v43
    s_waitcnt vmcnt(7)
    v_lshlrev_b32 v44, 16, v14
    v_and_b32 v45, 0xffff0000, v14
    v_lshlrev_b32 v46, 16, v15
    v_and_b32 v47, 0xffff0000, v15
    v_add_f32 v70, v70, v44
    v_fmac_f32 v71, v44, v44
    v_add_f32 v70, v70, v45
    v_fmac_f32 v71, v45, v45
    v_add_f32 v70, v70, v46
    v_fmac_f32 v71, v46, v46
    v_add_f32 v70, v70, v47
    v_fmac_f32 v71, v47, v47
    s_waitcnt vmcnt(6)
    v_lshlrev_b32 v48, 16, v16
    v_and_b32 v49, 0xffff0000, v16
    v_lshlrev_b32 v50, 16, v17
    v_and_b32 v51, 0xffff0000, v17
    v_add_f32 v70, v70, v48
    v_fmac_f32 v71, v48, v48
    v_add_f32 v70, v70, v49
    v_fmac_f32 v71, v49, v49
    v_add_f32 v70, v70, v50
    v_fmac_f32 v71, v50, v50
    v_add_f32 v70, v70, v51
    v_fmac_f32 v71, v51, v51
    s_waitcnt vmcnt(5)
    v_lshlrev_b32 v52, 16, v18
    v_and_b32 v53, 0xffff0000, v18
    v_lshlrev_b32 v54, 16, v19
    v_and_b32 v55, 0xffff0000, v19
    v_add_f32 v70, v70, v52
    v_fmac_f32 v71, v52, v52
    v_add_f32 v70, v70, v53
    v_fmac_f32 v71, v53, v53
    v_add_f32 v70, v70, v54
    v_fmac_f32 v71, v54, v54
    v_add_f32 v70, v70, v55
    v_fmac_f32 v71, v55, v55
    s_waitcnt vmcnt(4)
    v_lshlrev_b32 v56, 16, v20
    v_and_b32 v57, 0xffff0000, v20
    v_lshlrev_b32 v58, 16, v21
    v_and_b32 v59, 0xffff0000, v21
    v_add_f32 v70, v70, v56
    v_fmac_f32 v71, v56, v56
    v_add_f32 v70, v70, v57
    v_fmac_f32 v71, v57, v57
    v_add_f32 v70, v70, v58
    v_fmac_f32 v71, v58, v58
    v_add_f32 v70, v70, v59
    v_fmac_f32 v71, v59, v59
    s_waitcnt vmcnt(3)
    v_lshlrev_b32 v60, 16, v22
    v_and_b32 v61, 0xffff0000, v22
    v_lshlrev_b32 v62, 16, v23
    v_and_b32 v63, 0xffff0000, v23
    v_add_f32 v70, v70, v60
    v_fmac_f32 v71, v60, v60
    v_add_f32 v70, v70, v61
    v_fmac_f32 v71, v61, v61
    v_add_f32 v70, v70, v62
    v_fmac_f32 v71, v62, v62
    v_add_f32 v70, v70, v63
    v_fmac_f32 v71, v63, v63
    s_waitcnt vmcnt(2)
    v_lshlrev_b32 v64, 16, v24
    v_and_b32 v65, 0xffff0000, v24
    v_lshlrev_b32 v66, 16, v25
    v_and_b32 v67, 0xffff0000, v25
    v_add_f32 v70, v70, v64
    v_fmac_f32 v71, v64, v64
    v_add_f32 v70, v70, v65
    v_fmac_f32 v71, v65, v65
    v_add_f32 v70, v70, v66
    v_fmac_f32 v71, v66, v66
    v_add_f32 v70, v70, v67
    v_fmac_f32 v71, v67, v67
    s_nop 0
    v_add_f32_dpp v70, v70, v70 row_ror:8 row_mask:0xf bank_mask:0xf
    v_add_f32_dpp v71, v71, v71 row_ror:8 row_mask:0xf bank_mask:0xf
    s_nop 0
    v_add_f32_dpp v70, v70, v70 row_ror:4 row_mask:0xf bank_mask:0xf
    v_add_f32_dpp v71, v71, v71 row_ror:4 row_mask:0xf bank_mask:0xf
    s_nop 0
    v_add_f32_dpp v70, v70, v70 row_ror:2 row_mask:0xf bank_mask:0xf
    v_add_f32_dpp v71, v71, v71 row_ror:2 row_mask:0xf bank_mask:0xf
    s_nop 0
    v_add_f32_dpp v70, v70, v70 row_ror:1 row_mask:0xf bank_mask:0xf
    v_add_f32_dpp v71, v71, v71 row_ror:1 row_mask:0xf bank_mask:0xf
    v_mul_f32 v70, 0x3ae38e39, v70
    v_mul_f32 v71, 0x3ae38e39, v71
    v_fma_f32 v71, -v70, v70, v71
    v_max_f32 v71, 0, v71
    v_cvt_pk_bf16_f32 v72, v70, v71
    v_lshlrev_b32 v70, 16, v72
    v_and_b32 v71, 0xffff0000, v72
    v_add_f32 v71, 0x3727c5ac, v71
    v_cvt_pk_bf16_f32 v71, v71, v71
    v_and_b32 v71, 0xffff0000, v71
    v_sqrt_f32 v71, v71
    s_nop 0
    v_cvt_pk_bf16_f32 v71, v71, v71
    v_and_b32 v71, 0xffff0000, v71
    v_rcp_f32 v71, v71
    v_sub_f32 v32, v32, v70
    v_sub_f32 v33, v33, v70
    v_sub_f32 v34, v34, v70
    v_sub_f32 v35, v35, v70
    v_cvt_pk_bf16_f32 v72, v32, v33
    v_lshlrev_b32 v32, 16, v72
    v_and_b32 v33, 0xffff0000, v72
    v_cvt_pk_bf16_f32 v73, v34, v35
    v_lshlrev_b32 v34, 16, v73
    v_and_b32 v35, 0xffff0000, v73
    v_mul_f32 v32, v32, v71
    v_mul_f32 v33, v33, v71
    v_mul_f32 v34, v34, v71
    v_mul_f32 v35, v35, v71
    v_cvt_pk_bf16_f32 v72, v32, v33
    v_lshlrev_b32 v32, 16, v72
    v_and_b32 v33, 0xffff0000, v72
    v_cvt_pk_bf16_f32 v73, v34, v35
    v_lshlrev_b32 v34, 16, v73
    v_and_b32 v35, 0xffff0000, v73
    v_sub_f32 v36, v36, v70
    v_sub_f32 v37, v37, v70
    v_sub_f32 v38, v38, v70
    v_sub_f32 v39, v39, v70
    v_cvt_pk_bf16_f32 v72, v36, v37
    v_lshlrev_b32 v36, 16, v72
    v_and_b32 v37, 0xffff0000, v72
    v_cvt_pk_bf16_f32 v73, v38, v39
    v_lshlrev_b32 v38, 16, v73
    v_and_b32 v39, 0xffff0000, v73
    v_mul_f32 v36, v36, v71
    v_mul_f32 v37, v37, v71
    v_mul_f32 v38, v38, v71
    v_mul_f32 v39, v39, v71
    v_cvt_pk_bf16_f32 v72, v36, v37
    v_lshlrev_b32 v36, 16, v72
    v_and_b32 v37, 0xffff0000, v72
    v_cvt_pk_bf16_f32 v73, v38, v39
    v_lshlrev_b32 v38, 16, v73
    v_and_b32 v39, 0xffff0000, v73
    v_sub_f32 v40, v40, v70
    v_sub_f32 v41, v41, v70
    v_sub_f32 v42, v42, v70
    v_sub_f32 v43, v43, v70
    v_cvt_pk_bf16_f32 v72, v40, v41
    v_lshlrev_b32 v40, 16, v72
    v_and_b32 v41, 0xffff0000, v72
    v_cvt_pk_bf16_f32 v73, v42, v43
    v_lshlrev_b32 v42, 16, v73
    v_and_b32 v43, 0xffff0000, v73
    v_mul_f32 v40, v40, v71
    v_mul_f32 v41, v41, v71
    v_mul_f32 v42, v42, v71
    v_mul_f32 v43, v43, v71
    v_cvt_pk_bf16_f32 v72, v40, v41
    v_lshlrev_b32 v40, 16, v72
    v_and_b32 v41, 0xffff0000, v72
    v_cvt_pk_bf16_f32 v73, v42, v43
    v_lshlrev_b32 v42, 16, v73
    v_and_b32 v43, 0xffff0000, v73
    v_sub_f32 v44, v44, v70
    v_sub_f32 v45, v45, v70
    v_sub_f32 v46, v46, v70
    v_sub_f32 v47, v47, v70
    v_cvt_pk_bf16_f32 v72, v44, v45
    v_lshlrev_b32 v44, 16, v72
    v_and_b32 v45, 0xffff0000, v72
    v_cvt_pk_bf16_f32 v73, v46, v47
    v_lshlrev_b32 v46, 16, v73
    v_and_b32 v47, 0xffff0000, v73
    v_mul_f32 v44, v44, v71
    v_mul_f32 v45, v45, v71
    v_mul_f32 v46, v46, v71
    v_mul_f32 v47, v47, v71
    v_cvt_pk_bf16_f32 v72, v44, v45
    v_lshlrev_b32 v44, 16, v72
    v_and_b32 v45, 0xffff0000, v72
    v_cvt_pk_bf16_f32 v73, v46, v47
    v_lshlrev_b32 v46, 16, v73
    v_and_b32 v47, 0xffff0000, v73
    v_sub_f32 v48, v48, v70
    v_sub_f32 v49, v49, v70
    v_sub_f32 v50, v50, v70
    v_sub_f32 v51, v51, v70
    v_cvt_pk_bf16_f32 v72, v48, v49
    v_lshlrev_b32 v48, 16, v72
    v_and_b32 v49, 0xffff0000, v72
    v_cvt_pk_bf16_f32 v73, v50, v51
    v_lshlrev_b32 v50, 16, v73
    v_and_b32 v51, 0xffff0000, v73
    v_mul_f32 v48, v48, v71
    v_mul_f32 v49, v49, v71
    v_mul_f32 v50, v50, v71
    v_mul_f32 v51, v51, v71
    v_cvt_pk_bf16_f32 v72, v48, v49
    v_lshlrev_b32 v48, 16, v72
    v_and_b32 v49, 0xffff0000, v72
    v_cvt_pk_bf16_f32 v73, v50, v51
    v_lshlrev_b32 v50, 16, v73
    v_and_b32 v51, 0xffff0000, v73
    v_sub_f32 v52, v52, v70
    v_sub_f32 v53, v53, v70
    v_sub_f32 v54, v54, v70
    v_sub_f32 v55, v55, v70
    v_cvt_pk_bf16_f32 v72, v52, v53
    v_lshlrev_b32 v52, 16, v72
    v_and_b32 v53, 0xffff0000, v72
    v_cvt_pk_bf16_f32 v73, v54, v55
    v_lshlrev_b32 v54, 16, v73
    v_and_b32 v55, 0xffff0000, v73
    v_mul_f32 v52, v52, v71
    v_mul_f32 v53, v53, v71
    v_mul_f32 v54, v54, v71
    v_mul_f32 v55, v55, v71
    v_cvt_pk_bf16_f32 v72, v52, v53
    v_lshlrev_b32 v52, 16, v72
    v_and_b32 v53, 0xffff0000, v72
    v_cvt_pk_bf16_f32 v73, v54, v55
    v_lshlrev_b32 v54, 16, v73
    v_and_b32 v55, 0xffff0000, v73
    v_sub_f32 v56, v56, v70
    v_sub_f32 v57, v57, v70
    v_sub_f32 v58, v58, v70
    v_sub_f32 v59, v59, v70
    v_cvt_pk_bf16_f32 v72, v56, v57
    v_lshlrev_b32 v56, 16, v72
    v_and_b32 v57, 0xffff0000, v72
    v_cvt_pk_bf16_f32 v73, v58, v59
    v_lshlrev_b32 v58, 16, v73
    v_and_b32 v59, 0xffff0000, v73
    v_mul_f32 v56, v56, v71
    v_mul_f32 v57, v57, v71
    v_mul_f32 v58, v58, v71
    v_mul_f32 v59, v59, v71
    v_cvt_pk_bf16_f32 v72, v56, v57
    v_lshlrev_b32 v56, 16, v72
    v_and_b32 v57, 0xffff0000, v72
    v_cvt_pk_bf16_f32 v73, v58, v59
    v_lshlrev_b32 v58, 16, v73
    v_and_b32 v59, 0xffff0000, v73
    v_sub_f32 v60, v60, v70
    v_sub_f32 v61, v61, v70
    v_sub_f32 v62, v62, v70
    v_sub_f32 v63, v63, v70
    v_cvt_pk_bf16_f32 v72, v60, v61
    v_lshlrev_b32 v60, 16, v72
    v_and_b32 v61, 0xffff0000, v72
    v_cvt_pk_bf16_f32 v73, v62, v63
    v_lshlrev_b32 v62, 16, v73
    v_and_b32 v63, 0xffff0000, v73
    v_mul_f32 v60, v60, v71
    v_mul_f32 v61, v61, v71
    v_mul_f32 v62, v62, v71
    v_mul_f32 v63, v63, v71
    v_cvt_pk_bf16_f32 v72, v60, v61
    v_lshlrev_b32 v60, 16, v72
    v_and_b32 v61, 0xffff0000, v72
    v_cvt_pk_bf16_f32 v73, v62, v63
    v_lshlrev_b32 v62, 16, v73
    v_and_b32 v63, 0xffff0000, v73
    v_sub_f32 v64, v64, v70
    v_sub_f32 v65, v65, v70
    v_sub_f32 v66, v66, v70
    v_sub_f32 v67, v67, v70
    v_cvt_pk_bf16_f32 v72, v64, v65
    v_lshlrev_b32 v64, 16, v72
    v_and_b32 v65, 0xffff0000, v72
    v_cvt_pk_bf16_f32 v73, v66, v67
    v_lshlrev_b32 v66, 16, v73
    v_and_b32 v67, 0xffff0000, v73
    v_mul_f32 v64, v64, v71
    v_mul_f32 v65, v65, v71
    v_mul_f32 v66, v66, v71
    v_mul_f32 v67, v67, v71
    v_cvt_pk_bf16_f32 v72, v64, v65
    v_lshlrev_b32 v64, 16, v72
    v_and_b32 v65, 0xffff0000, v72
    v_cvt_pk_bf16_f32 v73, v66, v67
    v_lshlrev_b32 v66, 16, v73
    v_and_b32 v67, 0xffff0000, v73
    v_lshlrev_b32 v5, 4, v2
    v_add_u32 v5, 131072, v5
    v_and_b32 v6, 0xff, v4
    v_lshrrev_b32 v7, 1, v2
    v_mul_u32_u24 v7, 272, v7
    v_add_u32 v6, v6, v7
    v_add_u32 v6, 139264, v6
    s_mul_i32 s30, s40, 1088
    s_add_u32 s30, s30, 139264
    v_lshrrev_b32 v7, 8, v225
    v_lshl_add_u32 v7, v7, 4, v225
    v_add_u32 v7, s30, v7
    s_waitcnt vmcnt(0)
    s_mov_b32 s101, 200000
F_TAG1154:
    v_readfirstlane_b32 s54, v126
    s_cmp_lg_u32 s54, 0
    s_cbranch_scc1 F_TAG1154X
    global_load_dword v126, v127, s[36:37] sc1
    s_sub_u32 s101, s101, 1
    s_waitcnt vmcnt(0)
    s_cbranch_scc0 F_TAG1154
F_TAG1154X:
    s_branch F_COMMON
F_NOLN1:
    s_cmp_lt_u32 s2, 253
    s_cbranch_scc1 F_NOINIT
    s_sub_u32 s30, s2, 253
    s_lshl_b32 s30, s30, 12
    s_add_u32 s30, s30, 40960
    v_mov_b32 v120, -1
    v_mov_b32 v121, -1
    v_mov_b32 v122, -1
    v_mov_b32 v123, -1
    v_lshlrev_b32 v113, 4, v223
    buffer_store_dwordx4 v[120:123], v113, s[24:27], s30 offen sc1
F_NOINIT:
    s_waitcnt vmcnt(0)
    s_mov_b32 s101, 200000
F_TAG1179:
    v_readfirstlane_b32 s54, v126
    s_cmp_lg_u32 s54, 0
    s_cbranch_scc1 F_TAG1179X
    global_load_dword v126, v127, s[36:37] sc1
    s_sub_u32 s101, s101, 1
    s_waitcnt vmcnt(0)
    s_cbranch_scc0 F_TAG1179
F_TAG1179X:
F_COMMON:
    s_sub_u32 s43, s2, 112
    s_cmp_lt_u32 s43, 128
    s_cbranch_scc1 F_LN2
    s_min_u32 s43, s42, 7
    s_mul_i32 s43, s43, 458752
    s_add_u32 s43, s43, 1048576
    buffer_load_dword a140, v125, s[16:19], s43 offen
    s_branch F_ALL2
F_LN2:
    s_mov_b32 s31, 4096
    s_mov_b32 s101, 200000
F_POLL7:
    buffer_load_dwordx4 v[100:103], v116, s[24:27], 0 offen sc1
    buffer_load_dwordx4 v[104:107], v117, s[24:27], s31 offen sc1
    s_waitcnt vmcnt(0)
    v_cmp_ne_u32 vcc, s54, v101
    v_cmp_ne_u32 s[48:49], s54, v103
    s_or_b64 vcc, vcc, s[48:49]
    v_cmp_ne_u32 s[48:49], s54, v105
    s_or_b64 vcc, vcc, s[48:49]
    v_cmp_ne_u32 s[48:49], s54, v107
    s_or_b64 vcc, vcc, s[48:49]
    s_sub_u32 s101, s101, 1
    s_cselect_b64 vcc, 0, vcc
    s_cbranch_vccnz F_POLL7
    v_and_b32 v101, 0xffff0000, v100
    v_lshlrev_b32 v100, 16, v100
    v_and_b32 v103, 0xffff0000, v102
    v_lshlrev_b32 v102, 16, v102
    v_and_b32 v105, 0xffff0000, v104
    v_lshlrev_b32 v104, 16, v104
    v_and_b32 v107, 0xffff0000, v106
    v_lshlrev_b32 v106, 16, v106
    ds_write_b128 v119, v[100:103]
    ds_write_b128 v118, v[104:107]
    s_waitcnt lgkmcnt(0)
    s_barrier
F_LNC:
    ds_read_b128 v[128:131], v5 offset:2304
    ds_read_b128 v[132:135], v5 offset:0
    ds_read_b128 v[136:139], v5 offset:2560
    ds_read_b128 v[140:143], v5 offset:256
    ds_read_b128 v[144:147], v5 offset:2816
    ds_read_b128 v[148:151], v5 offset:512
    ds_read_b128 v[152:155], v5 offset:3072
    ds_read_b128 v[156:159], v5 offset:768
    ds_read_b128 v[160:163], v5 offset:3328
    ds_read_b128 v[164:167], v5 offset:1024
    ds_read_b128 v[168:171], v5 offset:3584
    ds_read_b128 v[172:175], v5 offset:1280
    ds_read_b128 v[176:179], v5 offset:3840
    ds_read_b128 v[180:183], v5 offset:1536
    ds_read_b128 v[184:187], v5 offset:4096
    ds_read_b128 v[188:191], v5 offset:1792
    ds_read_b128 v[192:195], v5 offset:4352
    ds_read_b128 v[196:199], v5 offset:2048
    s_waitcnt lgkmcnt(12)
    v_mul_f32 v128, v32, v128
    v_mul_f32 v129, v33, v129
    v_mul_f32 v130, v34, v130
    v_mul_f32 v131, v35, v131
    v_mul_f32 v136, v36, v136
    v_mul_f32 v137, v37, v137
    v_mul_f32 v138, v38, v138
    v_mul_f32 v139, v39, v139
    v_mul_f32 v144, v40, v144
    v_mul_f32 v145, v41, v145
    v_mul_f32 v146, v42, v146
    v_mul_f32 v147, v43, v147
    v_cvt_pk_bf16_f32 v8, v128, v129
    v_cvt_pk_bf16_f32 v9, v130, v131
    v_cvt_pk_bf16_f32 v10, v136, v137
    v_cvt_pk_bf16_f32 v11, v138, v139
    v_cvt_pk_bf16_f32 v12, v144, v145
    v_cvt_pk_bf16_f32 v13, v146, v147
    v_lshlrev_b32 v128, 16, v8
    v_and_b32 v129, 0xffff0000, v8
    v_lshlrev_b32 v130, 16, v9
    v_and_b32 v131, 0xffff0000, v9
    v_lshlrev_b32 v136, 16, v10
    v_and_b32 v137, 0xffff0000, v10
    v_lshlrev_b32 v138, 16, v11
    v_and_b32 v139, 0xffff0000, v11
    v_lshlrev_b32 v144, 16, v12
    v_and_b32 v145, 0xffff0000, v12
    v_lshlrev_b32 v146, 16, v13
    v_and_b32 v147, 0xffff0000, v13
    v_add_f32 v128, v128, v132
    v_add_f32 v129, v129, v133
    v_add_f32 v130, v130, v134
    v_add_f32 v131, v131, v135
    v_add_f32 v136, v136, v140
    v_add_f32 v137, v137, v141
    v_add_f32 v138, v138, v142
    v_add_f32 v139, v139, v143
    v_add_f32 v144, v144, v148
    v_add_f32 v145, v145, v149
    v_add_f32 v146, v146, v150
    v_add_f32 v147, v147, v151
    v_cvt_pk_bf16_f32 v8, v128, v129
    v_cvt_pk_bf16_f32 v9, v130, v131
    v_cvt_pk_bf16_f32 v10, v136, v137
    v_cvt_pk_bf16_f32 v11, v138, v139
    v_cvt_pk_bf16_f32 v12, v144, v145
    v_cvt_pk_bf16_f32 v13, v146, v147
    ds_write_b64 v6, v[8:9] offset:0
    ds_write_b64 v6, v[10:11] offset:2176
    ds_write_b64 v6, v[12:13] offset:4352
    s_waitcnt lgkmcnt(9)
    v_mul_f32 v152, v44, v152
    v_mul_f32 v153, v45, v153
    v_mul_f32 v154, v46, v154
    v_mul_f32 v155, v47, v155
    v_mul_f32 v160, v48, v160
    v_mul_f32 v161, v49, v161
    v_mul_f32 v162, v50, v162
    v_mul_f32 v163, v51, v163
    v_mul_f32 v168, v52, v168
    v_mul_f32 v169, v53, v169
    v_mul_f32 v170, v54, v170
    v_mul_f32 v171, v55, v171
    v_cvt_pk_bf16_f32 v14, v152, v153
    v_cvt_pk_bf16_f32 v15, v154, v155
    v_cvt_pk_bf16_f32 v16, v160, v161
    v_cvt_pk_bf16_f32 v17, v162, v163
    v_cvt_pk_bf16_f32 v18, v168, v169
    v_cvt_pk_bf16_f32 v19, v170, v171
    v_lshlrev_b32 v152, 16, v14
    v_and_b32 v153, 0xffff0000, v14
    v_lshlrev_b32 v154, 16, v15
    v_and_b32 v155, 0xffff0000, v15
    v_lshlrev_b32 v160, 16, v16
    v_and_b32 v161, 0xffff0000, v16
    v_lshlrev_b32 v162, 16, v17
    v_and_b32 v163, 0xffff0000, v17
    v_lshlrev_b32 v168, 16, v18
    v_and_b32 v169, 0xffff0000, v18
    v_lshlrev_b32 v170, 16, v19
    v_and_b32 v171, 0xffff0000, v19
    v_add_f32 v152, v152, v156
    v_add_f32 v153, v153, v157
    v_add_f32 v154, v154, v158
    v_add_f32 v155, v155, v159
    v_add_f32 v160, v160, v164
    v_add_f32 v161, v161, v165
    v_add_f32 v162, v162, v166
    v_add_f32 v163, v163, v167
    v_add_f32 v168, v168, v172
    v_add_f32 v169, v169, v173
    v_add_f32 v170, v170, v174
    v_add_f32 v171, v171, v175
    v_cvt_pk_bf16_f32 v14, v152, v153
    v_cvt_pk_bf16_f32 v15, v154, v155
    v_cvt_pk_bf16_f32 v16, v160, v161
    v_cvt_pk_bf16_f32 v17, v162, v163
    v_cvt_pk_bf16_f32 v18, v168, v169
    v_cvt_pk_bf16_f32 v19, v170, v171
    ds_write_b64 v6, v[14:15] offset:6528
    ds_write_b64 v6, v[16:17] offset:8704
    ds_write_b64 v6, v[18:19] offset:10880
    s_waitcnt lgkmcnt(6)
    v_mul_f32 v176, v56, v176
    v_mul_f32 v177, v57, v177
    v_mul_f32 v178, v58, v178
    v_mul_f32 v179, v59, v179
    v_mul_f32 v184, v60, v184
    v_mul_f32 v185, v61, v185
    v_mul_f32 v186, v62, v186
    v_mul_f32 v187, v63, v187
    v_mul_f32 v192, v64, v192
    v_mul_f32 v193, v65, v193
    v_mul_f32 v194, v66, v194
    v_mul_f32 v195, v67, v195
    v_cvt_pk_bf16_f32 v20, v176, v177
    v_cvt_pk_bf16_f32 v21, v178, v179
    v_cvt_pk_bf16_f32 v22, v184, v185
    v_cvt_pk_bf16_f32 v23, v186, v187
    v_cvt_pk_bf16_f32 v24, v192, v193
    v_cvt_pk_bf16_f32 v25, v194, v195
    v_lshlrev_b32 v176, 16, v20
    v_and_b32 v177, 0xffff0000, v20
    v_lshlrev_b32 v178, 16, v21
    v_and_b32 v179, 0xffff0000, v21
    v_lshlrev_b32 v184, 16, v22
    v_and_b32 v185, 0xffff0000, v22
    v_lshlrev_b32 v186, 16, v23
    v_and_b32 v187, 0xffff0000, v23
    v_lshlrev_b32 v192, 16, v24
    v_and_b32 v193, 0xffff0000, v24
    v_lshlrev_b32 v194, 16, v25
    v_and_b32 v195, 0xffff0000, v25
    v_add_f32 v176, v176, v180
    v_add_f32 v177, v177, v181
    v_add_f32 v178, v178, v182
    v_add_f32 v179, v179, v183
    v_add_f32 v184, v184, v188
    v_add_f32 v185, v185, v189
    v_add_f32 v186, v186, v190
    v_add_f32 v187, v187, v191
    v_add_f32 v192, v192, v196
    v_add_f32 v193, v193, v197
    v_add_f32 v194, v194, v198
    v_add_f32 v195, v195, v199
    v_cvt_pk_bf16_f32 v20, v176, v177
    v_cvt_pk_bf16_f32 v21, v178, v179
    v_cvt_pk_bf16_f32 v22, v184, v185
    v_cvt_pk_bf16_f32 v23, v186, v187
    v_cvt_pk_bf16_f32 v24, v192, v193
    v_cvt_pk_bf16_f32 v25, v194, v195
    ds_write_b64 v6, v[20:21] offset:13056
    ds_write_b64 v6, v[22:23] offset:15232
    ds_write_b64 v6, v[24:25] offset:17408
    s_sub_u32 s30, s2, 112
    s_lshr_b32 s31, s30, 1
    s_mul_i32 s31, s31, 36864
    s_and_b32 s30, s30, 1
    s_lshl_b32 s30, s30, 10
    s_add_u32 s31, s31, s30
    s_lshl_b32 s30, s40, 11
    s_add_u32 s31, s31, s30
    s_add_u32 s31, s31, 98304
    s_waitcnt lgkmcnt(0)
    s_barrier
    ds_read_b128 v[24:27], v7 offset:17408
    ds_read_b128 v[20:23], v7 offset:13056
    ds_read_b128 v[16:19], v7 offset:8704
    ds_read_b128 v[12:15], v7 offset:4352
    ds_read_b128 v[8:11], v7 offset:0
    s_cmp_ge_u32 s40, 2
    s_waitcnt lgkmcnt(0)
    s_cbranch_scc1 F_LN4
    buffer_store_dwordx4 v[24:27], v225, s[24:27], s31 offen sc1
F_LN4:
    s_sub_u32 s31, s31, 8192
    buffer_store_dwordx4 v[20:23], v225, s[24:27], s31 offen sc1
    s_sub_u32 s31, s31, 8192
    buffer_store_dwordx4 v[16:19], v225, s[24:27], s31 offen sc1
    s_sub_u32 s31, s31, 8192
    buffer_store_dwordx4 v[12:15], v225, s[24:27], s31 offen sc1
    s_sub_u32 s31, s31, 8192
    buffer_store_dwordx4 v[8:11], v225, s[24:27], s31 offen sc1
    s_waitcnt vmcnt(0)
    s_barrier
    s_cmp_lg_u32 s40, 0
    s_cbranch_scc1 F_ALL
    s_lshl_b32 s30, s2, 7
    s_add_u32 s30, s30, 2541568
    v_mov_b32 v2, 0
    v_mov_b32 v3, s54
    s_mov_b64 exec, 1
    buffer_store_dword v3, v2, s[24:27], s30 offen sc1
    s_mov_b64 exec, -1
F_ALL:
    s_barrier
F_ALL2:
    s_mov_b32 s32, 0
    s_add_u32 m0, s28, 0
    s_nop 0
    buffer_load_dwordx4 v242, s[16:19], s32 offen offset:0  lds
    buffer_load_dwordx4 v243, s[16:19], s32 offen offset:1024  lds
    buffer_load_dwordx4 v244, s[16:19], s32 offen offset:2048  lds
    buffer_load_dwordx4 v245, s[16:19], s32 offen offset:3072  lds
    s_mov_b32 s33, 256
    s_add_u32 m0, s28, 65536
    s_nop 0
    buffer_load_dwordx4 v242, s[16:19], s33 offen offset:0  lds
    buffer_load_dwordx4 v243, s[16:19], s33 offen offset:1024  lds
    buffer_load_dwordx4 v244, s[16:19], s33 offen offset:2048  lds
    buffer_load_dwordx4 v245, s[16:19], s33 offen offset:3072  lds
    s_mov_b32 s32, 524288
    s_add_u32 m0, s28, 16384
    s_nop 0
    buffer_load_dwordx4 v242, s[16:19], s32 offen offset:0  lds
    buffer_load_dwordx4 v243, s[16:19], s32 offen offset:1024  lds
    buffer_load_dwordx4 v244, s[16:19], s32 offen offset:2048  lds
    buffer_load_dwordx4 v245, s[16:19], s32 offen offset:3072  lds
    s_mov_b32 s33, 524544
    s_add_u32 m0, s28, 81920
    s_nop 0
    buffer_load_dwordx4 v242, s[16:19], s33 offen offset:0  lds
    buffer_load_dwordx4 v243, s[16:19], s33 offen offset:1024  lds
    buffer_load_dwordx4 v244, s[16:19], s33 offen offset:2048  lds
    buffer_load_dwordx4 v245, s[16:19], s33 offen offset:3072  lds
    s_lshl_b32 s30, s55, 8
    s_add_u32 s30, s30, 2555904
    s_mov_b32 s101, 200000
F_POLL6:
    buffer_load_dword v113, v112, s[24:27], s30 offen sc1
    s_waitcnt vmcnt(0)
    v_cmp_ne_u32 vcc, s54, v113
    s_sub_u32 s101, s101, 1
    s_cselect_b64 vcc, 0, vcc
    s_cbranch_vccnz F_POLL6
    buffer_load_dwordx4 v[176:179], v225, s[24:27], s38 offen offset:0 sc1
    buffer_load_dwordx4 v[180:183], v225, s[24:27], s38 offen offset:1024 sc1
    buffer_load_dwordx4 v[184:187], v225, s[24:27], s38 offen offset:2048 sc1
    buffer_load_dwordx4 v[188:191], v225, s[24:27], s38 offen offset:3072 sc1
    s_add_u32 s38, s38, 4096
    buffer_load_dwordx4 v[128:131], v225, s[24:27], s38 offen offset:0 sc1
    buffer_load_dwordx4 v[132:135], v225, s[24:27], s38 offen offset:1024 sc1
    buffer_load_dwordx4 v[136:139], v225, s[24:27], s38 offen offset:2048 sc1
    buffer_load_dwordx4 v[140:143], v225, s[24:27], s38 offen offset:3072 sc1
    s_add_u32 s38, s38, 4096
    buffer_load_dwordx4 v[144:147], v225, s[24:27], s38 offen offset:0 sc1
    buffer_load_dwordx4 v[148:151], v225, s[24:27], s38 offen offset:1024 sc1
    buffer_load_dwordx4 v[152:155], v225, s[24:27], s38 offen offset:2048 sc1
    buffer_load_dwordx4 v[156:159], v225, s[24:27], s38 offen offset:3072 sc1
    s_mov_b32 s53, 0x3e0293ee
    s_barrier
    ds_read_b64_tr_b16 a[192:193], v226 offset:0
    ds_read_b64_tr_b16 a[194:195], v226 offset:1024
    ds_read_b64_tr_b16 a[196:197], v226 offset:8192
    ds_read_b64_tr_b16 a[198:199], v226 offset:9216
    ds_read_b64_tr_b16 a[200:201], v227 offset:0
    ds_read_b64_tr_b16 a[202:203], v227 offset:1024
    ds_read_b64_tr_b16 a[204:205], v227 offset:8192
    ds_read_b64_tr_b16 a[206:207], v227 offset:9216
    ds_read_b64_tr_b16 a[208:209], v228 offset:0
    ds_read_b64_tr_b16 a[210:211], v228 offset:1024
    ds_read_b64_tr_b16 a[212:213], v228 offset:8192
    ds_read_b64_tr_b16 a[214:215], v228 offset:9216
    ds_read_b64_tr_b16 a[216:217], v229 offset:0
    ds_read_b64_tr_b16 a[218:219], v229 offset:1024
    ds_read_b64_tr_b16 a[220:221], v229 offset:8192
    ds_read_b64_tr_b16 a[222:223], v229 offset:9216
    s_waitcnt vmcnt(8)
    s_waitcnt lgkmcnt(0)
    v_mfma_f32_16x16x32_bf16 v[0:3], a[192:195], v[176:179], 0
    ds_read_b64_tr_b16 a[224:225], v230 offset:0
    v_mfma_f32_16x16x32_bf16 v[0:3], a[196:199], v[184:187], v[0:3]
    ds_read_b64_tr_b16 a[226:227], v230 offset:1024
    v_mfma_f32_16x16x32_bf16 v[4:7], a[192:195], v[180:183], 0
    ds_read_b64_tr_b16 a[228:229], v230 offset:8192
    v_mfma_f32_16x16x32_bf16 v[4:7], a[196:199], v[188:191], v[4:7]
    ds_read_b64_tr_b16 a[230:231], v230 offset:9216
    v_mfma_f32_16x16x32_bf16 v[8:11], a[200:203], v[176:179], 0
    ds_read_b64_tr_b16 a[232:233], v231 offset:0
    v_mfma_f32_16x16x32_bf16 v[8:11], a[204:207], v[184:187], v[8:11]
    ds_read_b64_tr_b16 a[234:235], v231 offset:1024
    v_mfma_f32_16x16x32_bf16 v[12:15], a[200:203], v[180:183], 0
    ds_read_b64_tr_b16 a[236:237], v231 offset:8192
    s_add_u32 s38, s38, 4096
    v_mfma_f32_16x16x32_bf16 v[12:15], a[204:207], v[188:191], v[12:15]
    ds_read_b64_tr_b16 a[238:239], v231 offset:9216
    s_mov_b32 s32, 1048576
    s_waitcnt lgkmcnt(8)
    v_mfma_f32_16x16x32_bf16 v[16:19], a[208:211], v[176:179], 0
    ds_read_b64_tr_b16 a[240:241], v232 offset:0
    s_add_u32 m0, s28, 32768
    v_mfma_f32_16x16x32_bf16 v[16:19], a[212:215], v[184:187], v[16:19]
    ds_read_b64_tr_b16 a[242:243], v232 offset:1024
    v_mfma_f32_16x16x32_bf16 v[20:23], a[208:211], v[180:183], 0
    ds_read_b64_tr_b16 a[244:245], v232 offset:8192
    buffer_load_dwordx4 v242, s[16:19], s32 offen offset:0  lds
    v_mfma_f32_16x16x32_bf16 v[20:23], a[212:215], v[188:191], v[20:23]
    ds_read_b64_tr_b16 a[246:247], v232 offset:9216
    v_mfma_f32_16x16x32_bf16 v[24:27], a[216:219], v[176:179], 0
    ds_read_b64_tr_b16 a[248:249], v233 offset:0
    buffer_load_dwordx4 v243, s[16:19], s32 offen offset:1024  lds
    v_mfma_f32_16x16x32_bf16 v[24:27], a[220:223], v[184:187], v[24:27]
    ds_read_b64_tr_b16 a[250:251], v233 offset:1024
    v_mfma_f32_16x16x32_bf16 v[28:31], a[216:219], v[180:183], 0
    ds_read_b64_tr_b16 a[252:253], v233 offset:8192
    buffer_load_dwordx4 v[160:163], v225, s[24:27], s38 offen offset:0 sc1
    v_mfma_f32_16x16x32_bf16 v[28:31], a[220:223], v[188:191], v[28:31]
    ds_read_b64_tr_b16 a[254:255], v233 offset:9216
    s_waitcnt lgkmcnt(8)
    v_mfma_f32_16x16x32_bf16 v[32:35], a[224:227], v[176:179], 0
    ds_read_b64_tr_b16 a[192:193], v234 offset:0
    v_mfma_f32_16x16x32_bf16 v[32:35], a[228:231], v[184:187], v[32:35]
    ds_read_b64_tr_b16 a[194:195], v234 offset:1024
    v_mfma_f32_16x16x32_bf16 v[36:39], a[224:227], v[180:183], 0
    ds_read_b64_tr_b16 a[196:197], v234 offset:8192
    v_mfma_f32_16x16x32_bf16 v[36:39], a[228:231], v[188:191], v[36:39]
    ds_read_b64_tr_b16 a[198:199], v234 offset:9216
    buffer_load_dwordx4 v[192:195], v225, s[12:15], s28 offen
    v_mfma_f32_16x16x32_bf16 v[40:43], a[232:235], v[176:179], 0
    ds_read_b64_tr_b16 a[200:201], v235 offset:0
    v_mfma_f32_16x16x32_bf16 v[40:43], a[236:239], v[184:187], v[40:43]
    ds_read_b64_tr_b16 a[202:203], v235 offset:1024
    v_mfma_f32_16x16x32_bf16 v[44:47], a[232:235], v[180:183], 0
    ds_read_b64_tr_b16 a[204:205], v235 offset:8192
    v_mfma_f32_16x16x32_bf16 v[44:47], a[236:239], v[188:191], v[44:47]
    ds_read_b64_tr_b16 a[206:207], v235 offset:9216
    s_waitcnt lgkmcnt(8)
    v_mfma_f32_16x16x32_bf16 v[48:51], a[240:243], v[176:179], 0
    ds_read_b64_tr_b16 a[208:209], v236 offset:0
    v_mfma_f32_16x16x32_bf16 v[48:51], a[244:247], v[184:187], v[48:51]
    ds_read_b64_tr_b16 a[210:211], v236 offset:1024
    v_mfma_f32_16x16x32_bf16 v[52:55], a[240:243], v[180:183], 0
    ds_read_b64_tr_b16 a[212:213], v236 offset:8192
    buffer_load_dwordx4 v244, s[16:19], s32 offen offset:2048  lds
    v_mfma_f32_16x16x32_bf16 v[52:55], a[244:247], v[188:191], v[52:55]
    ds_read_b64_tr_b16 a[214:215], v236 offset:9216
    v_mfma_f32_16x16x32_bf16 v[56:59], a[248:251], v[176:179], 0
    ds_read_b64_tr_b16 a[216:217], v237 offset:0
    buffer_load_dwordx4 v245, s[16:19], s32 offen offset:3072  lds
    v_mfma_f32_16x16x32_bf16 v[56:59], a[252:255], v[184:187], v[56:59]
    ds_read_b64_tr_b16 a[218:219], v237 offset:1024
    v_mfma_f32_16x16x32_bf16 v[60:63], a[248:251], v[180:183], 0
    ds_read_b64_tr_b16 a[220:221], v237 offset:8192
    buffer_load_dwordx4 v[164:167], v225, s[24:27], s38 offen offset:1024 sc1
    v_mfma_f32_16x16x32_bf16 v[60:63], a[252:255], v[188:191], v[60:63]
    ds_read_b64_tr_b16 a[222:223], v237 offset:9216
    s_waitcnt lgkmcnt(8)
    v_mfma_f32_16x16x32_bf16 v[64:67], a[192:195], v[176:179], 0
    ds_read_b64_tr_b16 a[224:225], v238 offset:0
    v_mfma_f32_16x16x32_bf16 v[64:67], a[196:199], v[184:187], v[64:67]
    ds_read_b64_tr_b16 a[226:227], v238 offset:1024
    v_mfma_f32_16x16x32_bf16 v[68:71], a[192:195], v[180:183], 0
    ds_read_b64_tr_b16 a[228:229], v238 offset:8192
    v_mfma_f32_16x16x32_bf16 v[68:71], a[196:199], v[188:191], v[68:71]
    ds_read_b64_tr_b16 a[230:231], v238 offset:9216
    v_mfma_f32_16x16x32_bf16 v[72:75], a[200:203], v[176:179], 0
    ds_read_b64_tr_b16 a[232:233], v239 offset:0
    v_mfma_f32_16x16x32_bf16 v[72:75], a[204:207], v[184:187], v[72:75]
    ds_read_b64_tr_b16 a[234:235], v239 offset:1024
    v_mfma_f32_16x16x32_bf16 v[76:79], a[200:203], v[180:183], 0
    ds_read_b64_tr_b16 a[236:237], v239 offset:8192
    v_mfma_f32_16x16x32_bf16 v[76:79], a[204:207], v[188:191], v[76:79]
    ds_read_b64_tr_b16 a[238:239], v239 offset:9216
    s_mov_b32 s33, 1048832
    s_waitcnt lgkmcnt(8)
    v_mfma_f32_16x16x32_bf16 v[80:83], a[208:211], v[176:179], 0
    ds_read_b64_tr_b16 a[240:241], v240 offset:0
    s_add_u32 m0, s28, 98304
    v_mfma_f32_16x16x32_bf16 v[80:83], a[212:215], v[184:187], v[80:83]
    ds_read_b64_tr_b16 a[242:243], v240 offset:1024
    v_mfma_f32_16x16x32_bf16 v[84:87], a[208:211], v[180:183], 0
    ds_read_b64_tr_b16 a[244:245], v240 offset:8192
    buffer_load_dwordx4 v242, s[16:19], s33 offen offset:0  lds
    v_mfma_f32_16x16x32_bf16 v[84:87], a[212:215], v[188:191], v[84:87]
    ds_read_b64_tr_b16 a[246:247], v240 offset:9216
    v_mfma_f32_16x16x32_bf16 v[88:91], a[216:219], v[176:179], 0
    ds_read_b64_tr_b16 a[248:249], v241 offset:0
    buffer_load_dwordx4 v243, s[16:19], s33 offen offset:1024  lds
    v_mfma_f32_16x16x32_bf16 v[88:91], a[220:223], v[184:187], v[88:91]
    ds_read_b64_tr_b16 a[250:251], v241 offset:1024
    v_mfma_f32_16x16x32_bf16 v[92:95], a[216:219], v[180:183], 0
    ds_read_b64_tr_b16 a[252:253], v241 offset:8192
    buffer_load_dwordx4 v[168:171], v225, s[24:27], s38 offen offset:2048 sc1
    v_mfma_f32_16x16x32_bf16 v[92:95], a[220:223], v[188:191], v[92:95]
    ds_read_b64_tr_b16 a[254:255], v241 offset:9216
    s_waitcnt lgkmcnt(8)
    v_mfma_f32_16x16x32_bf16 v[96:99], a[224:227], v[176:179], 0
    s_waitcnt vmcnt(14)
    s_barrier
    ds_read_b64_tr_b16 a[192:193], v226 offset:16384
    v_mfma_f32_16x16x32_bf16 v[96:99], a[228:231], v[184:187], v[96:99]
    ds_read_b64_tr_b16 a[194:195], v226 offset:17408
    v_mfma_f32_16x16x32_bf16 v[100:103], a[224:227], v[180:183], 0
    ds_read_b64_tr_b16 a[196:197], v226 offset:24576
    v_mfma_f32_16x16x32_bf16 v[100:103], a[228:231], v[188:191], v[100:103]
    ds_read_b64_tr_b16 a[198:199], v226 offset:25600
    v_mfma_f32_16x16x32_bf16 v[104:107], a[232:235], v[176:179], 0
    ds_read_b64_tr_b16 a[200:201], v227 offset:16384
    v_mfma_f32_16x16x32_bf16 v[104:107], a[236:239], v[184:187], v[104:107]
    ds_read_b64_tr_b16 a[202:203], v227 offset:17408
    v_mfma_f32_16x16x32_bf16 v[108:111], a[232:235], v[180:183], 0
    ds_read_b64_tr_b16 a[204:205], v227 offset:24576
    v_mfma_f32_16x16x32_bf16 v[108:111], a[236:239], v[188:191], v[108:111]
    ds_read_b64_tr_b16 a[206:207], v227 offset:25600
    s_waitcnt lgkmcnt(8)
    v_mfma_f32_16x16x32_bf16 v[112:115], a[240:243], v[176:179], 0
    ds_read_b64_tr_b16 a[208:209], v228 offset:16384
    v_mfma_f32_16x16x32_bf16 v[112:115], a[244:247], v[184:187], v[112:115]
    ds_read_b64_tr_b16 a[210:211], v228 offset:17408
    v_mfma_f32_16x16x32_bf16 v[116:119], a[240:243], v[180:183], 0
    ds_read_b64_tr_b16 a[212:213], v228 offset:24576
    buffer_load_dwordx4 v244, s[16:19], s33 offen offset:2048  lds
    v_mfma_f32_16x16x32_bf16 v[116:119], a[244:247], v[188:191], v[116:119]
    ds_read_b64_tr_b16 a[214:215], v228 offset:25600
    v_mfma_f32_16x16x32_bf16 v[120:123], a[248:251], v[176:179], 0
    ds_read_b64_tr_b16 a[216:217], v229 offset:16384
    buffer_load_dwordx4 v245, s[16:19], s33 offen offset:3072  lds
    v_mfma_f32_16x16x32_bf16 v[120:123], a[252:255], v[184:187], v[120:123]
    ds_read_b64_tr_b16 a[218:219], v229 offset:17408
    v_mfma_f32_16x16x32_bf16 v[124:127], a[248:251], v[180:183], 0
    ds_read_b64_tr_b16 a[220:221], v229 offset:24576
    buffer_load_dwordx4 v[172:175], v225, s[24:27], s38 offen offset:3072 sc1
    v_mfma_f32_16x16x32_bf16 v[124:127], a[252:255], v[188:191], v[124:127]
    ds_read_b64_tr_b16 a[222:223], v229 offset:25600
    s_waitcnt lgkmcnt(8)
    v_mfma_f32_16x16x32_bf16 v[0:3], a[192:195], v[128:131], v[0:3]
    ds_read_b64_tr_b16 a[224:225], v230 offset:16384
    v_mfma_f32_16x16x32_bf16 v[0:3], a[196:199], v[136:139], v[0:3]
    ds_read_b64_tr_b16 a[226:227], v230 offset:17408
    v_mfma_f32_16x16x32_bf16 v[4:7], a[192:195], v[132:135], v[4:7]
    ds_read_b64_tr_b16 a[228:229], v230 offset:24576
    v_mfma_f32_16x16x32_bf16 v[4:7], a[196:199], v[140:143], v[4:7]
    ds_read_b64_tr_b16 a[230:231], v230 offset:25600
    v_mfma_f32_16x16x32_bf16 v[8:11], a[200:203], v[128:131], v[8:11]
    ds_read_b64_tr_b16 a[232:233], v231 offset:16384
    v_mfma_f32_16x16x32_bf16 v[8:11], a[204:207], v[136:139], v[8:11]
    ds_read_b64_tr_b16 a[234:235], v231 offset:17408
    v_mfma_f32_16x16x32_bf16 v[12:15], a[200:203], v[132:135], v[12:15]
    ds_read_b64_tr_b16 a[236:237], v231 offset:24576
    s_add_u32 s38, s38, 4096
    v_mfma_f32_16x16x32_bf16 v[12:15], a[204:207], v[140:143], v[12:15]
    ds_read_b64_tr_b16 a[238:239], v231 offset:25600
    s_mov_b32 s32, 1572864
    s_waitcnt lgkmcnt(8)
    v_mfma_f32_16x16x32_bf16 v[16:19], a[208:211], v[128:131], v[16:19]
    ds_read_b64_tr_b16 a[240:241], v232 offset:16384
    s_add_u32 m0, s28, 49152
    v_mfma_f32_16x16x32_bf16 v[16:19], a[212:215], v[136:139], v[16:19]
    ds_read_b64_tr_b16 a[242:243], v232 offset:17408
    v_mfma_f32_16x16x32_bf16 v[20:23], a[208:211], v[132:135], v[20:23]
    ds_read_b64_tr_b16 a[244:245], v232 offset:24576
    buffer_load_dwordx4 v242, s[16:19], s32 offen offset:0  lds
    v_mfma_f32_16x16x32_bf16 v[20:23], a[212:215], v[140:143], v[20:23]
    ds_read_b64_tr_b16 a[246:247], v232 offset:25600
    v_mfma_f32_16x16x32_bf16 v[24:27], a[216:219], v[128:131], v[24:27]
    ds_read_b64_tr_b16 a[248:249], v233 offset:16384
    buffer_load_dwordx4 v243, s[16:19], s32 offen offset:1024  lds
    v_mfma_f32_16x16x32_bf16 v[24:27], a[220:223], v[136:139], v[24:27]
    ds_read_b64_tr_b16 a[250:251], v233 offset:17408
    v_mfma_f32_16x16x32_bf16 v[28:31], a[216:219], v[132:135], v[28:31]
    ds_read_b64_tr_b16 a[252:253], v233 offset:24576
    buffer_load_dwordx4 v[176:179], v225, s[24:27], s38 offen offset:0 sc1
    v_mfma_f32_16x16x32_bf16 v[28:31], a[220:223], v[140:143], v[28:31]
    ds_read_b64_tr_b16 a[254:255], v233 offset:25600
    s_waitcnt lgkmcnt(8)
    v_mfma_f32_16x16x32_bf16 v[32:35], a[224:227], v[128:131], v[32:35]
    ds_read_b64_tr_b16 a[192:193], v234 offset:16384
    v_mfma_f32_16x16x32_bf16 v[32:35], a[228:231], v[136:139], v[32:35]
    ds_read_b64_tr_b16 a[194:195], v234 offset:17408
    v_mfma_f32_16x16x32_bf16 v[36:39], a[224:227], v[132:135], v[36:39]
    ds_read_b64_tr_b16 a[196:197], v234 offset:24576
    v_mfma_f32_16x16x32_bf16 v[36:39], a[228:231], v[140:143], v[36:39]
    ds_read_b64_tr_b16 a[198:199], v234 offset:25600
    v_mfma_f32_16x16x32_bf16 v[40:43], a[232:235], v[128:131], v[40:43]
    ds_read_b64_tr_b16 a[200:201], v235 offset:16384
    v_mfma_f32_16x16x32_bf16 v[40:43], a[236:239], v[136:139], v[40:43]
    ds_read_b64_tr_b16 a[202:203], v235 offset:17408
    v_mfma_f32_16x16x32_bf16 v[44:47], a[232:235], v[132:135], v[44:47]
    ds_read_b64_tr_b16 a[204:205], v235 offset:24576
    v_mfma_f32_16x16x32_bf16 v[44:47], a[236:239], v[140:143], v[44:47]
    ds_read_b64_tr_b16 a[206:207], v235 offset:25600
    s_waitcnt lgkmcnt(8)
    v_mfma_f32_16x16x32_bf16 v[48:51], a[240:243], v[128:131], v[48:51]
    ds_read_b64_tr_b16 a[208:209], v236 offset:16384
    v_mfma_f32_16x16x32_bf16 v[48:51], a[244:247], v[136:139], v[48:51]
    ds_read_b64_tr_b16 a[210:211], v236 offset:17408
    v_mfma_f32_16x16x32_bf16 v[52:55], a[240:243], v[132:135], v[52:55]
    ds_read_b64_tr_b16 a[212:213], v236 offset:24576
    buffer_load_dwordx4 v244, s[16:19], s32 offen offset:2048  lds
    v_mfma_f32_16x16x32_bf16 v[52:55], a[244:247], v[140:143], v[52:55]
    ds_read_b64_tr_b16 a[214:215], v236 offset:25600
    v_mfma_f32_16x16x32_bf16 v[56:59], a[248:251], v[128:131], v[56:59]
    ds_read_b64_tr_b16 a[216:217], v237 offset:16384
    buffer_load_dwordx4 v245, s[16:19], s32 offen offset:3072  lds
    v_mfma_f32_16x16x32_bf16 v[56:59], a[252:255], v[136:139], v[56:59]
    ds_read_b64_tr_b16 a[218:219], v237 offset:17408
    v_mfma_f32_16x16x32_bf16 v[60:63], a[248:251], v[132:135], v[60:63]
    ds_read_b64_tr_b16 a[220:221], v237 offset:24576
    buffer_load_dwordx4 v[180:183], v225, s[24:27], s38 offen offset:1024 sc1
    v_mfma_f32_16x16x32_bf16 v[60:63], a[252:255], v[140:143], v[60:63]
    ds_read_b64_tr_b16 a[222:223], v237 offset:25600
    s_waitcnt lgkmcnt(8)
    v_mfma_f32_16x16x32_bf16 v[64:67], a[192:195], v[128:131], v[64:67]
    ds_read_b64_tr_b16 a[224:225], v238 offset:16384
    v_mfma_f32_16x16x32_bf16 v[64:67], a[196:199], v[136:139], v[64:67]
    ds_read_b64_tr_b16 a[226:227], v238 offset:17408
    v_mfma_f32_16x16x32_bf16 v[68:71], a[192:195], v[132:135], v[68:71]
    ds_read_b64_tr_b16 a[228:229], v238 offset:24576
    v_mfma_f32_16x16x32_bf16 v[68:71], a[196:199], v[140:143], v[68:71]
    ds_read_b64_tr_b16 a[230:231], v238 offset:25600
    v_mfma_f32_16x16x32_bf16 v[72:75], a[200:203], v[128:131], v[72:75]
    ds_read_b64_tr_b16 a[232:233], v239 offset:16384
    v_mfma_f32_16x16x32_bf16 v[72:75], a[204:207], v[136:139], v[72:75]
    ds_read_b64_tr_b16 a[234:235], v239 offset:17408
    v_mfma_f32_16x16x32_bf16 v[76:79], a[200:203], v[132:135], v[76:79]
    ds_read_b64_tr_b16 a[236:237], v239 offset:24576
    v_mfma_f32_16x16x32_bf16 v[76:79], a[204:207], v[140:143], v[76:79]
    ds_read_b64_tr_b16 a[238:239], v239 offset:25600
    s_mov_b32 s33, 1573120
    s_waitcnt lgkmcnt(8)
    v_mfma_f32_16x16x32_bf16 v[80:83], a[208:211], v[128:131], v[80:83]
    ds_read_b64_tr_b16 a[240:241], v240 offset:16384
    s_add_u32 m0, s28, 114688
    v_mfma_f32_16x16x32_bf16 v[80:83], a[212:215], v[136:139], v[80:83]
    ds_read_b64_tr_b16 a[242:243], v240 offset:17408
    v_mfma_f32_16x16x32_bf16 v[84:87], a[208:211], v[132:135], v[84:87]
    ds_read_b64_tr_b16 a[244:245], v240 offset:24576
    buffer_load_dwordx4 v242, s[16:19], s33 offen offset:0  lds
    v_mfma_f32_16x16x32_bf16 v[84:87], a[212:215], v[140:143], v[84:87]
    ds_read_b64_tr_b16 a[246:247], v240 offset:25600
    v_mfma_f32_16x16x32_bf16 v[88:91], a[216:219], v[128:131], v[88:91]
    ds_read_b64_tr_b16 a[248:249], v241 offset:16384
    buffer_load_dwordx4 v243, s[16:19], s33 offen offset:1024  lds
    v_mfma_f32_16x16x32_bf16 v[88:91], a[220:223], v[136:139], v[88:91]
    ds_read_b64_tr_b16 a[250:251], v241 offset:17408
    v_mfma_f32_16x16x32_bf16 v[92:95], a[216:219], v[132:135], v[92:95]
    ds_read_b64_tr_b16 a[252:253], v241 offset:24576
    buffer_load_dwordx4 v[184:187], v225, s[24:27], s38 offen offset:2048 sc1
    v_mfma_f32_16x16x32_bf16 v[92:95], a[220:223], v[140:143], v[92:95]
    ds_read_b64_tr_b16 a[254:255], v241 offset:25600
    s_waitcnt lgkmcnt(8)
    v_mfma_f32_16x16x32_bf16 v[96:99], a[224:227], v[128:131], v[96:99]
    s_waitcnt vmcnt(9)
    s_barrier
    ds_read_b64_tr_b16 a[192:193], v226 offset:32768
    v_mfma_f32_16x16x32_bf16 v[96:99], a[228:231], v[136:139], v[96:99]
    ds_read_b64_tr_b16 a[194:195], v226 offset:33792
    v_mfma_f32_16x16x32_bf16 v[100:103], a[224:227], v[132:135], v[100:103]
    ds_read_b64_tr_b16 a[196:197], v226 offset:40960
    v_mfma_f32_16x16x32_bf16 v[100:103], a[228:231], v[140:143], v[100:103]
    ds_read_b64_tr_b16 a[198:199], v226 offset:41984
    v_mfma_f32_16x16x32_bf16 v[104:107], a[232:235], v[128:131], v[104:107]
    ds_read_b64_tr_b16 a[200:201], v227 offset:32768
    v_mfma_f32_16x16x32_bf16 v[104:107], a[236:239], v[136:139], v[104:107]
    ds_read_b64_tr_b16 a[202:203], v227 offset:33792
    v_mfma_f32_16x16x32_bf16 v[108:111], a[232:235], v[132:135], v[108:111]
    ds_read_b64_tr_b16 a[204:205], v227 offset:40960
    v_mfma_f32_16x16x32_bf16 v[108:111], a[236:239], v[140:143], v[108:111]
    ds_read_b64_tr_b16 a[206:207], v227 offset:41984
    s_waitcnt lgkmcnt(8)
    v_mfma_f32_16x16x32_bf16 v[112:115], a[240:243], v[128:131], v[112:115]
    ds_read_b64_tr_b16 a[208:209], v228 offset:32768
    v_mfma_f32_16x16x32_bf16 v[112:115], a[244:247], v[136:139], v[112:115]
    ds_read_b64_tr_b16 a[210:211], v228 offset:33792
    v_mfma_f32_16x16x32_bf16 v[116:119], a[240:243], v[132:135], v[116:119]
    ds_read_b64_tr_b16 a[212:213], v228 offset:40960
    buffer_load_dwordx4 v244, s[16:19], s33 offen offset:2048  lds
    v_mfma_f32_16x16x32_bf16 v[116:119], a[244:247], v[140:143], v[116:119]
    ds_read_b64_tr_b16 a[214:215], v228 offset:41984
    v_mfma_f32_16x16x32_bf16 v[120:123], a[248:251], v[128:131], v[120:123]
    ds_read_b64_tr_b16 a[216:217], v229 offset:32768
    buffer_load_dwordx4 v245, s[16:19], s33 offen offset:3072  lds
    v_mfma_f32_16x16x32_bf16 v[120:123], a[252:255], v[136:139], v[120:123]
    ds_read_b64_tr_b16 a[218:219], v229 offset:33792
    v_mfma_f32_16x16x32_bf16 v[124:127], a[248:251], v[132:135], v[124:127]
    ds_read_b64_tr_b16 a[220:221], v229 offset:40960
    buffer_load_dwordx4 v[188:191], v225, s[24:27], s38 offen offset:3072 sc1
    v_mfma_f32_16x16x32_bf16 v[124:127], a[252:255], v[140:143], v[124:127]
    ds_read_b64_tr_b16 a[222:223], v229 offset:41984
    s_waitcnt lgkmcnt(8)
    v_mfma_f32_16x16x32_bf16 v[0:3], a[192:195], v[144:147], v[0:3]
    ds_read_b64_tr_b16 a[224:225], v230 offset:32768
    v_mfma_f32_16x16x32_bf16 v[0:3], a[196:199], v[152:155], v[0:3]
    ds_read_b64_tr_b16 a[226:227], v230 offset:33792
    v_mfma_f32_16x16x32_bf16 v[4:7], a[192:195], v[148:151], v[4:7]
    ds_read_b64_tr_b16 a[228:229], v230 offset:40960
    v_mfma_f32_16x16x32_bf16 v[4:7], a[196:199], v[156:159], v[4:7]
    ds_read_b64_tr_b16 a[230:231], v230 offset:41984
    v_mfma_f32_16x16x32_bf16 v[8:11], a[200:203], v[144:147], v[8:11]
    ds_read_b64_tr_b16 a[232:233], v231 offset:32768
    v_mfma_f32_16x16x32_bf16 v[8:11], a[204:207], v[152:155], v[8:11]
    ds_read_b64_tr_b16 a[234:235], v231 offset:33792
    v_mfma_f32_16x16x32_bf16 v[12:15], a[200:203], v[148:151], v[12:15]
    ds_read_b64_tr_b16 a[236:237], v231 offset:40960
    s_add_u32 s38, s38, 4096
    v_mfma_f32_16x16x32_bf16 v[12:15], a[204:207], v[156:159], v[12:15]
    ds_read_b64_tr_b16 a[238:239], v231 offset:41984
    s_mov_b32 s32, 2097152
    s_waitcnt lgkmcnt(8)
    v_mfma_f32_16x16x32_bf16 v[16:19], a[208:211], v[144:147], v[16:19]
    ds_read_b64_tr_b16 a[240:241], v232 offset:32768
    s_add_u32 m0, s28, 0
    v_mfma_f32_16x16x32_bf16 v[16:19], a[212:215], v[152:155], v[16:19]
    ds_read_b64_tr_b16 a[242:243], v232 offset:33792
    v_mfma_f32_16x16x32_bf16 v[20:23], a[208:211], v[148:151], v[20:23]
    ds_read_b64_tr_b16 a[244:245], v232 offset:40960
    buffer_load_dwordx4 v242, s[16:19], s32 offen offset:0  lds
    v_mfma_f32_16x16x32_bf16 v[20:23], a[212:215], v[156:159], v[20:23]
    ds_read_b64_tr_b16 a[246:247], v232 offset:41984
    v_mfma_f32_16x16x32_bf16 v[24:27], a[216:219], v[144:147], v[24:27]
    ds_read_b64_tr_b16 a[248:249], v233 offset:32768
    buffer_load_dwordx4 v243, s[16:19], s32 offen offset:1024  lds
    v_mfma_f32_16x16x32_bf16 v[24:27], a[220:223], v[152:155], v[24:27]
    ds_read_b64_tr_b16 a[250:251], v233 offset:33792
    v_mfma_f32_16x16x32_bf16 v[28:31], a[216:219], v[148:151], v[28:31]
    ds_read_b64_tr_b16 a[252:253], v233 offset:40960
    buffer_load_dwordx4 v[128:131], v225, s[24:27], s38 offen offset:0 sc1
    v_mfma_f32_16x16x32_bf16 v[28:31], a[220:223], v[156:159], v[28:31]
    ds_read_b64_tr_b16 a[254:255], v233 offset:41984
    s_waitcnt lgkmcnt(8)
    v_mfma_f32_16x16x32_bf16 v[32:35], a[224:227], v[144:147], v[32:35]
    ds_read_b64_tr_b16 a[192:193], v234 offset:32768
    v_mfma_f32_16x16x32_bf16 v[32:35], a[228:231], v[152:155], v[32:35]
    ds_read_b64_tr_b16 a[194:195], v234 offset:33792
    v_mfma_f32_16x16x32_bf16 v[36:39], a[224:227], v[148:151], v[36:39]
    ds_read_b64_tr_b16 a[196:197], v234 offset:40960
    v_mfma_f32_16x16x32_bf16 v[36:39], a[228:231], v[156:159], v[36:39]
    ds_read_b64_tr_b16 a[198:199], v234 offset:41984
    v_mfma_f32_16x16x32_bf16 v[40:43], a[232:235], v[144:147], v[40:43]
    ds_read_b64_tr_b16 a[200:201], v235 offset:32768
    v_mfma_f32_16x16x32_bf16 v[40:43], a[236:239], v[152:155], v[40:43]
    ds_read_b64_tr_b16 a[202:203], v235 offset:33792
    v_mfma_f32_16x16x32_bf16 v[44:47], a[232:235], v[148:151], v[44:47]
    ds_read_b64_tr_b16 a[204:205], v235 offset:40960
    v_mfma_f32_16x16x32_bf16 v[44:47], a[236:239], v[156:159], v[44:47]
    ds_read_b64_tr_b16 a[206:207], v235 offset:41984
    s_waitcnt lgkmcnt(8)
    v_mfma_f32_16x16x32_bf16 v[48:51], a[240:243], v[144:147], v[48:51]
    ds_read_b64_tr_b16 a[208:209], v236 offset:32768
    v_mfma_f32_16x16x32_bf16 v[48:51], a[244:247], v[152:155], v[48:51]
    ds_read_b64_tr_b16 a[210:211], v236 offset:33792
    v_mfma_f32_16x16x32_bf16 v[52:55], a[240:243], v[148:151], v[52:55]
    ds_read_b64_tr_b16 a[212:213], v236 offset:40960
    buffer_load_dwordx4 v244, s[16:19], s32 offen offset:2048  lds
    v_mfma_f32_16x16x32_bf16 v[52:55], a[244:247], v[156:159], v[52:55]
    ds_read_b64_tr_b16 a[214:215], v236 offset:41984
    v_mfma_f32_16x16x32_bf16 v[56:59], a[248:251], v[144:147], v[56:59]
    ds_read_b64_tr_b16 a[216:217], v237 offset:32768
    buffer_load_dwordx4 v245, s[16:19], s32 offen offset:3072  lds
    v_mfma_f32_16x16x32_bf16 v[56:59], a[252:255], v[152:155], v[56:59]
    ds_read_b64_tr_b16 a[218:219], v237 offset:33792
    v_mfma_f32_16x16x32_bf16 v[60:63], a[248:251], v[148:151], v[60:63]
    ds_read_b64_tr_b16 a[220:221], v237 offset:40960
    buffer_load_dwordx4 v[132:135], v225, s[24:27], s38 offen offset:1024 sc1
    v_mfma_f32_16x16x32_bf16 v[60:63], a[252:255], v[156:159], v[60:63]
    ds_read_b64_tr_b16 a[222:223], v237 offset:41984
    s_waitcnt lgkmcnt(8)
    v_mfma_f32_16x16x32_bf16 v[64:67], a[192:195], v[144:147], v[64:67]
    ds_read_b64_tr_b16 a[224:225], v238 offset:32768
    v_mfma_f32_16x16x32_bf16 v[64:67], a[196:199], v[152:155], v[64:67]
    ds_read_b64_tr_b16 a[226:227], v238 offset:33792
    v_mfma_f32_16x16x32_bf16 v[68:71], a[192:195], v[148:151], v[68:71]
    ds_read_b64_tr_b16 a[228:229], v238 offset:40960
    v_mfma_f32_16x16x32_bf16 v[68:71], a[196:199], v[156:159], v[68:71]
    ds_read_b64_tr_b16 a[230:231], v238 offset:41984
    v_mfma_f32_16x16x32_bf16 v[72:75], a[200:203], v[144:147], v[72:75]
    ds_read_b64_tr_b16 a[232:233], v239 offset:32768
    v_mfma_f32_16x16x32_bf16 v[72:75], a[204:207], v[152:155], v[72:75]
    ds_read_b64_tr_b16 a[234:235], v239 offset:33792
    v_mfma_f32_16x16x32_bf16 v[76:79], a[200:203], v[148:151], v[76:79]
    ds_read_b64_tr_b16 a[236:237], v239 offset:40960
    v_mfma_f32_16x16x32_bf16 v[76:79], a[204:207], v[156:159], v[76:79]
    ds_read_b64_tr_b16 a[238:239], v239 offset:41984
    s_mov_b32 s33, 2097408
    s_waitcnt lgkmcnt(8)
    v_mfma_f32_16x16x32_bf16 v[80:83], a[208:211], v[144:147], v[80:83]
    ds_read_b64_tr_b16 a[240:241], v240 offset:32768
    s_add_u32 m0, s28, 65536
    v_mfma_f32_16x16x32_bf16 v[80:83], a[212:215], v[152:155], v[80:83]
    ds_read_b64_tr_b16 a[242:243], v240 offset:33792
    v_mfma_f32_16x16x32_bf16 v[84:87], a[208:211], v[148:151], v[84:87]
    ds_read_b64_tr_b16 a[244:245], v240 offset:40960
    buffer_load_dwordx4 v242, s[16:19], s33 offen offset:0  lds
    v_mfma_f32_16x16x32_bf16 v[84:87], a[212:215], v[156:159], v[84:87]
    ds_read_b64_tr_b16 a[246:247], v240 offset:41984
    v_mfma_f32_16x16x32_bf16 v[88:91], a[216:219], v[144:147], v[88:91]
    ds_read_b64_tr_b16 a[248:249], v241 offset:32768
    buffer_load_dwordx4 v243, s[16:19], s33 offen offset:1024  lds
    v_mfma_f32_16x16x32_bf16 v[88:91], a[220:223], v[152:155], v[88:91]
    ds_read_b64_tr_b16 a[250:251], v241 offset:33792
    v_mfma_f32_16x16x32_bf16 v[92:95], a[216:219], v[148:151], v[92:95]
    ds_read_b64_tr_b16 a[252:253], v241 offset:40960
    buffer_load_dwordx4 v[136:139], v225, s[24:27], s38 offen offset:2048 sc1
    v_mfma_f32_16x16x32_bf16 v[92:95], a[220:223], v[156:159], v[92:95]
    ds_read_b64_tr_b16 a[254:255], v241 offset:41984
    s_waitcnt lgkmcnt(8)
    v_mfma_f32_16x16x32_bf16 v[96:99], a[224:227], v[144:147], v[96:99]
    s_waitcnt vmcnt(9)
    s_barrier
    ds_read_b64_tr_b16 a[192:193], v226 offset:49152
    v_mfma_f32_16x16x32_bf16 v[96:99], a[228:231], v[152:155], v[96:99]
    ds_read_b64_tr_b16 a[194:195], v226 offset:50176
    v_mfma_f32_16x16x32_bf16 v[100:103], a[224:227], v[148:151], v[100:103]
    ds_read_b64_tr_b16 a[196:197], v226 offset:57344
    v_mfma_f32_16x16x32_bf16 v[100:103], a[228:231], v[156:159], v[100:103]
    ds_read_b64_tr_b16 a[198:199], v226 offset:58368
    v_mfma_f32_16x16x32_bf16 v[104:107], a[232:235], v[144:147], v[104:107]
    ds_read_b64_tr_b16 a[200:201], v227 offset:49152
    v_mfma_f32_16x16x32_bf16 v[104:107], a[236:239], v[152:155], v[104:107]
    ds_read_b64_tr_b16 a[202:203], v227 offset:50176
    v_mfma_f32_16x16x32_bf16 v[108:111], a[232:235], v[148:151], v[108:111]
    ds_read_b64_tr_b16 a[204:205], v227 offset:57344
    v_mfma_f32_16x16x32_bf16 v[108:111], a[236:239], v[156:159], v[108:111]
    ds_read_b64_tr_b16 a[206:207], v227 offset:58368
    s_waitcnt lgkmcnt(8)
    v_mfma_f32_16x16x32_bf16 v[112:115], a[240:243], v[144:147], v[112:115]
    ds_read_b64_tr_b16 a[208:209], v228 offset:49152
    v_mfma_f32_16x16x32_bf16 v[112:115], a[244:247], v[152:155], v[112:115]
    ds_read_b64_tr_b16 a[210:211], v228 offset:50176
    v_mfma_f32_16x16x32_bf16 v[116:119], a[240:243], v[148:151], v[116:119]
    ds_read_b64_tr_b16 a[212:213], v228 offset:57344
    buffer_load_dwordx4 v244, s[16:19], s33 offen offset:2048  lds
    v_mfma_f32_16x16x32_bf16 v[116:119], a[244:247], v[156:159], v[116:119]
    ds_read_b64_tr_b16 a[214:215], v228 offset:58368
    v_mfma_f32_16x16x32_bf16 v[120:123], a[248:251], v[144:147], v[120:123]
    ds_read_b64_tr_b16 a[216:217], v229 offset:49152
    buffer_load_dwordx4 v245, s[16:19], s33 offen offset:3072  lds
    v_mfma_f32_16x16x32_bf16 v[120:123], a[252:255], v[152:155], v[120:123]
    ds_read_b64_tr_b16 a[218:219], v229 offset:50176
    v_mfma_f32_16x16x32_bf16 v[124:127], a[248:251], v[148:151], v[124:127]
    ds_read_b64_tr_b16 a[220:221], v229 offset:57344
    buffer_load_dwordx4 v[140:143], v225, s[24:27], s38 offen offset:3072 sc1
    v_mfma_f32_16x16x32_bf16 v[124:127], a[252:255], v[156:159], v[124:127]
    ds_read_b64_tr_b16 a[222:223], v229 offset:58368
    s_waitcnt lgkmcnt(8)
    v_mfma_f32_16x16x32_bf16 v[0:3], a[192:195], v[160:163], v[0:3]
    ds_read_b64_tr_b16 a[224:225], v230 offset:49152
    v_mfma_f32_16x16x32_bf16 v[0:3], a[196:199], v[168:171], v[0:3]
    ds_read_b64_tr_b16 a[226:227], v230 offset:50176
    v_mfma_f32_16x16x32_bf16 v[4:7], a[192:195], v[164:167], v[4:7]
    ds_read_b64_tr_b16 a[228:229], v230 offset:57344
    v_mfma_f32_16x16x32_bf16 v[4:7], a[196:199], v[172:175], v[4:7]
    ds_read_b64_tr_b16 a[230:231], v230 offset:58368
    v_mfma_f32_16x16x32_bf16 v[8:11], a[200:203], v[160:163], v[8:11]
    ds_read_b64_tr_b16 a[232:233], v231 offset:49152
    v_mfma_f32_16x16x32_bf16 v[8:11], a[204:207], v[168:171], v[8:11]
    ds_read_b64_tr_b16 a[234:235], v231 offset:50176
    v_mfma_f32_16x16x32_bf16 v[12:15], a[200:203], v[164:167], v[12:15]
    ds_read_b64_tr_b16 a[236:237], v231 offset:57344
    s_add_u32 s38, s38, 4096
    v_mfma_f32_16x16x32_bf16 v[12:15], a[204:207], v[172:175], v[12:15]
    ds_read_b64_tr_b16 a[238:239], v231 offset:58368
    s_mov_b32 s32, 2621440
    s_waitcnt lgkmcnt(8)
    v_mfma_f32_16x16x32_bf16 v[16:19], a[208:211], v[160:163], v[16:19]
    ds_read_b64_tr_b16 a[240:241], v232 offset:49152
    s_add_u32 m0, s28, 16384
    v_mfma_f32_16x16x32_bf16 v[16:19], a[212:215], v[168:171], v[16:19]
    ds_read_b64_tr_b16 a[242:243], v232 offset:50176
    v_mfma_f32_16x16x32_bf16 v[20:23], a[208:211], v[164:167], v[20:23]
    ds_read_b64_tr_b16 a[244:245], v232 offset:57344
    buffer_load_dwordx4 v242, s[16:19], s32 offen offset:0  lds
    v_mfma_f32_16x16x32_bf16 v[20:23], a[212:215], v[172:175], v[20:23]
    ds_read_b64_tr_b16 a[246:247], v232 offset:58368
    v_mfma_f32_16x16x32_bf16 v[24:27], a[216:219], v[160:163], v[24:27]
    ds_read_b64_tr_b16 a[248:249], v233 offset:49152
    buffer_load_dwordx4 v243, s[16:19], s32 offen offset:1024  lds
    v_mfma_f32_16x16x32_bf16 v[24:27], a[220:223], v[168:171], v[24:27]
    ds_read_b64_tr_b16 a[250:251], v233 offset:50176
    v_mfma_f32_16x16x32_bf16 v[28:31], a[216:219], v[164:167], v[28:31]
    ds_read_b64_tr_b16 a[252:253], v233 offset:57344
    buffer_load_dwordx4 v[144:147], v225, s[24:27], s38 offen offset:0 sc1
    v_mfma_f32_16x16x32_bf16 v[28:31], a[220:223], v[172:175], v[28:31]
    ds_read_b64_tr_b16 a[254:255], v233 offset:58368
    s_waitcnt lgkmcnt(8)
    v_mfma_f32_16x16x32_bf16 v[32:35], a[224:227], v[160:163], v[32:35]
    ds_read_b64_tr_b16 a[192:193], v234 offset:49152
    v_mfma_f32_16x16x32_bf16 v[32:35], a[228:231], v[168:171], v[32:35]
    ds_read_b64_tr_b16 a[194:195], v234 offset:50176
    v_mfma_f32_16x16x32_bf16 v[36:39], a[224:227], v[164:167], v[36:39]
    ds_read_b64_tr_b16 a[196:197], v234 offset:57344
    v_mfma_f32_16x16x32_bf16 v[36:39], a[228:231], v[172:175], v[36:39]
    ds_read_b64_tr_b16 a[198:199], v234 offset:58368
    v_mfma_f32_16x16x32_bf16 v[40:43], a[232:235], v[160:163], v[40:43]
    ds_read_b64_tr_b16 a[200:201], v235 offset:49152
    v_mfma_f32_16x16x32_bf16 v[40:43], a[236:239], v[168:171], v[40:43]
    ds_read_b64_tr_b16 a[202:203], v235 offset:50176
    v_mfma_f32_16x16x32_bf16 v[44:47], a[232:235], v[164:167], v[44:47]
    ds_read_b64_tr_b16 a[204:205], v235 offset:57344
    v_mfma_f32_16x16x32_bf16 v[44:47], a[236:239], v[172:175], v[44:47]
    ds_read_b64_tr_b16 a[206:207], v235 offset:58368
    s_waitcnt lgkmcnt(8)
    v_mfma_f32_16x16x32_bf16 v[48:51], a[240:243], v[160:163], v[48:51]
    ds_read_b64_tr_b16 a[208:209], v236 offset:49152
    v_mfma_f32_16x16x32_bf16 v[48:51], a[244:247], v[168:171], v[48:51]
    ds_read_b64_tr_b16 a[210:211], v236 offset:50176
    v_mfma_f32_16x16x32_bf16 v[52:55], a[240:243], v[164:167], v[52:55]
    ds_read_b64_tr_b16 a[212:213], v236 offset:57344
    buffer_load_dwordx4 v244, s[16:19], s32 offen offset:2048  lds
    v_mfma_f32_16x16x32_bf16 v[52:55], a[244:247], v[172:175], v[52:55]
    ds_read_b64_tr_b16 a[214:215], v236 offset:58368
    v_mfma_f32_16x16x32_bf16 v[56:59], a[248:251], v[160:163], v[56:59]
    ds_read_b64_tr_b16 a[216:217], v237 offset:49152
    buffer_load_dwordx4 v245, s[16:19], s32 offen offset:3072  lds
    v_mfma_f32_16x16x32_bf16 v[56:59], a[252:255], v[168:171], v[56:59]
    ds_read_b64_tr_b16 a[218:219], v237 offset:50176
    v_mfma_f32_16x16x32_bf16 v[60:63], a[248:251], v[164:167], v[60:63]
    ds_read_b64_tr_b16 a[220:221], v237 offset:57344
    buffer_load_dwordx4 v[148:151], v225, s[24:27], s38 offen offset:1024 sc1
    v_mfma_f32_16x16x32_bf16 v[60:63], a[252:255], v[172:175], v[60:63]
    ds_read_b64_tr_b16 a[222:223], v237 offset:58368
    s_waitcnt lgkmcnt(8)
    v_mfma_f32_16x16x32_bf16 v[64:67], a[192:195], v[160:163], v[64:67]
    ds_read_b64_tr_b16 a[224:225], v238 offset:49152
    v_mfma_f32_16x16x32_bf16 v[64:67], a[196:199], v[168:171], v[64:67]
    ds_read_b64_tr_b16 a[226:227], v238 offset:50176
    v_mfma_f32_16x16x32_bf16 v[68:71], a[192:195], v[164:167], v[68:71]
    ds_read_b64_tr_b16 a[228:229], v238 offset:57344
    v_mfma_f32_16x16x32_bf16 v[68:71], a[196:199], v[172:175], v[68:71]
    ds_read_b64_tr_b16 a[230:231], v238 offset:58368
    v_mfma_f32_16x16x32_bf16 v[72:75], a[200:203], v[160:163], v[72:75]
    ds_read_b64_tr_b16 a[232:233], v239 offset:49152
    v_mfma_f32_16x16x32_bf16 v[72:75], a[204:207], v[168:171], v[72:75]
    ds_read_b64_tr_b16 a[234:235], v239 offset:50176
    v_mfma_f32_16x16x32_bf16 v[76:79], a[200:203], v[164:167], v[76:79]
    ds_read_b64_tr_b16 a[236:237], v239 offset:57344
    v_mfma_f32_16x16x32_bf16 v[76:79], a[204:207], v[172:175], v[76:79]
    ds_read_b64_tr_b16 a[238:239], v239 offset:58368
    s_mov_b32 s33, 2621696
    s_waitcnt lgkmcnt(8)
    v_mfma_f32_16x16x32_bf16 v[80:83], a[208:211], v[160:163], v[80:83]
    ds_read_b64_tr_b16 a[240:241], v240 offset:49152
    s_add_u32 m0, s28, 81920
    v_mfma_f32_16x16x32_bf16 v[80:83], a[212:215], v[168:171], v[80:83]
    ds_read_b64_tr_b16 a[242:243], v240 offset:50176
    v_mfma_f32_16x16x32_bf16 v[84:87], a[208:211], v[164:167], v[84:87]
    ds_read_b64_tr_b16 a[244:245], v240 offset:57344
    buffer_load_dwordx4 v242, s[16:19], s33 offen offset:0  lds
    v_mfma_f32_16x16x32_bf16 v[84:87], a[212:215], v[172:175], v[84:87]
    ds_read_b64_tr_b16 a[246:247], v240 offset:58368
    v_mfma_f32_16x16x32_bf16 v[88:91], a[216:219], v[160:163], v[88:91]
    ds_read_b64_tr_b16 a[248:249], v241 offset:49152
    buffer_load_dwordx4 v243, s[16:19], s33 offen offset:1024  lds
    v_mfma_f32_16x16x32_bf16 v[88:91], a[220:223], v[168:171], v[88:91]
    ds_read_b64_tr_b16 a[250:251], v241 offset:50176
    v_mfma_f32_16x16x32_bf16 v[92:95], a[216:219], v[164:167], v[92:95]
    ds_read_b64_tr_b16 a[252:253], v241 offset:57344
    buffer_load_dwordx4 v[152:155], v225, s[24:27], s38 offen offset:2048 sc1
    v_mfma_f32_16x16x32_bf16 v[92:95], a[220:223], v[172:175], v[92:95]
    ds_read_b64_tr_b16 a[254:255], v241 offset:58368
    s_waitcnt lgkmcnt(8)
    v_mfma_f32_16x16x32_bf16 v[96:99], a[224:227], v[160:163], v[96:99]
    s_waitcnt vmcnt(9)
    s_barrier
    ds_read_b64_tr_b16 a[192:193], v226 offset:0
    v_mfma_f32_16x16x32_bf16 v[96:99], a[228:231], v[168:171], v[96:99]
    ds_read_b64_tr_b16 a[194:195], v226 offset:1024
    v_mfma_f32_16x16x32_bf16 v[100:103], a[224:227], v[164:167], v[100:103]
    ds_read_b64_tr_b16 a[196:197], v226 offset:8192
    v_mfma_f32_16x16x32_bf16 v[100:103], a[228:231], v[172:175], v[100:103]
    ds_read_b64_tr_b16 a[198:199], v226 offset:9216
    v_mfma_f32_16x16x32_bf16 v[104:107], a[232:235], v[160:163], v[104:107]
    ds_read_b64_tr_b16 a[200:201], v227 offset:0
    v_mfma_f32_16x16x32_bf16 v[104:107], a[236:239], v[168:171], v[104:107]
    ds_read_b64_tr_b16 a[202:203], v227 offset:1024
    v_mfma_f32_16x16x32_bf16 v[108:111], a[232:235], v[164:167], v[108:111]
    ds_read_b64_tr_b16 a[204:205], v227 offset:8192
    v_mfma_f32_16x16x32_bf16 v[108:111], a[236:239], v[172:175], v[108:111]
    ds_read_b64_tr_b16 a[206:207], v227 offset:9216
    s_waitcnt lgkmcnt(8)
    v_mfma_f32_16x16x32_bf16 v[112:115], a[240:243], v[160:163], v[112:115]
    ds_read_b64_tr_b16 a[208:209], v228 offset:0
    v_mfma_f32_16x16x32_bf16 v[112:115], a[244:247], v[168:171], v[112:115]
    ds_read_b64_tr_b16 a[210:211], v228 offset:1024
    v_mfma_f32_16x16x32_bf16 v[116:119], a[240:243], v[164:167], v[116:119]
    ds_read_b64_tr_b16 a[212:213], v228 offset:8192
    buffer_load_dwordx4 v244, s[16:19], s33 offen offset:2048  lds
    v_mfma_f32_16x16x32_bf16 v[116:119], a[244:247], v[172:175], v[116:119]
    ds_read_b64_tr_b16 a[214:215], v228 offset:9216
    v_mfma_f32_16x16x32_bf16 v[120:123], a[248:251], v[160:163], v[120:123]
    ds_read_b64_tr_b16 a[216:217], v229 offset:0
    buffer_load_dwordx4 v245, s[16:19], s33 offen offset:3072  lds
    v_mfma_f32_16x16x32_bf16 v[120:123], a[252:255], v[168:171], v[120:123]
    ds_read_b64_tr_b16 a[218:219], v229 offset:1024
    v_mfma_f32_16x16x32_bf16 v[124:127], a[248:251], v[164:167], v[124:127]
    ds_read_b64_tr_b16 a[220:221], v229 offset:8192
    buffer_load_dwordx4 v[156:159], v225, s[24:27], s38 offen offset:3072 sc1
    v_mfma_f32_16x16x32_bf16 v[124:127], a[252:255], v[172:175], v[124:127]
    ds_read_b64_tr_b16 a[222:223], v229 offset:9216
    s_waitcnt lgkmcnt(8)
    v_mfma_f32_16x16x32_bf16 v[0:3], a[192:195], v[176:179], v[0:3]
    ds_read_b64_tr_b16 a[224:225], v230 offset:0
    v_lshlrev_b32 v196, 16, v192
    v_mfma_f32_16x16x32_bf16 v[0:3], a[196:199], v[184:187], v[0:3]
    ds_read_b64_tr_b16 a[226:227], v230 offset:1024
    v_lshlrev_b32 v197, 16, v193
    v_mfma_f32_16x16x32_bf16 v[4:7], a[192:195], v[180:183], v[4:7]
    ds_read_b64_tr_b16 a[228:229], v230 offset:8192
    v_lshlrev_b32 v198, 16, v194
    v_mfma_f32_16x16x32_bf16 v[4:7], a[196:199], v[188:191], v[4:7]
    ds_read_b64_tr_b16 a[230:231], v230 offset:9216
    v_lshlrev_b32 v199, 16, v195
    v_mfma_f32_16x16x32_bf16 v[8:11], a[200:203], v[176:179], v[8:11]
    ds_read_b64_tr_b16 a[232:233], v231 offset:0
    v_max3_f32 v192, |v192|, |v193|, |v194|
    v_mfma_f32_16x16x32_bf16 v[8:11], a[204:207], v[184:187], v[8:11]
    ds_read_b64_tr_b16 a[234:235], v231 offset:1024
    v_max3_f32 v196, |v196|, |v197|, |v198|
    v_mfma_f32_16x16x32_bf16 v[12:15], a[200:203], v[180:183], v[12:15]
    ds_read_b64_tr_b16 a[236:237], v231 offset:8192
    s_add_u32 s38, s38, 4096
    v_max3_f32 v192, v192, |v195|, |v199|
    v_mfma_f32_16x16x32_bf16 v[12:15], a[204:207], v[188:191], v[12:15]
    ds_read_b64_tr_b16 a[238:239], v231 offset:9216
    s_mov_b32 s32, 3145728
    v_max_f32 v192, v192, v196
    s_waitcnt lgkmcnt(8)
    v_mfma_f32_16x16x32_bf16 v[16:19], a[208:211], v[176:179], v[16:19]
    ds_read_b64_tr_b16 a[240:241], v232 offset:0
    s_add_u32 m0, s28, 32768
    v_max_u32_dpp v192, v192, v192 row_ror:8 row_mask:0xf bank_mask:0xf
    v_mfma_f32_16x16x32_bf16 v[16:19], a[212:215], v[184:187], v[16:19]
    ds_read_b64_tr_b16 a[242:243], v232 offset:1024
    v_max_u32_dpp v192, v192, v192 row_ror:4 row_mask:0xf bank_mask:0xf
    v_mfma_f32_16x16x32_bf16 v[20:23], a[208:211], v[180:183], v[20:23]
    ds_read_b64_tr_b16 a[244:245], v232 offset:8192
    buffer_load_dwordx4 v242, s[16:19], s32 offen offset:0  lds
    v_max_u32_dpp v192, v192, v192 row_ror:2 row_mask:0xf bank_mask:0xf
    v_mfma_f32_16x16x32_bf16 v[20:23], a[212:215], v[188:191], v[20:23]
    ds_read_b64_tr_b16 a[246:247], v232 offset:9216
    v_max_u32_dpp v192, v192, v192 row_ror:1 row_mask:0xf bank_mask:0xf
    v_mfma_f32_16x16x32_bf16 v[24:27], a[216:219], v[176:179], v[24:27]
    ds_read_b64_tr_b16 a[248:249], v233 offset:0
    buffer_load_dwordx4 v243, s[16:19], s32 offen offset:1024  lds
    v_readlane_b32 s48, v192, 0
    v_mfma_f32_16x16x32_bf16 v[24:27], a[220:223], v[184:187], v[24:27]
    ds_read_b64_tr_b16 a[250:251], v233 offset:1024
    v_readlane_b32 s49, v192, 16
    v_mfma_f32_16x16x32_bf16 v[28:31], a[216:219], v[180:183], v[28:31]
    ds_read_b64_tr_b16 a[252:253], v233 offset:8192
    buffer_load_dwordx4 v[160:163], v225, s[24:27], s38 offen offset:0 sc1
    v_readlane_b32 s50, v192, 32
    v_mfma_f32_16x16x32_bf16 v[28:31], a[220:223], v[188:191], v[28:31]
    ds_read_b64_tr_b16 a[254:255], v233 offset:9216
    v_readlane_b32 s51, v192, 48
    s_waitcnt lgkmcnt(8)
    v_mfma_f32_16x16x32_bf16 v[32:35], a[224:227], v[176:179], v[32:35]
    ds_read_b64_tr_b16 a[192:193], v234 offset:0
    s_max_u32 s48, s48, s49
    v_mfma_f32_16x16x32_bf16 v[32:35], a[228:231], v[184:187], v[32:35]
    ds_read_b64_tr_b16 a[194:195], v234 offset:1024
    v_mfma_f32_16x16x32_bf16 v[36:39], a[224:227], v[180:183], v[36:39]
    ds_read_b64_tr_b16 a[196:197], v234 offset:8192
    s_max_u32 s50, s50, s51
    v_mfma_f32_16x16x32_bf16 v[36:39], a[228:231], v[188:191], v[36:39]
    ds_read_b64_tr_b16 a[198:199], v234 offset:9216
    v_mfma_f32_16x16x32_bf16 v[40:43], a[232:235], v[176:179], v[40:43]
    ds_read_b64_tr_b16 a[200:201], v235 offset:0
    s_max_u32 s48, s48, s50
    v_mfma_f32_16x16x32_bf16 v[40:43], a[236:239], v[184:187], v[40:43]
    ds_read_b64_tr_b16 a[202:203], v235 offset:1024
    v_mfma_f32_16x16x32_bf16 v[44:47], a[232:235], v[180:183], v[44:47]
    ds_read_b64_tr_b16 a[204:205], v235 offset:8192
    s_lshr_b32 s48, s48, 23
    v_mfma_f32_16x16x32_bf16 v[44:47], a[236:239], v[188:191], v[44:47]
    ds_read_b64_tr_b16 a[206:207], v235 offset:9216
    s_waitcnt lgkmcnt(8)
    v_mfma_f32_16x16x32_bf16 v[48:51], a[240:243], v[176:179], v[48:51]
    ds_read_b64_tr_b16 a[208:209], v236 offset:0
    s_min_u32 s48, s48, 127
    v_mfma_f32_16x16x32_bf16 v[48:51], a[244:247], v[184:187], v[48:51]
    ds_read_b64_tr_b16 a[210:211], v236 offset:1024
    v_mfma_f32_16x16x32_bf16 v[52:55], a[240:243], v[180:183], v[52:55]
    ds_read_b64_tr_b16 a[212:213], v236 offset:8192
    buffer_load_dwordx4 v244, s[16:19], s32 offen offset:2048  lds
    s_max_u32 s48, s48, 29
    v_mfma_f32_16x16x32_bf16 v[52:55], a[244:247], v[188:191], v[52:55]
    ds_read_b64_tr_b16 a[214:215], v236 offset:9216
    v_mfma_f32_16x16x32_bf16 v[56:59], a[248:251], v[176:179], v[56:59]
    ds_read_b64_tr_b16 a[216:217], v237 offset:0
    buffer_load_dwordx4 v245, s[16:19], s32 offen offset:3072  lds
    s_sub_u32 s48, 232, s48
    v_mfma_f32_16x16x32_bf16 v[56:59], a[252:255], v[184:187], v[56:59]
    ds_read_b64_tr_b16 a[218:219], v237 offset:1024
    v_mfma_f32_16x16x32_bf16 v[60:63], a[248:251], v[180:183], v[60:63]
    ds_read_b64_tr_b16 a[220:221], v237 offset:8192
    buffer_load_dwordx4 v[164:167], v225, s[24:27], s38 offen offset:1024 sc1
    s_lshl_b32 s34, s48, 23
    v_mfma_f32_16x16x32_bf16 v[60:63], a[252:255], v[188:191], v[60:63]
    ds_read_b64_tr_b16 a[222:223], v237 offset:9216
    s_waitcnt lgkmcnt(8)
    v_mfma_f32_16x16x32_bf16 v[64:67], a[192:195], v[176:179], v[64:67]
    ds_read_b64_tr_b16 a[224:225], v238 offset:0
    v_mfma_f32_16x16x32_bf16 v[64:67], a[196:199], v[184:187], v[64:67]
    ds_read_b64_tr_b16 a[226:227], v238 offset:1024
    v_mfma_f32_16x16x32_bf16 v[68:71], a[192:195], v[180:183], v[68:71]
    ds_read_b64_tr_b16 a[228:229], v238 offset:8192
    v_mfma_f32_16x16x32_bf16 v[68:71], a[196:199], v[188:191], v[68:71]
    ds_read_b64_tr_b16 a[230:231], v238 offset:9216
    v_mfma_f32_16x16x32_bf16 v[72:75], a[200:203], v[176:179], v[72:75]
    ds_read_b64_tr_b16 a[232:233], v239 offset:0
    v_mfma_f32_16x16x32_bf16 v[72:75], a[204:207], v[184:187], v[72:75]
    ds_read_b64_tr_b16 a[234:235], v239 offset:1024
    v_mfma_f32_16x16x32_bf16 v[76:79], a[200:203], v[180:183], v[76:79]
    ds_read_b64_tr_b16 a[236:237], v239 offset:8192
    v_mfma_f32_16x16x32_bf16 v[76:79], a[204:207], v[188:191], v[76:79]
    ds_read_b64_tr_b16 a[238:239], v239 offset:9216
    s_mov_b32 s33, 3145984
    s_waitcnt lgkmcnt(8)
    v_mfma_f32_16x16x32_bf16 v[80:83], a[208:211], v[176:179], v[80:83]
    ds_read_b64_tr_b16 a[240:241], v240 offset:0
    s_add_u32 m0, s28, 98304
    v_mfma_f32_16x16x32_bf16 v[80:83], a[212:215], v[184:187], v[80:83]
    ds_read_b64_tr_b16 a[242:243], v240 offset:1024
    v_mfma_f32_16x16x32_bf16 v[84:87], a[208:211], v[180:183], v[84:87]
    ds_read_b64_tr_b16 a[244:245], v240 offset:8192
    buffer_load_dwordx4 v242, s[16:19], s33 offen offset:0  lds
    v_mfma_f32_16x16x32_bf16 v[84:87], a[212:215], v[188:191], v[84:87]
    ds_read_b64_tr_b16 a[246:247], v240 offset:9216
    v_mfma_f32_16x16x32_bf16 v[88:91], a[216:219], v[176:179], v[88:91]
    ds_read_b64_tr_b16 a[248:249], v241 offset:0
    buffer_load_dwordx4 v243, s[16:19], s33 offen offset:1024  lds
    v_mfma_f32_16x16x32_bf16 v[88:91], a[220:223], v[184:187], v[88:91]
    ds_read_b64_tr_b16 a[250:251], v241 offset:1024
    v_mfma_f32_16x16x32_bf16 v[92:95], a[216:219], v[180:183], v[92:95]
    ds_read_b64_tr_b16 a[252:253], v241 offset:8192
    buffer_load_dwordx4 v[168:171], v225, s[24:27], s38 offen offset:2048 sc1
    v_mfma_f32_16x16x32_bf16 v[92:95], a[220:223], v[188:191], v[92:95]
    ds_read_b64_tr_b16 a[254:255], v241 offset:9216
    s_waitcnt lgkmcnt(8)
    v_mfma_f32_16x16x32_bf16 v[96:99], a[224:227], v[176:179], v[96:99]
    s_waitcnt vmcnt(9)
    s_barrier
    ds_read_b64_tr_b16 a[192:193], v226 offset:16384
    v_mfma_f32_16x16x32_bf16 v[96:99], a[228:231], v[184:187], v[96:99]
    ds_read_b64_tr_b16 a[194:195], v226 offset:17408
    v_mfma_f32_16x16x32_bf16 v[100:103], a[224:227], v[180:183], v[100:103]
    ds_read_b64_tr_b16 a[196:197], v226 offset:24576
    v_mfma_f32_16x16x32_bf16 v[100:103], a[228:231], v[188:191], v[100:103]
    ds_read_b64_tr_b16 a[198:199], v226 offset:25600
    v_mfma_f32_16x16x32_bf16 v[104:107], a[232:235], v[176:179], v[104:107]
    ds_read_b64_tr_b16 a[200:201], v227 offset:16384
    v_mfma_f32_16x16x32_bf16 v[104:107], a[236:239], v[184:187], v[104:107]
    ds_read_b64_tr_b16 a[202:203], v227 offset:17408
    v_mfma_f32_16x16x32_bf16 v[108:111], a[232:235], v[180:183], v[108:111]
    ds_read_b64_tr_b16 a[204:205], v227 offset:24576
    v_mfma_f32_16x16x32_bf16 v[108:111], a[236:239], v[188:191], v[108:111]
    ds_read_b64_tr_b16 a[206:207], v227 offset:25600
    s_waitcnt lgkmcnt(8)
    v_mfma_f32_16x16x32_bf16 v[112:115], a[240:243], v[176:179], v[112:115]
    ds_read_b64_tr_b16 a[208:209], v228 offset:16384
    v_mfma_f32_16x16x32_bf16 v[112:115], a[244:247], v[184:187], v[112:115]
    ds_read_b64_tr_b16 a[210:211], v228 offset:17408
    v_mfma_f32_16x16x32_bf16 v[116:119], a[240:243], v[180:183], v[116:119]
    ds_read_b64_tr_b16 a[212:213], v228 offset:24576
    buffer_load_dwordx4 v244, s[16:19], s33 offen offset:2048  lds
    v_mfma_f32_16x16x32_bf16 v[116:119], a[244:247], v[188:191], v[116:119]
    ds_read_b64_tr_b16 a[214:215], v228 offset:25600
    v_mfma_f32_16x16x32_bf16 v[120:123], a[248:251], v[176:179], v[120:123]
    ds_read_b64_tr_b16 a[216:217], v229 offset:16384
    buffer_load_dwordx4 v245, s[16:19], s33 offen offset:3072  lds
    v_mfma_f32_16x16x32_bf16 v[120:123], a[252:255], v[184:187], v[120:123]
    ds_read_b64_tr_b16 a[218:219], v229 offset:17408
    v_mfma_f32_16x16x32_bf16 v[124:127], a[248:251], v[180:183], v[124:127]
    ds_read_b64_tr_b16 a[220:221], v229 offset:24576
    buffer_load_dwordx4 v[172:175], v225, s[24:27], s38 offen offset:3072 sc1
    v_mfma_f32_16x16x32_bf16 v[124:127], a[252:255], v[188:191], v[124:127]
    ds_read_b64_tr_b16 a[222:223], v229 offset:25600
    s_waitcnt lgkmcnt(8)
    v_mfma_f32_16x16x32_bf16 v[0:3], a[192:195], v[128:131], v[0:3]
    ds_read_b64_tr_b16 a[224:225], v230 offset:16384
    v_mfma_f32_16x16x32_bf16 v[0:3], a[196:199], v[136:139], v[0:3]
    ds_read_b64_tr_b16 a[226:227], v230 offset:17408
    v_mfma_f32_16x16x32_bf16 v[4:7], a[192:195], v[132:135], v[4:7]
    ds_read_b64_tr_b16 a[228:229], v230 offset:24576
    v_mfma_f32_16x16x32_bf16 v[4:7], a[196:199], v[140:143], v[4:7]
    ds_read_b64_tr_b16 a[230:231], v230 offset:25600
    v_mfma_f32_16x16x32_bf16 v[8:11], a[200:203], v[128:131], v[8:11]
    ds_read_b64_tr_b16 a[232:233], v231 offset:16384
    v_mfma_f32_16x16x32_bf16 v[8:11], a[204:207], v[136:139], v[8:11]
    ds_read_b64_tr_b16 a[234:235], v231 offset:17408
    v_mfma_f32_16x16x32_bf16 v[12:15], a[200:203], v[132:135], v[12:15]
    ds_read_b64_tr_b16 a[236:237], v231 offset:24576
    s_add_u32 s38, s38, 4096
    v_mfma_f32_16x16x32_bf16 v[12:15], a[204:207], v[140:143], v[12:15]
    ds_read_b64_tr_b16 a[238:239], v231 offset:25600
    s_mov_b32 s32, 3670016
    s_waitcnt lgkmcnt(8)
    v_mfma_f32_16x16x32_bf16 v[16:19], a[208:211], v[128:131], v[16:19]
    ds_read_b64_tr_b16 a[240:241], v232 offset:16384
    s_add_u32 m0, s28, 49152
    v_mfma_f32_16x16x32_bf16 v[16:19], a[212:215], v[136:139], v[16:19]
    ds_read_b64_tr_b16 a[242:243], v232 offset:17408
    v_mfma_f32_16x16x32_bf16 v[20:23], a[208:211], v[132:135], v[20:23]
    ds_read_b64_tr_b16 a[244:245], v232 offset:24576
    buffer_load_dwordx4 v242, s[16:19], s32 offen offset:0  lds
    v_mfma_f32_16x16x32_bf16 v[20:23], a[212:215], v[140:143], v[20:23]
    ds_read_b64_tr_b16 a[246:247], v232 offset:25600
    v_mfma_f32_16x16x32_bf16 v[24:27], a[216:219], v[128:131], v[24:27]
    ds_read_b64_tr_b16 a[248:249], v233 offset:16384
    buffer_load_dwordx4 v243, s[16:19], s32 offen offset:1024  lds
    v_mfma_f32_16x16x32_bf16 v[24:27], a[220:223], v[136:139], v[24:27]
    ds_read_b64_tr_b16 a[250:251], v233 offset:17408
    v_mfma_f32_16x16x32_bf16 v[28:31], a[216:219], v[132:135], v[28:31]
    ds_read_b64_tr_b16 a[252:253], v233 offset:24576
    buffer_load_dwordx4 v[176:179], v225, s[24:27], s38 offen offset:0 sc1
    v_mfma_f32_16x16x32_bf16 v[28:31], a[220:223], v[140:143], v[28:31]
    ds_read_b64_tr_b16 a[254:255], v233 offset:25600
    s_waitcnt lgkmcnt(8)
    v_mfma_f32_16x16x32_bf16 v[32:35], a[224:227], v[128:131], v[32:35]
    ds_read_b64_tr_b16 a[192:193], v234 offset:16384
    v_mfma_f32_16x16x32_bf16 v[32:35], a[228:231], v[136:139], v[32:35]
    ds_read_b64_tr_b16 a[194:195], v234 offset:17408
    v_mfma_f32_16x16x32_bf16 v[36:39], a[224:227], v[132:135], v[36:39]
    ds_read_b64_tr_b16 a[196:197], v234 offset:24576
    v_mfma_f32_16x16x32_bf16 v[36:39], a[228:231], v[140:143], v[36:39]
    ds_read_b64_tr_b16 a[198:199], v234 offset:25600
    v_mfma_f32_16x16x32_bf16 v[40:43], a[232:235], v[128:131], v[40:43]
    ds_read_b64_tr_b16 a[200:201], v235 offset:16384
    v_mfma_f32_16x16x32_bf16 v[40:43], a[236:239], v[136:139], v[40:43]
    ds_read_b64_tr_b16 a[202:203], v235 offset:17408
    v_mfma_f32_16x16x32_bf16 v[44:47], a[232:235], v[132:135], v[44:47]
    ds_read_b64_tr_b16 a[204:205], v235 offset:24576
    v_mfma_f32_16x16x32_bf16 v[44:47], a[236:239], v[140:143], v[44:47]
    ds_read_b64_tr_b16 a[206:207], v235 offset:25600
    s_waitcnt lgkmcnt(8)
    v_mfma_f32_16x16x32_bf16 v[48:51], a[240:243], v[128:131], v[48:51]
    ds_read_b64_tr_b16 a[208:209], v236 offset:16384
    v_mfma_f32_16x16x32_bf16 v[48:51], a[244:247], v[136:139], v[48:51]
    ds_read_b64_tr_b16 a[210:211], v236 offset:17408
    v_mfma_f32_16x16x32_bf16 v[52:55], a[240:243], v[132:135], v[52:55]
    ds_read_b64_tr_b16 a[212:213], v236 offset:24576
    buffer_load_dwordx4 v244, s[16:19], s32 offen offset:2048  lds
    v_mfma_f32_16x16x32_bf16 v[52:55], a[244:247], v[140:143], v[52:55]
    ds_read_b64_tr_b16 a[214:215], v236 offset:25600
    v_mfma_f32_16x16x32_bf16 v[56:59], a[248:251], v[128:131], v[56:59]
    ds_read_b64_tr_b16 a[216:217], v237 offset:16384
    buffer_load_dwordx4 v245, s[16:19], s32 offen offset:3072  lds
    v_mfma_f32_16x16x32_bf16 v[56:59], a[252:255], v[136:139], v[56:59]
    ds_read_b64_tr_b16 a[218:219], v237 offset:17408
    v_mfma_f32_16x16x32_bf16 v[60:63], a[248:251], v[132:135], v[60:63]
    ds_read_b64_tr_b16 a[220:221], v237 offset:24576
    buffer_load_dwordx4 v[180:183], v225, s[24:27], s38 offen offset:1024 sc1
    v_mfma_f32_16x16x32_bf16 v[60:63], a[252:255], v[140:143], v[60:63]
    ds_read_b64_tr_b16 a[222:223], v237 offset:25600
    s_waitcnt lgkmcnt(8)
    v_mfma_f32_16x16x32_bf16 v[64:67], a[192:195], v[128:131], v[64:67]
    ds_read_b64_tr_b16 a[224:225], v238 offset:16384
    v_mfma_f32_16x16x32_bf16 v[64:67], a[196:199], v[136:139], v[64:67]
    ds_read_b64_tr_b16 a[226:227], v238 offset:17408
    v_mfma_f32_16x16x32_bf16 v[68:71], a[192:195], v[132:135], v[68:71]
    ds_read_b64_tr_b16 a[228:229], v238 offset:24576
    v_mfma_f32_16x16x32_bf16 v[68:71], a[196:199], v[140:143], v[68:71]
    ds_read_b64_tr_b16 a[230:231], v238 offset:25600
    v_mfma_f32_16x16x32_bf16 v[72:75], a[200:203], v[128:131], v[72:75]
    ds_read_b64_tr_b16 a[232:233], v239 offset:16384
    v_mfma_f32_16x16x32_bf16 v[72:75], a[204:207], v[136:139], v[72:75]
    ds_read_b64_tr_b16 a[234:235], v239 offset:17408
    v_mfma_f32_16x16x32_bf16 v[76:79], a[200:203], v[132:135], v[76:79]
    ds_read_b64_tr_b16 a[236:237], v239 offset:24576
    v_mfma_f32_16x16x32_bf16 v[76:79], a[204:207], v[140:143], v[76:79]
    ds_read_b64_tr_b16 a[238:239], v239 offset:25600
    s_mov_b32 s33, 3670272
    s_waitcnt lgkmcnt(8)
    v_mfma_f32_16x16x32_bf16 v[80:83], a[208:211], v[128:131], v[80:83]
    ds_read_b64_tr_b16 a[240:241], v240 offset:16384
    s_add_u32 m0, s28, 114688
    v_mfma_f32_16x16x32_bf16 v[80:83], a[212:215], v[136:139], v[80:83]
    ds_read_b64_tr_b16 a[242:243], v240 offset:17408
    v_mfma_f32_16x16x32_bf16 v[84:87], a[208:211], v[132:135], v[84:87]
    ds_read_b64_tr_b16 a[244:245], v240 offset:24576
    buffer_load_dwordx4 v242, s[16:19], s33 offen offset:0  lds
    v_mfma_f32_16x16x32_bf16 v[84:87], a[212:215], v[140:143], v[84:87]
    ds_read_b64_tr_b16 a[246:247], v240 offset:25600
    v_mfma_f32_16x16x32_bf16 v[88:91], a[216:219], v[128:131], v[88:91]
    ds_read_b64_tr_b16 a[248:249], v241 offset:16384
    buffer_load_dwordx4 v243, s[16:19], s33 offen offset:1024  lds
    v_mfma_f32_16x16x32_bf16 v[88:91], a[220:223], v[136:139], v[88:91]
    ds_read_b64_tr_b16 a[250:251], v241 offset:17408
    v_mfma_f32_16x16x32_bf16 v[92:95], a[216:219], v[132:135], v[92:95]
    ds_read_b64_tr_b16 a[252:253], v241 offset:24576
    buffer_load_dwordx4 v[184:187], v225, s[24:27], s38 offen offset:2048 sc1
    v_mfma_f32_16x16x32_bf16 v[92:95], a[220:223], v[140:143], v[92:95]
    ds_read_b64_tr_b16 a[254:255], v241 offset:25600
    s_waitcnt lgkmcnt(8)
    v_mfma_f32_16x16x32_bf16 v[96:99], a[224:227], v[128:131], v[96:99]
    s_waitcnt vmcnt(9)
    s_barrier
    ds_read_b64_tr_b16 a[192:193], v226 offset:32768
    v_mfma_f32_16x16x32_bf16 v[96:99], a[228:231], v[136:139], v[96:99]
    ds_read_b64_tr_b16 a[194:195], v226 offset:33792
    v_mfma_f32_16x16x32_bf16 v[100:103], a[224:227], v[132:135], v[100:103]
    ds_read_b64_tr_b16 a[196:197], v226 offset:40960
    v_mfma_f32_16x16x32_bf16 v[100:103], a[228:231], v[140:143], v[100:103]
    ds_read_b64_tr_b16 a[198:199], v226 offset:41984
    v_mfma_f32_16x16x32_bf16 v[104:107], a[232:235], v[128:131], v[104:107]
    ds_read_b64_tr_b16 a[200:201], v227 offset:32768
    v_mfma_f32_16x16x32_bf16 v[104:107], a[236:239], v[136:139], v[104:107]
    ds_read_b64_tr_b16 a[202:203], v227 offset:33792
    v_mfma_f32_16x16x32_bf16 v[108:111], a[232:235], v[132:135], v[108:111]
    ds_read_b64_tr_b16 a[204:205], v227 offset:40960
    v_mfma_f32_16x16x32_bf16 v[108:111], a[236:239], v[140:143], v[108:111]
    ds_read_b64_tr_b16 a[206:207], v227 offset:41984
    s_waitcnt lgkmcnt(8)
    v_mfma_f32_16x16x32_bf16 v[112:115], a[240:243], v[128:131], v[112:115]
    ds_read_b64_tr_b16 a[208:209], v228 offset:32768
    v_mfma_f32_16x16x32_bf16 v[112:115], a[244:247], v[136:139], v[112:115]
    ds_read_b64_tr_b16 a[210:211], v228 offset:33792
    v_mfma_f32_16x16x32_bf16 v[116:119], a[240:243], v[132:135], v[116:119]
    ds_read_b64_tr_b16 a[212:213], v228 offset:40960
    buffer_load_dwordx4 v244, s[16:19], s33 offen offset:2048  lds
    v_mfma_f32_16x16x32_bf16 v[116:119], a[244:247], v[140:143], v[116:119]
    ds_read_b64_tr_b16 a[214:215], v228 offset:41984
    v_mfma_f32_16x16x32_bf16 v[120:123], a[248:251], v[128:131], v[120:123]
    ds_read_b64_tr_b16 a[216:217], v229 offset:32768
    buffer_load_dwordx4 v245, s[16:19], s33 offen offset:3072  lds
    v_mfma_f32_16x16x32_bf16 v[120:123], a[252:255], v[136:139], v[120:123]
    ds_read_b64_tr_b16 a[218:219], v229 offset:33792
    v_mfma_f32_16x16x32_bf16 v[124:127], a[248:251], v[132:135], v[124:127]
    ds_read_b64_tr_b16 a[220:221], v229 offset:40960
    buffer_load_dwordx4 v[188:191], v225, s[24:27], s38 offen offset:3072 sc1
    v_mfma_f32_16x16x32_bf16 v[124:127], a[252:255], v[140:143], v[124:127]
    ds_read_b64_tr_b16 a[222:223], v229 offset:41984
    s_waitcnt lgkmcnt(8)
    v_mfma_f32_16x16x32_bf16 v[0:3], a[192:195], v[144:147], v[0:3]
    ds_read_b64_tr_b16 a[224:225], v230 offset:32768
    v_mfma_f32_16x16x32_bf16 v[0:3], a[196:199], v[152:155], v[0:3]
    ds_read_b64_tr_b16 a[226:227], v230 offset:33792
    v_mfma_f32_16x16x32_bf16 v[4:7], a[192:195], v[148:151], v[4:7]
    ds_read_b64_tr_b16 a[228:229], v230 offset:40960
    v_mfma_f32_16x16x32_bf16 v[4:7], a[196:199], v[156:159], v[4:7]
    ds_read_b64_tr_b16 a[230:231], v230 offset:41984
    v_mfma_f32_16x16x32_bf16 v[8:11], a[200:203], v[144:147], v[8:11]
    ds_read_b64_tr_b16 a[232:233], v231 offset:32768
    v_mfma_f32_16x16x32_bf16 v[8:11], a[204:207], v[152:155], v[8:11]
    ds_read_b64_tr_b16 a[234:235], v231 offset:33792
    v_mfma_f32_16x16x32_bf16 v[12:15], a[200:203], v[148:151], v[12:15]
    ds_read_b64_tr_b16 a[236:237], v231 offset:40960
    v_mfma_f32_16x16x32_bf16 v[12:15], a[204:207], v[156:159], v[12:15]
    ds_read_b64_tr_b16 a[238:239], v231 offset:41984
    s_mov_b32 s32, 4194304
    s_waitcnt lgkmcnt(8)
    v_mfma_f32_16x16x32_bf16 v[16:19], a[208:211], v[144:147], v[16:19]
    ds_read_b64_tr_b16 a[240:241], v232 offset:32768
    s_add_u32 m0, s28, 0
    v_mfma_f32_16x16x32_bf16 v[16:19], a[212:215], v[152:155], v[16:19]
    ds_read_b64_tr_b16 a[242:243], v232 offset:33792
    v_mfma_f32_16x16x32_bf16 v[20:23], a[208:211], v[148:151], v[20:23]
    ds_read_b64_tr_b16 a[244:245], v232 offset:40960
    buffer_load_dwordx4 v242, s[16:19], s32 offen offset:0  lds
    v_mfma_f32_16x16x32_bf16 v[20:23], a[212:215], v[156:159], v[20:23]
    ds_read_b64_tr_b16 a[246:247], v232 offset:41984
    v_mfma_f32_16x16x32_bf16 v[24:27], a[216:219], v[144:147], v[24:27]
    ds_read_b64_tr_b16 a[248:249], v233 offset:32768
    buffer_load_dwordx4 v243, s[16:19], s32 offen offset:1024  lds
    v_mfma_f32_16x16x32_bf16 v[24:27], a[220:223], v[152:155], v[24:27]
    ds_read_b64_tr_b16 a[250:251], v233 offset:33792
    v_mfma_f32_16x16x32_bf16 v[28:31], a[216:219], v[148:151], v[28:31]
    ds_read_b64_tr_b16 a[252:253], v233 offset:40960
    v_mfma_f32_16x16x32_bf16 v[28:31], a[220:223], v[156:159], v[28:31]
    ds_read_b64_tr_b16 a[254:255], v233 offset:41984
    s_waitcnt lgkmcnt(8)
    v_mfma_f32_16x16x32_bf16 v[32:35], a[224:227], v[144:147], v[32:35]
    ds_read_b64_tr_b16 a[192:193], v234 offset:32768
    v_mfma_f32_16x16x32_bf16 v[32:35], a[228:231], v[152:155], v[32:35]
    ds_read_b64_tr_b16 a[194:195], v234 offset:33792
    v_mfma_f32_16x16x32_bf16 v[36:39], a[224:227], v[148:151], v[36:39]
    ds_read_b64_tr_b16 a[196:197], v234 offset:40960
    v_mfma_f32_16x16x32_bf16 v[36:39], a[228:231], v[156:159], v[36:39]
    ds_read_b64_tr_b16 a[198:199], v234 offset:41984
    v_mfma_f32_16x16x32_bf16 v[40:43], a[232:235], v[144:147], v[40:43]
    ds_read_b64_tr_b16 a[200:201], v235 offset:32768
    v_mfma_f32_16x16x32_bf16 v[40:43], a[236:239], v[152:155], v[40:43]
    ds_read_b64_tr_b16 a[202:203], v235 offset:33792
    v_mfma_f32_16x16x32_bf16 v[44:47], a[232:235], v[148:151], v[44:47]
    ds_read_b64_tr_b16 a[204:205], v235 offset:40960
    v_mfma_f32_16x16x32_bf16 v[44:47], a[236:239], v[156:159], v[44:47]
    ds_read_b64_tr_b16 a[206:207], v235 offset:41984
    s_waitcnt lgkmcnt(8)
    v_mfma_f32_16x16x32_bf16 v[48:51], a[240:243], v[144:147], v[48:51]
    ds_read_b64_tr_b16 a[208:209], v236 offset:32768
    v_mfma_f32_16x16x32_bf16 v[48:51], a[244:247], v[152:155], v[48:51]
    ds_read_b64_tr_b16 a[210:211], v236 offset:33792
    v_mfma_f32_16x16x32_bf16 v[52:55], a[240:243], v[148:151], v[52:55]
    ds_read_b64_tr_b16 a[212:213], v236 offset:40960
    buffer_load_dwordx4 v244, s[16:19], s32 offen offset:2048  lds
    v_mfma_f32_16x16x32_bf16 v[52:55], a[244:247], v[156:159], v[52:55]
    ds_read_b64_tr_b16 a[214:215], v236 offset:41984
    v_mfma_f32_16x16x32_bf16 v[56:59], a[248:251], v[144:147], v[56:59]
    ds_read_b64_tr_b16 a[216:217], v237 offset:32768
    buffer_load_dwordx4 v245, s[16:19], s32 offen offset:3072  lds
    v_mfma_f32_16x16x32_bf16 v[56:59], a[252:255], v[152:155], v[56:59]
    ds_read_b64_tr_b16 a[218:219], v237 offset:33792
    v_mfma_f32_16x16x32_bf16 v[60:63], a[248:251], v[148:151], v[60:63]
    ds_read_b64_tr_b16 a[220:221], v237 offset:40960
    v_mfma_f32_16x16x32_bf16 v[60:63], a[252:255], v[156:159], v[60:63]
    ds_read_b64_tr_b16 a[222:223], v237 offset:41984
    s_waitcnt lgkmcnt(8)
    v_mfma_f32_16x16x32_bf16 v[64:67], a[192:195], v[144:147], v[64:67]
    ds_read_b64_tr_b16 a[224:225], v238 offset:32768
    v_mfma_f32_16x16x32_bf16 v[64:67], a[196:199], v[152:155], v[64:67]
    ds_read_b64_tr_b16 a[226:227], v238 offset:33792
    v_mfma_f32_16x16x32_bf16 v[68:71], a[192:195], v[148:151], v[68:71]
    ds_read_b64_tr_b16 a[228:229], v238 offset:40960
    v_mfma_f32_16x16x32_bf16 v[68:71], a[196:199], v[156:159], v[68:71]
    ds_read_b64_tr_b16 a[230:231], v238 offset:41984
    v_mfma_f32_16x16x32_bf16 v[72:75], a[200:203], v[144:147], v[72:75]
    ds_read_b64_tr_b16 a[232:233], v239 offset:32768
    v_mfma_f32_16x16x32_bf16 v[72:75], a[204:207], v[152:155], v[72:75]
    ds_read_b64_tr_b16 a[234:235], v239 offset:33792
    v_mfma_f32_16x16x32_bf16 v[76:79], a[200:203], v[148:151], v[76:79]
    ds_read_b64_tr_b16 a[236:237], v239 offset:40960
    v_mfma_f32_16x16x32_bf16 v[76:79], a[204:207], v[156:159], v[76:79]
    ds_read_b64_tr_b16 a[238:239], v239 offset:41984
    s_mov_b32 s33, 4194560
    s_waitcnt lgkmcnt(8)
    v_mfma_f32_16x16x32_bf16 v[80:83], a[208:211], v[144:147], v[80:83]
    ds_read_b64_tr_b16 a[240:241], v240 offset:32768
    s_add_u32 m0, s28, 65536
    v_mfma_f32_16x16x32_bf16 v[80:83], a[212:215], v[152:155], v[80:83]
    ds_read_b64_tr_b16 a[242:243], v240 offset:33792
    v_mfma_f32_16x16x32_bf16 v[84:87], a[208:211], v[148:151], v[84:87]
    ds_read_b64_tr_b16 a[244:245], v240 offset:40960
    buffer_load_dwordx4 v242, s[16:19], s33 offen offset:0  lds
    v_mfma_f32_16x16x32_bf16 v[84:87], a[212:215], v[156:159], v[84:87]
    ds_read_b64_tr_b16 a[246:247], v240 offset:41984
    v_mfma_f32_16x16x32_bf16 v[88:91], a[216:219], v[144:147], v[88:91]
    ds_read_b64_tr_b16 a[248:249], v241 offset:32768
    buffer_load_dwordx4 v243, s[16:19], s33 offen offset:1024  lds
    v_mfma_f32_16x16x32_bf16 v[88:91], a[220:223], v[152:155], v[88:91]
    ds_read_b64_tr_b16 a[250:251], v241 offset:33792
    v_mfma_f32_16x16x32_bf16 v[92:95], a[216:219], v[148:151], v[92:95]
    ds_read_b64_tr_b16 a[252:253], v241 offset:40960
    v_mfma_f32_16x16x32_bf16 v[92:95], a[220:223], v[156:159], v[92:95]
    ds_read_b64_tr_b16 a[254:255], v241 offset:41984
    s_waitcnt lgkmcnt(8)
    v_mfma_f32_16x16x32_bf16 v[96:99], a[224:227], v[144:147], v[96:99]
    s_waitcnt vmcnt(6)
    s_barrier
    ds_read_b64_tr_b16 a[192:193], v226 offset:49152
    v_mfma_f32_16x16x32_bf16 v[96:99], a[228:231], v[152:155], v[96:99]
    ds_read_b64_tr_b16 a[194:195], v226 offset:50176
    v_mfma_f32_16x16x32_bf16 v[100:103], a[224:227], v[148:151], v[100:103]
    ds_read_b64_tr_b16 a[196:197], v226 offset:57344
    v_mfma_f32_16x16x32_bf16 v[100:103], a[228:231], v[156:159], v[100:103]
    ds_read_b64_tr_b16 a[198:199], v226 offset:58368
    v_mfma_f32_16x16x32_bf16 v[104:107], a[232:235], v[144:147], v[104:107]
    ds_read_b64_tr_b16 a[200:201], v227 offset:49152
    v_mfma_f32_16x16x32_bf16 v[104:107], a[236:239], v[152:155], v[104:107]
    ds_read_b64_tr_b16 a[202:203], v227 offset:50176
    v_mfma_f32_16x16x32_bf16 v[108:111], a[232:235], v[148:151], v[108:111]
    ds_read_b64_tr_b16 a[204:205], v227 offset:57344
    v_mfma_f32_16x16x32_bf16 v[108:111], a[236:239], v[156:159], v[108:111]
    ds_read_b64_tr_b16 a[206:207], v227 offset:58368
    s_waitcnt lgkmcnt(8)
    v_mfma_f32_16x16x32_bf16 v[112:115], a[240:243], v[144:147], v[112:115]
    ds_read_b64_tr_b16 a[208:209], v228 offset:49152
    v_mfma_f32_16x16x32_bf16 v[112:115], a[244:247], v[152:155], v[112:115]
    ds_read_b64_tr_b16 a[210:211], v228 offset:50176
    v_mfma_f32_16x16x32_bf16 v[116:119], a[240:243], v[148:151], v[116:119]
    ds_read_b64_tr_b16 a[212:213], v228 offset:57344
    buffer_load_dwordx4 v244, s[16:19], s33 offen offset:2048  lds
    v_mfma_f32_16x16x32_bf16 v[116:119], a[244:247], v[156:159], v[116:119]
    ds_read_b64_tr_b16 a[214:215], v228 offset:58368
    v_mfma_f32_16x16x32_bf16 v[120:123], a[248:251], v[144:147], v[120:123]
    ds_read_b64_tr_b16 a[216:217], v229 offset:49152
    buffer_load_dwordx4 v245, s[16:19], s33 offen offset:3072  lds
    v_mfma_f32_16x16x32_bf16 v[120:123], a[252:255], v[152:155], v[120:123]
    ds_read_b64_tr_b16 a[218:219], v229 offset:50176
    v_mfma_f32_16x16x32_bf16 v[124:127], a[248:251], v[148:151], v[124:127]
    ds_read_b64_tr_b16 a[220:221], v229 offset:57344
    v_mfma_f32_16x16x32_bf16 v[124:127], a[252:255], v[156:159], v[124:127]
    ds_read_b64_tr_b16 a[222:223], v229 offset:58368
    s_waitcnt lgkmcnt(8)
    v_mfma_f32_16x16x32_bf16 v[0:3], a[192:195], v[160:163], v[0:3]
    ds_read_b64_tr_b16 a[224:225], v230 offset:49152
    v_mfma_f32_16x16x32_bf16 v[0:3], a[196:199], v[168:171], v[0:3]
    ds_read_b64_tr_b16 a[226:227], v230 offset:50176
    v_mfma_f32_16x16x32_bf16 v[4:7], a[192:195], v[164:167], v[4:7]
    ds_read_b64_tr_b16 a[228:229], v230 offset:57344
    v_mfma_f32_16x16x32_bf16 v[4:7], a[196:199], v[172:175], v[4:7]
    ds_read_b64_tr_b16 a[230:231], v230 offset:58368
    v_mfma_f32_16x16x32_bf16 v[8:11], a[200:203], v[160:163], v[8:11]
    ds_read_b64_tr_b16 a[232:233], v231 offset:49152
    v_mfma_f32_16x16x32_bf16 v[8:11], a[204:207], v[168:171], v[8:11]
    ds_read_b64_tr_b16 a[234:235], v231 offset:50176
    v_mfma_f32_16x16x32_bf16 v[12:15], a[200:203], v[164:167], v[12:15]
    ds_read_b64_tr_b16 a[236:237], v231 offset:57344
    v_mfma_f32_16x16x32_bf16 v[12:15], a[204:207], v[172:175], v[12:15]
    ds_read_b64_tr_b16 a[238:239], v231 offset:58368
    s_waitcnt lgkmcnt(8)
    v_mfma_f32_16x16x32_bf16 v[16:19], a[208:211], v[160:163], v[16:19]
    ds_read_b64_tr_b16 a[240:241], v232 offset:49152
    s_add_u32 m0, s28, 16384
    v_mfma_f32_16x16x32_bf16 v[16:19], a[212:215], v[168:171], v[16:19]
    ds_read_b64_tr_b16 a[242:243], v232 offset:50176
    v_mfma_f32_16x16x32_bf16 v[20:23], a[208:211], v[164:167], v[20:23]
    ds_read_b64_tr_b16 a[244:245], v232 offset:57344
    buffer_load_dwordx4 v250, s[8:11], 0 offen offset:0 lds
    v_mfma_f32_16x16x32_bf16 v[20:23], a[212:215], v[172:175], v[20:23]
    ds_read_b64_tr_b16 a[246:247], v232 offset:58368
    v_mfma_f32_16x16x32_bf16 v[24:27], a[216:219], v[160:163], v[24:27]
    ds_read_b64_tr_b16 a[248:249], v233 offset:49152
    buffer_load_dwordx4 v251, s[8:11], 0 offen offset:1024 lds
    v_mfma_f32_16x16x32_bf16 v[24:27], a[220:223], v[168:171], v[24:27]
    ds_read_b64_tr_b16 a[250:251], v233 offset:50176
    v_mfma_f32_16x16x32_bf16 v[28:31], a[216:219], v[164:167], v[28:31]
    ds_read_b64_tr_b16 a[252:253], v233 offset:57344
    v_mfma_f32_16x16x32_bf16 v[28:31], a[220:223], v[172:175], v[28:31]
    ds_read_b64_tr_b16 a[254:255], v233 offset:58368
    s_waitcnt lgkmcnt(8)
    v_mfma_f32_16x16x32_bf16 v[32:35], a[224:227], v[160:163], v[32:35]
    ds_read_b64_tr_b16 a[192:193], v234 offset:49152
    v_mfma_f32_16x16x32_bf16 v[32:35], a[228:231], v[168:171], v[32:35]
    ds_read_b64_tr_b16 a[194:195], v234 offset:50176
    v_mfma_f32_16x16x32_bf16 v[36:39], a[224:227], v[164:167], v[36:39]
    ds_read_b64_tr_b16 a[196:197], v234 offset:57344
    v_mfma_f32_16x16x32_bf16 v[36:39], a[228:231], v[172:175], v[36:39]
    ds_read_b64_tr_b16 a[198:199], v234 offset:58368
    v_mfma_f32_16x16x32_bf16 v[40:43], a[232:235], v[160:163], v[40:43]
    ds_read_b64_tr_b16 a[200:201], v235 offset:49152
    v_mfma_f32_16x16x32_bf16 v[40:43], a[236:239], v[168:171], v[40:43]
    ds_read_b64_tr_b16 a[202:203], v235 offset:50176
    v_mfma_f32_16x16x32_bf16 v[44:47], a[232:235], v[164:167], v[44:47]
    ds_read_b64_tr_b16 a[204:205], v235 offset:57344
    v_mfma_f32_16x16x32_bf16 v[44:47], a[236:239], v[172:175], v[44:47]
    ds_read_b64_tr_b16 a[206:207], v235 offset:58368
    s_waitcnt lgkmcnt(8)
    v_mfma_f32_16x16x32_bf16 v[48:51], a[240:243], v[160:163], v[48:51]
    ds_read_b64_tr_b16 a[208:209], v236 offset:49152
    v_mfma_f32_16x16x32_bf16 v[48:51], a[244:247], v[168:171], v[48:51]
    ds_read_b64_tr_b16 a[210:211], v236 offset:50176
    v_mfma_f32_16x16x32_bf16 v[52:55], a[240:243], v[164:167], v[52:55]
    ds_read_b64_tr_b16 a[212:213], v236 offset:57344
    buffer_load_dwordx4 v252, s[8:11], 0 offen offset:2048 lds
    v_mfma_f32_16x16x32_bf16 v[52:55], a[244:247], v[172:175], v[52:55]
    ds_read_b64_tr_b16 a[214:215], v236 offset:58368
    v_mfma_f32_16x16x32_bf16 v[56:59], a[248:251], v[160:163], v[56:59]
    ds_read_b64_tr_b16 a[216:217], v237 offset:49152
    buffer_load_dwordx4 v253, s[8:11], 0 offen offset:3072 lds
    v_mfma_f32_16x16x32_bf16 v[56:59], a[252:255], v[168:171], v[56:59]
    ds_read_b64_tr_b16 a[218:219], v237 offset:50176
    v_mfma_f32_16x16x32_bf16 v[60:63], a[248:251], v[164:167], v[60:63]
    ds_read_b64_tr_b16 a[220:221], v237 offset:57344
    v_mfma_f32_16x16x32_bf16 v[60:63], a[252:255], v[172:175], v[60:63]
    ds_read_b64_tr_b16 a[222:223], v237 offset:58368
    s_waitcnt lgkmcnt(8)
    v_mfma_f32_16x16x32_bf16 v[64:67], a[192:195], v[160:163], v[64:67]
    ds_read_b64_tr_b16 a[224:225], v238 offset:49152
    v_mfma_f32_16x16x32_bf16 v[64:67], a[196:199], v[168:171], v[64:67]
    ds_read_b64_tr_b16 a[226:227], v238 offset:50176
    v_mfma_f32_16x16x32_bf16 v[68:71], a[192:195], v[164:167], v[68:71]
    ds_read_b64_tr_b16 a[228:229], v238 offset:57344
    v_mfma_f32_16x16x32_bf16 v[68:71], a[196:199], v[172:175], v[68:71]
    ds_read_b64_tr_b16 a[230:231], v238 offset:58368
    v_mfma_f32_16x16x32_bf16 v[72:75], a[200:203], v[160:163], v[72:75]
    ds_read_b64_tr_b16 a[232:233], v239 offset:49152
    v_mfma_f32_16x16x32_bf16 v[72:75], a[204:207], v[168:171], v[72:75]
    ds_read_b64_tr_b16 a[234:235], v239 offset:50176
    v_mfma_f32_16x16x32_bf16 v[76:79], a[200:203], v[164:167], v[76:79]
    ds_read_b64_tr_b16 a[236:237], v239 offset:57344
    v_mfma_f32_16x16x32_bf16 v[76:79], a[204:207], v[172:175], v[76:79]
    ds_read_b64_tr_b16 a[238:239], v239 offset:58368
    s_waitcnt lgkmcnt(8)
    v_mfma_f32_16x16x32_bf16 v[80:83], a[208:211], v[160:163], v[80:83]
    ds_read_b64_tr_b16 a[240:241], v240 offset:49152
    v_mfma_f32_16x16x32_bf16 v[80:83], a[212:215], v[168:171], v[80:83]
    ds_read_b64_tr_b16 a[242:243], v240 offset:50176
    v_mfma_f32_16x16x32_bf16 v[84:87], a[208:211], v[164:167], v[84:87]
    ds_read_b64_tr_b16 a[244:245], v240 offset:57344
    v_mfma_f32_16x16x32_bf16 v[84:87], a[212:215], v[172:175], v[84:87]
    ds_read_b64_tr_b16 a[246:247], v240 offset:58368
    v_mfma_f32_16x16x32_bf16 v[88:91], a[216:219], v[160:163], v[88:91]
    ds_read_b64_tr_b16 a[248:249], v241 offset:49152
    v_mfma_f32_16x16x32_bf16 v[88:91], a[220:223], v[168:171], v[88:91]
    ds_read_b64_tr_b16 a[250:251], v241 offset:50176
    v_mfma_f32_16x16x32_bf16 v[92:95], a[216:219], v[164:167], v[92:95]
    ds_read_b64_tr_b16 a[252:253], v241 offset:57344
    v_mfma_f32_16x16x32_bf16 v[92:95], a[220:223], v[172:175], v[92:95]
    ds_read_b64_tr_b16 a[254:255], v241 offset:58368
    s_waitcnt lgkmcnt(8)
    v_mfma_f32_16x16x32_bf16 v[96:99], a[224:227], v[160:163], v[96:99]
    s_waitcnt vmcnt(4)
    s_barrier
    ds_read_b64_tr_b16 a[192:193], v226 offset:0
    v_mfma_f32_16x16x32_bf16 v[96:99], a[228:231], v[168:171], v[96:99]
    ds_read_b64_tr_b16 a[194:195], v226 offset:1024
    v_mfma_f32_16x16x32_bf16 v[100:103], a[224:227], v[164:167], v[100:103]
    ds_read_b64_tr_b16 a[196:197], v226 offset:8192
    v_mfma_f32_16x16x32_bf16 v[100:103], a[228:231], v[172:175], v[100:103]
    ds_read_b64_tr_b16 a[198:199], v226 offset:9216
    v_mfma_f32_16x16x32_bf16 v[104:107], a[232:235], v[160:163], v[104:107]
    ds_read_b64_tr_b16 a[200:201], v227 offset:0
    v_mfma_f32_16x16x32_bf16 v[104:107], a[236:239], v[168:171], v[104:107]
    ds_read_b64_tr_b16 a[202:203], v227 offset:1024
    v_mfma_f32_16x16x32_bf16 v[108:111], a[232:235], v[164:167], v[108:111]
    ds_read_b64_tr_b16 a[204:205], v227 offset:8192
    v_mfma_f32_16x16x32_bf16 v[108:111], a[236:239], v[172:175], v[108:111]
    ds_read_b64_tr_b16 a[206:207], v227 offset:9216
    s_waitcnt lgkmcnt(8)
    v_mfma_f32_16x16x32_bf16 v[112:115], a[240:243], v[160:163], v[112:115]
    ds_read_b64_tr_b16 a[208:209], v228 offset:0
    v_mfma_f32_16x16x32_bf16 v[112:115], a[244:247], v[168:171], v[112:115]
    ds_read_b64_tr_b16 a[210:211], v228 offset:1024
    v_mfma_f32_16x16x32_bf16 v[116:119], a[240:243], v[164:167], v[116:119]
    ds_read_b64_tr_b16 a[212:213], v228 offset:8192
    v_mfma_f32_16x16x32_bf16 v[116:119], a[244:247], v[172:175], v[116:119]
    ds_read_b64_tr_b16 a[214:215], v228 offset:9216
    v_mfma_f32_16x16x32_bf16 v[120:123], a[248:251], v[160:163], v[120:123]
    ds_read_b64_tr_b16 a[216:217], v229 offset:0
    v_mfma_f32_16x16x32_bf16 v[120:123], a[252:255], v[168:171], v[120:123]
    ds_read_b64_tr_b16 a[218:219], v229 offset:1024
    v_mfma_f32_16x16x32_bf16 v[124:127], a[248:251], v[164:167], v[124:127]
    ds_read_b64_tr_b16 a[220:221], v229 offset:8192
    v_mfma_f32_16x16x32_bf16 v[124:127], a[252:255], v[172:175], v[124:127]
    ds_read_b64_tr_b16 a[222:223], v229 offset:9216
    s_waitcnt lgkmcnt(8)
    v_mfma_f32_16x16x32_bf16 v[0:3], a[192:195], v[176:179], v[0:3]
    ds_read_b64_tr_b16 a[224:225], v230 offset:0
    v_and_b32 v243, 48, v225
    v_lshrrev_b32 v243, 2, v243
    v_mfma_f32_16x16x32_bf16 v[0:3], a[196:199], v[184:187], v[0:3]
    ds_read_b64_tr_b16 a[226:227], v230 offset:1024
    v_add_u32 v243, 139264, v243
    v_mfma_f32_16x16x32_bf16 v[4:7], a[192:195], v[180:183], v[4:7]
    ds_read_b64_tr_b16 a[228:229], v230 offset:8192
    s_lshl_b32 s43, s40, 2
    v_mfma_f32_16x16x32_bf16 v[4:7], a[196:199], v[188:191], v[4:7]
    ds_read_b64_tr_b16 a[230:231], v230 offset:9216
    s_add_u32 s43, s43, 139264
    v_mfma_f32_16x16x32_bf16 v[8:11], a[200:203], v[176:179], v[8:11]
    ds_read_b64_tr_b16 a[232:233], v231 offset:0
    v_mov_b32 v242, s43
    v_mfma_f32_16x16x32_bf16 v[8:11], a[204:207], v[184:187], v[8:11]
    ds_read_b64_tr_b16 a[234:235], v231 offset:1024
    v_mov_b32 v245, 0
    v_mfma_f32_16x16x32_bf16 v[12:15], a[200:203], v[180:183], v[12:15]
    ds_read_b64_tr_b16 a[236:237], v231 offset:8192
    v_bfe_u32 v217, v225, 4, 6
    v_mfma_f32_16x16x32_bf16 v[12:15], a[204:207], v[188:191], v[12:15]
    ds_read_b64_tr_b16 a[238:239], v231 offset:9216
    s_mov_b32 s32, 16384
    v_min_u32 v217, 8, v217
    s_waitcnt lgkmcnt(8)
    v_mfma_f32_16x16x32_bf16 v[16:19], a[208:211], v[176:179], v[16:19]
    ds_read_b64_tr_b16 a[240:241], v232 offset:0
    s_add_u32 m0, s28, 32768
    v_lshlrev_b32 v217, 7, v217
    v_mfma_f32_16x16x32_bf16 v[16:19], a[212:215], v[184:187], v[16:19]
    ds_read_b64_tr_b16 a[242:243], v232 offset:1024
    v_bfe_u32 v224, v225, 5, 1
    v_mfma_f32_16x16x32_bf16 v[20:23], a[208:211], v[180:183], v[20:23]
    ds_read_b64_tr_b16 a[244:245], v232 offset:8192
    buffer_load_dwordx4 v250, s[8:11], s32 offen offset:0 lds
    v_bfe_u32 v218, v225, 4, 1
    v_mfma_f32_16x16x32_bf16 v[20:23], a[212:215], v[188:191], v[20:23]
    ds_read_b64_tr_b16 a[246:247], v232 offset:9216
    v_sub_u32 v224, v224, v218
    v_mfma_f32_16x16x32_bf16 v[24:27], a[216:219], v[176:179], v[24:27]
    ds_read_b64_tr_b16 a[248:249], v233 offset:0
    buffer_load_dwordx4 v251, s[8:11], s32 offen offset:1024 lds
    v_lshlrev_b32 v224, 3, v224
    v_mfma_f32_16x16x32_bf16 v[24:27], a[220:223], v[184:187], v[24:27]
    ds_read_b64_tr_b16 a[250:251], v233 offset:1024
    v_lshrrev_b32 v218, 8, v225
    v_mfma_f32_16x16x32_bf16 v[28:31], a[216:219], v[180:183], v[28:31]
    ds_read_b64_tr_b16 a[252:253], v233 offset:8192
    v_lshlrev_b32 v218, 10, v218
    v_mfma_f32_16x16x32_bf16 v[28:31], a[220:223], v[188:191], v[28:31]
    ds_read_b64_tr_b16 a[254:255], v233 offset:9216
    v_sub_u32 v224, v224, v218
    s_waitcnt lgkmcnt(8)
    v_mfma_f32_16x16x32_bf16 v[32:35], a[224:227], v[176:179], v[32:35]
    ds_read_b64_tr_b16 a[192:193], v234 offset:0
    v_cvt_pk_bf16_f32 v1, v0, v1
    v_cvt_pk_bf16_f32 v3, v2, v3
    v_lshlrev_b32 v0, 16, v1
    v_and_b32 v1, 0xffff0000, v1
    v_lshlrev_b32 v2, 16, v3
    v_and_b32 v3, 0xffff0000, v3
    v_mul_f32 v0, s53, v0
    v_mfma_f32_16x16x32_bf16 v[32:35], a[228:231], v[184:187], v[32:35]
    ds_read_b64_tr_b16 a[194:195], v234 offset:1024
    v_mul_f32 v1, s53, v1
    v_mul_f32 v2, s53, v2
    v_mul_f32 v3, s53, v3
    v_cvt_pk_bf16_f32 v128, v0, v1
    v_cvt_pk_bf16_f32 v129, v2, v3
    v_cvt_pk_bf16_f32 v9, v8, v9
    v_mfma_f32_16x16x32_bf16 v[36:39], a[224:227], v[180:183], v[36:39]
    ds_read_b64_tr_b16 a[196:197], v234 offset:8192
    v_cvt_pk_bf16_f32 v11, v10, v11
    v_lshlrev_b32 v8, 16, v9
    v_and_b32 v9, 0xffff0000, v9
    v_lshlrev_b32 v10, 16, v11
    v_and_b32 v11, 0xffff0000, v11
    v_mul_f32 v8, s53, v8
    v_mul_f32 v9, s53, v9
    v_mfma_f32_16x16x32_bf16 v[36:39], a[228:231], v[188:191], v[36:39]
    ds_read_b64_tr_b16 a[198:199], v234 offset:9216
    v_mul_f32 v10, s53, v10
    v_mul_f32 v11, s53, v11
    v_cvt_pk_bf16_f32 v130, v8, v9
    v_cvt_pk_bf16_f32 v131, v10, v11
    v_cvt_pk_bf16_f32 v5, v4, v5
    v_cvt_pk_bf16_f32 v7, v6, v7
    v_mfma_f32_16x16x32_bf16 v[40:43], a[232:235], v[176:179], v[40:43]
    ds_read_b64_tr_b16 a[200:201], v235 offset:0
    v_lshlrev_b32 v4, 16, v5
    v_and_b32 v5, 0xffff0000, v5
    v_lshlrev_b32 v6, 16, v7
    v_and_b32 v7, 0xffff0000, v7
    v_mul_f32 v4, s53, v4
    v_mul_f32 v5, s53, v5
    v_mul_f32 v6, s53, v6
    v_mfma_f32_16x16x32_bf16 v[40:43], a[236:239], v[184:187], v[40:43]
    ds_read_b64_tr_b16 a[202:203], v235 offset:1024
    v_mul_f32 v7, s53, v7
    v_cvt_pk_bf16_f32 v132, v4, v5
    v_cvt_pk_bf16_f32 v133, v6, v7
    v_cvt_pk_bf16_f32 v13, v12, v13
    v_cvt_pk_bf16_f32 v15, v14, v15
    v_lshlrev_b32 v12, 16, v13
    v_mfma_f32_16x16x32_bf16 v[44:47], a[232:235], v[180:183], v[44:47]
    ds_read_b64_tr_b16 a[204:205], v235 offset:8192
    v_and_b32 v13, 0xffff0000, v13
    v_lshlrev_b32 v14, 16, v15
    v_and_b32 v15, 0xffff0000, v15
    v_mul_f32 v12, s53, v12
    v_mul_f32 v13, s53, v13
    v_mul_f32 v14, s53, v14
    v_mul_f32 v15, s53, v15
    v_mfma_f32_16x16x32_bf16 v[44:47], a[236:239], v[188:191], v[44:47]
    ds_read_b64_tr_b16 a[206:207], v235 offset:9216
    v_cvt_pk_bf16_f32 v134, v12, v13
    v_cvt_pk_bf16_f32 v135, v14, v15
    v_permlane32_swap_b32 v128, v130
    v_permlane32_swap_b32 v129, v131
    v_cvt_pk_bf16_f32 v17, v16, v17
    v_cvt_pk_bf16_f32 v19, v18, v19
    s_waitcnt lgkmcnt(8)
    v_mfma_f32_16x16x32_bf16 v[48:51], a[240:243], v[176:179], v[48:51]
    ds_read_b64_tr_b16 a[208:209], v236 offset:0
    v_lshlrev_b32 v16, 16, v17
    v_and_b32 v17, 0xffff0000, v17
    v_lshlrev_b32 v18, 16, v19
    v_and_b32 v19, 0xffff0000, v19
    v_mul_f32 v16, s53, v16
    v_mul_f32 v17, s53, v17
    v_mul_f32 v18, s53, v18
    v_mfma_f32_16x16x32_bf16 v[48:51], a[244:247], v[184:187], v[48:51]
    ds_read_b64_tr_b16 a[210:211], v236 offset:1024
    v_mul_f32 v19, s53, v19
    v_cvt_pk_bf16_f32 v136, v16, v17
    v_cvt_pk_bf16_f32 v137, v18, v19
    v_cvt_pk_bf16_f32 v25, v24, v25
    v_cvt_pk_bf16_f32 v27, v26, v27
    v_lshlrev_b32 v24, 16, v25
    v_mfma_f32_16x16x32_bf16 v[52:55], a[240:243], v[180:183], v[52:55]
    ds_read_b64_tr_b16 a[212:213], v236 offset:8192
    buffer_load_dwordx4 v252, s[8:11], s32 offen offset:2048 lds
    v_and_b32 v25, 0xffff0000, v25
    v_lshlrev_b32 v26, 16, v27
    v_and_b32 v27, 0xffff0000, v27
    v_mul_f32 v24, s53, v24
    v_mul_f32 v25, s53, v25
    v_mul_f32 v26, s53, v26
    v_mul_f32 v27, s53, v27
    v_mfma_f32_16x16x32_bf16 v[52:55], a[244:247], v[188:191], v[52:55]
    ds_read_b64_tr_b16 a[214:215], v236 offset:9216
    v_cvt_pk_bf16_f32 v138, v24, v25
    v_cvt_pk_bf16_f32 v139, v26, v27
    v_permlane32_swap_b32 v132, v134
    v_permlane32_swap_b32 v133, v135
    v_cvt_pk_bf16_f32 v21, v20, v21
    v_cvt_pk_bf16_f32 v23, v22, v23
    v_mfma_f32_16x16x32_bf16 v[56:59], a[248:251], v[176:179], v[56:59]
    ds_read_b64_tr_b16 a[216:217], v237 offset:0
    buffer_load_dwordx4 v253, s[8:11], s32 offen offset:3072 lds
    v_lshlrev_b32 v20, 16, v21
    v_and_b32 v21, 0xffff0000, v21
    v_lshlrev_b32 v22, 16, v23
    v_and_b32 v23, 0xffff0000, v23
    v_mul_f32 v20, s53, v20
    v_mul_f32 v21, s53, v21
    v_mul_f32 v22, s53, v22
    v_mfma_f32_16x16x32_bf16 v[56:59], a[252:255], v[184:187], v[56:59]
    ds_read_b64_tr_b16 a[218:219], v237 offset:1024
    v_mul_f32 v23, s53, v23
    v_cvt_pk_bf16_f32 v140, v20, v21
    v_cvt_pk_bf16_f32 v141, v22, v23
    v_cvt_pk_bf16_f32 v29, v28, v29
    v_cvt_pk_bf16_f32 v31, v30, v31
    v_lshlrev_b32 v28, 16, v29
    v_mfma_f32_16x16x32_bf16 v[60:63], a[248:251], v[180:183], v[60:63]
    ds_read_b64_tr_b16 a[220:221], v237 offset:8192
    v_and_b32 v29, 0xffff0000, v29
    v_lshlrev_b32 v30, 16, v31
    v_and_b32 v31, 0xffff0000, v31
    v_mul_f32 v28, s53, v28
    v_mul_f32 v29, s53, v29
    v_mul_f32 v30, s53, v30
    v_mul_f32 v31, s53, v31
    v_mfma_f32_16x16x32_bf16 v[60:63], a[252:255], v[188:191], v[60:63]
    ds_read_b64_tr_b16 a[222:223], v237 offset:9216
    v_cvt_pk_bf16_f32 v142, v28, v29
    v_cvt_pk_bf16_f32 v143, v30, v31
    v_permlane32_swap_b32 v136, v138
    v_permlane32_swap_b32 v137, v139
    v_permlane32_swap_b32 v140, v142
    v_permlane32_swap_b32 v141, v143
    s_waitcnt lgkmcnt(8)
    v_mfma_f32_16x16x32_bf16 v[64:67], a[192:195], v[176:179], v[64:67]
    ds_read_b64_tr_b16 a[224:225], v238 offset:0
    v_cvt_pk_bf16_f32 v33, v32, v33
    v_cvt_pk_bf16_f32 v35, v34, v35
    v_lshlrev_b32 v32, 16, v33
    v_and_b32 v33, 0xffff0000, v33
    v_lshlrev_b32 v34, 16, v35
    v_and_b32 v35, 0xffff0000, v35
    v_mul_f32 v32, s53, v32
    v_mfma_f32_16x16x32_bf16 v[64:67], a[196:199], v[184:187], v[64:67]
    ds_read_b64_tr_b16 a[226:227], v238 offset:1024
    v_mul_f32 v33, s53, v33
    v_mul_f32 v34, s53, v34
    v_mul_f32 v35, s53, v35
    v_cvt_pk_bf16_f32 v144, v32, v33
    v_cvt_pk_bf16_f32 v145, v34, v35
    v_cvt_pk_bf16_f32 v41, v40, v41
    v_mfma_f32_16x16x32_bf16 v[68:71], a[192:195], v[180:183], v[68:71]
    ds_read_b64_tr_b16 a[228:229], v238 offset:8192
    v_cvt_pk_bf16_f32 v43, v42, v43
    v_lshlrev_b32 v40, 16, v41
    v_and_b32 v41, 0xffff0000, v41
    v_lshlrev_b32 v42, 16, v43
    v_and_b32 v43, 0xffff0000, v43
    v_mul_f32 v40, s53, v40
    v_mul_f32 v41, s53, v41
    v_mfma_f32_16x16x32_bf16 v[68:71], a[196:199], v[188:191], v[68:71]
    ds_read_b64_tr_b16 a[230:231], v238 offset:9216
    v_mul_f32 v42, s53, v42
    v_mul_f32 v43, s53, v43
    v_cvt_pk_bf16_f32 v146, v40, v41
    v_cvt_pk_bf16_f32 v147, v42, v43
    v_cvt_pk_bf16_f32 v37, v36, v37
    v_cvt_pk_bf16_f32 v39, v38, v39
    v_mfma_f32_16x16x32_bf16 v[72:75], a[200:203], v[176:179], v[72:75]
    ds_read_b64_tr_b16 a[232:233], v239 offset:0
    v_lshlrev_b32 v36, 16, v37
    v_and_b32 v37, 0xffff0000, v37
    v_lshlrev_b32 v38, 16, v39
    v_and_b32 v39, 0xffff0000, v39
    v_mul_f32 v36, s53, v36
    v_mul_f32 v37, s53, v37
    v_mul_f32 v38, s53, v38
    v_mfma_f32_16x16x32_bf16 v[72:75], a[204:207], v[184:187], v[72:75]
    ds_read_b64_tr_b16 a[234:235], v239 offset:1024
    v_mul_f32 v39, s53, v39
    v_cvt_pk_bf16_f32 v148, v36, v37
    v_cvt_pk_bf16_f32 v149, v38, v39
    v_cvt_pk_bf16_f32 v45, v44, v45
    v_cvt_pk_bf16_f32 v47, v46, v47
    v_lshlrev_b32 v44, 16, v45
    v_mfma_f32_16x16x32_bf16 v[76:79], a[200:203], v[180:183], v[76:79]
    ds_read_b64_tr_b16 a[236:237], v239 offset:8192
    v_and_b32 v45, 0xffff0000, v45
    v_lshlrev_b32 v46, 16, v47
    v_and_b32 v47, 0xffff0000, v47
    v_mul_f32 v44, s53, v44
    v_mul_f32 v45, s53, v45
    v_mul_f32 v46, s53, v46
    v_mul_f32 v47, s53, v47
    v_mfma_f32_16x16x32_bf16 v[76:79], a[204:207], v[188:191], v[76:79]
    ds_read_b64_tr_b16 a[238:239], v239 offset:9216
    s_mov_b32 s33, 0
    v_cvt_pk_bf16_f32 v150, v44, v45
    v_cvt_pk_bf16_f32 v151, v46, v47
    v_permlane32_swap_b32 v144, v146
    v_permlane32_swap_b32 v145, v147
    v_cvt_pk_bf16_f32 v49, v48, v49
    v_cvt_pk_bf16_f32 v51, v50, v51
    s_waitcnt lgkmcnt(8)
    v_mfma_f32_16x16x32_bf16 v[80:83], a[208:211], v[176:179], v[80:83]
    ds_read_b64_tr_b16 a[240:241], v240 offset:0
    s_add_u32 m0, s28, 98304
    v_lshlrev_b32 v48, 16, v49
    v_and_b32 v49, 0xffff0000, v49
    v_lshlrev_b32 v50, 16, v51
    v_and_b32 v51, 0xffff0000, v51
    v_mul_f32 v48, s53, v48
    v_mul_f32 v49, s53, v49
    v_mul_f32 v50, s53, v50
    v_mfma_f32_16x16x32_bf16 v[80:83], a[212:215], v[184:187], v[80:83]
    ds_read_b64_tr_b16 a[242:243], v240 offset:1024
    v_mul_f32 v51, s53, v51
    v_cvt_pk_bf16_f32 v152, v48, v49
    v_cvt_pk_bf16_f32 v153, v50, v51
    v_cvt_pk_bf16_f32 v57, v56, v57
    v_cvt_pk_bf16_f32 v59, v58, v59
    v_lshlrev_b32 v56, 16, v57
    v_mfma_f32_16x16x32_bf16 v[84:87], a[208:211], v[180:183], v[84:87]
    ds_read_b64_tr_b16 a[244:245], v240 offset:8192
    buffer_load_dwordx4 v254, s[12:15], s33 offen offset:0 lds
    v_and_b32 v57, 0xffff0000, v57
    v_lshlrev_b32 v58, 16, v59
    v_and_b32 v59, 0xffff0000, v59
    v_mul_f32 v56, s53, v56
    v_mul_f32 v57, s53, v57
    v_mul_f32 v58, s53, v58
    v_mul_f32 v59, s53, v59
    v_mfma_f32_16x16x32_bf16 v[84:87], a[212:215], v[188:191], v[84:87]
    ds_read_b64_tr_b16 a[246:247], v240 offset:9216
    v_cvt_pk_bf16_f32 v154, v56, v57
    v_cvt_pk_bf16_f32 v155, v58, v59
    v_permlane32_swap_b32 v148, v150
    v_permlane32_swap_b32 v149, v151
    v_cvt_pk_bf16_f32 v53, v52, v53
    v_cvt_pk_bf16_f32 v55, v54, v55
    v_mfma_f32_16x16x32_bf16 v[88:91], a[216:219], v[176:179], v[88:91]
    ds_read_b64_tr_b16 a[248:249], v241 offset:0
    buffer_load_dwordx4 v255, s[12:15], s33 offen offset:1024 lds
    v_lshlrev_b32 v52, 16, v53
    v_and_b32 v53, 0xffff0000, v53
    v_lshlrev_b32 v54, 16, v55
    v_and_b32 v55, 0xffff0000, v55
    v_mul_f32 v52, s53, v52
    v_mul_f32 v53, s53, v53
    v_mul_f32 v54, s53, v54
    v_mfma_f32_16x16x32_bf16 v[88:91], a[220:223], v[184:187], v[88:91]
    ds_read_b64_tr_b16 a[250:251], v241 offset:1024
    v_mul_f32 v55, s53, v55
    v_cvt_pk_bf16_f32 v156, v52, v53
    v_cvt_pk_bf16_f32 v157, v54, v55
    v_cvt_pk_bf16_f32 v61, v60, v61
    v_cvt_pk_bf16_f32 v63, v62, v63
    v_lshlrev_b32 v60, 16, v61
    v_mfma_f32_16x16x32_bf16 v[92:95], a[216:219], v[180:183], v[92:95]
    ds_read_b64_tr_b16 a[252:253], v241 offset:8192
    v_and_b32 v61, 0xffff0000, v61
    v_lshlrev_b32 v62, 16, v63
    v_and_b32 v63, 0xffff0000, v63
    v_mul_f32 v60, s53, v60
    v_mul_f32 v61, s53, v61
    v_mul_f32 v62, s53, v62
    v_mul_f32 v63, s53, v63
    v_mfma_f32_16x16x32_bf16 v[92:95], a[220:223], v[188:191], v[92:95]
    ds_read_b64_tr_b16 a[254:255], v241 offset:9216
    v_cvt_pk_bf16_f32 v158, v60, v61
    v_cvt_pk_bf16_f32 v159, v62, v63
    v_permlane32_swap_b32 v152, v154
    v_permlane32_swap_b32 v153, v155
    v_permlane32_swap_b32 v156, v158
    v_permlane32_swap_b32 v157, v159
    s_waitcnt lgkmcnt(0)
    v_mfma_f32_16x16x32_bf16 v[96:99], a[224:227], v[176:179], v[96:99]
    s_waitcnt vmcnt(6)
    s_barrier
    ds_read_b128 a[128:131], v246 offset:16384
    ds_read_b128 a[132:135], v247 offset:16384
    v_cvt_pk_bf16_f32 v65, v64, v65
    v_cvt_pk_bf16_f32 v67, v66, v67
    v_lshlrev_b32 v64, 16, v65
    v_and_b32 v65, 0xffff0000, v65
    v_lshlrev_b32 v66, 16, v67
    v_and_b32 v67, 0xffff0000, v67
    v_mul_f32 v64, s53, v64
    v_mfma_f32_16x16x32_bf16 v[96:99], a[228:231], v[184:187], v[96:99]
    ds_read_b128 a[136:139], v248 offset:16384
    v_mul_f32 v65, s53, v65
    v_mul_f32 v66, s53, v66
    v_mul_f32 v67, s53, v67
    v_cvt_pk_bf16_f32 v160, v64, v65
    v_cvt_pk_bf16_f32 v161, v66, v67
    v_cvt_pk_bf16_f32 v73, v72, v73
    v_cvt_pk_bf16_f32 v75, v74, v75
    v_mfma_f32_16x16x32_bf16 v[100:103], a[224:227], v[180:183], v[100:103]
    ds_read_b128 a[140:143], v249 offset:16384
    v_lshlrev_b32 v72, 16, v73
    v_and_b32 v73, 0xffff0000, v73
    v_lshlrev_b32 v74, 16, v75
    v_and_b32 v75, 0xffff0000, v75
    v_mul_f32 v72, s53, v72
    v_mul_f32 v73, s53, v73
    v_mul_f32 v74, s53, v74
    v_mfma_f32_16x16x32_bf16 v[100:103], a[228:231], v[188:191], v[100:103]
    ds_read_b128 a[144:147], v246 offset:20480
    ds_read_b128 a[148:151], v247 offset:20480
    v_mul_f32 v75, s53, v75
    v_cvt_pk_bf16_f32 v162, v72, v73
    v_cvt_pk_bf16_f32 v163, v74, v75
    v_cvt_pk_bf16_f32 v69, v68, v69
    v_cvt_pk_bf16_f32 v71, v70, v71
    v_lshlrev_b32 v68, 16, v69
    v_and_b32 v69, 0xffff0000, v69
    v_mfma_f32_16x16x32_bf16 v[104:107], a[232:235], v[176:179], v[104:107]
    ds_read_b128 a[152:155], v248 offset:20480
    v_lshlrev_b32 v70, 16, v71
    v_and_b32 v71, 0xffff0000, v71
    v_mul_f32 v68, s53, v68
    v_mul_f32 v69, s53, v69
    v_mul_f32 v70, s53, v70
    v_mul_f32 v71, s53, v71
    v_cvt_pk_bf16_f32 v164, v68, v69
    v_mfma_f32_16x16x32_bf16 v[104:107], a[236:239], v[184:187], v[104:107]
    ds_read_b128 a[156:159], v249 offset:20480
    v_cvt_pk_bf16_f32 v165, v70, v71
    v_cvt_pk_bf16_f32 v77, v76, v77
    v_cvt_pk_bf16_f32 v79, v78, v79
    v_lshlrev_b32 v76, 16, v77
    v_and_b32 v77, 0xffff0000, v77
    v_lshlrev_b32 v78, 16, v79
    v_and_b32 v79, 0xffff0000, v79
    v_mfma_f32_16x16x32_bf16 v[108:111], a[232:235], v[180:183], v[108:111]
    ds_read_b128 a[160:163], v246 offset:24576
    ds_read_b128 a[164:167], v247 offset:24576
    v_mul_f32 v76, s53, v76
    v_mul_f32 v77, s53, v77
    v_mul_f32 v78, s53, v78
    v_mul_f32 v79, s53, v79
    v_cvt_pk_bf16_f32 v166, v76, v77
    v_cvt_pk_bf16_f32 v167, v78, v79
    v_permlane32_swap_b32 v160, v162
    v_mfma_f32_16x16x32_bf16 v[108:111], a[236:239], v[188:191], v[108:111]
    ds_read_b128 a[168:171], v248 offset:24576
    v_permlane32_swap_b32 v161, v163
    v_cvt_pk_bf16_f32 v81, v80, v81
    v_cvt_pk_bf16_f32 v83, v82, v83
    v_lshlrev_b32 v80, 16, v81
    v_and_b32 v81, 0xffff0000, v81
    v_lshlrev_b32 v82, 16, v83
    v_and_b32 v83, 0xffff0000, v83
    v_mfma_f32_16x16x32_bf16 v[112:115], a[240:243], v[176:179], v[112:115]
    ds_read_b128 a[172:175], v249 offset:24576
    v_mul_f32 v80, s53, v80
    v_mul_f32 v81, s53, v81
    v_mul_f32 v82, s53, v82
    v_mul_f32 v83, s53, v83
    v_cvt_pk_bf16_f32 v168, v80, v81
    v_cvt_pk_bf16_f32 v169, v82, v83
    v_cvt_pk_bf16_f32 v89, v88, v89
    v_mfma_f32_16x16x32_bf16 v[112:115], a[244:247], v[184:187], v[112:115]
    ds_read_b128 a[176:179], v246 offset:28672
    ds_read_b128 a[180:183], v247 offset:28672
    v_cvt_pk_bf16_f32 v91, v90, v91
    v_lshlrev_b32 v88, 16, v89
    v_and_b32 v89, 0xffff0000, v89
    v_lshlrev_b32 v90, 16, v91
    v_and_b32 v91, 0xffff0000, v91
    v_mul_f32 v88, s53, v88
    v_mul_f32 v89, s53, v89
    v_mfma_f32_16x16x32_bf16 v[116:119], a[240:243], v[180:183], v[116:119]
    ds_read_b128 a[184:187], v248 offset:28672
    buffer_load_dwordx4 v254, s[12:15], s33 offen offset:2048 lds
    v_mul_f32 v90, s53, v90
    v_mul_f32 v91, s53, v91
    v_cvt_pk_bf16_f32 v170, v88, v89
    v_cvt_pk_bf16_f32 v171, v90, v91
    v_permlane32_swap_b32 v164, v166
    v_permlane32_swap_b32 v165, v167
    v_cvt_pk_bf16_f32 v85, v84, v85
    v_mfma_f32_16x16x32_bf16 v[116:119], a[244:247], v[188:191], v[116:119]
    ds_read_b128 a[188:191], v249 offset:28672
    v_cvt_pk_bf16_f32 v87, v86, v87
    v_lshlrev_b32 v84, 16, v85
    v_and_b32 v85, 0xffff0000, v85
    v_lshlrev_b32 v86, 16, v87
    v_and_b32 v87, 0xffff0000, v87
    v_mul_f32 v84, s53, v84
    v_mul_f32 v85, s53, v85
    v_mfma_f32_16x16x32_bf16 v[120:123], a[248:251], v[176:179], v[120:123]
    buffer_load_dwordx4 v255, s[12:15], s33 offen offset:3072 lds
    v_mul_f32 v86, s53, v86
    v_mul_f32 v87, s53, v87
    v_cvt_pk_bf16_f32 v172, v84, v85
    v_cvt_pk_bf16_f32 v173, v86, v87
    v_cvt_pk_bf16_f32 v93, v92, v93
    v_cvt_pk_bf16_f32 v95, v94, v95
    v_lshlrev_b32 v92, 16, v93
    v_mfma_f32_16x16x32_bf16 v[120:123], a[252:255], v[184:187], v[120:123]
    v_and_b32 v93, 0xffff0000, v93
    v_lshlrev_b32 v94, 16, v95
    v_and_b32 v95, 0xffff0000, v95
    v_mul_f32 v92, s53, v92
    v_mul_f32 v93, s53, v93
    v_mul_f32 v94, s53, v94
    v_mul_f32 v95, s53, v95
    v_mfma_f32_16x16x32_bf16 v[124:127], a[248:251], v[180:183], v[124:127]
    v_cvt_pk_bf16_f32 v174, v92, v93
    v_cvt_pk_bf16_f32 v175, v94, v95
    v_permlane32_swap_b32 v168, v170
    v_permlane32_swap_b32 v169, v171
    v_permlane32_swap_b32 v172, v174
    v_permlane32_swap_b32 v173, v175
    v_add_u32 v234, v234, v224
    v_mfma_f32_16x16x32_bf16 v[124:127], a[252:255], v[188:191], v[124:127]
    v_add_u32 v235, v235, v224
    v_add_u32 v236, v236, v224
    v_add_u32 v237, v237, v224
    v_add_u32 v238, v238, v224
    v_add_u32 v239, v239, v224
    v_add_u32 v240, v240, v224
    v_add_u32 v241, v241, v224
    s_waitcnt lgkmcnt(8)
    v_mfma_f32_16x16x32_bf16 v[0:3], a[128:131], v[128:131], 0
    s_mov_b32 s32, 32768
    v_mfma_f32_16x16x32_bf16 v[0:3], a[132:135], v[136:139], v[0:3]
    v_cvt_pk_bf16_f32 v97, v96, v97
    v_cvt_pk_bf16_f32 v99, v98, v99
    v_lshlrev_b32 v96, 16, v97
    v_and_b32 v97, 0xffff0000, v97
    v_lshlrev_b32 v98, 16, v99
    v_and_b32 v99, 0xffff0000, v99
    v_mfma_f32_16x16x32_bf16 v[0:3], a[136:139], v[144:147], v[0:3]
    s_add_u32 m0, s28, 49152
    v_mul_f32 v96, s53, v96
    v_mul_f32 v97, s53, v97
    v_mul_f32 v98, s53, v98
    v_mul_f32 v99, s53, v99
    v_cvt_pk_bf16_f32 v176, v96, v97
    v_mfma_f32_16x16x32_bf16 v[0:3], a[140:143], v[152:155], v[0:3]
    v_cvt_pk_bf16_f32 v177, v98, v99
    v_cvt_pk_bf16_f32 v105, v104, v105
    v_cvt_pk_bf16_f32 v107, v106, v107
    v_lshlrev_b32 v104, 16, v105
    v_and_b32 v105, 0xffff0000, v105
    v_lshlrev_b32 v106, 16, v107
    v_mfma_f32_16x16x32_bf16 v[4:7], a[144:147], v[128:131], 0
    buffer_load_dwordx4 v250, s[8:11], s32 offen offset:0 lds
    v_and_b32 v107, 0xffff0000, v107
    v_mul_f32 v104, s53, v104
    v_mul_f32 v105, s53, v105
    v_mul_f32 v106, s53, v106
    v_mul_f32 v107, s53, v107
    v_mfma_f32_16x16x32_bf16 v[4:7], a[148:151], v[136:139], v[4:7]
    v_cvt_pk_bf16_f32 v178, v104, v105
    v_cvt_pk_bf16_f32 v179, v106, v107
    v_cvt_pk_bf16_f32 v101, v100, v101
    v_cvt_pk_bf16_f32 v103, v102, v103
    v_lshlrev_b32 v100, 16, v101
    v_and_b32 v101, 0xffff0000, v101
    v_mfma_f32_16x16x32_bf16 v[4:7], a[152:155], v[144:147], v[4:7]
    buffer_load_dwordx4 v251, s[8:11], s32 offen offset:1024 lds
    v_lshlrev_b32 v102, 16, v103
    v_and_b32 v103, 0xffff0000, v103
    v_mul_f32 v100, s53, v100
    v_mul_f32 v101, s53, v101
    v_mul_f32 v102, s53, v102
    v_mfma_f32_16x16x32_bf16 v[4:7], a[156:159], v[152:155], v[4:7]
    s_waitcnt lgkmcnt(0)
    v_mul_f32 v103, s53, v103
    v_cvt_pk_bf16_f32 v180, v100, v101
    v_cvt_pk_bf16_f32 v181, v102, v103
    v_cvt_pk_bf16_f32 v109, v108, v109
    v_cvt_pk_bf16_f32 v111, v110, v111
    v_lshlrev_b32 v108, 16, v109
    v_mfma_f32_16x16x32_bf16 v[8:11], a[160:163], v[128:131], 0
    buffer_load_dwordx4 v252, s[8:11], s32 offen offset:2048 lds
    v_and_b32 v109, 0xffff0000, v109
    v_lshlrev_b32 v110, 16, v111
    v_and_b32 v111, 0xffff0000, v111
    v_mul_f32 v108, s53, v108
    v_mul_f32 v109, s53, v109
    v_mov_b32 v192, 0
    v_mov_b32 v193, 0
    v_mfma_f32_16x16x32_bf16 v[8:11], a[164:167], v[136:139], v[8:11]
    v_mul_f32 v110, s53, v110
    v_mul_f32 v111, s53, v111
    v_cvt_pk_bf16_f32 v182, v108, v109
    v_cvt_pk_bf16_f32 v183, v110, v111
    v_permlane32_swap_b32 v176, v178
    v_permlane32_swap_b32 v177, v179
    v_mov_b32 v194, 0
    v_mov_b32 v195, 0
    v_mfma_f32_16x16x32_bf16 v[8:11], a[168:171], v[144:147], v[8:11]
    buffer_load_dwordx4 v253, s[8:11], s32 offen offset:3072 lds
    v_cvt_pk_bf16_f32 v113, v112, v113
    v_cvt_pk_bf16_f32 v115, v114, v115
    v_lshlrev_b32 v112, 16, v113
    v_and_b32 v113, 0xffff0000, v113
    v_lshlrev_b32 v114, 16, v115
    v_mov_b32 v196, 0
    v_mov_b32 v197, 0
    v_mfma_f32_16x16x32_bf16 v[8:11], a[172:175], v[152:155], v[8:11]
    v_and_b32 v115, 0xffff0000, v115
    v_mul_f32 v112, s53, v112
    v_mul_f32 v113, s53, v113
    v_mul_f32 v114, s53, v114
    v_mul_f32 v115, s53, v115
    v_cvt_pk_bf16_f32 v184, v112, v113
    v_mov_b32 v198, 0
    v_mov_b32 v199, 0
    v_mfma_f32_16x16x32_bf16 v[12:15], a[176:179], v[128:131], 0
    s_mov_b32 s33, 16384
    v_cvt_pk_bf16_f32 v185, v114, v115
    v_cvt_pk_bf16_f32 v121, v120, v121
    v_cvt_pk_bf16_f32 v123, v122, v123
    v_lshlrev_b32 v120, 16, v121
    v_and_b32 v121, 0xffff0000, v121
    v_mov_b32 v200, 0
    v_mov_b32 v201, 0
    v_mfma_f32_16x16x32_bf16 v[12:15], a[180:183], v[136:139], v[12:15]
    v_lshlrev_b32 v122, 16, v123
    v_and_b32 v123, 0xffff0000, v123
    v_mul_f32 v120, s53, v120
    v_mul_f32 v121, s53, v121
    v_mul_f32 v122, s53, v122
    v_mul_f32 v123, s53, v123
    v_mov_b32 v202, 0
    v_mov_b32 v203, 0
    v_mfma_f32_16x16x32_bf16 v[12:15], a[184:187], v[144:147], v[12:15]
    s_add_u32 m0, s28, 114688
    v_cvt_pk_bf16_f32 v186, v120, v121
    v_cvt_pk_bf16_f32 v187, v122, v123
    v_permlane32_swap_b32 v180, v182
    v_permlane32_swap_b32 v181, v183
    v_cvt_pk_bf16_f32 v117, v116, v117
    v_mov_b32 v204, 0
    v_mov_b32 v205, 0
    v_mfma_f32_16x16x32_bf16 v[12:15], a[188:191], v[152:155], v[12:15]
    v_cvt_pk_bf16_f32 v119, v118, v119
    v_lshlrev_b32 v116, 16, v117
    v_and_b32 v117, 0xffff0000, v117
    v_lshlrev_b32 v118, 16, v119
    v_and_b32 v119, 0xffff0000, v119
    v_mul_f32 v116, s53, v116
    v_mov_b32 v206, 0
    v_mov_b32 v207, 0
    v_mfma_f32_16x16x32_bf16 v[16:19], a[128:131], v[132:135], 0
    buffer_load_dwordx4 v254, s[12:15], s33 offen offset:0 lds
    v_mul_f32 v117, s53, v117
    v_mul_f32 v118, s53, v118
    v_mul_f32 v119, s53, v119
    v_cvt_pk_bf16_f32 v188, v116, v117
    v_cvt_pk_bf16_f32 v189, v118, v119
    v_mov_b32 v226, 0x3f803f80
    v_mov_b32 v227, 0x3f803f80
    v_mfma_f32_16x16x32_bf16 v[16:19], a[132:135], v[140:143], v[16:19]
    v_cvt_pk_bf16_f32 v125, v124, v125
    v_cvt_pk_bf16_f32 v127, v126, v127
    v_lshlrev_b32 v124, 16, v125
    v_and_b32 v125, 0xffff0000, v125
    v_lshlrev_b32 v126, 16, v127
    v_and_b32 v127, 0xffff0000, v127
    v_mov_b32 v228, 0x3f803f80
    v_mov_b32 v229, 0x3f803f80
    v_mfma_f32_16x16x32_bf16 v[16:19], a[136:139], v[148:151], v[16:19]
    buffer_load_dwordx4 v255, s[12:15], s33 offen offset:1024 lds
    v_mul_f32 v124, s53, v124
    v_mul_f32 v125, s53, v125
    v_mul_f32 v126, s53, v126
    v_mul_f32 v127, s53, v127
    v_cvt_pk_bf16_f32 v190, v124, v125
    v_mov_b32 v230, -1
    v_mov_b32 v231, -1
    v_mfma_f32_16x16x32_bf16 v[16:19], a[140:143], v[156:159], v[16:19]
    v_cvt_pk_bf16_f32 v191, v126, v127
    v_permlane32_swap_b32 v184, v186
    v_permlane32_swap_b32 v185, v187
    v_permlane32_swap_b32 v188, v190
    v_permlane32_swap_b32 v189, v191
    v_mov_b32 v232, -1
    v_mov_b32 v233, -1
    v_mfma_f32_16x16x32_bf16 v[20:23], a[144:147], v[132:135], 0
    buffer_load_dwordx4 v254, s[12:15], s33 offen offset:2048 lds
    v_max3_f32 v218, v0, v1, v2
    v_max3_f32 v219, v3, v4, v5
    v_max3_f32 v218, v218, v6, v7
    v_mfma_f32_16x16x32_bf16 v[20:23], a[148:151], v[140:143], v[20:23]
    v_bfe_u32 v112, v225, 4, 1
    v_max3_f32 v219, v219, v8, v9
    v_max3_f32 v218, v218, v10, v11
    v_mfma_f32_16x16x32_bf16 v[20:23], a[152:155], v[148:151], v[20:23]
    buffer_load_dwordx4 v255, s[12:15], s33 offen offset:3072 lds
    v_max3_f32 v219, v219, v12, v13
    v_max3_f32 v218, v218, v14, v15
    v_max_f32 v218, v218, v219
    v_mfma_f32_16x16x32_bf16 v[20:23], a[156:159], v[156:159], v[20:23]
    v_sub_u32 v112, 0, v112
    v_mov_b32 v219, v218
    s_nop 1
    v_permlane16_swap_b32 v218, v219
    v_mfma_f32_16x16x32_bf16 v[24:27], a[160:163], v[132:135], 0
    s_mov_b32 s32, 49152
    v_max_f32 v218, v218, v219
    v_mov_b32 v219, v218
    s_nop 1
    v_permlane32_swap_b32 v218, v219
    v_mfma_f32_16x16x32_bf16 v[24:27], a[164:167], v[140:143], v[24:27]
    v_and_b32 v112, 0xaaaaaaaa, v112
    v_max_f32 v218, v218, v219
    v_log_f32 v219, s34
    v_mfma_f32_16x16x32_bf16 v[24:27], a[168:171], v[148:151], v[24:27]
    s_add_u32 m0, s28, 0
    v_add_f32 v218, 0x42980000, v218
    v_sub_f32 v218, v218, v219
    v_sub_f32 v0, v0, v218
    v_mfma_f32_16x16x32_bf16 v[24:27], a[172:175], v[156:159], v[24:27]
    v_or_b32 v112, 0x44444444, v112
    v_sub_f32 v1, v1, v218
    v_sub_f32 v2, v2, v218
    v_mfma_f32_16x16x32_bf16 v[28:31], a[176:179], v[132:135], 0
    buffer_load_dwordx4 v250, s[8:11], s32 offen offset:0 lds
    v_sub_f32 v3, v3, v218
    v_sub_f32 v4, v4, v218
    v_sub_f32 v5, v5, v218
    v_mfma_f32_16x16x32_bf16 v[28:31], a[180:183], v[140:143], v[28:31]
    v_sub_f32 v6, v6, v218
    v_sub_f32 v7, v7, v218
    v_mfma_f32_16x16x32_bf16 v[28:31], a[184:187], v[148:151], v[28:31]
    buffer_load_dwordx4 v251, s[8:11], s32 offen offset:1024 lds
    v_sub_f32 v8, v8, v218
    v_sub_f32 v9, v9, v218
    v_sub_f32 v10, v10, v218
    v_mfma_f32_16x16x32_bf16 v[28:31], a[188:191], v[156:159], v[28:31]
    v_sub_f32 v11, v11, v218
    v_sub_f32 v12, v12, v218
    v_mfma_f32_16x16x32_bf16 v[32:35], a[128:131], v[160:163], 0
    buffer_load_dwordx4 v252, s[8:11], s32 offen offset:2048 lds
    v_sub_f32 v13, v13, v218
    v_sub_f32 v14, v14, v218
    v_sub_f32 v15, v15, v218
    v_mfma_f32_16x16x32_bf16 v[32:35], a[132:135], v[168:171], v[32:35]
    v_sub_f32 v96, 0, v218
    v_sub_f32 v97, 0, v218
    v_mfma_f32_16x16x32_bf16 v[32:35], a[136:139], v[176:179], v[32:35]
    buffer_load_dwordx4 v253, s[8:11], s32 offen offset:3072 lds
    v_sub_f32 v98, 0, v218
    v_sub_f32 v99, 0, v218
    v_mfma_f32_16x16x32_bf16 v[32:35], a[140:143], v[184:187], v[32:35]
    v_max3_f32 v220, v16, v17, v18
    v_max3_f32 v221, v19, v20, v21
    v_max3_f32 v220, v220, v22, v23
    v_mfma_f32_16x16x32_bf16 v[36:39], a[144:147], v[160:163], 0
    s_mov_b32 s33, 32768
    v_max3_f32 v221, v221, v24, v25
    v_max3_f32 v220, v220, v26, v27
    v_max3_f32 v221, v221, v28, v29
    v_mfma_f32_16x16x32_bf16 v[36:39], a[148:151], v[168:171], v[36:39]
    v_max3_f32 v220, v220, v30, v31
    v_max_f32 v220, v220, v221
    v_mov_b32 v221, v220
    v_mfma_f32_16x16x32_bf16 v[36:39], a[152:155], v[176:179], v[36:39]
    s_add_u32 m0, s28, 65536
    v_permlane16_swap_b32 v220, v221
    v_max_f32 v220, v220, v221
    v_mov_b32 v221, v220
    v_mfma_f32_16x16x32_bf16 v[36:39], a[156:159], v[184:187], v[36:39]
    s_nop 0
    v_permlane32_swap_b32 v220, v221
    v_max_f32 v220, v220, v221
    v_log_f32 v221, s34
    v_mfma_f32_16x16x32_bf16 v[40:43], a[160:163], v[160:163], 0
    buffer_load_dwordx4 v254, s[12:15], s33 offen offset:0 lds
    v_add_f32 v220, 0x42980000, v220
    v_sub_f32 v220, v220, v221
    v_sub_f32 v16, v16, v220
    v_mfma_f32_16x16x32_bf16 v[40:43], a[164:167], v[168:171], v[40:43]
    v_sub_f32 v17, v17, v220
    v_sub_f32 v18, v18, v220
    v_mfma_f32_16x16x32_bf16 v[40:43], a[168:171], v[176:179], v[40:43]
    buffer_load_dwordx4 v255, s[12:15], s33 offen offset:1024 lds
    v_sub_f32 v19, v19, v220
    v_sub_f32 v20, v20, v220
    v_sub_f32 v21, v21, v220
    v_mfma_f32_16x16x32_bf16 v[40:43], a[172:175], v[184:187], v[40:43]
    v_sub_f32 v22, v22, v220
    v_sub_f32 v23, v23, v220
    v_sub_f32 v24, v24, v220
    v_mfma_f32_16x16x32_bf16 v[44:47], a[176:179], v[160:163], 0
    buffer_load_dwordx4 v254, s[12:15], s33 offen offset:2048 lds
    v_sub_f32 v25, v25, v220
    v_sub_f32 v26, v26, v220
    v_sub_f32 v27, v27, v220
    v_mfma_f32_16x16x32_bf16 v[44:47], a[180:183], v[168:171], v[44:47]
    v_sub_f32 v28, v28, v220
    v_sub_f32 v29, v29, v220
    v_sub_f32 v30, v30, v220
    v_mfma_f32_16x16x32_bf16 v[44:47], a[184:187], v[176:179], v[44:47]
    buffer_load_dwordx4 v255, s[12:15], s33 offen offset:3072 lds
    v_sub_f32 v31, v31, v220
    v_sub_f32 v100, 0, v220
    v_sub_f32 v101, 0, v220
    v_mfma_f32_16x16x32_bf16 v[44:47], a[188:191], v[184:187], v[44:47]
    v_sub_f32 v102, 0, v220
    v_sub_f32 v103, 0, v220
    v_mfma_f32_16x16x32_bf16 v[48:51], a[128:131], v[164:167], 0
    v_exp_f32 v208, v0
    v_exp_f32 v209, v1
    v_mfma_f32_16x16x32_bf16 v[48:51], a[132:135], v[172:175], v[48:51]
    v_exp_f32 v210, v2
    v_mfma_f32_16x16x32_bf16 v[48:51], a[136:139], v[180:183], v[48:51]
    v_exp_f32 v211, v3
    v_mfma_f32_16x16x32_bf16 v[48:51], a[140:143], v[188:191], v[48:51]
    v_exp_f32 v212, v4
    v_mfma_f32_16x16x32_bf16 v[52:55], a[144:147], v[164:167], 0
    v_cvt_pk_bf16_f32 v64, v208, v209
    v_mfma_f32_16x16x32_bf16 v[52:55], a[148:151], v[172:175], v[52:55]
    v_cvt_pk_bf16_f32 v65, v210, v211
    v_mfma_f32_16x16x32_bf16 v[52:55], a[152:155], v[180:183], v[52:55]
    v_exp_f32 v213, v5
    v_mfma_f32_16x16x32_bf16 v[52:55], a[156:159], v[188:191], v[52:55]
    v_exp_f32 v214, v6
    v_mfma_f32_16x16x32_bf16 v[56:59], a[160:163], v[164:167], 0
    v_exp_f32 v215, v7
    v_exp_f32 v208, v8
    v_mfma_f32_16x16x32_bf16 v[56:59], a[164:167], v[172:175], v[56:59]
    v_cvt_pk_bf16_f32 v66, v212, v213
    v_mfma_f32_16x16x32_bf16 v[56:59], a[168:171], v[180:183], v[56:59]
    v_cvt_pk_bf16_f32 v67, v214, v215
    v_mfma_f32_16x16x32_bf16 v[56:59], a[172:175], v[188:191], v[56:59]
    v_exp_f32 v209, v9
    v_mfma_f32_16x16x32_bf16 v[60:63], a[176:179], v[164:167], 0
    v_exp_f32 v210, v10
    v_mfma_f32_16x16x32_bf16 v[60:63], a[180:183], v[172:175], v[60:63]
    v_exp_f32 v211, v11
    v_mfma_f32_16x16x32_bf16 v[60:63], a[184:187], v[180:183], v[60:63]
    v_exp_f32 v212, v12
    v_mfma_f32_16x16x32_bf16 v[60:63], a[188:191], v[188:191], v[60:63]
    v_cvt_pk_bf16_f32 v68, v208, v209
    v_cvt_pk_bf16_f32 v69, v210, v211
    v_exp_f32 v213, v13
    v_exp_f32 v214, v14
    v_exp_f32 v215, v15
    v_max3_f32 v218, v32, v33, v34
    v_max3_f32 v220, v48, v49, v50
    v_exp_f32 v208, v16
    v_max3_f32 v219, v35, v36, v37
    v_max3_f32 v221, v51, v52, v53
    v_cvt_pk_bf16_f32 v70, v212, v213
    v_max3_f32 v218, v218, v38, v39
    v_max3_f32 v220, v220, v54, v55
    v_cvt_pk_bf16_f32 v71, v214, v215
    v_max3_f32 v219, v219, v40, v41
    v_max3_f32 v221, v221, v56, v57
    v_exp_f32 v209, v17
    v_max3_f32 v218, v218, v42, v43
    v_max3_f32 v220, v220, v58, v59
    v_exp_f32 v210, v18
    v_max3_f32 v219, v219, v44, v45
    v_max3_f32 v221, v221, v60, v61
    v_exp_f32 v211, v19
    v_max3_f32 v218, v218, v46, v47
    v_max3_f32 v220, v220, v62, v63
    v_exp_f32 v212, v20
    v_max_f32 v218, v218, v219
    v_max_f32 v220, v220, v221
    v_cvt_pk_bf16_f32 v72, v208, v209
    v_mov_b32 v219, v218
    v_mov_b32 v221, v220
    v_cvt_pk_bf16_f32 v73, v210, v211
    v_permlane16_swap_b32 v218, v219
    v_permlane16_swap_b32 v220, v221
    v_exp_f32 v213, v21
    v_max_f32 v218, v218, v219
    v_max_f32 v220, v220, v221
    v_exp_f32 v214, v22
    v_mov_b32 v219, v218
    v_mov_b32 v221, v220
    v_exp_f32 v215, v23
    v_permlane32_swap_b32 v218, v219
    v_permlane32_swap_b32 v220, v221
    v_max_f32 v218, v218, v219
    v_max_f32 v220, v220, v221
    v_log_f32 v219, s34
    v_log_f32 v221, s34
    v_add_f32 v218, 0x42980000, v218
    v_add_f32 v220, 0x42980000, v220
    v_sub_f32 v218, v218, v219
    v_sub_f32 v220, v220, v221
    v_sub_f32 v104, 0, v218
    v_sub_f32 v108, 0, v220
    v_sub_f32 v105, 0, v218
    v_sub_f32 v109, 0, v220
    v_sub_f32 v106, 0, v218
    v_sub_f32 v110, 0, v220
    v_sub_f32 v107, 0, v218
    v_sub_f32 v111, 0, v220
    s_cmp_lg_u32 s40, 0
    s_cbranch_scc1 F_NOSIG
    s_cmp_ge_u32 s52, 108
    s_cbranch_scc1 F_NOSIG
    s_lshl_b32 s30, s52, 5
    s_add_u32 s30, s30, 8192
    v_mov_b32 v218, 0
    v_mov_b32 v219, s54
    s_mov_b64 exec, 1
    buffer_store_dword v219, v218, s[24:27], s30 offen sc1
    s_mov_b64 exec, -1
F_NOSIG:
    ds_write_b32 v242, v245
    s_waitcnt vmcnt(16) lgkmcnt(0)
    s_barrier
    s_mov_b32 s29, 65536
    s_mov_b32 s30, 49152
    s_mov_b32 s31, 7
    .p2align 6
K2_LOOP:
    v_mfma_f32_16x16x32_bf16 v[32:35], a[128:131], v[160:163], v[104:107]
    v_mov_b32 v245, s29
    v_mfma_f32_16x16x32_bf16 v[32:35], a[132:135], v[168:171], v[32:35]
    v_exp_f32 v208, v24
    v_mfma_f32_16x16x32_bf16 v[32:35], a[136:139], v[176:179], v[32:35]
    ds_read_b64_tr_b16 a[192:193], v234 offset:32768
    ds_read_b64_tr_b16 a[194:195], v234 offset:36864
    v_mfma_f32_16x16x32_bf16 v[32:35], a[140:143], v[184:187], v[32:35]
    v_cvt_pk_bf16_f32 v74, v212, v213
    v_cvt_pk_bf16_f32 v75, v214, v215
    v_smfmac_f32_16x16x64_bf16 v[192:195], v[226:229], v[64:71], v112
    ds_read_b64_tr_b16 a[196:197], v234 offset:40960
    ds_read_b64_tr_b16 a[198:199], v234 offset:45056
    v_mfma_f32_16x16x32_bf16 v[36:39], a[144:147], v[160:163], v[104:107]
    v_exp_f32 v209, v25
    v_mfma_f32_16x16x32_bf16 v[36:39], a[148:151], v[168:171], v[36:39]
    v_exp_f32 v210, v26
    v_mfma_f32_16x16x32_bf16 v[36:39], a[152:155], v[176:179], v[36:39]
    ds_read_b64_tr_b16 a[200:201], v235 offset:32768
    ds_read_b64_tr_b16 a[202:203], v235 offset:36864
    v_mfma_f32_16x16x32_bf16 v[36:39], a[156:159], v[184:187], v[36:39]
    ds_read_b64_tr_b16 a[204:205], v235 offset:40960
    v_cvt_pk_bf16_f32 v76, v208, v209
    v_mfma_f32_16x16x32_bf16 v[40:43], a[160:163], v[160:163], v[104:107]
    ds_read_b64_tr_b16 a[206:207], v235 offset:45056
    ds_read_b64_tr_b16 a[208:209], v236 offset:32768
    v_mfma_f32_16x16x32_bf16 v[40:43], a[164:167], v[168:171], v[40:43]
    v_exp_f32 v211, v27
    v_mfma_f32_16x16x32_bf16 v[40:43], a[168:171], v[176:179], v[40:43]
    v_exp_f32 v212, v28
    v_mfma_f32_16x16x32_bf16 v[40:43], a[172:175], v[184:187], v[40:43]
    ds_read_b64_tr_b16 a[210:211], v236 offset:36864
    ds_read_b64_tr_b16 a[212:213], v236 offset:40960
    v_mfma_f32_16x16x32_bf16 v[44:47], a[176:179], v[160:163], v[104:107]
    ds_read_b64_tr_b16 a[214:215], v236 offset:45056
    v_cvt_pk_bf16_f32 v77, v210, v211
    v_mfma_f32_16x16x32_bf16 v[44:47], a[180:183], v[168:171], v[44:47]
    ds_read_b64_tr_b16 a[216:217], v237 offset:32768
    ds_read_b64_tr_b16 a[218:219], v237 offset:36864
    v_mfma_f32_16x16x32_bf16 v[44:47], a[184:187], v[176:179], v[44:47]
    v_exp_f32 v213, v29
    v_mfma_f32_16x16x32_bf16 v[44:47], a[188:191], v[184:187], v[44:47]
    ds_read_b64_tr_b16 a[220:221], v237 offset:40960
    ds_read_b64_tr_b16 a[222:223], v237 offset:45056
    v_mfma_f32_16x16x32_bf16 v[48:51], a[128:131], v[164:167], v[108:111]
    v_exp_f32 v214, v30
    v_mfma_f32_16x16x32_bf16 v[48:51], a[132:135], v[172:175], v[48:51]
    ds_read_b64_tr_b16 a[224:225], v238 offset:32768
    v_cvt_pk_bf16_f32 v78, v212, v213
    v_mfma_f32_16x16x32_bf16 v[48:51], a[136:139], v[180:183], v[48:51]
    ds_read_b64_tr_b16 a[226:227], v238 offset:36864
    ds_read_b64_tr_b16 a[228:229], v238 offset:40960
    v_mfma_f32_16x16x32_bf16 v[48:51], a[140:143], v[188:191], v[48:51]
    v_exp_f32 v215, v31
    v_mfma_f32_16x16x32_bf16 v[52:55], a[144:147], v[164:167], v[108:111]
    ds_read_b64_tr_b16 a[230:231], v238 offset:45056
    ds_read_b64_tr_b16 a[232:233], v239 offset:32768
    v_mfma_f32_16x16x32_bf16 v[52:55], a[148:151], v[172:175], v[52:55]
    ds_read_b64_tr_b16 a[234:235], v239 offset:36864
    v_cvt_pk_bf16_f32 v79, v214, v215
    v_mfma_f32_16x16x32_bf16 v[52:55], a[152:155], v[180:183], v[52:55]
    ds_read_b64_tr_b16 a[236:237], v239 offset:40960
    ds_read_b64_tr_b16 a[238:239], v239 offset:45056
    v_mfma_f32_16x16x32_bf16 v[52:55], a[156:159], v[188:191], v[52:55]
    ds_read_b64_tr_b16 a[240:241], v240 offset:32768
    ds_read_b64_tr_b16 a[242:243], v240 offset:36864
    v_smfmac_f32_16x16x64_bf16 v[196:199], v[226:229], v[72:79], v112
    ds_read_b64_tr_b16 a[244:245], v240 offset:40960
    ds_read_b64_tr_b16 a[246:247], v240 offset:45056
    v_mfma_f32_16x16x32_bf16 v[56:59], a[160:163], v[164:167], v[108:111]
    ds_read_b64_tr_b16 a[248:249], v241 offset:32768
    ds_read_b64_tr_b16 a[250:251], v241 offset:36864
    v_mfma_f32_16x16x32_bf16 v[56:59], a[164:167], v[172:175], v[56:59]
    ds_read_b64_tr_b16 a[252:253], v241 offset:40960
    ds_read_b64_tr_b16 a[254:255], v241 offset:45056
    v_mfma_f32_16x16x32_bf16 v[56:59], a[168:171], v[180:183], v[56:59]
    s_add_u32 m0, s28, 16384
    v_mfma_f32_16x16x32_bf16 v[56:59], a[172:175], v[188:191], v[56:59]
    buffer_load_dwordx4 v250, s[8:11], s29 offen offset:0 lds
    v_mfma_f32_16x16x32_bf16 v[60:63], a[176:179], v[164:167], v[108:111]
    v_mfma_f32_16x16x32_bf16 v[60:63], a[180:183], v[172:175], v[60:63]
    v_max3_f32 v216, v192, v193, v196
    v_max_f32 v216, v216, v197
    v_mfma_f32_16x16x32_bf16 v[60:63], a[184:187], v[180:183], v[60:63]
    v_cmp_nge_f32 vcc, s34, v216
    v_mfma_f32_16x16x32_bf16 v[60:63], a[188:191], v[188:191], v[60:63]
    buffer_load_dwordx4 v251, s[8:11], s29 offen offset:1024 lds
    s_cbranch_vccnz RARE_L0_0
BACK_L0_0:
    s_waitcnt lgkmcnt(0)
    v_mfma_f32_16x16x32_bf16 a[0:3], a[192:195], v[64:67], a[0:3]
    v_exp_f32 v208, v32
    v_mfma_f32_16x16x32_bf16 a[0:3], a[196:199], v[68:71], a[0:3]
    v_exp_f32 v209, v33
    v_mfma_f32_16x16x32_bf16 a[4:7], a[200:203], v[64:67], a[4:7]
    ds_read_b128 a[128:131], v246 offset:32768
    ds_read_b128 a[132:135], v247 offset:32768
    v_mfma_f32_16x16x32_bf16 a[4:7], a[204:207], v[68:71], a[4:7]
    v_exp_f32 v210, v34
    v_mfma_f32_16x16x32_bf16 a[8:11], a[208:211], v[64:67], a[8:11]
    ds_read_b128 a[136:139], v248 offset:32768
    v_cvt_pk_bf16_f32 v80, v208, v209
    v_mfma_f32_16x16x32_bf16 a[8:11], a[212:215], v[68:71], a[8:11]
    v_exp_f32 v211, v35
    v_mfma_f32_16x16x32_bf16 a[12:15], a[216:219], v[64:67], a[12:15]
    v_exp_f32 v212, v36
    v_mfma_f32_16x16x32_bf16 a[12:15], a[220:223], v[68:71], a[12:15]
    ds_read_b128 a[140:143], v249 offset:32768
    v_cvt_pk_bf16_f32 v81, v210, v211
    v_mfma_f32_16x16x32_bf16 a[16:19], a[224:227], v[64:67], a[16:19]
    ds_read_b128 a[144:147], v246 offset:36864
    ds_read_b128 a[148:151], v247 offset:36864
    v_mfma_f32_16x16x32_bf16 a[16:19], a[228:231], v[68:71], a[16:19]
    v_exp_f32 v213, v37
    v_mfma_f32_16x16x32_bf16 a[20:23], a[232:235], v[64:67], a[20:23]
    v_exp_f32 v214, v38
    v_mfma_f32_16x16x32_bf16 a[20:23], a[236:239], v[68:71], a[20:23]
    ds_read_b128 a[152:155], v248 offset:36864
    v_cvt_pk_bf16_f32 v82, v212, v213
    v_mfma_f32_16x16x32_bf16 a[24:27], a[240:243], v[64:67], a[24:27]
    v_exp_f32 v215, v39
    v_mfma_f32_16x16x32_bf16 a[24:27], a[244:247], v[68:71], a[24:27]
    ds_read_b128 a[156:159], v249 offset:36864
    ds_read_b128 a[160:163], v246 offset:40960
    v_mfma_f32_16x16x32_bf16 a[28:31], a[248:251], v[64:67], a[28:31]
    v_exp_f32 v208, v40
    v_mfma_f32_16x16x32_bf16 a[28:31], a[252:255], v[68:71], a[28:31]
    ds_read_b128 a[164:167], v247 offset:40960
    v_cvt_pk_bf16_f32 v83, v214, v215
    v_mfma_f32_16x16x32_bf16 a[32:35], a[192:195], v[72:75], a[32:35]
    v_exp_f32 v209, v41
    v_mfma_f32_16x16x32_bf16 a[32:35], a[196:199], v[76:79], a[32:35]
    v_exp_f32 v210, v42
    v_mfma_f32_16x16x32_bf16 a[36:39], a[200:203], v[72:75], a[36:39]
    ds_read_b128 a[168:171], v248 offset:40960
    ds_read_b128 a[172:175], v249 offset:40960
    v_mfma_f32_16x16x32_bf16 a[36:39], a[204:207], v[76:79], a[36:39]
    ds_read_b128 a[176:179], v246 offset:45056
    v_cvt_pk_bf16_f32 v84, v208, v209
    v_mfma_f32_16x16x32_bf16 a[40:43], a[208:211], v[72:75], a[40:43]
    v_exp_f32 v211, v43
    v_mfma_f32_16x16x32_bf16 a[40:43], a[212:215], v[76:79], a[40:43]
    v_exp_f32 v212, v44
    v_mfma_f32_16x16x32_bf16 a[44:47], a[216:219], v[72:75], a[44:47]
    ds_read_b128 a[180:183], v247 offset:45056
    v_cvt_pk_bf16_f32 v85, v210, v211
    v_mfma_f32_16x16x32_bf16 a[44:47], a[220:223], v[76:79], a[44:47]
    v_exp_f32 v213, v45
    v_mfma_f32_16x16x32_bf16 a[48:51], a[224:227], v[72:75], a[48:51]
    ds_read_b128 a[184:187], v248 offset:45056
    ds_read_b128 a[188:191], v249 offset:45056
    v_mfma_f32_16x16x32_bf16 a[48:51], a[228:231], v[76:79], a[48:51]
    v_exp_f32 v214, v46
    v_mfma_f32_16x16x32_bf16 a[52:55], a[232:235], v[72:75], a[52:55]
    v_cvt_pk_bf16_f32 v86, v212, v213
    v_mfma_f32_16x16x32_bf16 a[52:55], a[236:239], v[76:79], a[52:55]
    v_exp_f32 v215, v47
    v_mfma_f32_16x16x32_bf16 a[56:59], a[240:243], v[72:75], a[56:59]
    v_exp_f32 v208, v48
    v_mfma_f32_16x16x32_bf16 a[56:59], a[244:247], v[76:79], a[56:59]
    buffer_load_dwordx4 v252, s[8:11], s29 offen offset:2048 lds
    v_mfma_f32_16x16x32_bf16 a[60:63], a[248:251], v[72:75], a[60:63]
    v_cvt_pk_bf16_f32 v87, v214, v215
    v_mfma_f32_16x16x32_bf16 a[60:63], a[252:255], v[76:79], a[60:63]
    v_exp_f32 v209, v49
    s_waitcnt lgkmcnt(0)
    v_mfma_f32_16x16x32_bf16 v[0:3], a[128:131], v[128:131], v[96:99]
    v_exp_f32 v210, v50
    v_mfma_f32_16x16x32_bf16 v[0:3], a[132:135], v[136:139], v[0:3]
    v_exp_f32 v211, v51
    v_mfma_f32_16x16x32_bf16 v[0:3], a[136:139], v[144:147], v[0:3]
    s_waitcnt vmcnt(11)
    ds_write_b32 v242, v245
    v_mfma_f32_16x16x32_bf16 v[0:3], a[140:143], v[152:155], v[0:3]
    v_exp_f32 v212, v52
    v_smfmac_f32_16x16x64_bf16 v[200:203], v[226:229], v[80:87], v112
    v_cvt_pk_bf16_f32 v88, v208, v209
    v_cvt_pk_bf16_f32 v89, v210, v211
    v_mfma_f32_16x16x32_bf16 v[4:7], a[144:147], v[128:131], v[96:99]
    v_exp_f32 v213, v53
    v_mfma_f32_16x16x32_bf16 v[4:7], a[148:151], v[136:139], v[4:7]
    buffer_load_dwordx4 v253, s[8:11], s29 offen offset:3072 lds
    v_mfma_f32_16x16x32_bf16 v[4:7], a[152:155], v[144:147], v[4:7]
    v_exp_f32 v214, v54
    v_mfma_f32_16x16x32_bf16 v[4:7], a[156:159], v[152:155], v[4:7]
    v_exp_f32 v215, v55
    v_mfma_f32_16x16x32_bf16 v[8:11], a[160:163], v[128:131], v[96:99]
    v_exp_f32 v208, v56
    v_mfma_f32_16x16x32_bf16 v[8:11], a[164:167], v[136:139], v[8:11]
    v_cvt_pk_bf16_f32 v90, v212, v213
    v_cvt_pk_bf16_f32 v91, v214, v215
    v_mfma_f32_16x16x32_bf16 v[8:11], a[168:171], v[144:147], v[8:11]
    s_add_u32 m0, s28, 81920
    v_mfma_f32_16x16x32_bf16 v[8:11], a[172:175], v[152:155], v[8:11]
    v_exp_f32 v209, v57
    v_mfma_f32_16x16x32_bf16 v[12:15], a[176:179], v[128:131], v[96:99]
    v_exp_f32 v210, v58
    v_mfma_f32_16x16x32_bf16 v[12:15], a[180:183], v[136:139], v[12:15]
    v_exp_f32 v211, v59
    v_mfma_f32_16x16x32_bf16 v[12:15], a[184:187], v[144:147], v[12:15]
    v_exp_f32 v212, v60
    v_mfma_f32_16x16x32_bf16 v[12:15], a[188:191], v[152:155], v[12:15]
    buffer_load_dwordx4 v254, s[12:15], s30 offen offset:0 lds
    v_mfma_f32_16x16x32_bf16 v[16:19], a[128:131], v[132:135], v[100:103]
    v_cvt_pk_bf16_f32 v92, v208, v209
    v_cvt_pk_bf16_f32 v93, v210, v211
    v_mfma_f32_16x16x32_bf16 v[16:19], a[132:135], v[140:143], v[16:19]
    v_exp_f32 v213, v61
    v_mfma_f32_16x16x32_bf16 v[16:19], a[136:139], v[148:151], v[16:19]
    v_exp_f32 v214, v62
    v_mfma_f32_16x16x32_bf16 v[16:19], a[140:143], v[156:159], v[16:19]
    buffer_load_dwordx4 v255, s[12:15], s30 offen offset:1024 lds
    v_mfma_f32_16x16x32_bf16 v[20:23], a[144:147], v[132:135], v[100:103]
    v_exp_f32 v215, v63
    v_mfma_f32_16x16x32_bf16 v[20:23], a[148:151], v[140:143], v[20:23]
    v_cvt_pk_bf16_f32 v94, v212, v213
    v_cvt_pk_bf16_f32 v95, v214, v215
    v_mfma_f32_16x16x32_bf16 v[20:23], a[152:155], v[148:151], v[20:23]
    buffer_load_dwordx4 v254, s[12:15], s30 offen offset:2048 lds
    v_mfma_f32_16x16x32_bf16 v[20:23], a[156:159], v[156:159], v[20:23]
    v_smfmac_f32_16x16x64_bf16 v[204:207], v[226:229], v[88:95], v112
    buffer_store_dwordx4 v[230:233], v225, s[24:27], s60 offen sc1
    v_mfma_f32_16x16x32_bf16 v[24:27], a[160:163], v[132:135], v[100:103]
    s_add_u32 s60, s60, 1024
    v_mfma_f32_16x16x32_bf16 v[24:27], a[164:167], v[140:143], v[24:27]
    buffer_load_dwordx4 v255, s[12:15], s30 offen offset:3072 lds
    v_mfma_f32_16x16x32_bf16 v[24:27], a[168:171], v[148:151], v[24:27]
    s_cmp_eq_u32 s31, 3
    s_cselect_b32 s60, s62, s60
    v_mfma_f32_16x16x32_bf16 v[24:27], a[172:175], v[156:159], v[24:27]
    buffer_load_dword v224, v217, s[56:59], s35 offen
    v_mfma_f32_16x16x32_bf16 v[28:31], a[176:179], v[132:135], v[100:103]
    s_add_u32 s35, s35, s3
    v_mfma_f32_16x16x32_bf16 v[28:31], a[180:183], v[140:143], v[28:31]
    v_max3_f32 v216, v200, v201, v204
    v_max_f32 v216, v216, v205
    v_mfma_f32_16x16x32_bf16 v[28:31], a[184:187], v[148:151], v[28:31]
    v_cmp_nge_f32 vcc, s34, v216
    v_mfma_f32_16x16x32_bf16 v[28:31], a[188:191], v[156:159], v[28:31]
    s_cbranch_vccnz RARE_L0_1
BACK_L0_1:
    v_mfma_f32_16x16x32_bf16 a[64:67], a[192:195], v[80:83], a[64:67]
    v_exp_f32 v208, v0
    v_mfma_f32_16x16x32_bf16 a[64:67], a[196:199], v[84:87], a[64:67]
    v_exp_f32 v209, v1
    v_mfma_f32_16x16x32_bf16 a[68:71], a[200:203], v[80:83], a[68:71]
    v_exp_f32 v210, v2
    v_mfma_f32_16x16x32_bf16 a[68:71], a[204:207], v[84:87], a[68:71]
    v_exp_f32 v211, v3
    v_mfma_f32_16x16x32_bf16 a[72:75], a[208:211], v[80:83], a[72:75]
    v_exp_f32 v212, v4
    v_mfma_f32_16x16x32_bf16 a[72:75], a[212:215], v[84:87], a[72:75]
    s_add_u32 s29, s29, 16384
    s_add_u32 s30, s30, 16384
    v_mfma_f32_16x16x32_bf16 a[76:79], a[216:219], v[80:83], a[76:79]
    v_cvt_pk_bf16_f32 v64, v208, v209
    v_cvt_pk_bf16_f32 v65, v210, v211
    v_mfma_f32_16x16x32_bf16 a[76:79], a[220:223], v[84:87], a[76:79]
    v_exp_f32 v213, v5
    v_mfma_f32_16x16x32_bf16 a[80:83], a[224:227], v[80:83], a[80:83]
    v_exp_f32 v214, v6
    v_mfma_f32_16x16x32_bf16 a[80:83], a[228:231], v[84:87], a[80:83]
    v_exp_f32 v215, v7
    v_mfma_f32_16x16x32_bf16 a[84:87], a[232:235], v[80:83], a[84:87]
    v_exp_f32 v208, v8
    v_mfma_f32_16x16x32_bf16 a[84:87], a[236:239], v[84:87], a[84:87]
    v_cvt_pk_bf16_f32 v66, v212, v213
    v_cvt_pk_bf16_f32 v67, v214, v215
    v_mfma_f32_16x16x32_bf16 a[88:91], a[240:243], v[80:83], a[88:91]
    v_exp_f32 v209, v9
    v_mfma_f32_16x16x32_bf16 a[88:91], a[244:247], v[84:87], a[88:91]
    v_exp_f32 v210, v10
    v_mfma_f32_16x16x32_bf16 a[92:95], a[248:251], v[80:83], a[92:95]
    v_exp_f32 v211, v11
    v_mfma_f32_16x16x32_bf16 a[92:95], a[252:255], v[84:87], a[92:95]
    v_exp_f32 v212, v12
    v_mfma_f32_16x16x32_bf16 a[96:99], a[192:195], v[88:91], a[96:99]
    ds_read_b32 v244, v243
    v_mfma_f32_16x16x32_bf16 a[96:99], a[196:199], v[92:95], a[96:99]
    v_cvt_pk_bf16_f32 v68, v208, v209
    v_cvt_pk_bf16_f32 v69, v210, v211
    v_mfma_f32_16x16x32_bf16 a[100:103], a[200:203], v[88:91], a[100:103]
    v_exp_f32 v213, v13
    v_mfma_f32_16x16x32_bf16 a[100:103], a[204:207], v[92:95], a[100:103]
    v_exp_f32 v214, v14
    v_mfma_f32_16x16x32_bf16 a[104:107], a[208:211], v[88:91], a[104:107]
    v_exp_f32 v215, v15
    v_mfma_f32_16x16x32_bf16 a[104:107], a[212:215], v[92:95], a[104:107]
    v_exp_f32 v208, v16
    v_mfma_f32_16x16x32_bf16 a[108:111], a[216:219], v[88:91], a[108:111]
    v_cvt_pk_bf16_f32 v70, v212, v213
    v_cvt_pk_bf16_f32 v71, v214, v215
    v_mfma_f32_16x16x32_bf16 a[108:111], a[220:223], v[92:95], a[108:111]
    v_exp_f32 v209, v17
    v_mfma_f32_16x16x32_bf16 a[112:115], a[224:227], v[88:91], a[112:115]
    v_exp_f32 v210, v18
    v_mfma_f32_16x16x32_bf16 a[112:115], a[228:231], v[92:95], a[112:115]
    v_exp_f32 v211, v19
    v_mfma_f32_16x16x32_bf16 a[116:119], a[232:235], v[88:91], a[116:119]
    s_waitcnt lgkmcnt(0)
    v_cmp_gt_u32 vcc, s30, v244
    v_mfma_f32_16x16x32_bf16 a[116:119], a[236:239], v[92:95], a[116:119]
    v_exp_f32 v212, v20
    v_mfma_f32_16x16x32_bf16 a[120:123], a[240:243], v[88:91], a[120:123]
    v_cvt_pk_bf16_f32 v72, v208, v209
    v_cvt_pk_bf16_f32 v73, v210, v211
    v_mfma_f32_16x16x32_bf16 a[120:123], a[244:247], v[92:95], a[120:123]
    v_exp_f32 v213, v21
    v_mfma_f32_16x16x32_bf16 a[124:127], a[248:251], v[88:91], a[124:127]
    v_exp_f32 v214, v22
    v_mfma_f32_16x16x32_bf16 a[124:127], a[252:255], v[92:95], a[124:127]
    v_exp_f32 v215, v23
    s_cbranch_vccnz LWAIT_L0
LBACK_L0:
    v_mfma_f32_16x16x32_bf16 v[32:35], a[128:131], v[160:163], v[104:107]
    v_mov_b32 v245, s29
    v_mfma_f32_16x16x32_bf16 v[32:35], a[132:135], v[168:171], v[32:35]
    v_exp_f32 v208, v24
    v_mfma_f32_16x16x32_bf16 v[32:35], a[136:139], v[176:179], v[32:35]
    ds_read_b64_tr_b16 a[192:193], v234 offset:49152
    ds_read_b64_tr_b16 a[194:195], v234 offset:53248
    v_mfma_f32_16x16x32_bf16 v[32:35], a[140:143], v[184:187], v[32:35]
    v_cvt_pk_bf16_f32 v74, v212, v213
    v_cvt_pk_bf16_f32 v75, v214, v215
    v_smfmac_f32_16x16x64_bf16 v[192:195], v[226:229], v[64:71], v112
    ds_read_b64_tr_b16 a[196:197], v234 offset:57344
    ds_read_b64_tr_b16 a[198:199], v234 offset:61440
    v_mfma_f32_16x16x32_bf16 v[36:39], a[144:147], v[160:163], v[104:107]
    v_exp_f32 v209, v25
    v_mfma_f32_16x16x32_bf16 v[36:39], a[148:151], v[168:171], v[36:39]
    v_exp_f32 v210, v26
    v_mfma_f32_16x16x32_bf16 v[36:39], a[152:155], v[176:179], v[36:39]
    ds_read_b64_tr_b16 a[200:201], v235 offset:49152
    ds_read_b64_tr_b16 a[202:203], v235 offset:53248
    v_mfma_f32_16x16x32_bf16 v[36:39], a[156:159], v[184:187], v[36:39]
    ds_read_b64_tr_b16 a[204:205], v235 offset:57344
    v_cvt_pk_bf16_f32 v76, v208, v209
    v_mfma_f32_16x16x32_bf16 v[40:43], a[160:163], v[160:163], v[104:107]
    ds_read_b64_tr_b16 a[206:207], v235 offset:61440
    ds_read_b64_tr_b16 a[208:209], v236 offset:49152
    v_mfma_f32_16x16x32_bf16 v[40:43], a[164:167], v[168:171], v[40:43]
    v_exp_f32 v211, v27
    v_mfma_f32_16x16x32_bf16 v[40:43], a[168:171], v[176:179], v[40:43]
    v_exp_f32 v212, v28
    v_mfma_f32_16x16x32_bf16 v[40:43], a[172:175], v[184:187], v[40:43]
    ds_read_b64_tr_b16 a[210:211], v236 offset:53248
    ds_read_b64_tr_b16 a[212:213], v236 offset:57344
    v_mfma_f32_16x16x32_bf16 v[44:47], a[176:179], v[160:163], v[104:107]
    ds_read_b64_tr_b16 a[214:215], v236 offset:61440
    v_cvt_pk_bf16_f32 v77, v210, v211
    v_mfma_f32_16x16x32_bf16 v[44:47], a[180:183], v[168:171], v[44:47]
    ds_read_b64_tr_b16 a[216:217], v237 offset:49152
    ds_read_b64_tr_b16 a[218:219], v237 offset:53248
    v_mfma_f32_16x16x32_bf16 v[44:47], a[184:187], v[176:179], v[44:47]
    v_exp_f32 v213, v29
    v_mfma_f32_16x16x32_bf16 v[44:47], a[188:191], v[184:187], v[44:47]
    ds_read_b64_tr_b16 a[220:221], v237 offset:57344
    ds_read_b64_tr_b16 a[222:223], v237 offset:61440
    v_mfma_f32_16x16x32_bf16 v[48:51], a[128:131], v[164:167], v[108:111]
    v_exp_f32 v214, v30
    v_mfma_f32_16x16x32_bf16 v[48:51], a[132:135], v[172:175], v[48:51]
    ds_read_b64_tr_b16 a[224:225], v238 offset:49152
    v_cvt_pk_bf16_f32 v78, v212, v213
    v_mfma_f32_16x16x32_bf16 v[48:51], a[136:139], v[180:183], v[48:51]
    ds_read_b64_tr_b16 a[226:227], v238 offset:53248
    ds_read_b64_tr_b16 a[228:229], v238 offset:57344
    v_mfma_f32_16x16x32_bf16 v[48:51], a[140:143], v[188:191], v[48:51]
    v_exp_f32 v215, v31
    v_mfma_f32_16x16x32_bf16 v[52:55], a[144:147], v[164:167], v[108:111]
    ds_read_b64_tr_b16 a[230:231], v238 offset:61440
    ds_read_b64_tr_b16 a[232:233], v239 offset:49152
    v_mfma_f32_16x16x32_bf16 v[52:55], a[148:151], v[172:175], v[52:55]
    ds_read_b64_tr_b16 a[234:235], v239 offset:53248
    v_cvt_pk_bf16_f32 v79, v214, v215
    v_mfma_f32_16x16x32_bf16 v[52:55], a[152:155], v[180:183], v[52:55]
    ds_read_b64_tr_b16 a[236:237], v239 offset:57344
    ds_read_b64_tr_b16 a[238:239], v239 offset:61440
    v_mfma_f32_16x16x32_bf16 v[52:55], a[156:159], v[188:191], v[52:55]
    ds_read_b64_tr_b16 a[240:241], v240 offset:49152
    ds_read_b64_tr_b16 a[242:243], v240 offset:53248
    v_smfmac_f32_16x16x64_bf16 v[196:199], v[226:229], v[72:79], v112
    ds_read_b64_tr_b16 a[244:245], v240 offset:57344
    ds_read_b64_tr_b16 a[246:247], v240 offset:61440
    v_mfma_f32_16x16x32_bf16 v[56:59], a[160:163], v[164:167], v[108:111]
    ds_read_b64_tr_b16 a[248:249], v241 offset:49152
    ds_read_b64_tr_b16 a[250:251], v241 offset:53248
    v_mfma_f32_16x16x32_bf16 v[56:59], a[164:167], v[172:175], v[56:59]
    ds_read_b64_tr_b16 a[252:253], v241 offset:57344
    ds_read_b64_tr_b16 a[254:255], v241 offset:61440
    v_mfma_f32_16x16x32_bf16 v[56:59], a[168:171], v[180:183], v[56:59]
    s_add_u32 m0, s28, 32768
    v_mfma_f32_16x16x32_bf16 v[56:59], a[172:175], v[188:191], v[56:59]
    buffer_load_dwordx4 v250, s[8:11], s29 offen offset:0 lds
    v_mfma_f32_16x16x32_bf16 v[60:63], a[176:179], v[164:167], v[108:111]
    v_mfma_f32_16x16x32_bf16 v[60:63], a[180:183], v[172:175], v[60:63]
    v_max3_f32 v216, v192, v193, v196
    v_max_f32 v216, v216, v197
    v_mfma_f32_16x16x32_bf16 v[60:63], a[184:187], v[180:183], v[60:63]
    v_cmp_nge_f32 vcc, s34, v216
    v_mfma_f32_16x16x32_bf16 v[60:63], a[188:191], v[188:191], v[60:63]
    buffer_load_dwordx4 v251, s[8:11], s29 offen offset:1024 lds
    s_cbranch_vccnz RARE_L1_0
BACK_L1_0:
    s_waitcnt lgkmcnt(0)
    v_mfma_f32_16x16x32_bf16 a[0:3], a[192:195], v[64:67], a[0:3]
    v_exp_f32 v208, v32
    v_mfma_f32_16x16x32_bf16 a[0:3], a[196:199], v[68:71], a[0:3]
    v_exp_f32 v209, v33
    v_mfma_f32_16x16x32_bf16 a[4:7], a[200:203], v[64:67], a[4:7]
    ds_read_b128 a[128:131], v246 offset:49152
    ds_read_b128 a[132:135], v247 offset:49152
    v_mfma_f32_16x16x32_bf16 a[4:7], a[204:207], v[68:71], a[4:7]
    v_exp_f32 v210, v34
    v_mfma_f32_16x16x32_bf16 a[8:11], a[208:211], v[64:67], a[8:11]
    ds_read_b128 a[136:139], v248 offset:49152
    v_cvt_pk_bf16_f32 v80, v208, v209
    v_mfma_f32_16x16x32_bf16 a[8:11], a[212:215], v[68:71], a[8:11]
    v_exp_f32 v211, v35
    v_mfma_f32_16x16x32_bf16 a[12:15], a[216:219], v[64:67], a[12:15]
    v_exp_f32 v212, v36
    v_mfma_f32_16x16x32_bf16 a[12:15], a[220:223], v[68:71], a[12:15]
    ds_read_b128 a[140:143], v249 offset:49152
    v_cvt_pk_bf16_f32 v81, v210, v211
    v_mfma_f32_16x16x32_bf16 a[16:19], a[224:227], v[64:67], a[16:19]
    ds_read_b128 a[144:147], v246 offset:53248
    ds_read_b128 a[148:151], v247 offset:53248
    v_mfma_f32_16x16x32_bf16 a[16:19], a[228:231], v[68:71], a[16:19]
    v_exp_f32 v213, v37
    v_mfma_f32_16x16x32_bf16 a[20:23], a[232:235], v[64:67], a[20:23]
    v_exp_f32 v214, v38
    v_mfma_f32_16x16x32_bf16 a[20:23], a[236:239], v[68:71], a[20:23]
    ds_read_b128 a[152:155], v248 offset:53248
    v_cvt_pk_bf16_f32 v82, v212, v213
    v_mfma_f32_16x16x32_bf16 a[24:27], a[240:243], v[64:67], a[24:27]
    v_exp_f32 v215, v39
    v_mfma_f32_16x16x32_bf16 a[24:27], a[244:247], v[68:71], a[24:27]
    ds_read_b128 a[156:159], v249 offset:53248
    ds_read_b128 a[160:163], v246 offset:57344
    v_mfma_f32_16x16x32_bf16 a[28:31], a[248:251], v[64:67], a[28:31]
    v_exp_f32 v208, v40
    v_mfma_f32_16x16x32_bf16 a[28:31], a[252:255], v[68:71], a[28:31]
    ds_read_b128 a[164:167], v247 offset:57344
    v_cvt_pk_bf16_f32 v83, v214, v215
    v_mfma_f32_16x16x32_bf16 a[32:35], a[192:195], v[72:75], a[32:35]
    v_exp_f32 v209, v41
    v_mfma_f32_16x16x32_bf16 a[32:35], a[196:199], v[76:79], a[32:35]
    v_exp_f32 v210, v42
    v_mfma_f32_16x16x32_bf16 a[36:39], a[200:203], v[72:75], a[36:39]
    ds_read_b128 a[168:171], v248 offset:57344
    ds_read_b128 a[172:175], v249 offset:57344
    v_mfma_f32_16x16x32_bf16 a[36:39], a[204:207], v[76:79], a[36:39]
    ds_read_b128 a[176:179], v246 offset:61440
    v_cvt_pk_bf16_f32 v84, v208, v209
    v_mfma_f32_16x16x32_bf16 a[40:43], a[208:211], v[72:75], a[40:43]
    v_exp_f32 v211, v43
    v_mfma_f32_16x16x32_bf16 a[40:43], a[212:215], v[76:79], a[40:43]
    v_exp_f32 v212, v44
    v_mfma_f32_16x16x32_bf16 a[44:47], a[216:219], v[72:75], a[44:47]
    ds_read_b128 a[180:183], v247 offset:61440
    v_cvt_pk_bf16_f32 v85, v210, v211
    v_mfma_f32_16x16x32_bf16 a[44:47], a[220:223], v[76:79], a[44:47]
    v_exp_f32 v213, v45
    v_mfma_f32_16x16x32_bf16 a[48:51], a[224:227], v[72:75], a[48:51]
    ds_read_b128 a[184:187], v248 offset:61440
    ds_read_b128 a[188:191], v249 offset:61440
    v_mfma_f32_16x16x32_bf16 a[48:51], a[228:231], v[76:79], a[48:51]
    v_exp_f32 v214, v46
    v_mfma_f32_16x16x32_bf16 a[52:55], a[232:235], v[72:75], a[52:55]
    v_cvt_pk_bf16_f32 v86, v212, v213
    v_mfma_f32_16x16x32_bf16 a[52:55], a[236:239], v[76:79], a[52:55]
    v_exp_f32 v215, v47
    v_mfma_f32_16x16x32_bf16 a[56:59], a[240:243], v[72:75], a[56:59]
    v_exp_f32 v208, v48
    v_mfma_f32_16x16x32_bf16 a[56:59], a[244:247], v[76:79], a[56:59]
    buffer_load_dwordx4 v252, s[8:11], s29 offen offset:2048 lds
    v_mfma_f32_16x16x32_bf16 a[60:63], a[248:251], v[72:75], a[60:63]
    v_cvt_pk_bf16_f32 v87, v214, v215
    v_mfma_f32_16x16x32_bf16 a[60:63], a[252:255], v[76:79], a[60:63]
    v_exp_f32 v209, v49
    s_waitcnt lgkmcnt(0)
    v_mfma_f32_16x16x32_bf16 v[0:3], a[128:131], v[128:131], v[96:99]
    v_exp_f32 v210, v50
    v_mfma_f32_16x16x32_bf16 v[0:3], a[132:135], v[136:139], v[0:3]
    v_exp_f32 v211, v51
    v_mfma_f32_16x16x32_bf16 v[0:3], a[136:139], v[144:147], v[0:3]
    s_waitcnt vmcnt(11)
    ds_write_b32 v242, v245
    v_mfma_f32_16x16x32_bf16 v[0:3], a[140:143], v[152:155], v[0:3]
    v_exp_f32 v212, v52
    v_smfmac_f32_16x16x64_bf16 v[200:203], v[226:229], v[80:87], v112
    v_cvt_pk_bf16_f32 v88, v208, v209
    v_cvt_pk_bf16_f32 v89, v210, v211
    v_mfma_f32_16x16x32_bf16 v[4:7], a[144:147], v[128:131], v[96:99]
    v_exp_f32 v213, v53
    v_mfma_f32_16x16x32_bf16 v[4:7], a[148:151], v[136:139], v[4:7]
    buffer_load_dwordx4 v253, s[8:11], s29 offen offset:3072 lds
    v_mfma_f32_16x16x32_bf16 v[4:7], a[152:155], v[144:147], v[4:7]
    v_exp_f32 v214, v54
    v_mfma_f32_16x16x32_bf16 v[4:7], a[156:159], v[152:155], v[4:7]
    v_exp_f32 v215, v55
    v_mfma_f32_16x16x32_bf16 v[8:11], a[160:163], v[128:131], v[96:99]
    v_exp_f32 v208, v56
    v_mfma_f32_16x16x32_bf16 v[8:11], a[164:167], v[136:139], v[8:11]
    v_cvt_pk_bf16_f32 v90, v212, v213
    v_cvt_pk_bf16_f32 v91, v214, v215
    v_mfma_f32_16x16x32_bf16 v[8:11], a[168:171], v[144:147], v[8:11]
    s_add_u32 m0, s28, 98304
    v_mfma_f32_16x16x32_bf16 v[8:11], a[172:175], v[152:155], v[8:11]
    v_exp_f32 v209, v57
    v_mfma_f32_16x16x32_bf16 v[12:15], a[176:179], v[128:131], v[96:99]
    v_exp_f32 v210, v58
    v_mfma_f32_16x16x32_bf16 v[12:15], a[180:183], v[136:139], v[12:15]
    v_exp_f32 v211, v59
    v_mfma_f32_16x16x32_bf16 v[12:15], a[184:187], v[144:147], v[12:15]
    v_exp_f32 v212, v60
    v_mfma_f32_16x16x32_bf16 v[12:15], a[188:191], v[152:155], v[12:15]
    buffer_load_dwordx4 v254, s[12:15], s30 offen offset:0 lds
    v_mfma_f32_16x16x32_bf16 v[16:19], a[128:131], v[132:135], v[100:103]
    v_cvt_pk_bf16_f32 v92, v208, v209
    v_cvt_pk_bf16_f32 v93, v210, v211
    v_mfma_f32_16x16x32_bf16 v[16:19], a[132:135], v[140:143], v[16:19]
    v_exp_f32 v213, v61
    v_mfma_f32_16x16x32_bf16 v[16:19], a[136:139], v[148:151], v[16:19]
    v_exp_f32 v214, v62
    v_mfma_f32_16x16x32_bf16 v[16:19], a[140:143], v[156:159], v[16:19]
    buffer_load_dwordx4 v255, s[12:15], s30 offen offset:1024 lds
    v_mfma_f32_16x16x32_bf16 v[20:23], a[144:147], v[132:135], v[100:103]
    v_exp_f32 v215, v63
    v_mfma_f32_16x16x32_bf16 v[20:23], a[148:151], v[140:143], v[20:23]
    v_cvt_pk_bf16_f32 v94, v212, v213
    v_cvt_pk_bf16_f32 v95, v214, v215
    v_mfma_f32_16x16x32_bf16 v[20:23], a[152:155], v[148:151], v[20:23]
    buffer_load_dwordx4 v254, s[12:15], s30 offen offset:2048 lds
    v_mfma_f32_16x16x32_bf16 v[20:23], a[156:159], v[156:159], v[20:23]
    v_smfmac_f32_16x16x64_bf16 v[204:207], v[226:229], v[88:95], v112
    v_mfma_f32_16x16x32_bf16 v[24:27], a[160:163], v[132:135], v[100:103]
    v_mfma_f32_16x16x32_bf16 v[24:27], a[164:167], v[140:143], v[24:27]
    buffer_load_dwordx4 v255, s[12:15], s30 offen offset:3072 lds
    v_mfma_f32_16x16x32_bf16 v[24:27], a[168:171], v[148:151], v[24:27]
    v_mfma_f32_16x16x32_bf16 v[24:27], a[172:175], v[156:159], v[24:27]
    buffer_load_dword v224, v217, s[56:59], s35 offen
    v_mfma_f32_16x16x32_bf16 v[28:31], a[176:179], v[132:135], v[100:103]
    s_add_u32 s35, s35, s3
    v_mfma_f32_16x16x32_bf16 v[28:31], a[180:183], v[140:143], v[28:31]
    v_max3_f32 v216, v200, v201, v204
    v_max_f32 v216, v216, v205
    v_mfma_f32_16x16x32_bf16 v[28:31], a[184:187], v[148:151], v[28:31]
    v_cmp_nge_f32 vcc, s34, v216
    v_mfma_f32_16x16x32_bf16 v[28:31], a[188:191], v[156:159], v[28:31]
    s_cbranch_vccnz RARE_L1_1
BACK_L1_1:
    v_mfma_f32_16x16x32_bf16 a[64:67], a[192:195], v[80:83], a[64:67]
    v_exp_f32 v208, v0
    v_mfma_f32_16x16x32_bf16 a[64:67], a[196:199], v[84:87], a[64:67]
    v_exp_f32 v209, v1
    v_mfma_f32_16x16x32_bf16 a[68:71], a[200:203], v[80:83], a[68:71]
    v_exp_f32 v210, v2
    v_mfma_f32_16x16x32_bf16 a[68:71], a[204:207], v[84:87], a[68:71]
    v_exp_f32 v211, v3
    v_mfma_f32_16x16x32_bf16 a[72:75], a[208:211], v[80:83], a[72:75]
    v_exp_f32 v212, v4
    v_mfma_f32_16x16x32_bf16 a[72:75], a[212:215], v[84:87], a[72:75]
    s_add_u32 s29, s29, 16384
    s_add_u32 s30, s30, 16384
    v_mfma_f32_16x16x32_bf16 a[76:79], a[216:219], v[80:83], a[76:79]
    v_cvt_pk_bf16_f32 v64, v208, v209
    v_cvt_pk_bf16_f32 v65, v210, v211
    v_mfma_f32_16x16x32_bf16 a[76:79], a[220:223], v[84:87], a[76:79]
    v_exp_f32 v213, v5
    v_mfma_f32_16x16x32_bf16 a[80:83], a[224:227], v[80:83], a[80:83]
    v_exp_f32 v214, v6
    v_mfma_f32_16x16x32_bf16 a[80:83], a[228:231], v[84:87], a[80:83]
    v_exp_f32 v215, v7
    v_mfma_f32_16x16x32_bf16 a[84:87], a[232:235], v[80:83], a[84:87]
    v_exp_f32 v208, v8
    v_mfma_f32_16x16x32_bf16 a[84:87], a[236:239], v[84:87], a[84:87]
    v_cvt_pk_bf16_f32 v66, v212, v213
    v_cvt_pk_bf16_f32 v67, v214, v215
    v_mfma_f32_16x16x32_bf16 a[88:91], a[240:243], v[80:83], a[88:91]
    v_exp_f32 v209, v9
    v_mfma_f32_16x16x32_bf16 a[88:91], a[244:247], v[84:87], a[88:91]
    v_exp_f32 v210, v10
    v_mfma_f32_16x16x32_bf16 a[92:95], a[248:251], v[80:83], a[92:95]
    v_exp_f32 v211, v11
    v_mfma_f32_16x16x32_bf16 a[92:95], a[252:255], v[84:87], a[92:95]
    v_exp_f32 v212, v12
    v_mfma_f32_16x16x32_bf16 a[96:99], a[192:195], v[88:91], a[96:99]
    ds_read_b32 v244, v243
    v_mfma_f32_16x16x32_bf16 a[96:99], a[196:199], v[92:95], a[96:99]
    v_cvt_pk_bf16_f32 v68, v208, v209
    v_cvt_pk_bf16_f32 v69, v210, v211
    v_mfma_f32_16x16x32_bf16 a[100:103], a[200:203], v[88:91], a[100:103]
    v_exp_f32 v213, v13
    v_mfma_f32_16x16x32_bf16 a[100:103], a[204:207], v[92:95], a[100:103]
    v_exp_f32 v214, v14
    v_mfma_f32_16x16x32_bf16 a[104:107], a[208:211], v[88:91], a[104:107]
    v_exp_f32 v215, v15
    v_mfma_f32_16x16x32_bf16 a[104:107], a[212:215], v[92:95], a[104:107]
    v_exp_f32 v208, v16
    v_mfma_f32_16x16x32_bf16 a[108:111], a[216:219], v[88:91], a[108:111]
    v_cvt_pk_bf16_f32 v70, v212, v213
    v_cvt_pk_bf16_f32 v71, v214, v215
    v_mfma_f32_16x16x32_bf16 a[108:111], a[220:223], v[92:95], a[108:111]
    v_exp_f32 v209, v17
    v_mfma_f32_16x16x32_bf16 a[112:115], a[224:227], v[88:91], a[112:115]
    v_exp_f32 v210, v18
    v_mfma_f32_16x16x32_bf16 a[112:115], a[228:231], v[92:95], a[112:115]
    v_exp_f32 v211, v19
    v_mfma_f32_16x16x32_bf16 a[116:119], a[232:235], v[88:91], a[116:119]
    s_waitcnt lgkmcnt(0)
    v_cmp_gt_u32 vcc, s30, v244
    v_mfma_f32_16x16x32_bf16 a[116:119], a[236:239], v[92:95], a[116:119]
    v_exp_f32 v212, v20
    v_mfma_f32_16x16x32_bf16 a[120:123], a[240:243], v[88:91], a[120:123]
    v_cvt_pk_bf16_f32 v72, v208, v209
    v_cvt_pk_bf16_f32 v73, v210, v211
    v_mfma_f32_16x16x32_bf16 a[120:123], a[244:247], v[92:95], a[120:123]
    v_exp_f32 v213, v21
    v_mfma_f32_16x16x32_bf16 a[124:127], a[248:251], v[88:91], a[124:127]
    v_exp_f32 v214, v22
    v_mfma_f32_16x16x32_bf16 a[124:127], a[252:255], v[92:95], a[124:127]
    v_exp_f32 v215, v23
    s_cbranch_vccnz LWAIT_L1
LBACK_L1:
    v_mfma_f32_16x16x32_bf16 v[32:35], a[128:131], v[160:163], v[104:107]
    v_mov_b32 v245, s29
    v_mfma_f32_16x16x32_bf16 v[32:35], a[132:135], v[168:171], v[32:35]
    v_exp_f32 v208, v24
    v_mfma_f32_16x16x32_bf16 v[32:35], a[136:139], v[176:179], v[32:35]
    ds_read_b64_tr_b16 a[192:193], v234 offset:0
    ds_read_b64_tr_b16 a[194:195], v234 offset:4096
    v_mfma_f32_16x16x32_bf16 v[32:35], a[140:143], v[184:187], v[32:35]
    v_cvt_pk_bf16_f32 v74, v212, v213
    v_cvt_pk_bf16_f32 v75, v214, v215
    v_smfmac_f32_16x16x64_bf16 v[192:195], v[226:229], v[64:71], v112
    ds_read_b64_tr_b16 a[196:197], v234 offset:8192
    ds_read_b64_tr_b16 a[198:199], v234 offset:12288
    v_mfma_f32_16x16x32_bf16 v[36:39], a[144:147], v[160:163], v[104:107]
    v_exp_f32 v209, v25
    v_mfma_f32_16x16x32_bf16 v[36:39], a[148:151], v[168:171], v[36:39]
    v_exp_f32 v210, v26
    v_mfma_f32_16x16x32_bf16 v[36:39], a[152:155], v[176:179], v[36:39]
    ds_read_b64_tr_b16 a[200:201], v235 offset:0
    ds_read_b64_tr_b16 a[202:203], v235 offset:4096
    v_mfma_f32_16x16x32_bf16 v[36:39], a[156:159], v[184:187], v[36:39]
    ds_read_b64_tr_b16 a[204:205], v235 offset:8192
    v_cvt_pk_bf16_f32 v76, v208, v209
    v_mfma_f32_16x16x32_bf16 v[40:43], a[160:163], v[160:163], v[104:107]
    ds_read_b64_tr_b16 a[206:207], v235 offset:12288
    ds_read_b64_tr_b16 a[208:209], v236 offset:0
    v_mfma_f32_16x16x32_bf16 v[40:43], a[164:167], v[168:171], v[40:43]
    v_exp_f32 v211, v27
    v_mfma_f32_16x16x32_bf16 v[40:43], a[168:171], v[176:179], v[40:43]
    v_exp_f32 v212, v28
    v_mfma_f32_16x16x32_bf16 v[40:43], a[172:175], v[184:187], v[40:43]
    ds_read_b64_tr_b16 a[210:211], v236 offset:4096
    ds_read_b64_tr_b16 a[212:213], v236 offset:8192
    v_mfma_f32_16x16x32_bf16 v[44:47], a[176:179], v[160:163], v[104:107]
    ds_read_b64_tr_b16 a[214:215], v236 offset:12288
    v_cvt_pk_bf16_f32 v77, v210, v211
    v_mfma_f32_16x16x32_bf16 v[44:47], a[180:183], v[168:171], v[44:47]
    ds_read_b64_tr_b16 a[216:217], v237 offset:0
    ds_read_b64_tr_b16 a[218:219], v237 offset:4096
    v_mfma_f32_16x16x32_bf16 v[44:47], a[184:187], v[176:179], v[44:47]
    v_exp_f32 v213, v29
    v_mfma_f32_16x16x32_bf16 v[44:47], a[188:191], v[184:187], v[44:47]
    ds_read_b64_tr_b16 a[220:221], v237 offset:8192
    ds_read_b64_tr_b16 a[222:223], v237 offset:12288
    v_mfma_f32_16x16x32_bf16 v[48:51], a[128:131], v[164:167], v[108:111]
    v_exp_f32 v214, v30
    v_mfma_f32_16x16x32_bf16 v[48:51], a[132:135], v[172:175], v[48:51]
    ds_read_b64_tr_b16 a[224:225], v238 offset:0
    v_cvt_pk_bf16_f32 v78, v212, v213
    v_mfma_f32_16x16x32_bf16 v[48:51], a[136:139], v[180:183], v[48:51]
    ds_read_b64_tr_b16 a[226:227], v238 offset:4096
    ds_read_b64_tr_b16 a[228:229], v238 offset:8192
    v_mfma_f32_16x16x32_bf16 v[48:51], a[140:143], v[188:191], v[48:51]
    v_exp_f32 v215, v31
    v_mfma_f32_16x16x32_bf16 v[52:55], a[144:147], v[164:167], v[108:111]
    ds_read_b64_tr_b16 a[230:231], v238 offset:12288
    ds_read_b64_tr_b16 a[232:233], v239 offset:0
    v_mfma_f32_16x16x32_bf16 v[52:55], a[148:151], v[172:175], v[52:55]
    ds_read_b64_tr_b16 a[234:235], v239 offset:4096
    v_cvt_pk_bf16_f32 v79, v214, v215
    v_mfma_f32_16x16x32_bf16 v[52:55], a[152:155], v[180:183], v[52:55]
    ds_read_b64_tr_b16 a[236:237], v239 offset:8192
    ds_read_b64_tr_b16 a[238:239], v239 offset:12288
    v_mfma_f32_16x16x32_bf16 v[52:55], a[156:159], v[188:191], v[52:55]
    ds_read_b64_tr_b16 a[240:241], v240 offset:0
    ds_read_b64_tr_b16 a[242:243], v240 offset:4096
    v_smfmac_f32_16x16x64_bf16 v[196:199], v[226:229], v[72:79], v112
    ds_read_b64_tr_b16 a[244:245], v240 offset:8192
    ds_read_b64_tr_b16 a[246:247], v240 offset:12288
    v_mfma_f32_16x16x32_bf16 v[56:59], a[160:163], v[164:167], v[108:111]
    ds_read_b64_tr_b16 a[248:249], v241 offset:0
    ds_read_b64_tr_b16 a[250:251], v241 offset:4096
    v_mfma_f32_16x16x32_bf16 v[56:59], a[164:167], v[172:175], v[56:59]
    ds_read_b64_tr_b16 a[252:253], v241 offset:8192
    ds_read_b64_tr_b16 a[254:255], v241 offset:12288
    v_mfma_f32_16x16x32_bf16 v[56:59], a[168:171], v[180:183], v[56:59]
    s_add_u32 m0, s28, 49152
    v_mfma_f32_16x16x32_bf16 v[56:59], a[172:175], v[188:191], v[56:59]
    buffer_load_dwordx4 v250, s[8:11], s29 offen offset:0 lds
    v_mfma_f32_16x16x32_bf16 v[60:63], a[176:179], v[164:167], v[108:111]
    v_mfma_f32_16x16x32_bf16 v[60:63], a[180:183], v[172:175], v[60:63]
    v_max3_f32 v216, v192, v193, v196
    v_max_f32 v216, v216, v197
    v_mfma_f32_16x16x32_bf16 v[60:63], a[184:187], v[180:183], v[60:63]
    v_cmp_nge_f32 vcc, s34, v216
    v_mfma_f32_16x16x32_bf16 v[60:63], a[188:191], v[188:191], v[60:63]
    buffer_load_dwordx4 v251, s[8:11], s29 offen offset:1024 lds
    s_cbranch_vccnz RARE_L2_0
BACK_L2_0:
    s_waitcnt lgkmcnt(0)
    v_mfma_f32_16x16x32_bf16 a[0:3], a[192:195], v[64:67], a[0:3]
    v_exp_f32 v208, v32
    v_mfma_f32_16x16x32_bf16 a[0:3], a[196:199], v[68:71], a[0:3]
    v_exp_f32 v209, v33
    v_mfma_f32_16x16x32_bf16 a[4:7], a[200:203], v[64:67], a[4:7]
    ds_read_b128 a[128:131], v246 offset:0
    ds_read_b128 a[132:135], v247 offset:0
    v_mfma_f32_16x16x32_bf16 a[4:7], a[204:207], v[68:71], a[4:7]
    v_exp_f32 v210, v34
    v_mfma_f32_16x16x32_bf16 a[8:11], a[208:211], v[64:67], a[8:11]
    ds_read_b128 a[136:139], v248 offset:0
    v_cvt_pk_bf16_f32 v80, v208, v209
    v_mfma_f32_16x16x32_bf16 a[8:11], a[212:215], v[68:71], a[8:11]
    v_exp_f32 v211, v35
    v_mfma_f32_16x16x32_bf16 a[12:15], a[216:219], v[64:67], a[12:15]
    v_exp_f32 v212, v36
    v_mfma_f32_16x16x32_bf16 a[12:15], a[220:223], v[68:71], a[12:15]
    ds_read_b128 a[140:143], v249 offset:0
    v_cvt_pk_bf16_f32 v81, v210, v211
    v_mfma_f32_16x16x32_bf16 a[16:19], a[224:227], v[64:67], a[16:19]
    ds_read_b128 a[144:147], v246 offset:4096
    ds_read_b128 a[148:151], v247 offset:4096
    v_mfma_f32_16x16x32_bf16 a[16:19], a[228:231], v[68:71], a[16:19]
    v_exp_f32 v213, v37
    v_mfma_f32_16x16x32_bf16 a[20:23], a[232:235], v[64:67], a[20:23]
    v_exp_f32 v214, v38
    v_mfma_f32_16x16x32_bf16 a[20:23], a[236:239], v[68:71], a[20:23]
    ds_read_b128 a[152:155], v248 offset:4096
    v_cvt_pk_bf16_f32 v82, v212, v213
    v_mfma_f32_16x16x32_bf16 a[24:27], a[240:243], v[64:67], a[24:27]
    v_exp_f32 v215, v39
    v_mfma_f32_16x16x32_bf16 a[24:27], a[244:247], v[68:71], a[24:27]
    ds_read_b128 a[156:159], v249 offset:4096
    ds_read_b128 a[160:163], v246 offset:8192
    v_mfma_f32_16x16x32_bf16 a[28:31], a[248:251], v[64:67], a[28:31]
    v_exp_f32 v208, v40
    v_mfma_f32_16x16x32_bf16 a[28:31], a[252:255], v[68:71], a[28:31]
    ds_read_b128 a[164:167], v247 offset:8192
    v_cvt_pk_bf16_f32 v83, v214, v215
    v_mfma_f32_16x16x32_bf16 a[32:35], a[192:195], v[72:75], a[32:35]
    v_exp_f32 v209, v41
    v_mfma_f32_16x16x32_bf16 a[32:35], a[196:199], v[76:79], a[32:35]
    v_exp_f32 v210, v42
    v_mfma_f32_16x16x32_bf16 a[36:39], a[200:203], v[72:75], a[36:39]
    ds_read_b128 a[168:171], v248 offset:8192
    ds_read_b128 a[172:175], v249 offset:8192
    v_mfma_f32_16x16x32_bf16 a[36:39], a[204:207], v[76:79], a[36:39]
    ds_read_b128 a[176:179], v246 offset:12288
    v_cvt_pk_bf16_f32 v84, v208, v209
    v_mfma_f32_16x16x32_bf16 a[40:43], a[208:211], v[72:75], a[40:43]
    v_exp_f32 v211, v43
    v_mfma_f32_16x16x32_bf16 a[40:43], a[212:215], v[76:79], a[40:43]
    v_exp_f32 v212, v44
    v_mfma_f32_16x16x32_bf16 a[44:47], a[216:219], v[72:75], a[44:47]
    ds_read_b128 a[180:183], v247 offset:12288
    v_cvt_pk_bf16_f32 v85, v210, v211
    v_mfma_f32_16x16x32_bf16 a[44:47], a[220:223], v[76:79], a[44:47]
    v_exp_f32 v213, v45
    v_mfma_f32_16x16x32_bf16 a[48:51], a[224:227], v[72:75], a[48:51]
    ds_read_b128 a[184:187], v248 offset:12288
    ds_read_b128 a[188:191], v249 offset:12288
    v_mfma_f32_16x16x32_bf16 a[48:51], a[228:231], v[76:79], a[48:51]
    v_exp_f32 v214, v46
    v_mfma_f32_16x16x32_bf16 a[52:55], a[232:235], v[72:75], a[52:55]
    v_cvt_pk_bf16_f32 v86, v212, v213
    v_mfma_f32_16x16x32_bf16 a[52:55], a[236:239], v[76:79], a[52:55]
    v_exp_f32 v215, v47
    v_mfma_f32_16x16x32_bf16 a[56:59], a[240:243], v[72:75], a[56:59]
    v_exp_f32 v208, v48
    v_mfma_f32_16x16x32_bf16 a[56:59], a[244:247], v[76:79], a[56:59]
    buffer_load_dwordx4 v252, s[8:11], s29 offen offset:2048 lds
    v_mfma_f32_16x16x32_bf16 a[60:63], a[248:251], v[72:75], a[60:63]
    v_cvt_pk_bf16_f32 v87, v214, v215
    v_mfma_f32_16x16x32_bf16 a[60:63], a[252:255], v[76:79], a[60:63]
    v_exp_f32 v209, v49
    s_waitcnt lgkmcnt(0)
    v_mfma_f32_16x16x32_bf16 v[0:3], a[128:131], v[128:131], v[96:99]
    v_exp_f32 v210, v50
    v_mfma_f32_16x16x32_bf16 v[0:3], a[132:135], v[136:139], v[0:3]
    v_exp_f32 v211, v51
    v_mfma_f32_16x16x32_bf16 v[0:3], a[136:139], v[144:147], v[0:3]
    s_waitcnt vmcnt(11)
    ds_write_b32 v242, v245
    v_mfma_f32_16x16x32_bf16 v[0:3], a[140:143], v[152:155], v[0:3]
    v_exp_f32 v212, v52
    v_smfmac_f32_16x16x64_bf16 v[200:203], v[226:229], v[80:87], v112
    v_cvt_pk_bf16_f32 v88, v208, v209
    v_cvt_pk_bf16_f32 v89, v210, v211
    v_mfma_f32_16x16x32_bf16 v[4:7], a[144:147], v[128:131], v[96:99]
    v_exp_f32 v213, v53
    v_mfma_f32_16x16x32_bf16 v[4:7], a[148:151], v[136:139], v[4:7]
    buffer_load_dwordx4 v253, s[8:11], s29 offen offset:3072 lds
    v_mfma_f32_16x16x32_bf16 v[4:7], a[152:155], v[144:147], v[4:7]
    v_exp_f32 v214, v54
    v_mfma_f32_16x16x32_bf16 v[4:7], a[156:159], v[152:155], v[4:7]
    v_exp_f32 v215, v55
    v_mfma_f32_16x16x32_bf16 v[8:11], a[160:163], v[128:131], v[96:99]
    v_exp_f32 v208, v56
    v_mfma_f32_16x16x32_bf16 v[8:11], a[164:167], v[136:139], v[8:11]
    v_cvt_pk_bf16_f32 v90, v212, v213
    v_cvt_pk_bf16_f32 v91, v214, v215
    v_mfma_f32_16x16x32_bf16 v[8:11], a[168:171], v[144:147], v[8:11]
    s_add_u32 m0, s28, 114688
    v_mfma_f32_16x16x32_bf16 v[8:11], a[172:175], v[152:155], v[8:11]
    v_exp_f32 v209, v57
    v_mfma_f32_16x16x32_bf16 v[12:15], a[176:179], v[128:131], v[96:99]
    v_exp_f32 v210, v58
    v_mfma_f32_16x16x32_bf16 v[12:15], a[180:183], v[136:139], v[12:15]
    v_exp_f32 v211, v59
    v_mfma_f32_16x16x32_bf16 v[12:15], a[184:187], v[144:147], v[12:15]
    v_exp_f32 v212, v60
    v_mfma_f32_16x16x32_bf16 v[12:15], a[188:191], v[152:155], v[12:15]
    buffer_load_dwordx4 v254, s[12:15], s30 offen offset:0 lds
    v_mfma_f32_16x16x32_bf16 v[16:19], a[128:131], v[132:135], v[100:103]
    v_cvt_pk_bf16_f32 v92, v208, v209
    v_cvt_pk_bf16_f32 v93, v210, v211
    v_mfma_f32_16x16x32_bf16 v[16:19], a[132:135], v[140:143], v[16:19]
    v_exp_f32 v213, v61
    v_mfma_f32_16x16x32_bf16 v[16:19], a[136:139], v[148:151], v[16:19]
    v_exp_f32 v214, v62
    v_mfma_f32_16x16x32_bf16 v[16:19], a[140:143], v[156:159], v[16:19]
    buffer_load_dwordx4 v255, s[12:15], s30 offen offset:1024 lds
    v_mfma_f32_16x16x32_bf16 v[20:23], a[144:147], v[132:135], v[100:103]
    v_exp_f32 v215, v63
    v_mfma_f32_16x16x32_bf16 v[20:23], a[148:151], v[140:143], v[20:23]
    v_cvt_pk_bf16_f32 v94, v212, v213
    v_cvt_pk_bf16_f32 v95, v214, v215
    v_mfma_f32_16x16x32_bf16 v[20:23], a[152:155], v[148:151], v[20:23]
    buffer_load_dwordx4 v254, s[12:15], s30 offen offset:2048 lds
    v_mfma_f32_16x16x32_bf16 v[20:23], a[156:159], v[156:159], v[20:23]
    v_smfmac_f32_16x16x64_bf16 v[204:207], v[226:229], v[88:95], v112
    v_mfma_f32_16x16x32_bf16 v[24:27], a[160:163], v[132:135], v[100:103]
    v_mfma_f32_16x16x32_bf16 v[24:27], a[164:167], v[140:143], v[24:27]
    buffer_load_dwordx4 v255, s[12:15], s30 offen offset:3072 lds
    v_mfma_f32_16x16x32_bf16 v[24:27], a[168:171], v[148:151], v[24:27]
    v_mfma_f32_16x16x32_bf16 v[24:27], a[172:175], v[156:159], v[24:27]
    buffer_load_dword v224, v217, s[56:59], s35 offen
    v_mfma_f32_16x16x32_bf16 v[28:31], a[176:179], v[132:135], v[100:103]
    s_add_u32 s35, s35, s3
    v_mfma_f32_16x16x32_bf16 v[28:31], a[180:183], v[140:143], v[28:31]
    v_max3_f32 v216, v200, v201, v204
    v_max_f32 v216, v216, v205
    v_mfma_f32_16x16x32_bf16 v[28:31], a[184:187], v[148:151], v[28:31]
    v_cmp_nge_f32 vcc, s34, v216
    v_mfma_f32_16x16x32_bf16 v[28:31], a[188:191], v[156:159], v[28:31]
    s_cbranch_vccnz RARE_L2_1
BACK_L2_1:
    v_mfma_f32_16x16x32_bf16 a[64:67], a[192:195], v[80:83], a[64:67]
    v_exp_f32 v208, v0
    v_mfma_f32_16x16x32_bf16 a[64:67], a[196:199], v[84:87], a[64:67]
    v_exp_f32 v209, v1
    v_mfma_f32_16x16x32_bf16 a[68:71], a[200:203], v[80:83], a[68:71]
    v_exp_f32 v210, v2
    v_mfma_f32_16x16x32_bf16 a[68:71], a[204:207], v[84:87], a[68:71]
    v_exp_f32 v211, v3
    v_mfma_f32_16x16x32_bf16 a[72:75], a[208:211], v[80:83], a[72:75]
    v_exp_f32 v212, v4
    v_mfma_f32_16x16x32_bf16 a[72:75], a[212:215], v[84:87], a[72:75]
    s_add_u32 s29, s29, 16384
    s_add_u32 s30, s30, 16384
    v_mfma_f32_16x16x32_bf16 a[76:79], a[216:219], v[80:83], a[76:79]
    v_cvt_pk_bf16_f32 v64, v208, v209
    v_cvt_pk_bf16_f32 v65, v210, v211
    v_mfma_f32_16x16x32_bf16 a[76:79], a[220:223], v[84:87], a[76:79]
    v_exp_f32 v213, v5
    v_mfma_f32_16x16x32_bf16 a[80:83], a[224:227], v[80:83], a[80:83]
    v_exp_f32 v214, v6
    v_mfma_f32_16x16x32_bf16 a[80:83], a[228:231], v[84:87], a[80:83]
    v_exp_f32 v215, v7
    v_mfma_f32_16x16x32_bf16 a[84:87], a[232:235], v[80:83], a[84:87]
    v_exp_f32 v208, v8
    v_mfma_f32_16x16x32_bf16 a[84:87], a[236:239], v[84:87], a[84:87]
    v_cvt_pk_bf16_f32 v66, v212, v213
    v_cvt_pk_bf16_f32 v67, v214, v215
    v_mfma_f32_16x16x32_bf16 a[88:91], a[240:243], v[80:83], a[88:91]
    v_exp_f32 v209, v9
    v_mfma_f32_16x16x32_bf16 a[88:91], a[244:247], v[84:87], a[88:91]
    v_exp_f32 v210, v10
    v_mfma_f32_16x16x32_bf16 a[92:95], a[248:251], v[80:83], a[92:95]
    v_exp_f32 v211, v11
    v_mfma_f32_16x16x32_bf16 a[92:95], a[252:255], v[84:87], a[92:95]
    v_exp_f32 v212, v12
    v_mfma_f32_16x16x32_bf16 a[96:99], a[192:195], v[88:91], a[96:99]
    ds_read_b32 v244, v243
    v_mfma_f32_16x16x32_bf16 a[96:99], a[196:199], v[92:95], a[96:99]
    v_cvt_pk_bf16_f32 v68, v208, v209
    v_cvt_pk_bf16_f32 v69, v210, v211
    v_mfma_f32_16x16x32_bf16 a[100:103], a[200:203], v[88:91], a[100:103]
    v_exp_f32 v213, v13
    v_mfma_f32_16x16x32_bf16 a[100:103], a[204:207], v[92:95], a[100:103]
    v_exp_f32 v214, v14
    v_mfma_f32_16x16x32_bf16 a[104:107], a[208:211], v[88:91], a[104:107]
    v_exp_f32 v215, v15
    v_mfma_f32_16x16x32_bf16 a[104:107], a[212:215], v[92:95], a[104:107]
    v_exp_f32 v208, v16
    v_mfma_f32_16x16x32_bf16 a[108:111], a[216:219], v[88:91], a[108:111]
    v_cvt_pk_bf16_f32 v70, v212, v213
    v_cvt_pk_bf16_f32 v71, v214, v215
    v_mfma_f32_16x16x32_bf16 a[108:111], a[220:223], v[92:95], a[108:111]
    v_exp_f32 v209, v17
    v_mfma_f32_16x16x32_bf16 a[112:115], a[224:227], v[88:91], a[112:115]
    v_exp_f32 v210, v18
    v_mfma_f32_16x16x32_bf16 a[112:115], a[228:231], v[92:95], a[112:115]
    v_exp_f32 v211, v19
    v_mfma_f32_16x16x32_bf16 a[116:119], a[232:235], v[88:91], a[116:119]
    s_waitcnt lgkmcnt(0)
    v_cmp_gt_u32 vcc, s30, v244
    v_mfma_f32_16x16x32_bf16 a[116:119], a[236:239], v[92:95], a[116:119]
    v_exp_f32 v212, v20
    v_mfma_f32_16x16x32_bf16 a[120:123], a[240:243], v[88:91], a[120:123]
    v_cvt_pk_bf16_f32 v72, v208, v209
    v_cvt_pk_bf16_f32 v73, v210, v211
    v_mfma_f32_16x16x32_bf16 a[120:123], a[244:247], v[92:95], a[120:123]
    v_exp_f32 v213, v21
    v_mfma_f32_16x16x32_bf16 a[124:127], a[248:251], v[88:91], a[124:127]
    v_exp_f32 v214, v22
    v_mfma_f32_16x16x32_bf16 a[124:127], a[252:255], v[92:95], a[124:127]
    v_exp_f32 v215, v23
    s_cbranch_vccnz LWAIT_L2
LBACK_L2:
    v_mfma_f32_16x16x32_bf16 v[32:35], a[128:131], v[160:163], v[104:107]
    v_mov_b32 v245, s29
    v_mfma_f32_16x16x32_bf16 v[32:35], a[132:135], v[168:171], v[32:35]
    v_exp_f32 v208, v24
    v_mfma_f32_16x16x32_bf16 v[32:35], a[136:139], v[176:179], v[32:35]
    ds_read_b64_tr_b16 a[192:193], v234 offset:16384
    ds_read_b64_tr_b16 a[194:195], v234 offset:20480
    v_mfma_f32_16x16x32_bf16 v[32:35], a[140:143], v[184:187], v[32:35]
    v_cvt_pk_bf16_f32 v74, v212, v213
    v_cvt_pk_bf16_f32 v75, v214, v215
    v_smfmac_f32_16x16x64_bf16 v[192:195], v[226:229], v[64:71], v112
    ds_read_b64_tr_b16 a[196:197], v234 offset:24576
    ds_read_b64_tr_b16 a[198:199], v234 offset:28672
    v_mfma_f32_16x16x32_bf16 v[36:39], a[144:147], v[160:163], v[104:107]
    v_exp_f32 v209, v25
    v_mfma_f32_16x16x32_bf16 v[36:39], a[148:151], v[168:171], v[36:39]
    v_exp_f32 v210, v26
    v_mfma_f32_16x16x32_bf16 v[36:39], a[152:155], v[176:179], v[36:39]
    ds_read_b64_tr_b16 a[200:201], v235 offset:16384
    ds_read_b64_tr_b16 a[202:203], v235 offset:20480
    v_mfma_f32_16x16x32_bf16 v[36:39], a[156:159], v[184:187], v[36:39]
    ds_read_b64_tr_b16 a[204:205], v235 offset:24576
    v_cvt_pk_bf16_f32 v76, v208, v209
    v_mfma_f32_16x16x32_bf16 v[40:43], a[160:163], v[160:163], v[104:107]
    ds_read_b64_tr_b16 a[206:207], v235 offset:28672
    ds_read_b64_tr_b16 a[208:209], v236 offset:16384
    v_mfma_f32_16x16x32_bf16 v[40:43], a[164:167], v[168:171], v[40:43]
    v_exp_f32 v211, v27
    v_mfma_f32_16x16x32_bf16 v[40:43], a[168:171], v[176:179], v[40:43]
    v_exp_f32 v212, v28
    v_mfma_f32_16x16x32_bf16 v[40:43], a[172:175], v[184:187], v[40:43]
    ds_read_b64_tr_b16 a[210:211], v236 offset:20480
    ds_read_b64_tr_b16 a[212:213], v236 offset:24576
    v_mfma_f32_16x16x32_bf16 v[44:47], a[176:179], v[160:163], v[104:107]
    ds_read_b64_tr_b16 a[214:215], v236 offset:28672
    v_cvt_pk_bf16_f32 v77, v210, v211
    v_mfma_f32_16x16x32_bf16 v[44:47], a[180:183], v[168:171], v[44:47]
    ds_read_b64_tr_b16 a[216:217], v237 offset:16384
    ds_read_b64_tr_b16 a[218:219], v237 offset:20480
    v_mfma_f32_16x16x32_bf16 v[44:47], a[184:187], v[176:179], v[44:47]
    v_exp_f32 v213, v29
    v_mfma_f32_16x16x32_bf16 v[44:47], a[188:191], v[184:187], v[44:47]
    ds_read_b64_tr_b16 a[220:221], v237 offset:24576
    ds_read_b64_tr_b16 a[222:223], v237 offset:28672
    v_mfma_f32_16x16x32_bf16 v[48:51], a[128:131], v[164:167], v[108:111]
    v_exp_f32 v214, v30
    v_mfma_f32_16x16x32_bf16 v[48:51], a[132:135], v[172:175], v[48:51]
    ds_read_b64_tr_b16 a[224:225], v238 offset:16384
    v_cvt_pk_bf16_f32 v78, v212, v213
    v_mfma_f32_16x16x32_bf16 v[48:51], a[136:139], v[180:183], v[48:51]
    ds_read_b64_tr_b16 a[226:227], v238 offset:20480
    ds_read_b64_tr_b16 a[228:229], v238 offset:24576
    v_mfma_f32_16x16x32_bf16 v[48:51], a[140:143], v[188:191], v[48:51]
    v_exp_f32 v215, v31
    v_mfma_f32_16x16x32_bf16 v[52:55], a[144:147], v[164:167], v[108:111]
    ds_read_b64_tr_b16 a[230:231], v238 offset:28672
    ds_read_b64_tr_b16 a[232:233], v239 offset:16384
    v_mfma_f32_16x16x32_bf16 v[52:55], a[148:151], v[172:175], v[52:55]
    ds_read_b64_tr_b16 a[234:235], v239 offset:20480
    v_cvt_pk_bf16_f32 v79, v214, v215
    v_mfma_f32_16x16x32_bf16 v[52:55], a[152:155], v[180:183], v[52:55]
    ds_read_b64_tr_b16 a[236:237], v239 offset:24576
    ds_read_b64_tr_b16 a[238:239], v239 offset:28672
    v_mfma_f32_16x16x32_bf16 v[52:55], a[156:159], v[188:191], v[52:55]
    ds_read_b64_tr_b16 a[240:241], v240 offset:16384
    ds_read_b64_tr_b16 a[242:243], v240 offset:20480
    v_smfmac_f32_16x16x64_bf16 v[196:199], v[226:229], v[72:79], v112
    ds_read_b64_tr_b16 a[244:245], v240 offset:24576
    ds_read_b64_tr_b16 a[246:247], v240 offset:28672
    v_mfma_f32_16x16x32_bf16 v[56:59], a[160:163], v[164:167], v[108:111]
    ds_read_b64_tr_b16 a[248:249], v241 offset:16384
    ds_read_b64_tr_b16 a[250:251], v241 offset:20480
    v_mfma_f32_16x16x32_bf16 v[56:59], a[164:167], v[172:175], v[56:59]
    ds_read_b64_tr_b16 a[252:253], v241 offset:24576
    ds_read_b64_tr_b16 a[254:255], v241 offset:28672
    v_mfma_f32_16x16x32_bf16 v[56:59], a[168:171], v[180:183], v[56:59]
    s_add_u32 m0, s28, 0
    v_mfma_f32_16x16x32_bf16 v[56:59], a[172:175], v[188:191], v[56:59]
    buffer_load_dwordx4 v250, s[8:11], s29 offen offset:0 lds
    v_mfma_f32_16x16x32_bf16 v[60:63], a[176:179], v[164:167], v[108:111]
    v_mfma_f32_16x16x32_bf16 v[60:63], a[180:183], v[172:175], v[60:63]
    v_max3_f32 v216, v192, v193, v196
    v_max_f32 v216, v216, v197
    v_mfma_f32_16x16x32_bf16 v[60:63], a[184:187], v[180:183], v[60:63]
    v_cmp_nge_f32 vcc, s34, v216
    v_mfma_f32_16x16x32_bf16 v[60:63], a[188:191], v[188:191], v[60:63]
    buffer_load_dwordx4 v251, s[8:11], s29 offen offset:1024 lds
    s_cbranch_vccnz RARE_L3_0
BACK_L3_0:
    s_waitcnt lgkmcnt(0)
    v_mfma_f32_16x16x32_bf16 a[0:3], a[192:195], v[64:67], a[0:3]
    v_exp_f32 v208, v32
    v_mfma_f32_16x16x32_bf16 a[0:3], a[196:199], v[68:71], a[0:3]
    v_exp_f32 v209, v33
    v_mfma_f32_16x16x32_bf16 a[4:7], a[200:203], v[64:67], a[4:7]
    ds_read_b128 a[128:131], v246 offset:16384
    ds_read_b128 a[132:135], v247 offset:16384
    v_mfma_f32_16x16x32_bf16 a[4:7], a[204:207], v[68:71], a[4:7]
    v_exp_f32 v210, v34
    v_mfma_f32_16x16x32_bf16 a[8:11], a[208:211], v[64:67], a[8:11]
    ds_read_b128 a[136:139], v248 offset:16384
    v_cvt_pk_bf16_f32 v80, v208, v209
    v_mfma_f32_16x16x32_bf16 a[8:11], a[212:215], v[68:71], a[8:11]
    v_exp_f32 v211, v35
    v_mfma_f32_16x16x32_bf16 a[12:15], a[216:219], v[64:67], a[12:15]
    v_exp_f32 v212, v36
    v_mfma_f32_16x16x32_bf16 a[12:15], a[220:223], v[68:71], a[12:15]
    ds_read_b128 a[140:143], v249 offset:16384
    v_cvt_pk_bf16_f32 v81, v210, v211
    v_mfma_f32_16x16x32_bf16 a[16:19], a[224:227], v[64:67], a[16:19]
    ds_read_b128 a[144:147], v246 offset:20480
    ds_read_b128 a[148:151], v247 offset:20480
    v_mfma_f32_16x16x32_bf16 a[16:19], a[228:231], v[68:71], a[16:19]
    v_exp_f32 v213, v37
    v_mfma_f32_16x16x32_bf16 a[20:23], a[232:235], v[64:67], a[20:23]
    v_exp_f32 v214, v38
    v_mfma_f32_16x16x32_bf16 a[20:23], a[236:239], v[68:71], a[20:23]
    ds_read_b128 a[152:155], v248 offset:20480
    v_cvt_pk_bf16_f32 v82, v212, v213
    v_mfma_f32_16x16x32_bf16 a[24:27], a[240:243], v[64:67], a[24:27]
    v_exp_f32 v215, v39
    v_mfma_f32_16x16x32_bf16 a[24:27], a[244:247], v[68:71], a[24:27]
    ds_read_b128 a[156:159], v249 offset:20480
    ds_read_b128 a[160:163], v246 offset:24576
    v_mfma_f32_16x16x32_bf16 a[28:31], a[248:251], v[64:67], a[28:31]
    v_exp_f32 v208, v40
    v_mfma_f32_16x16x32_bf16 a[28:31], a[252:255], v[68:71], a[28:31]
    ds_read_b128 a[164:167], v247 offset:24576
    v_cvt_pk_bf16_f32 v83, v214, v215
    v_mfma_f32_16x16x32_bf16 a[32:35], a[192:195], v[72:75], a[32:35]
    v_exp_f32 v209, v41
    v_mfma_f32_16x16x32_bf16 a[32:35], a[196:199], v[76:79], a[32:35]
    v_exp_f32 v210, v42
    v_mfma_f32_16x16x32_bf16 a[36:39], a[200:203], v[72:75], a[36:39]
    ds_read_b128 a[168:171], v248 offset:24576
    ds_read_b128 a[172:175], v249 offset:24576
    v_mfma_f32_16x16x32_bf16 a[36:39], a[204:207], v[76:79], a[36:39]
    ds_read_b128 a[176:179], v246 offset:28672
    v_cvt_pk_bf16_f32 v84, v208, v209
    v_mfma_f32_16x16x32_bf16 a[40:43], a[208:211], v[72:75], a[40:43]
    v_exp_f32 v211, v43
    v_mfma_f32_16x16x32_bf16 a[40:43], a[212:215], v[76:79], a[40:43]
    v_exp_f32 v212, v44
    v_mfma_f32_16x16x32_bf16 a[44:47], a[216:219], v[72:75], a[44:47]
    ds_read_b128 a[180:183], v247 offset:28672
    v_cvt_pk_bf16_f32 v85, v210, v211
    v_mfma_f32_16x16x32_bf16 a[44:47], a[220:223], v[76:79], a[44:47]
    v_exp_f32 v213, v45
    v_mfma_f32_16x16x32_bf16 a[48:51], a[224:227], v[72:75], a[48:51]
    ds_read_b128 a[184:187], v248 offset:28672
    ds_read_b128 a[188:191], v249 offset:28672
    v_mfma_f32_16x16x32_bf16 a[48:51], a[228:231], v[76:79], a[48:51]
    v_exp_f32 v214, v46
    v_mfma_f32_16x16x32_bf16 a[52:55], a[232:235], v[72:75], a[52:55]
    v_cvt_pk_bf16_f32 v86, v212, v213
    v_mfma_f32_16x16x32_bf16 a[52:55], a[236:239], v[76:79], a[52:55]
    v_exp_f32 v215, v47
    v_mfma_f32_16x16x32_bf16 a[56:59], a[240:243], v[72:75], a[56:59]
    v_exp_f32 v208, v48
    v_mfma_f32_16x16x32_bf16 a[56:59], a[244:247], v[76:79], a[56:59]
    buffer_load_dwordx4 v252, s[8:11], s29 offen offset:2048 lds
    v_mfma_f32_16x16x32_bf16 a[60:63], a[248:251], v[72:75], a[60:63]
    v_cvt_pk_bf16_f32 v87, v214, v215
    v_mfma_f32_16x16x32_bf16 a[60:63], a[252:255], v[76:79], a[60:63]
    v_exp_f32 v209, v49
    s_waitcnt lgkmcnt(0)
    v_mfma_f32_16x16x32_bf16 v[0:3], a[128:131], v[128:131], v[96:99]
    v_exp_f32 v210, v50
    v_mfma_f32_16x16x32_bf16 v[0:3], a[132:135], v[136:139], v[0:3]
    v_exp_f32 v211, v51
    v_mfma_f32_16x16x32_bf16 v[0:3], a[136:139], v[144:147], v[0:3]
    s_waitcnt vmcnt(11)
    ds_write_b32 v242, v245
    v_mfma_f32_16x16x32_bf16 v[0:3], a[140:143], v[152:155], v[0:3]
    v_exp_f32 v212, v52
    v_smfmac_f32_16x16x64_bf16 v[200:203], v[226:229], v[80:87], v112
    v_cvt_pk_bf16_f32 v88, v208, v209
    v_cvt_pk_bf16_f32 v89, v210, v211
    v_mfma_f32_16x16x32_bf16 v[4:7], a[144:147], v[128:131], v[96:99]
    v_exp_f32 v213, v53
    v_mfma_f32_16x16x32_bf16 v[4:7], a[148:151], v[136:139], v[4:7]
    buffer_load_dwordx4 v253, s[8:11], s29 offen offset:3072 lds
    v_mfma_f32_16x16x32_bf16 v[4:7], a[152:155], v[144:147], v[4:7]
    v_exp_f32 v214, v54
    v_mfma_f32_16x16x32_bf16 v[4:7], a[156:159], v[152:155], v[4:7]
    v_exp_f32 v215, v55
    v_mfma_f32_16x16x32_bf16 v[8:11], a[160:163], v[128:131], v[96:99]
    v_exp_f32 v208, v56
    v_mfma_f32_16x16x32_bf16 v[8:11], a[164:167], v[136:139], v[8:11]
    v_cvt_pk_bf16_f32 v90, v212, v213
    v_cvt_pk_bf16_f32 v91, v214, v215
    v_mfma_f32_16x16x32_bf16 v[8:11], a[168:171], v[144:147], v[8:11]
    s_add_u32 m0, s28, 65536
    v_mfma_f32_16x16x32_bf16 v[8:11], a[172:175], v[152:155], v[8:11]
    v_exp_f32 v209, v57
    v_mfma_f32_16x16x32_bf16 v[12:15], a[176:179], v[128:131], v[96:99]
    v_exp_f32 v210, v58
    v_mfma_f32_16x16x32_bf16 v[12:15], a[180:183], v[136:139], v[12:15]
    v_exp_f32 v211, v59
    v_mfma_f32_16x16x32_bf16 v[12:15], a[184:187], v[144:147], v[12:15]
    v_exp_f32 v212, v60
    v_mfma_f32_16x16x32_bf16 v[12:15], a[188:191], v[152:155], v[12:15]
    buffer_load_dwordx4 v254, s[12:15], s30 offen offset:0 lds
    v_mfma_f32_16x16x32_bf16 v[16:19], a[128:131], v[132:135], v[100:103]
    v_cvt_pk_bf16_f32 v92, v208, v209
    v_cvt_pk_bf16_f32 v93, v210, v211
    v_mfma_f32_16x16x32_bf16 v[16:19], a[132:135], v[140:143], v[16:19]
    v_exp_f32 v213, v61
    v_mfma_f32_16x16x32_bf16 v[16:19], a[136:139], v[148:151], v[16:19]
    v_exp_f32 v214, v62
    v_mfma_f32_16x16x32_bf16 v[16:19], a[140:143], v[156:159], v[16:19]
    buffer_load_dwordx4 v255, s[12:15], s30 offen offset:1024 lds
    v_mfma_f32_16x16x32_bf16 v[20:23], a[144:147], v[132:135], v[100:103]
    v_exp_f32 v215, v63
    v_mfma_f32_16x16x32_bf16 v[20:23], a[148:151], v[140:143], v[20:23]
    v_cvt_pk_bf16_f32 v94, v212, v213
    v_cvt_pk_bf16_f32 v95, v214, v215
    v_mfma_f32_16x16x32_bf16 v[20:23], a[152:155], v[148:151], v[20:23]
    buffer_load_dwordx4 v254, s[12:15], s30 offen offset:2048 lds
    v_mfma_f32_16x16x32_bf16 v[20:23], a[156:159], v[156:159], v[20:23]
    v_smfmac_f32_16x16x64_bf16 v[204:207], v[226:229], v[88:95], v112
    v_mfma_f32_16x16x32_bf16 v[24:27], a[160:163], v[132:135], v[100:103]
    v_mfma_f32_16x16x32_bf16 v[24:27], a[164:167], v[140:143], v[24:27]
    buffer_load_dwordx4 v255, s[12:15], s30 offen offset:3072 lds
    v_mfma_f32_16x16x32_bf16 v[24:27], a[168:171], v[148:151], v[24:27]
    v_mfma_f32_16x16x32_bf16 v[24:27], a[172:175], v[156:159], v[24:27]
    buffer_load_dword v224, v217, s[56:59], s35 offen
    v_mfma_f32_16x16x32_bf16 v[28:31], a[176:179], v[132:135], v[100:103]
    s_add_u32 s35, s35, s3
    v_mfma_f32_16x16x32_bf16 v[28:31], a[180:183], v[140:143], v[28:31]
    v_max3_f32 v216, v200, v201, v204
    v_max_f32 v216, v216, v205
    v_mfma_f32_16x16x32_bf16 v[28:31], a[184:187], v[148:151], v[28:31]
    v_cmp_nge_f32 vcc, s34, v216
    v_mfma_f32_16x16x32_bf16 v[28:31], a[188:191], v[156:159], v[28:31]
    s_cbranch_vccnz RARE_L3_1
BACK_L3_1:
    v_mfma_f32_16x16x32_bf16 a[64:67], a[192:195], v[80:83], a[64:67]
    v_exp_f32 v208, v0
    v_mfma_f32_16x16x32_bf16 a[64:67], a[196:199], v[84:87], a[64:67]
    v_exp_f32 v209, v1
    v_mfma_f32_16x16x32_bf16 a[68:71], a[200:203], v[80:83], a[68:71]
    v_exp_f32 v210, v2
    v_mfma_f32_16x16x32_bf16 a[68:71], a[204:207], v[84:87], a[68:71]
    v_exp_f32 v211, v3
    v_mfma_f32_16x16x32_bf16 a[72:75], a[208:211], v[80:83], a[72:75]
    v_exp_f32 v212, v4
    v_mfma_f32_16x16x32_bf16 a[72:75], a[212:215], v[84:87], a[72:75]
    s_add_u32 s29, s29, 16384
    s_add_u32 s30, s30, 16384
    v_mfma_f32_16x16x32_bf16 a[76:79], a[216:219], v[80:83], a[76:79]
    v_cvt_pk_bf16_f32 v64, v208, v209
    v_cvt_pk_bf16_f32 v65, v210, v211
    v_mfma_f32_16x16x32_bf16 a[76:79], a[220:223], v[84:87], a[76:79]
    v_exp_f32 v213, v5
    v_mfma_f32_16x16x32_bf16 a[80:83], a[224:227], v[80:83], a[80:83]
    v_exp_f32 v214, v6
    v_mfma_f32_16x16x32_bf16 a[80:83], a[228:231], v[84:87], a[80:83]
    v_exp_f32 v215, v7
    v_mfma_f32_16x16x32_bf16 a[84:87], a[232:235], v[80:83], a[84:87]
    v_exp_f32 v208, v8
    v_mfma_f32_16x16x32_bf16 a[84:87], a[236:239], v[84:87], a[84:87]
    v_cvt_pk_bf16_f32 v66, v212, v213
    v_cvt_pk_bf16_f32 v67, v214, v215
    v_mfma_f32_16x16x32_bf16 a[88:91], a[240:243], v[80:83], a[88:91]
    v_exp_f32 v209, v9
    v_mfma_f32_16x16x32_bf16 a[88:91], a[244:247], v[84:87], a[88:91]
    v_exp_f32 v210, v10
    v_mfma_f32_16x16x32_bf16 a[92:95], a[248:251], v[80:83], a[92:95]
    v_exp_f32 v211, v11
    v_mfma_f32_16x16x32_bf16 a[92:95], a[252:255], v[84:87], a[92:95]
    v_exp_f32 v212, v12
    v_mfma_f32_16x16x32_bf16 a[96:99], a[192:195], v[88:91], a[96:99]
    s_sub_u32 s31, s31, 1
    s_cmp_lg_u32 s31, 0
    ds_read_b32 v244, v243
    v_mfma_f32_16x16x32_bf16 a[96:99], a[196:199], v[92:95], a[96:99]
    v_cvt_pk_bf16_f32 v68, v208, v209
    v_cvt_pk_bf16_f32 v69, v210, v211
    v_mfma_f32_16x16x32_bf16 a[100:103], a[200:203], v[88:91], a[100:103]
    v_exp_f32 v213, v13
    v_mfma_f32_16x16x32_bf16 a[100:103], a[204:207], v[92:95], a[100:103]
    v_exp_f32 v214, v14
    v_mfma_f32_16x16x32_bf16 a[104:107], a[208:211], v[88:91], a[104:107]
    v_exp_f32 v215, v15
    v_mfma_f32_16x16x32_bf16 a[104:107], a[212:215], v[92:95], a[104:107]
    v_exp_f32 v208, v16
    v_mfma_f32_16x16x32_bf16 a[108:111], a[216:219], v[88:91], a[108:111]
    v_cvt_pk_bf16_f32 v70, v212, v213
    v_cvt_pk_bf16_f32 v71, v214, v215
    v_mfma_f32_16x16x32_bf16 a[108:111], a[220:223], v[92:95], a[108:111]
    v_exp_f32 v209, v17
    v_mfma_f32_16x16x32_bf16 a[112:115], a[224:227], v[88:91], a[112:115]
    v_exp_f32 v210, v18
    v_mfma_f32_16x16x32_bf16 a[112:115], a[228:231], v[92:95], a[112:115]
    v_exp_f32 v211, v19
    v_mfma_f32_16x16x32_bf16 a[116:119], a[232:235], v[88:91], a[116:119]
    s_waitcnt lgkmcnt(0)
    v_cmp_gt_u32 vcc, s30, v244
    v_mfma_f32_16x16x32_bf16 a[116:119], a[236:239], v[92:95], a[116:119]
    v_exp_f32 v212, v20
    v_mfma_f32_16x16x32_bf16 a[120:123], a[240:243], v[88:91], a[120:123]
    v_cvt_pk_bf16_f32 v72, v208, v209
    v_cvt_pk_bf16_f32 v73, v210, v211
    v_mfma_f32_16x16x32_bf16 a[120:123], a[244:247], v[92:95], a[120:123]
    v_exp_f32 v213, v21
    v_mfma_f32_16x16x32_bf16 a[124:127], a[248:251], v[88:91], a[124:127]
    v_exp_f32 v214, v22
    v_mfma_f32_16x16x32_bf16 a[124:127], a[252:255], v[92:95], a[124:127]
    v_exp_f32 v215, v23
    s_cbranch_vccnz LWAIT_L3
LBACK_L3:
    s_cbranch_scc1 K2_LOOP
    v_lshrrev_b32 v218, 4, v225
    s_lshl_b32 s43, s40, 6
    v_add_u32 v218, s43, v218
    s_getpc_b64 s[44:45]
TC4895_BACK_T28_1:
    s_add_u32 s44, s44, BACK_T28_1-TC4895_BACK_T28_1
    s_addc_u32 s45, s45, 0
    v_min_u32 v219, (K2_END-BACK_T28_1-1)/128, v218
    v_lshlrev_b32 v219, 7, v219
    global_load_dword v224, v219, s[44:45]
    v_add_u32 v219, 256, v218
    v_min_u32 v219, (K2_END-BACK_T28_1-1)/128, v219
    v_lshlrev_b32 v219, 7, v219
    global_load_dword v224, v219, s[44:45]
    buffer_store_dwordx4 v[230:233], v225, s[24:27], s62 offen offset:1280 sc1
    v_lshlrev_b32 v218, 1, v225
    s_mov_b32 s43, 9344
    buffer_load_dword v230, v218, s[24:27], s43 offen sc1
    buffer_load_dword v231, v218, s[24:27], s43 offen offset:256 sc1
    s_bitcmp1_b32 s41, 0
    s_cselect_b32 s3, 295552, 0
    s_cselect_b32 s55, 0, 294272
    s_add_u32 s55, s55, 640
    s_load_dwordx2 s[44:45], s[0:1], 0
    s_load_dwordx2 s[46:47], s[0:1], 48
    s_load_dwordx4 s[48:51], s[0:1], 56
    s_load_dwordx2 s[52:53], s[0:1], 72
    s_load_dwordx2 s[16:17], s[0:1], 96
    v_mfma_f32_16x16x32_bf16 v[32:35], a[128:131], v[160:163], v[104:107]
    s_waitcnt vmcnt(21)
    s_barrier
    v_mfma_f32_16x16x32_bf16 v[32:35], a[132:135], v[168:171], v[32:35]
    v_exp_f32 v208, v24
    v_mfma_f32_16x16x32_bf16 v[32:35], a[136:139], v[176:179], v[32:35]
    ds_read_b64_tr_b16 a[192:193], v234 offset:32768
    ds_read_b64_tr_b16 a[194:195], v234 offset:36864
    v_mfma_f32_16x16x32_bf16 v[32:35], a[140:143], v[184:187], v[32:35]
    v_cvt_pk_bf16_f32 v74, v212, v213
    v_cvt_pk_bf16_f32 v75, v214, v215
    v_smfmac_f32_16x16x64_bf16 v[192:195], v[226:229], v[64:71], v112
    ds_read_b64_tr_b16 a[196:197], v234 offset:40960
    ds_read_b64_tr_b16 a[198:199], v234 offset:45056
    v_mfma_f32_16x16x32_bf16 v[36:39], a[144:147], v[160:163], v[104:107]
    v_exp_f32 v209, v25
    v_mfma_f32_16x16x32_bf16 v[36:39], a[148:151], v[168:171], v[36:39]
    v_exp_f32 v210, v26
    v_mfma_f32_16x16x32_bf16 v[36:39], a[152:155], v[176:179], v[36:39]
    ds_read_b64_tr_b16 a[200:201], v235 offset:32768
    ds_read_b64_tr_b16 a[202:203], v235 offset:36864
    v_mfma_f32_16x16x32_bf16 v[36:39], a[156:159], v[184:187], v[36:39]
    ds_read_b64_tr_b16 a[204:205], v235 offset:40960
    v_cvt_pk_bf16_f32 v76, v208, v209
    v_mfma_f32_16x16x32_bf16 v[40:43], a[160:163], v[160:163], v[104:107]
    ds_read_b64_tr_b16 a[206:207], v235 offset:45056
    ds_read_b64_tr_b16 a[208:209], v236 offset:32768
    v_mfma_f32_16x16x32_bf16 v[40:43], a[164:167], v[168:171], v[40:43]
    v_exp_f32 v211, v27
    v_mfma_f32_16x16x32_bf16 v[40:43], a[168:171], v[176:179], v[40:43]
    v_exp_f32 v212, v28
    v_mfma_f32_16x16x32_bf16 v[40:43], a[172:175], v[184:187], v[40:43]
    ds_read_b64_tr_b16 a[210:211], v236 offset:36864
    ds_read_b64_tr_b16 a[212:213], v236 offset:40960
    v_mfma_f32_16x16x32_bf16 v[44:47], a[176:179], v[160:163], v[104:107]
    ds_read_b64_tr_b16 a[214:215], v236 offset:45056
    v_cvt_pk_bf16_f32 v77, v210, v211
    v_mfma_f32_16x16x32_bf16 v[44:47], a[180:183], v[168:171], v[44:47]
    ds_read_b64_tr_b16 a[216:217], v237 offset:32768
    ds_read_b64_tr_b16 a[218:219], v237 offset:36864
    v_mfma_f32_16x16x32_bf16 v[44:47], a[184:187], v[176:179], v[44:47]
    v_exp_f32 v213, v29
    v_mfma_f32_16x16x32_bf16 v[44:47], a[188:191], v[184:187], v[44:47]
    ds_read_b64_tr_b16 a[220:221], v237 offset:40960
    ds_read_b64_tr_b16 a[222:223], v237 offset:45056
    v_mfma_f32_16x16x32_bf16 v[48:51], a[128:131], v[164:167], v[108:111]
    v_exp_f32 v214, v30
    v_mfma_f32_16x16x32_bf16 v[48:51], a[132:135], v[172:175], v[48:51]
    ds_read_b64_tr_b16 a[224:225], v238 offset:32768
    v_cvt_pk_bf16_f32 v78, v212, v213
    v_mfma_f32_16x16x32_bf16 v[48:51], a[136:139], v[180:183], v[48:51]
    ds_read_b64_tr_b16 a[226:227], v238 offset:36864
    ds_read_b64_tr_b16 a[228:229], v238 offset:40960
    v_mfma_f32_16x16x32_bf16 v[48:51], a[140:143], v[188:191], v[48:51]
    v_exp_f32 v215, v31
    v_mfma_f32_16x16x32_bf16 v[52:55], a[144:147], v[164:167], v[108:111]
    ds_read_b64_tr_b16 a[230:231], v238 offset:45056
    ds_read_b64_tr_b16 a[232:233], v239 offset:32768
    v_mfma_f32_16x16x32_bf16 v[52:55], a[148:151], v[172:175], v[52:55]
    ds_read_b64_tr_b16 a[234:235], v239 offset:36864
    v_cvt_pk_bf16_f32 v79, v214, v215
    v_mfma_f32_16x16x32_bf16 v[52:55], a[152:155], v[180:183], v[52:55]
    ds_read_b64_tr_b16 a[236:237], v239 offset:40960
    ds_read_b64_tr_b16 a[238:239], v239 offset:45056
    v_mfma_f32_16x16x32_bf16 v[52:55], a[156:159], v[188:191], v[52:55]
    ds_read_b64_tr_b16 a[240:241], v240 offset:32768
    ds_read_b64_tr_b16 a[242:243], v240 offset:36864
    v_smfmac_f32_16x16x64_bf16 v[196:199], v[226:229], v[72:79], v112
    ds_read_b64_tr_b16 a[244:245], v240 offset:40960
    ds_read_b64_tr_b16 a[246:247], v240 offset:45056
    v_mfma_f32_16x16x32_bf16 v[56:59], a[160:163], v[164:167], v[108:111]
    ds_read_b64_tr_b16 a[248:249], v241 offset:32768
    ds_read_b64_tr_b16 a[250:251], v241 offset:36864
    v_mfma_f32_16x16x32_bf16 v[56:59], a[164:167], v[172:175], v[56:59]
    ds_read_b64_tr_b16 a[252:253], v241 offset:40960
    ds_read_b64_tr_b16 a[254:255], v241 offset:45056
    v_mfma_f32_16x16x32_bf16 v[56:59], a[168:171], v[180:183], v[56:59]
    s_mov_b32 s32, 524288
    s_add_u32 m0, s28, 16384
    v_mfma_f32_16x16x32_bf16 v[56:59], a[172:175], v[188:191], v[56:59]
    buffer_load_dwordx4 v250, s[8:11], s32 offen offset:0 lds
    v_mfma_f32_16x16x32_bf16 v[60:63], a[176:179], v[164:167], v[108:111]
    v_mfma_f32_16x16x32_bf16 v[60:63], a[180:183], v[172:175], v[60:63]
    v_max3_f32 v216, v192, v193, v196
    v_max_f32 v216, v216, v197
    v_mfma_f32_16x16x32_bf16 v[60:63], a[184:187], v[180:183], v[60:63]
    v_cmp_nge_f32 vcc, s34, v216
    v_mfma_f32_16x16x32_bf16 v[60:63], a[188:191], v[188:191], v[60:63]
    buffer_load_dwordx4 v251, s[8:11], s32 offen offset:1024 lds
    s_cbranch_vccnz RARE_T28_0
BACK_T28_0:
    s_waitcnt lgkmcnt(0)
    v_mfma_f32_16x16x32_bf16 a[0:3], a[192:195], v[64:67], a[0:3]
    v_exp_f32 v208, v32
    s_cmp_lt_u32 s2, 144
    s_cselect_b32 s43, 5308416, 0
    v_mfma_f32_16x16x32_bf16 a[0:3], a[196:199], v[68:71], a[0:3]
    v_exp_f32 v209, v33
    s_mov_b32 s56, s48
    v_mfma_f32_16x16x32_bf16 a[4:7], a[200:203], v[64:67], a[4:7]
    ds_read_b128 a[128:131], v246 offset:32768
    ds_read_b128 a[132:135], v247 offset:32768
    s_and_b32 s57, s49, 0xffff
    v_mfma_f32_16x16x32_bf16 a[4:7], a[204:207], v[68:71], a[4:7]
    v_exp_f32 v210, v34
    s_mov_b32 s58, s43
    v_mfma_f32_16x16x32_bf16 a[8:11], a[208:211], v[64:67], a[8:11]
    ds_read_b128 a[136:139], v248 offset:32768
    v_cvt_pk_bf16_f32 v80, v208, v209
    s_mov_b32 s59, 0x00020000
    v_mfma_f32_16x16x32_bf16 a[8:11], a[212:215], v[68:71], a[8:11]
    v_exp_f32 v211, v35
    s_mov_b32 s60, s50
    v_mfma_f32_16x16x32_bf16 a[12:15], a[216:219], v[64:67], a[12:15]
    v_exp_f32 v212, v36
    s_and_b32 s61, s51, 0xffff
    v_mfma_f32_16x16x32_bf16 a[12:15], a[220:223], v[68:71], a[12:15]
    ds_read_b128 a[140:143], v249 offset:32768
    v_cvt_pk_bf16_f32 v81, v210, v211
    s_mov_b32 s62, s43
    v_mfma_f32_16x16x32_bf16 a[16:19], a[224:227], v[64:67], a[16:19]
    ds_read_b128 a[144:147], v246 offset:36864
    ds_read_b128 a[148:151], v247 offset:36864
    s_mov_b32 s63, 0x00020000
    v_mfma_f32_16x16x32_bf16 a[16:19], a[228:231], v[68:71], a[16:19]
    v_exp_f32 v213, v37
    s_mov_b32 s4, s52
    v_mfma_f32_16x16x32_bf16 a[20:23], a[232:235], v[64:67], a[20:23]
    v_exp_f32 v214, v38
    s_and_b32 s5, s53, 0xffff
    v_mfma_f32_16x16x32_bf16 a[20:23], a[236:239], v[68:71], a[20:23]
    ds_read_b128 a[152:155], v248 offset:36864
    v_cvt_pk_bf16_f32 v82, v212, v213
    s_mov_b32 s6, s43
    v_mfma_f32_16x16x32_bf16 a[24:27], a[240:243], v[64:67], a[24:27]
    v_exp_f32 v215, v39
    s_mov_b32 s7, 0x00020000
    v_mfma_f32_16x16x32_bf16 a[24:27], a[244:247], v[68:71], a[24:27]
    ds_read_b128 a[156:159], v249 offset:36864
    ds_read_b128 a[160:163], v246 offset:40960
    v_lshrrev_b32 v217, 6, v225
    v_mfma_f32_16x16x32_bf16 a[28:31], a[248:251], v[64:67], a[28:31]
    v_exp_f32 v208, v40
    v_mul_u32_u24 v217, 9216, v217
    v_mfma_f32_16x16x32_bf16 a[28:31], a[252:255], v[68:71], a[28:31]
    ds_read_b128 a[164:167], v247 offset:40960
    v_cvt_pk_bf16_f32 v83, v214, v215
    v_and_b32 v232, 48, v225
    v_mfma_f32_16x16x32_bf16 a[32:35], a[192:195], v[72:75], a[32:35]
    v_exp_f32 v209, v41
    v_add_u32 v217, v217, v232
    v_mfma_f32_16x16x32_bf16 a[32:35], a[196:199], v[76:79], a[32:35]
    v_exp_f32 v210, v42
    s_lshl_b32 s48, s100, 6
    v_mfma_f32_16x16x32_bf16 a[36:39], a[200:203], v[72:75], a[36:39]
    ds_read_b128 a[168:171], v248 offset:40960
    ds_read_b128 a[172:175], v249 offset:40960
    s_mul_i32 s49, s40, 147456
    v_mfma_f32_16x16x32_bf16 a[36:39], a[204:207], v[76:79], a[36:39]
    ds_read_b128 a[176:179], v246 offset:45056
    v_cvt_pk_bf16_f32 v84, v208, v209
    s_add_u32 s49, s49, s48
    v_mfma_f32_16x16x32_bf16 a[40:43], a[208:211], v[72:75], a[40:43]
    v_exp_f32 v211, v43
    s_mul_i32 s50, s40, 1179648
    v_mfma_f32_16x16x32_bf16 a[40:43], a[212:215], v[76:79], a[40:43]
    v_exp_f32 v212, v44
    s_add_u32 s50, s50, s48
    v_mfma_f32_16x16x32_bf16 a[44:47], a[216:219], v[72:75], a[44:47]
    ds_read_b128 a[180:183], v247 offset:45056
    v_cvt_pk_bf16_f32 v85, v210, v211
    s_add_u32 s50, s50, 589824
    v_mfma_f32_16x16x32_bf16 a[44:47], a[220:223], v[76:79], a[44:47]
    v_exp_f32 v213, v45
    s_mul_i32 s51, s40, 1327104
    v_mfma_f32_16x16x32_bf16 a[48:51], a[224:227], v[72:75], a[48:51]
    ds_read_b128 a[184:187], v248 offset:45056
    ds_read_b128 a[188:191], v249 offset:45056
    s_add_u32 s51, s51, s48
    v_mfma_f32_16x16x32_bf16 a[48:51], a[228:231], v[76:79], a[48:51]
    v_exp_f32 v214, v46
    s_mul_i32 s52, s100, 36864
    v_mfma_f32_16x16x32_bf16 a[52:55], a[232:235], v[72:75], a[52:55]
    v_cvt_pk_bf16_f32 v86, v212, v213
    s_mul_i32 s53, s40, 9216
    v_mfma_f32_16x16x32_bf16 a[52:55], a[236:239], v[76:79], a[52:55]
    v_exp_f32 v215, v47
    s_add_u32 s52, s52, s53
    v_mfma_f32_16x16x32_bf16 a[56:59], a[240:243], v[72:75], a[56:59]
    v_exp_f32 v208, v48
    s_lshl_b32 s53, s40, 13
    v_mfma_f32_16x16x32_bf16 a[56:59], a[244:247], v[76:79], a[56:59]
    buffer_load_dwordx4 v252, s[8:11], s32 offen offset:2048 lds
    s_add_u32 s53, s53, 131072
    v_mfma_f32_16x16x32_bf16 a[60:63], a[248:251], v[72:75], a[60:63]
    v_cvt_pk_bf16_f32 v87, v214, v215
    v_mfma_f32_16x16x32_bf16 a[60:63], a[252:255], v[76:79], a[60:63]
    v_exp_f32 v209, v49
    s_waitcnt lgkmcnt(0)
    v_mfma_f32_16x16x32_bf16 v[0:3], a[128:131], v[128:131], v[96:99]
    v_exp_f32 v210, v50
    v_mfma_f32_16x16x32_bf16 v[0:3], a[132:135], v[136:139], v[0:3]
    v_exp_f32 v211, v51
    v_bfe_u32 v218, v225, 8, 2
    v_mfma_f32_16x16x32_bf16 v[0:3], a[136:139], v[144:147], v[0:3]
    v_bfe_u32 v219, v225, 4, 4
    v_mfma_f32_16x16x32_bf16 v[0:3], a[140:143], v[152:155], v[0:3]
    v_exp_f32 v212, v52
    v_lshlrev_b32 v220, 1, v218
    v_smfmac_f32_16x16x64_bf16 v[200:203], v[226:229], v[80:87], v112
    v_cvt_pk_bf16_f32 v88, v208, v209
    v_cvt_pk_bf16_f32 v89, v210, v211
    v_xor_b32 v219, v219, v220
    v_mfma_f32_16x16x32_bf16 v[4:7], a[144:147], v[128:131], v[96:99]
    v_exp_f32 v213, v53
    s_lshl_b32 s43, s40, 4
    v_mfma_f32_16x16x32_bf16 v[4:7], a[148:151], v[136:139], v[4:7]
    buffer_load_dwordx4 v253, s[8:11], s32 offen offset:3072 lds
    v_add_u32 v218, s43, v218
    v_mfma_f32_16x16x32_bf16 v[4:7], a[152:155], v[144:147], v[4:7]
    v_exp_f32 v214, v54
    v_mul_u32_u24 v218, 1152, v218
    v_mfma_f32_16x16x32_bf16 v[4:7], a[156:159], v[152:155], v[4:7]
    v_exp_f32 v215, v55
    v_lshrrev_b32 v220, 3, v219
    v_mfma_f32_16x16x32_bf16 v[8:11], a[160:163], v[128:131], v[96:99]
    v_exp_f32 v208, v56
    v_mul_u32_u24 v220, 73600, v220
    v_mfma_f32_16x16x32_bf16 v[8:11], a[164:167], v[136:139], v[8:11]
    v_cvt_pk_bf16_f32 v90, v212, v213
    v_cvt_pk_bf16_f32 v91, v214, v215
    v_add_u32 v220, v220, v218
    v_mfma_f32_16x16x32_bf16 v[8:11], a[168:171], v[144:147], v[8:11]
    s_mov_b32 s33, 507904
    s_add_u32 m0, s28, 81920
    v_lshl_add_u32 v242, v219, 4, v220
    v_mfma_f32_16x16x32_bf16 v[8:11], a[172:175], v[152:155], v[8:11]
    v_exp_f32 v209, v57
    v_add_u32 v244, 7168, v242
    v_mfma_f32_16x16x32_bf16 v[12:15], a[176:179], v[128:131], v[96:99]
    v_exp_f32 v210, v58
    v_xor_b32 v219, 8, v219
    v_mfma_f32_16x16x32_bf16 v[12:15], a[180:183], v[136:139], v[12:15]
    v_exp_f32 v211, v59
    v_lshrrev_b32 v220, 3, v219
    v_mfma_f32_16x16x32_bf16 v[12:15], a[184:187], v[144:147], v[12:15]
    v_exp_f32 v212, v60
    v_mul_u32_u24 v220, 73600, v220
    v_mfma_f32_16x16x32_bf16 v[12:15], a[188:191], v[152:155], v[12:15]
    buffer_load_dwordx4 v254, s[12:15], s33 offen offset:0 lds
    v_add_u32 v220, v220, v218
    v_mfma_f32_16x16x32_bf16 v[16:19], a[128:131], v[132:135], v[100:103]
    v_cvt_pk_bf16_f32 v92, v208, v209
    v_cvt_pk_bf16_f32 v93, v210, v211
    v_lshl_add_u32 v243, v219, 4, v220
    v_mfma_f32_16x16x32_bf16 v[16:19], a[132:135], v[140:143], v[16:19]
    v_exp_f32 v213, v61
    v_add_u32 v243, 3584, v243
    v_mfma_f32_16x16x32_bf16 v[16:19], a[136:139], v[148:151], v[16:19]
    v_exp_f32 v214, v62
    v_add_u32 v245, 7168, v243
    v_mfma_f32_16x16x32_bf16 v[16:19], a[140:143], v[156:159], v[16:19]
    buffer_load_dwordx4 v255, s[12:15], s33 offen offset:1024 lds
    v_mfma_f32_16x16x32_bf16 v[20:23], a[144:147], v[132:135], v[100:103]
    v_exp_f32 v215, v63
    v_mfma_f32_16x16x32_bf16 v[20:23], a[148:151], v[140:143], v[20:23]
    v_cvt_pk_bf16_f32 v94, v212, v213
    v_cvt_pk_bf16_f32 v95, v214, v215
    v_mfma_f32_16x16x32_bf16 v[20:23], a[152:155], v[148:151], v[20:23]
    buffer_load_dwordx4 v254, s[12:15], s33 offen offset:2048 lds
    v_mfma_f32_16x16x32_bf16 v[20:23], a[156:159], v[156:159], v[20:23]
    v_smfmac_f32_16x16x64_bf16 v[204:207], v[226:229], v[88:95], v112
    v_mfma_f32_16x16x32_bf16 v[24:27], a[160:163], v[132:135], v[100:103]
    v_mfma_f32_16x16x32_bf16 v[24:27], a[164:167], v[140:143], v[24:27]
    buffer_load_dwordx4 v255, s[12:15], s33 offen offset:3072 lds
    v_mfma_f32_16x16x32_bf16 v[24:27], a[168:171], v[148:151], v[24:27]
    v_mfma_f32_16x16x32_bf16 v[24:27], a[172:175], v[156:159], v[24:27]
    v_mfma_f32_16x16x32_bf16 v[28:31], a[176:179], v[132:135], v[100:103]
    v_mfma_f32_16x16x32_bf16 v[28:31], a[180:183], v[140:143], v[28:31]
    s_nop 0
    v_max3_f32 v216, v200, v201, v204
    v_max_f32 v216, v216, v205
    v_mfma_f32_16x16x32_bf16 v[28:31], a[184:187], v[148:151], v[28:31]
    v_cmp_nge_f32 vcc, s34, v216
    v_mfma_f32_16x16x32_bf16 v[28:31], a[188:191], v[156:159], v[28:31]
    s_cbranch_vccnz RARE_T28_1
BACK_T28_1:
    v_mfma_f32_16x16x32_bf16 a[64:67], a[192:195], v[80:83], a[64:67]
    v_exp_f32 v208, v0
    v_mfma_f32_16x16x32_bf16 a[64:67], a[196:199], v[84:87], a[64:67]
    v_exp_f32 v209, v1
    v_mfma_f32_16x16x32_bf16 a[68:71], a[200:203], v[80:83], a[68:71]
    v_exp_f32 v210, v2
    v_mfma_f32_16x16x32_bf16 a[68:71], a[204:207], v[84:87], a[68:71]
    v_exp_f32 v211, v3
    v_mfma_f32_16x16x32_bf16 a[72:75], a[208:211], v[80:83], a[72:75]
    v_exp_f32 v212, v4
    v_mfma_f32_16x16x32_bf16 a[72:75], a[212:215], v[84:87], a[72:75]
    s_add_u32 m0, s53, 0
    v_mfma_f32_16x16x32_bf16 a[76:79], a[216:219], v[80:83], a[76:79]
    v_cvt_pk_bf16_f32 v64, v208, v209
    v_cvt_pk_bf16_f32 v65, v210, v211
    buffer_load_dwordx4 v217, s[56:59], s50 offen lds
    v_mfma_f32_16x16x32_bf16 a[76:79], a[220:223], v[84:87], a[76:79]
    v_exp_f32 v213, v5
    s_add_u32 s50, s50, 147456
    v_mfma_f32_16x16x32_bf16 a[80:83], a[224:227], v[80:83], a[80:83]
    v_exp_f32 v214, v6
    v_mfma_f32_16x16x32_bf16 a[80:83], a[228:231], v[84:87], a[80:83]
    v_exp_f32 v215, v7
    v_mfma_f32_16x16x32_bf16 a[84:87], a[232:235], v[80:83], a[84:87]
    v_exp_f32 v208, v8
    v_mfma_f32_16x16x32_bf16 a[84:87], a[236:239], v[84:87], a[84:87]
    v_cvt_pk_bf16_f32 v66, v212, v213
    v_cvt_pk_bf16_f32 v67, v214, v215
    v_mfma_f32_16x16x32_bf16 a[88:91], a[240:243], v[80:83], a[88:91]
    v_exp_f32 v209, v9
    v_mfma_f32_16x16x32_bf16 a[88:91], a[244:247], v[84:87], a[88:91]
    v_exp_f32 v210, v10
    v_mfma_f32_16x16x32_bf16 a[92:95], a[248:251], v[80:83], a[92:95]
    v_exp_f32 v211, v11
    v_mfma_f32_16x16x32_bf16 a[92:95], a[252:255], v[84:87], a[92:95]
    v_exp_f32 v212, v12
    s_add_u32 m0, s53, 1024
    v_mfma_f32_16x16x32_bf16 a[96:99], a[192:195], v[88:91], a[96:99]
    buffer_load_dwordx4 v217, s[56:59], s50 offen lds
    v_mfma_f32_16x16x32_bf16 a[96:99], a[196:199], v[92:95], a[96:99]
    v_cvt_pk_bf16_f32 v68, v208, v209
    v_cvt_pk_bf16_f32 v69, v210, v211
    s_add_u32 s50, s50, 147456
    v_mfma_f32_16x16x32_bf16 a[100:103], a[200:203], v[88:91], a[100:103]
    v_exp_f32 v213, v13
    v_mfma_f32_16x16x32_bf16 a[100:103], a[204:207], v[92:95], a[100:103]
    v_exp_f32 v214, v14
    v_mfma_f32_16x16x32_bf16 a[104:107], a[208:211], v[88:91], a[104:107]
    v_exp_f32 v215, v15
    v_mfma_f32_16x16x32_bf16 a[104:107], a[212:215], v[92:95], a[104:107]
    v_exp_f32 v208, v16
    v_mfma_f32_16x16x32_bf16 a[108:111], a[216:219], v[88:91], a[108:111]
    v_cvt_pk_bf16_f32 v70, v212, v213
    v_cvt_pk_bf16_f32 v71, v214, v215
    v_mfma_f32_16x16x32_bf16 a[108:111], a[220:223], v[92:95], a[108:111]
    v_exp_f32 v209, v17
    v_mfma_f32_16x16x32_bf16 a[112:115], a[224:227], v[88:91], a[112:115]
    v_exp_f32 v210, v18
    v_mfma_f32_16x16x32_bf16 a[112:115], a[228:231], v[92:95], a[112:115]
    v_exp_f32 v211, v19
    s_add_u32 m0, s53, 2048
    v_mfma_f32_16x16x32_bf16 a[116:119], a[232:235], v[88:91], a[116:119]
    buffer_load_dwordx4 v217, s[56:59], s50 offen lds
    v_mfma_f32_16x16x32_bf16 a[116:119], a[236:239], v[92:95], a[116:119]
    v_exp_f32 v212, v20
    s_add_u32 s50, s50, 147456
    v_mfma_f32_16x16x32_bf16 a[120:123], a[240:243], v[88:91], a[120:123]
    v_cvt_pk_bf16_f32 v72, v208, v209
    v_cvt_pk_bf16_f32 v73, v210, v211
    v_mfma_f32_16x16x32_bf16 a[120:123], a[244:247], v[92:95], a[120:123]
    v_exp_f32 v213, v21
    v_mfma_f32_16x16x32_bf16 a[124:127], a[248:251], v[88:91], a[124:127]
    v_exp_f32 v214, v22
    v_mfma_f32_16x16x32_bf16 a[124:127], a[252:255], v[92:95], a[124:127]
    v_exp_f32 v215, v23
    v_mfma_f32_16x16x32_bf16 v[32:35], a[128:131], v[160:163], v[104:107]
    s_waitcnt vmcnt(24)
    s_barrier
    v_mfma_f32_16x16x32_bf16 v[32:35], a[132:135], v[168:171], v[32:35]
    v_exp_f32 v208, v24
    v_mfma_f32_16x16x32_bf16 v[32:35], a[136:139], v[176:179], v[32:35]
    ds_read_b64_tr_b16 a[192:193], v234 offset:49152
    ds_read_b64_tr_b16 a[194:195], v234 offset:53248
    v_mfma_f32_16x16x32_bf16 v[32:35], a[140:143], v[184:187], v[32:35]
    v_cvt_pk_bf16_f32 v74, v212, v213
    v_cvt_pk_bf16_f32 v75, v214, v215
    v_smfmac_f32_16x16x64_bf16 v[192:195], v[226:229], v[64:71], v112
    ds_read_b64_tr_b16 a[196:197], v234 offset:57344
    ds_read_b64_tr_b16 a[198:199], v234 offset:61440
    v_mfma_f32_16x16x32_bf16 v[36:39], a[144:147], v[160:163], v[104:107]
    v_exp_f32 v209, v25
    s_add_u32 m0, s53, 3072
    v_mfma_f32_16x16x32_bf16 v[36:39], a[148:151], v[168:171], v[36:39]
    v_exp_f32 v210, v26
    buffer_load_dwordx4 v217, s[56:59], s50 offen lds
    v_mfma_f32_16x16x32_bf16 v[36:39], a[152:155], v[176:179], v[36:39]
    ds_read_b64_tr_b16 a[200:201], v235 offset:49152
    ds_read_b64_tr_b16 a[202:203], v235 offset:53248
    s_add_u32 s50, s50, 147456
    v_mfma_f32_16x16x32_bf16 v[36:39], a[156:159], v[184:187], v[36:39]
    ds_read_b64_tr_b16 a[204:205], v235 offset:57344
    v_cvt_pk_bf16_f32 v76, v208, v209
    v_mfma_f32_16x16x32_bf16 v[40:43], a[160:163], v[160:163], v[104:107]
    ds_read_b64_tr_b16 a[206:207], v235 offset:61440
    ds_read_b64_tr_b16 a[208:209], v236 offset:49152
    v_mfma_f32_16x16x32_bf16 v[40:43], a[164:167], v[168:171], v[40:43]
    v_exp_f32 v211, v27
    v_mfma_f32_16x16x32_bf16 v[40:43], a[168:171], v[176:179], v[40:43]
    v_exp_f32 v212, v28
    v_mfma_f32_16x16x32_bf16 v[40:43], a[172:175], v[184:187], v[40:43]
    ds_read_b64_tr_b16 a[210:211], v236 offset:53248
    ds_read_b64_tr_b16 a[212:213], v236 offset:57344
    v_mfma_f32_16x16x32_bf16 v[44:47], a[176:179], v[160:163], v[104:107]
    ds_read_b64_tr_b16 a[214:215], v236 offset:61440
    v_cvt_pk_bf16_f32 v77, v210, v211
    v_mfma_f32_16x16x32_bf16 v[44:47], a[180:183], v[168:171], v[44:47]
    ds_read_b64_tr_b16 a[216:217], v237 offset:49152
    ds_read_b64_tr_b16 a[218:219], v237 offset:53248
    v_mfma_f32_16x16x32_bf16 v[44:47], a[184:187], v[176:179], v[44:47]
    v_exp_f32 v213, v29
    s_add_u32 m0, s53, 4096
    v_mfma_f32_16x16x32_bf16 v[44:47], a[188:191], v[184:187], v[44:47]
    ds_read_b64_tr_b16 a[220:221], v237 offset:57344
    ds_read_b64_tr_b16 a[222:223], v237 offset:61440
    buffer_load_dwordx4 v217, s[56:59], s50 offen lds
    v_mfma_f32_16x16x32_bf16 v[48:51], a[128:131], v[164:167], v[108:111]
    v_exp_f32 v214, v30
    s_add_u32 s50, s50, 147456
    v_mfma_f32_16x16x32_bf16 v[48:51], a[132:135], v[172:175], v[48:51]
    ds_read_b64_tr_b16 a[224:225], v238 offset:49152
    v_cvt_pk_bf16_f32 v78, v212, v213
    v_mfma_f32_16x16x32_bf16 v[48:51], a[136:139], v[180:183], v[48:51]
    ds_read_b64_tr_b16 a[226:227], v238 offset:53248
    ds_read_b64_tr_b16 a[228:229], v238 offset:57344
    v_mfma_f32_16x16x32_bf16 v[48:51], a[140:143], v[188:191], v[48:51]
    v_exp_f32 v215, v31
    v_mfma_f32_16x16x32_bf16 v[52:55], a[144:147], v[164:167], v[108:111]
    ds_read_b64_tr_b16 a[230:231], v238 offset:61440
    ds_read_b64_tr_b16 a[232:233], v239 offset:49152
    v_mfma_f32_16x16x32_bf16 v[52:55], a[148:151], v[172:175], v[52:55]
    ds_read_b64_tr_b16 a[234:235], v239 offset:53248
    v_cvt_pk_bf16_f32 v79, v214, v215
    v_mfma_f32_16x16x32_bf16 v[52:55], a[152:155], v[180:183], v[52:55]
    ds_read_b64_tr_b16 a[236:237], v239 offset:57344
    ds_read_b64_tr_b16 a[238:239], v239 offset:61440
    v_mfma_f32_16x16x32_bf16 v[52:55], a[156:159], v[188:191], v[52:55]
    ds_read_b64_tr_b16 a[240:241], v240 offset:49152
    ds_read_b64_tr_b16 a[242:243], v240 offset:53248
    v_smfmac_f32_16x16x64_bf16 v[196:199], v[226:229], v[72:79], v112
    ds_read_b64_tr_b16 a[244:245], v240 offset:57344
    ds_read_b64_tr_b16 a[246:247], v240 offset:61440
    v_mfma_f32_16x16x32_bf16 v[56:59], a[160:163], v[164:167], v[108:111]
    ds_read_b64_tr_b16 a[248:249], v241 offset:49152
    ds_read_b64_tr_b16 a[250:251], v241 offset:53248
    v_mfma_f32_16x16x32_bf16 v[56:59], a[164:167], v[172:175], v[56:59]
    ds_read_b64_tr_b16 a[252:253], v241 offset:57344
    ds_read_b64_tr_b16 a[254:255], v241 offset:61440
    v_mfma_f32_16x16x32_bf16 v[56:59], a[168:171], v[180:183], v[56:59]
    s_add_u32 s32, s3, 0
    s_add_u32 m0, s28, 32768
    v_mfma_f32_16x16x32_bf16 v[56:59], a[172:175], v[188:191], v[56:59]
    buffer_load_dwordx4 v242, s[20:23], s32 offen offset:0  lds
    v_mfma_f32_16x16x32_bf16 v[60:63], a[176:179], v[164:167], v[108:111]
    v_mfma_f32_16x16x32_bf16 v[60:63], a[180:183], v[172:175], v[60:63]
    v_max3_f32 v216, v192, v193, v196
    v_max_f32 v216, v216, v197
    v_mfma_f32_16x16x32_bf16 v[60:63], a[184:187], v[180:183], v[60:63]
    v_cmp_nge_f32 vcc, s34, v216
    v_mfma_f32_16x16x32_bf16 v[60:63], a[188:191], v[188:191], v[60:63]
    buffer_load_dwordx4 v243, s[20:23], s32 offen offset:1024  lds
    s_cbranch_vccnz RARE_T29_0
BACK_T29_0:
    s_waitcnt lgkmcnt(0)
    v_mfma_f32_16x16x32_bf16 a[0:3], a[192:195], v[64:67], a[0:3]
    v_exp_f32 v208, v32
    v_mfma_f32_16x16x32_bf16 a[0:3], a[196:199], v[68:71], a[0:3]
    v_exp_f32 v209, v33
    v_mfma_f32_16x16x32_bf16 a[4:7], a[200:203], v[64:67], a[4:7]
    ds_read_b128 a[128:131], v246 offset:49152
    ds_read_b128 a[132:135], v247 offset:49152
    v_mfma_f32_16x16x32_bf16 a[4:7], a[204:207], v[68:71], a[4:7]
    v_exp_f32 v210, v34
    v_mfma_f32_16x16x32_bf16 a[8:11], a[208:211], v[64:67], a[8:11]
    ds_read_b128 a[136:139], v248 offset:49152
    v_cvt_pk_bf16_f32 v80, v208, v209
    v_mfma_f32_16x16x32_bf16 a[8:11], a[212:215], v[68:71], a[8:11]
    v_exp_f32 v211, v35
    v_mfma_f32_16x16x32_bf16 a[12:15], a[216:219], v[64:67], a[12:15]
    v_exp_f32 v212, v36
    v_mfma_f32_16x16x32_bf16 a[12:15], a[220:223], v[68:71], a[12:15]
    ds_read_b128 a[140:143], v249 offset:49152
    v_cvt_pk_bf16_f32 v81, v210, v211
    v_mfma_f32_16x16x32_bf16 a[16:19], a[224:227], v[64:67], a[16:19]
    ds_read_b128 a[144:147], v246 offset:53248
    ds_read_b128 a[148:151], v247 offset:53248
    v_mfma_f32_16x16x32_bf16 a[16:19], a[228:231], v[68:71], a[16:19]
    v_exp_f32 v213, v37
    v_mfma_f32_16x16x32_bf16 a[20:23], a[232:235], v[64:67], a[20:23]
    v_exp_f32 v214, v38
    v_mfma_f32_16x16x32_bf16 a[20:23], a[236:239], v[68:71], a[20:23]
    ds_read_b128 a[152:155], v248 offset:53248
    v_cvt_pk_bf16_f32 v82, v212, v213
    v_mfma_f32_16x16x32_bf16 a[24:27], a[240:243], v[64:67], a[24:27]
    v_exp_f32 v215, v39
    v_mfma_f32_16x16x32_bf16 a[24:27], a[244:247], v[68:71], a[24:27]
    ds_read_b128 a[156:159], v249 offset:53248
    ds_read_b128 a[160:163], v246 offset:57344
    v_mfma_f32_16x16x32_bf16 a[28:31], a[248:251], v[64:67], a[28:31]
    v_exp_f32 v208, v40
    v_mfma_f32_16x16x32_bf16 a[28:31], a[252:255], v[68:71], a[28:31]
    ds_read_b128 a[164:167], v247 offset:57344
    v_cvt_pk_bf16_f32 v83, v214, v215
    v_mfma_f32_16x16x32_bf16 a[32:35], a[192:195], v[72:75], a[32:35]
    v_exp_f32 v209, v41
    v_mfma_f32_16x16x32_bf16 a[32:35], a[196:199], v[76:79], a[32:35]
    v_exp_f32 v210, v42
    v_mfma_f32_16x16x32_bf16 a[36:39], a[200:203], v[72:75], a[36:39]
    ds_read_b128 a[168:171], v248 offset:57344
    ds_read_b128 a[172:175], v249 offset:57344
    v_mfma_f32_16x16x32_bf16 a[36:39], a[204:207], v[76:79], a[36:39]
    ds_read_b128 a[176:179], v246 offset:61440
    v_cvt_pk_bf16_f32 v84, v208, v209
    v_mfma_f32_16x16x32_bf16 a[40:43], a[208:211], v[72:75], a[40:43]
    v_exp_f32 v211, v43
    v_mfma_f32_16x16x32_bf16 a[40:43], a[212:215], v[76:79], a[40:43]
    v_exp_f32 v212, v44
    v_mfma_f32_16x16x32_bf16 a[44:47], a[216:219], v[72:75], a[44:47]
    ds_read_b128 a[180:183], v247 offset:61440
    v_cvt_pk_bf16_f32 v85, v210, v211
    v_mfma_f32_16x16x32_bf16 a[44:47], a[220:223], v[76:79], a[44:47]
    v_exp_f32 v213, v45
    v_mfma_f32_16x16x32_bf16 a[48:51], a[224:227], v[72:75], a[48:51]
    ds_read_b128 a[184:187], v248 offset:61440
    ds_read_b128 a[188:191], v249 offset:61440
    v_mfma_f32_16x16x32_bf16 a[48:51], a[228:231], v[76:79], a[48:51]
    v_exp_f32 v214, v46
    v_mfma_f32_16x16x32_bf16 a[52:55], a[232:235], v[72:75], a[52:55]
    v_cvt_pk_bf16_f32 v86, v212, v213
    v_mfma_f32_16x16x32_bf16 a[52:55], a[236:239], v[76:79], a[52:55]
    v_exp_f32 v215, v47
    v_mfma_f32_16x16x32_bf16 a[56:59], a[240:243], v[72:75], a[56:59]
    v_exp_f32 v208, v48
    v_mfma_f32_16x16x32_bf16 a[56:59], a[244:247], v[76:79], a[56:59]
    buffer_load_dwordx4 v244, s[20:23], s32 offen offset:2048  lds
    v_mfma_f32_16x16x32_bf16 a[60:63], a[248:251], v[72:75], a[60:63]
    v_cvt_pk_bf16_f32 v87, v214, v215
    v_mfma_f32_16x16x32_bf16 a[60:63], a[252:255], v[76:79], a[60:63]
    v_exp_f32 v209, v49
    s_waitcnt lgkmcnt(0)
    v_mfma_f32_16x16x32_bf16 v[0:3], a[128:131], v[128:131], v[96:99]
    v_exp_f32 v210, v50
    v_mfma_f32_16x16x32_bf16 v[0:3], a[132:135], v[136:139], v[0:3]
    v_exp_f32 v211, v51
    v_mfma_f32_16x16x32_bf16 v[0:3], a[136:139], v[144:147], v[0:3]
    v_mfma_f32_16x16x32_bf16 v[0:3], a[140:143], v[152:155], v[0:3]
    v_exp_f32 v212, v52
    v_smfmac_f32_16x16x64_bf16 v[200:203], v[226:229], v[80:87], v112
    v_cvt_pk_bf16_f32 v88, v208, v209
    v_cvt_pk_bf16_f32 v89, v210, v211
    v_mfma_f32_16x16x32_bf16 v[4:7], a[144:147], v[128:131], v[96:99]
    v_exp_f32 v213, v53
    v_mfma_f32_16x16x32_bf16 v[4:7], a[148:151], v[136:139], v[4:7]
    buffer_load_dwordx4 v245, s[20:23], s32 offen offset:3072  lds
    v_mfma_f32_16x16x32_bf16 v[4:7], a[152:155], v[144:147], v[4:7]
    v_exp_f32 v214, v54
    v_mfma_f32_16x16x32_bf16 v[4:7], a[156:159], v[152:155], v[4:7]
    v_exp_f32 v215, v55
    v_mfma_f32_16x16x32_bf16 v[8:11], a[160:163], v[128:131], v[96:99]
    v_exp_f32 v208, v56
    v_mfma_f32_16x16x32_bf16 v[8:11], a[164:167], v[136:139], v[8:11]
    v_cvt_pk_bf16_f32 v90, v212, v213
    v_cvt_pk_bf16_f32 v91, v214, v215
    v_mfma_f32_16x16x32_bf16 v[8:11], a[168:171], v[144:147], v[8:11]
    s_add_u32 s33, s3, 147456
    s_add_u32 m0, s28, 98304
    v_mfma_f32_16x16x32_bf16 v[8:11], a[172:175], v[152:155], v[8:11]
    v_exp_f32 v209, v57
    v_mfma_f32_16x16x32_bf16 v[12:15], a[176:179], v[128:131], v[96:99]
    v_exp_f32 v210, v58
    v_mfma_f32_16x16x32_bf16 v[12:15], a[180:183], v[136:139], v[12:15]
    v_exp_f32 v211, v59
    v_mfma_f32_16x16x32_bf16 v[12:15], a[184:187], v[144:147], v[12:15]
    v_exp_f32 v212, v60
    v_mfma_f32_16x16x32_bf16 v[12:15], a[188:191], v[152:155], v[12:15]
    buffer_load_dwordx4 v242, s[20:23], s33 offen offset:0  lds
    v_mfma_f32_16x16x32_bf16 v[16:19], a[128:131], v[132:135], v[100:103]
    v_cvt_pk_bf16_f32 v92, v208, v209
    v_cvt_pk_bf16_f32 v93, v210, v211
    v_mfma_f32_16x16x32_bf16 v[16:19], a[132:135], v[140:143], v[16:19]
    v_exp_f32 v213, v61
    v_mfma_f32_16x16x32_bf16 v[16:19], a[136:139], v[148:151], v[16:19]
    v_exp_f32 v214, v62
    v_mfma_f32_16x16x32_bf16 v[16:19], a[140:143], v[156:159], v[16:19]
    buffer_load_dwordx4 v243, s[20:23], s33 offen offset:1024  lds
    v_mfma_f32_16x16x32_bf16 v[20:23], a[144:147], v[132:135], v[100:103]
    v_exp_f32 v215, v63
    v_mfma_f32_16x16x32_bf16 v[20:23], a[148:151], v[140:143], v[20:23]
    v_cvt_pk_bf16_f32 v94, v212, v213
    v_cvt_pk_bf16_f32 v95, v214, v215
    v_mfma_f32_16x16x32_bf16 v[20:23], a[152:155], v[148:151], v[20:23]
    buffer_load_dwordx4 v244, s[20:23], s33 offen offset:2048  lds
    v_mfma_f32_16x16x32_bf16 v[20:23], a[156:159], v[156:159], v[20:23]
    v_smfmac_f32_16x16x64_bf16 v[204:207], v[226:229], v[88:95], v112
    v_mfma_f32_16x16x32_bf16 v[24:27], a[160:163], v[132:135], v[100:103]
    v_mfma_f32_16x16x32_bf16 v[24:27], a[164:167], v[140:143], v[24:27]
    buffer_load_dwordx4 v245, s[20:23], s33 offen offset:3072  lds
    v_mfma_f32_16x16x32_bf16 v[24:27], a[168:171], v[148:151], v[24:27]
    v_mfma_f32_16x16x32_bf16 v[24:27], a[172:175], v[156:159], v[24:27]
    v_mfma_f32_16x16x32_bf16 v[28:31], a[176:179], v[132:135], v[100:103]
    v_mfma_f32_16x16x32_bf16 v[28:31], a[180:183], v[140:143], v[28:31]
    s_nop 0
    v_max3_f32 v216, v200, v201, v204
    v_max_f32 v216, v216, v205
    v_mfma_f32_16x16x32_bf16 v[28:31], a[184:187], v[148:151], v[28:31]
    v_cmp_nge_f32 vcc, s34, v216
    v_mfma_f32_16x16x32_bf16 v[28:31], a[188:191], v[156:159], v[28:31]
    s_cbranch_vccnz RARE_T29_1
BACK_T29_1:
    v_mfma_f32_16x16x32_bf16 a[64:67], a[192:195], v[80:83], a[64:67]
    v_exp_f32 v208, v0
    v_mfma_f32_16x16x32_bf16 a[64:67], a[196:199], v[84:87], a[64:67]
    v_exp_f32 v209, v1
    v_mfma_f32_16x16x32_bf16 a[68:71], a[200:203], v[80:83], a[68:71]
    v_exp_f32 v210, v2
    v_mfma_f32_16x16x32_bf16 a[68:71], a[204:207], v[84:87], a[68:71]
    v_exp_f32 v211, v3
    v_mfma_f32_16x16x32_bf16 a[72:75], a[208:211], v[80:83], a[72:75]
    v_exp_f32 v212, v4
    v_mfma_f32_16x16x32_bf16 a[72:75], a[212:215], v[84:87], a[72:75]
    s_add_u32 m0, s53, 5120
    v_mfma_f32_16x16x32_bf16 a[76:79], a[216:219], v[80:83], a[76:79]
    v_cvt_pk_bf16_f32 v64, v208, v209
    v_cvt_pk_bf16_f32 v65, v210, v211
    buffer_load_dwordx4 v217, s[56:59], s50 offen lds
    v_mfma_f32_16x16x32_bf16 a[76:79], a[220:223], v[84:87], a[76:79]
    v_exp_f32 v213, v5
    s_add_u32 s50, s50, 147456
    v_mfma_f32_16x16x32_bf16 a[80:83], a[224:227], v[80:83], a[80:83]
    v_exp_f32 v214, v6
    v_mfma_f32_16x16x32_bf16 a[80:83], a[228:231], v[84:87], a[80:83]
    v_exp_f32 v215, v7
    v_mfma_f32_16x16x32_bf16 a[84:87], a[232:235], v[80:83], a[84:87]
    v_exp_f32 v208, v8
    v_mfma_f32_16x16x32_bf16 a[84:87], a[236:239], v[84:87], a[84:87]
    v_cvt_pk_bf16_f32 v66, v212, v213
    v_cvt_pk_bf16_f32 v67, v214, v215
    v_mfma_f32_16x16x32_bf16 a[88:91], a[240:243], v[80:83], a[88:91]
    v_exp_f32 v209, v9
    v_mfma_f32_16x16x32_bf16 a[88:91], a[244:247], v[84:87], a[88:91]
    v_exp_f32 v210, v10
    v_mfma_f32_16x16x32_bf16 a[92:95], a[248:251], v[80:83], a[92:95]
    v_exp_f32 v211, v11
    v_mfma_f32_16x16x32_bf16 a[92:95], a[252:255], v[84:87], a[92:95]
    v_exp_f32 v212, v12
    s_add_u32 m0, s53, 6144
    v_mfma_f32_16x16x32_bf16 a[96:99], a[192:195], v[88:91], a[96:99]
    buffer_load_dwordx4 v217, s[56:59], s50 offen lds
    v_mfma_f32_16x16x32_bf16 a[96:99], a[196:199], v[92:95], a[96:99]
    v_cvt_pk_bf16_f32 v68, v208, v209
    v_cvt_pk_bf16_f32 v69, v210, v211
    s_add_u32 s50, s50, 147456
    v_mfma_f32_16x16x32_bf16 a[100:103], a[200:203], v[88:91], a[100:103]
    v_exp_f32 v213, v13
    v_mfma_f32_16x16x32_bf16 a[100:103], a[204:207], v[92:95], a[100:103]
    v_exp_f32 v214, v14
    v_mfma_f32_16x16x32_bf16 a[104:107], a[208:211], v[88:91], a[104:107]
    v_exp_f32 v215, v15
    v_mfma_f32_16x16x32_bf16 a[104:107], a[212:215], v[92:95], a[104:107]
    v_exp_f32 v208, v16
    v_mfma_f32_16x16x32_bf16 a[108:111], a[216:219], v[88:91], a[108:111]
    v_cvt_pk_bf16_f32 v70, v212, v213
    v_cvt_pk_bf16_f32 v71, v214, v215
    v_mfma_f32_16x16x32_bf16 a[108:111], a[220:223], v[92:95], a[108:111]
    v_exp_f32 v209, v17
    v_mfma_f32_16x16x32_bf16 a[112:115], a[224:227], v[88:91], a[112:115]
    v_exp_f32 v210, v18
    v_mfma_f32_16x16x32_bf16 a[112:115], a[228:231], v[92:95], a[112:115]
    v_exp_f32 v211, v19
    s_add_u32 m0, s53, 7168
    v_mfma_f32_16x16x32_bf16 a[116:119], a[232:235], v[88:91], a[116:119]
    buffer_load_dwordx4 v217, s[56:59], s50 offen lds
    v_mfma_f32_16x16x32_bf16 a[116:119], a[236:239], v[92:95], a[116:119]
    v_exp_f32 v212, v20
    s_add_u32 s50, s50, 147456
    v_mfma_f32_16x16x32_bf16 a[120:123], a[240:243], v[88:91], a[120:123]
    v_cvt_pk_bf16_f32 v72, v208, v209
    v_cvt_pk_bf16_f32 v73, v210, v211
    v_mfma_f32_16x16x32_bf16 a[120:123], a[244:247], v[92:95], a[120:123]
    v_exp_f32 v213, v21
    v_mfma_f32_16x16x32_bf16 a[124:127], a[248:251], v[88:91], a[124:127]
    v_exp_f32 v214, v22
    v_mfma_f32_16x16x32_bf16 a[124:127], a[252:255], v[92:95], a[124:127]
    v_exp_f32 v215, v23
    v_mfma_f32_16x16x32_bf16 v[32:35], a[128:131], v[160:163], v[104:107]
    s_waitcnt vmcnt(29)
    s_barrier
    v_mfma_f32_16x16x32_bf16 v[32:35], a[132:135], v[168:171], v[32:35]
    v_exp_f32 v208, v24
    v_mfma_f32_16x16x32_bf16 v[32:35], a[136:139], v[176:179], v[32:35]
    ds_read_b64_tr_b16 a[192:193], v234 offset:0
    ds_read_b64_tr_b16 a[194:195], v234 offset:4096
    v_mfma_f32_16x16x32_bf16 v[32:35], a[140:143], v[184:187], v[32:35]
    v_cvt_pk_bf16_f32 v74, v212, v213
    v_cvt_pk_bf16_f32 v75, v214, v215
    v_smfmac_f32_16x16x64_bf16 v[192:195], v[226:229], v[64:71], v112
    ds_read_b64_tr_b16 a[196:197], v234 offset:8192
    ds_read_b64_tr_b16 a[198:199], v234 offset:12288
    v_mfma_f32_16x16x32_bf16 v[36:39], a[144:147], v[160:163], v[104:107]
    v_exp_f32 v209, v25
    v_mfma_f32_16x16x32_bf16 v[36:39], a[148:151], v[168:171], v[36:39]
    v_exp_f32 v210, v26
    v_mfma_f32_16x16x32_bf16 v[36:39], a[152:155], v[176:179], v[36:39]
    ds_read_b64_tr_b16 a[200:201], v235 offset:0
    ds_read_b64_tr_b16 a[202:203], v235 offset:4096
    v_mfma_f32_16x16x32_bf16 v[36:39], a[156:159], v[184:187], v[36:39]
    ds_read_b64_tr_b16 a[204:205], v235 offset:8192
    v_cvt_pk_bf16_f32 v76, v208, v209
    v_mfma_f32_16x16x32_bf16 v[40:43], a[160:163], v[160:163], v[104:107]
    ds_read_b64_tr_b16 a[206:207], v235 offset:12288
    ds_read_b64_tr_b16 a[208:209], v236 offset:0
    v_mfma_f32_16x16x32_bf16 v[40:43], a[164:167], v[168:171], v[40:43]
    v_exp_f32 v211, v27
    v_mfma_f32_16x16x32_bf16 v[40:43], a[168:171], v[176:179], v[40:43]
    v_exp_f32 v212, v28
    v_mfma_f32_16x16x32_bf16 v[40:43], a[172:175], v[184:187], v[40:43]
    ds_read_b64_tr_b16 a[210:211], v236 offset:4096
    ds_read_b64_tr_b16 a[212:213], v236 offset:8192
    v_mfma_f32_16x16x32_bf16 v[44:47], a[176:179], v[160:163], v[104:107]
    ds_read_b64_tr_b16 a[214:215], v236 offset:12288
    v_cvt_pk_bf16_f32 v77, v210, v211
    v_mfma_f32_16x16x32_bf16 v[44:47], a[180:183], v[168:171], v[44:47]
    ds_read_b64_tr_b16 a[216:217], v237 offset:0
    ds_read_b64_tr_b16 a[218:219], v237 offset:4096
    v_mfma_f32_16x16x32_bf16 v[44:47], a[184:187], v[176:179], v[44:47]
    v_exp_f32 v213, v29
    v_mfma_f32_16x16x32_bf16 v[44:47], a[188:191], v[184:187], v[44:47]
    ds_read_b64_tr_b16 a[220:221], v237 offset:8192
    ds_read_b64_tr_b16 a[222:223], v237 offset:12288
    v_mfma_f32_16x16x32_bf16 v[48:51], a[128:131], v[164:167], v[108:111]
    v_exp_f32 v214, v30
    v_mfma_f32_16x16x32_bf16 v[48:51], a[132:135], v[172:175], v[48:51]
    ds_read_b64_tr_b16 a[224:225], v238 offset:0
    v_cvt_pk_bf16_f32 v78, v212, v213
    v_mfma_f32_16x16x32_bf16 v[48:51], a[136:139], v[180:183], v[48:51]
    ds_read_b64_tr_b16 a[226:227], v238 offset:4096
    ds_read_b64_tr_b16 a[228:229], v238 offset:8192
    v_mfma_f32_16x16x32_bf16 v[48:51], a[140:143], v[188:191], v[48:51]
    v_exp_f32 v215, v31
    v_mfma_f32_16x16x32_bf16 v[52:55], a[144:147], v[164:167], v[108:111]
    ds_read_b64_tr_b16 a[230:231], v238 offset:12288
    ds_read_b64_tr_b16 a[232:233], v239 offset:0
    v_mfma_f32_16x16x32_bf16 v[52:55], a[148:151], v[172:175], v[52:55]
    ds_read_b64_tr_b16 a[234:235], v239 offset:4096
    v_cvt_pk_bf16_f32 v79, v214, v215
    v_mfma_f32_16x16x32_bf16 v[52:55], a[152:155], v[180:183], v[52:55]
    ds_read_b64_tr_b16 a[236:237], v239 offset:8192
    ds_read_b64_tr_b16 a[238:239], v239 offset:12288
    v_mfma_f32_16x16x32_bf16 v[52:55], a[156:159], v[188:191], v[52:55]
    ds_read_b64_tr_b16 a[240:241], v240 offset:0
    ds_read_b64_tr_b16 a[242:243], v240 offset:4096
    v_smfmac_f32_16x16x64_bf16 v[196:199], v[226:229], v[72:79], v112
    ds_read_b64_tr_b16 a[244:245], v240 offset:8192
    ds_read_b64_tr_b16 a[246:247], v240 offset:12288
    v_mfma_f32_16x16x32_bf16 v[56:59], a[160:163], v[164:167], v[108:111]
    ds_read_b64_tr_b16 a[248:249], v241 offset:0
    ds_read_b64_tr_b16 a[250:251], v241 offset:4096
    v_mfma_f32_16x16x32_bf16 v[56:59], a[164:167], v[172:175], v[56:59]
    ds_read_b64_tr_b16 a[252:253], v241 offset:8192
    ds_read_b64_tr_b16 a[254:255], v241 offset:12288
    v_mfma_f32_16x16x32_bf16 v[56:59], a[168:171], v[180:183], v[56:59]
    s_add_u32 s32, s3, 128
    s_add_u32 m0, s28, 49152
    v_mfma_f32_16x16x32_bf16 v[56:59], a[172:175], v[188:191], v[56:59]
    buffer_load_dwordx4 v242, s[20:23], s32 offen offset:0  lds
    v_mfma_f32_16x16x32_bf16 v[60:63], a[176:179], v[164:167], v[108:111]
    v_mfma_f32_16x16x32_bf16 v[60:63], a[180:183], v[172:175], v[60:63]
    v_max3_f32 v216, v192, v193, v196
    v_max_f32 v216, v216, v197
    v_mfma_f32_16x16x32_bf16 v[60:63], a[184:187], v[180:183], v[60:63]
    v_cmp_nge_f32 vcc, s34, v216
    v_mfma_f32_16x16x32_bf16 v[60:63], a[188:191], v[188:191], v[60:63]
    buffer_load_dwordx4 v243, s[20:23], s32 offen offset:1024  lds
    s_cbranch_vccnz RARE_T30_0
BACK_T30_0:
    s_waitcnt lgkmcnt(0)
    v_mfma_f32_16x16x32_bf16 a[0:3], a[192:195], v[64:67], a[0:3]
    v_exp_f32 v208, v32
    v_mfma_f32_16x16x32_bf16 a[0:3], a[196:199], v[68:71], a[0:3]
    v_exp_f32 v209, v33
    v_mfma_f32_16x16x32_bf16 a[4:7], a[200:203], v[64:67], a[4:7]
    ds_read_b128 a[128:131], v246 offset:0
    ds_read_b128 a[132:135], v247 offset:0
    v_mfma_f32_16x16x32_bf16 a[4:7], a[204:207], v[68:71], a[4:7]
    v_exp_f32 v210, v34
    v_mfma_f32_16x16x32_bf16 a[8:11], a[208:211], v[64:67], a[8:11]
    ds_read_b128 a[136:139], v248 offset:0
    v_cvt_pk_bf16_f32 v80, v208, v209
    v_mfma_f32_16x16x32_bf16 a[8:11], a[212:215], v[68:71], a[8:11]
    v_exp_f32 v211, v35
    v_mfma_f32_16x16x32_bf16 a[12:15], a[216:219], v[64:67], a[12:15]
    v_exp_f32 v212, v36
    v_mfma_f32_16x16x32_bf16 a[12:15], a[220:223], v[68:71], a[12:15]
    ds_read_b128 a[140:143], v249 offset:0
    v_cvt_pk_bf16_f32 v81, v210, v211
    v_mfma_f32_16x16x32_bf16 a[16:19], a[224:227], v[64:67], a[16:19]
    ds_read_b128 a[144:147], v246 offset:4096
    ds_read_b128 a[148:151], v247 offset:4096
    v_mfma_f32_16x16x32_bf16 a[16:19], a[228:231], v[68:71], a[16:19]
    v_exp_f32 v213, v37
    v_mfma_f32_16x16x32_bf16 a[20:23], a[232:235], v[64:67], a[20:23]
    v_exp_f32 v214, v38
    v_mfma_f32_16x16x32_bf16 a[20:23], a[236:239], v[68:71], a[20:23]
    ds_read_b128 a[152:155], v248 offset:4096
    v_cvt_pk_bf16_f32 v82, v212, v213
    v_mfma_f32_16x16x32_bf16 a[24:27], a[240:243], v[64:67], a[24:27]
    v_exp_f32 v215, v39
    v_mfma_f32_16x16x32_bf16 a[24:27], a[244:247], v[68:71], a[24:27]
    ds_read_b128 a[156:159], v249 offset:4096
    ds_read_b128 a[160:163], v246 offset:8192
    v_mfma_f32_16x16x32_bf16 a[28:31], a[248:251], v[64:67], a[28:31]
    v_exp_f32 v208, v40
    v_mfma_f32_16x16x32_bf16 a[28:31], a[252:255], v[68:71], a[28:31]
    ds_read_b128 a[164:167], v247 offset:8192
    v_cvt_pk_bf16_f32 v83, v214, v215
    v_mfma_f32_16x16x32_bf16 a[32:35], a[192:195], v[72:75], a[32:35]
    v_exp_f32 v209, v41
    v_mfma_f32_16x16x32_bf16 a[32:35], a[196:199], v[76:79], a[32:35]
    v_exp_f32 v210, v42
    v_mfma_f32_16x16x32_bf16 a[36:39], a[200:203], v[72:75], a[36:39]
    ds_read_b128 a[168:171], v248 offset:8192
    ds_read_b128 a[172:175], v249 offset:8192
    v_mfma_f32_16x16x32_bf16 a[36:39], a[204:207], v[76:79], a[36:39]
    ds_read_b128 a[176:179], v246 offset:12288
    v_cvt_pk_bf16_f32 v84, v208, v209
    v_mfma_f32_16x16x32_bf16 a[40:43], a[208:211], v[72:75], a[40:43]
    v_exp_f32 v211, v43
    v_mfma_f32_16x16x32_bf16 a[40:43], a[212:215], v[76:79], a[40:43]
    v_exp_f32 v212, v44
    v_mfma_f32_16x16x32_bf16 a[44:47], a[216:219], v[72:75], a[44:47]
    ds_read_b128 a[180:183], v247 offset:12288
    v_cvt_pk_bf16_f32 v85, v210, v211
    v_mfma_f32_16x16x32_bf16 a[44:47], a[220:223], v[76:79], a[44:47]
    v_exp_f32 v213, v45
    v_mfma_f32_16x16x32_bf16 a[48:51], a[224:227], v[72:75], a[48:51]
    ds_read_b128 a[184:187], v248 offset:12288
    ds_read_b128 a[188:191], v249 offset:12288
    v_mfma_f32_16x16x32_bf16 a[48:51], a[228:231], v[76:79], a[48:51]
    v_exp_f32 v214, v46
    v_mfma_f32_16x16x32_bf16 a[52:55], a[232:235], v[72:75], a[52:55]
    v_cvt_pk_bf16_f32 v86, v212, v213
    v_mfma_f32_16x16x32_bf16 a[52:55], a[236:239], v[76:79], a[52:55]
    v_exp_f32 v215, v47
    v_mfma_f32_16x16x32_bf16 a[56:59], a[240:243], v[72:75], a[56:59]
    v_exp_f32 v208, v48
    v_mfma_f32_16x16x32_bf16 a[56:59], a[244:247], v[76:79], a[56:59]
    buffer_load_dwordx4 v244, s[20:23], s32 offen offset:2048  lds
    v_mfma_f32_16x16x32_bf16 a[60:63], a[248:251], v[72:75], a[60:63]
    v_cvt_pk_bf16_f32 v87, v214, v215
    v_mfma_f32_16x16x32_bf16 a[60:63], a[252:255], v[76:79], a[60:63]
    v_exp_f32 v209, v49
    s_waitcnt lgkmcnt(0)
    v_mfma_f32_16x16x32_bf16 v[0:3], a[128:131], v[128:131], v[96:99]
    v_exp_f32 v210, v50
    s_mov_b32 s8, s44
    v_mfma_f32_16x16x32_bf16 v[0:3], a[132:135], v[136:139], v[0:3]
    v_exp_f32 v211, v51
    s_and_b32 s9, s45, 0xffff
    v_mfma_f32_16x16x32_bf16 v[0:3], a[136:139], v[144:147], v[0:3]
    s_mov_b32 s10, 0x240000
    v_mfma_f32_16x16x32_bf16 v[0:3], a[140:143], v[152:155], v[0:3]
    v_exp_f32 v212, v52
    s_mov_b32 s11, 0x00020000
    v_smfmac_f32_16x16x64_bf16 v[200:203], v[226:229], v[80:87], v112
    v_cvt_pk_bf16_f32 v88, v208, v209
    v_cvt_pk_bf16_f32 v89, v210, v211
    s_mov_b32 s12, s46
    v_mfma_f32_16x16x32_bf16 v[4:7], a[144:147], v[128:131], v[96:99]
    v_exp_f32 v213, v53
    s_and_b32 s13, s47, 0xffff
    v_mfma_f32_16x16x32_bf16 v[4:7], a[148:151], v[136:139], v[4:7]
    buffer_load_dwordx4 v245, s[20:23], s32 offen offset:3072  lds
    s_mov_b32 s14, 0x480
    v_mfma_f32_16x16x32_bf16 v[4:7], a[152:155], v[144:147], v[4:7]
    v_exp_f32 v214, v54
    s_mov_b32 s15, 0x00020000
    v_mfma_f32_16x16x32_bf16 v[4:7], a[156:159], v[152:155], v[4:7]
    v_exp_f32 v215, v55
    v_lshrrev_b32 v246, 4, v225
    v_mfma_f32_16x16x32_bf16 v[8:11], a[160:163], v[128:131], v[96:99]
    v_exp_f32 v208, v56
    v_and_b32 v247, 15, v246
    v_mfma_f32_16x16x32_bf16 v[8:11], a[164:167], v[136:139], v[8:11]
    v_cvt_pk_bf16_f32 v90, v212, v213
    v_cvt_pk_bf16_f32 v91, v214, v215
    v_lshrrev_b32 v248, 4, v246
    v_mfma_f32_16x16x32_bf16 v[8:11], a[168:171], v[144:147], v[8:11]
    s_add_u32 s33, s3, 147584
    s_add_u32 m0, s28, 114688
    v_and_b32 v251, 11, v247
    v_mfma_f32_16x16x32_bf16 v[8:11], a[172:175], v[152:155], v[8:11]
    v_exp_f32 v209, v57
    v_and_b32 v232, 1, v248
    v_mfma_f32_16x16x32_bf16 v[12:15], a[176:179], v[128:131], v[96:99]
    v_exp_f32 v210, v58
    v_lshl_add_u32 v251, v232, 2, v251
    v_mfma_f32_16x16x32_bf16 v[12:15], a[180:183], v[136:139], v[12:15]
    v_exp_f32 v211, v59
    v_mul_u32_u24 v249, 9216, v232
    v_mfma_f32_16x16x32_bf16 v[12:15], a[184:187], v[144:147], v[12:15]
    v_exp_f32 v212, v60
    v_lshrrev_b32 v232, 1, v248
    v_mfma_f32_16x16x32_bf16 v[12:15], a[188:191], v[152:155], v[12:15]
    buffer_load_dwordx4 v242, s[20:23], s33 offen offset:0  lds
    v_lshl_add_u32 v251, v232, 4, v251
    v_mfma_f32_16x16x32_bf16 v[16:19], a[128:131], v[132:135], v[100:103]
    v_cvt_pk_bf16_f32 v92, v208, v209
    v_cvt_pk_bf16_f32 v93, v210, v211
    v_lshl_add_u32 v249, v232, 8, v249
    v_mfma_f32_16x16x32_bf16 v[16:19], a[132:135], v[140:143], v[16:19]
    v_exp_f32 v213, v61
    v_lshl_add_u32 v249, v247, 4, v249
    v_mfma_f32_16x16x32_bf16 v[16:19], a[136:139], v[148:151], v[16:19]
    v_exp_f32 v214, v62
    v_lshlrev_b32 v253, 3, v251
    v_mfma_f32_16x16x32_bf16 v[16:19], a[140:143], v[156:159], v[16:19]
    buffer_load_dwordx4 v243, s[20:23], s33 offen offset:1024  lds
    v_lshlrev_b32 v251, 5, v251
    v_mfma_f32_16x16x32_bf16 v[20:23], a[144:147], v[132:135], v[100:103]
    v_exp_f32 v215, v63
    v_bfe_u32 v232, v247, 2, 1
    v_mfma_f32_16x16x32_bf16 v[20:23], a[148:151], v[140:143], v[20:23]
    v_cvt_pk_bf16_f32 v94, v212, v213
    v_cvt_pk_bf16_f32 v95, v214, v215
    v_mul_u32_u24 v250, 1152, v232
    v_mfma_f32_16x16x32_bf16 v[20:23], a[152:155], v[148:151], v[20:23]
    buffer_load_dwordx4 v244, s[20:23], s33 offen offset:2048  lds
    v_add_u32 v250, v250, v253
    v_mfma_f32_16x16x32_bf16 v[20:23], a[156:159], v[156:159], v[20:23]
    s_lshl_b32 s31, s42, 4
    v_smfmac_f32_16x16x64_bf16 v[204:207], v[226:229], v[88:95], v112
    s_add_u32 s31, s31, s41
    v_mfma_f32_16x16x32_bf16 v[24:27], a[160:163], v[132:135], v[100:103]
    s_lshl_b32 s29, s31, 2
    v_mfma_f32_16x16x32_bf16 v[24:27], a[164:167], v[140:143], v[24:27]
    buffer_load_dwordx4 v245, s[20:23], s33 offen offset:3072  lds
    s_add_u32 s29, s29, s40
    v_mfma_f32_16x16x32_bf16 v[24:27], a[168:171], v[148:151], v[24:27]
    s_lshl_b32 s38, s29, 1
    v_mfma_f32_16x16x32_bf16 v[24:27], a[172:175], v[156:159], v[24:27]
    s_mul_i32 s29, s29, 2304
    v_mfma_f32_16x16x32_bf16 v[28:31], a[176:179], v[132:135], v[100:103]
    s_mov_b32 s46, 53248
    v_mfma_f32_16x16x32_bf16 v[28:31], a[180:183], v[140:143], v[28:31]
    v_max3_f32 v216, v200, v201, v204
    v_max_f32 v216, v216, v205
    s_mov_b32 s47, 57344
    v_mfma_f32_16x16x32_bf16 v[28:31], a[184:187], v[148:151], v[28:31]
    v_cmp_nge_f32 vcc, s34, v216
    v_mfma_f32_16x16x32_bf16 v[28:31], a[188:191], v[156:159], v[28:31]
    s_cbranch_vccnz RARE_T30_1
BACK_T30_1:
    v_mfma_f32_16x16x32_bf16 a[64:67], a[192:195], v[80:83], a[64:67]
    v_exp_f32 v208, v0
    v_mfma_f32_16x16x32_bf16 a[64:67], a[196:199], v[84:87], a[64:67]
    v_exp_f32 v209, v1
    v_mfma_f32_16x16x32_bf16 a[68:71], a[200:203], v[80:83], a[68:71]
    v_exp_f32 v210, v2
    v_mfma_f32_16x16x32_bf16 a[68:71], a[204:207], v[84:87], a[68:71]
    v_exp_f32 v211, v3
    v_mfma_f32_16x16x32_bf16 a[72:75], a[208:211], v[80:83], a[72:75]
    v_exp_f32 v212, v4
    v_mfma_f32_16x16x32_bf16 a[72:75], a[212:215], v[84:87], a[72:75]
    v_mfma_f32_16x16x32_bf16 a[76:79], a[216:219], v[80:83], a[76:79]
    v_cvt_pk_bf16_f32 v64, v208, v209
    v_cvt_pk_bf16_f32 v65, v210, v211
    v_mfma_f32_16x16x32_bf16 a[76:79], a[220:223], v[84:87], a[76:79]
    v_exp_f32 v213, v5
    v_mfma_f32_16x16x32_bf16 a[80:83], a[224:227], v[80:83], a[80:83]
    v_exp_f32 v214, v6
    v_mfma_f32_16x16x32_bf16 a[80:83], a[228:231], v[84:87], a[80:83]
    v_exp_f32 v215, v7
    v_mfma_f32_16x16x32_bf16 a[84:87], a[232:235], v[80:83], a[84:87]
    v_exp_f32 v208, v8
    v_mfma_f32_16x16x32_bf16 a[84:87], a[236:239], v[84:87], a[84:87]
    v_cvt_pk_bf16_f32 v66, v212, v213
    v_cvt_pk_bf16_f32 v67, v214, v215
    v_mfma_f32_16x16x32_bf16 a[88:91], a[240:243], v[80:83], a[88:91]
    v_exp_f32 v209, v9
    v_mfma_f32_16x16x32_bf16 a[88:91], a[244:247], v[84:87], a[88:91]
    v_exp_f32 v210, v10
    v_mfma_f32_16x16x32_bf16 a[92:95], a[248:251], v[80:83], a[92:95]
    v_exp_f32 v211, v11
    v_mfma_f32_16x16x32_bf16 a[92:95], a[252:255], v[84:87], a[92:95]
    v_exp_f32 v212, v12
    v_mfma_f32_16x16x32_bf16 a[96:99], a[192:195], v[88:91], a[96:99]
    v_mfma_f32_16x16x32_bf16 a[96:99], a[196:199], v[92:95], a[96:99]
    v_cvt_pk_bf16_f32 v68, v208, v209
    v_cvt_pk_bf16_f32 v69, v210, v211
    v_mfma_f32_16x16x32_bf16 a[100:103], a[200:203], v[88:91], a[100:103]
    v_exp_f32 v213, v13
    v_mfma_f32_16x16x32_bf16 a[100:103], a[204:207], v[92:95], a[100:103]
    v_exp_f32 v214, v14
    v_mfma_f32_16x16x32_bf16 a[104:107], a[208:211], v[88:91], a[104:107]
    v_exp_f32 v215, v15
    v_mfma_f32_16x16x32_bf16 a[104:107], a[212:215], v[92:95], a[104:107]
    v_exp_f32 v208, v16
    v_mfma_f32_16x16x32_bf16 a[108:111], a[216:219], v[88:91], a[108:111]
    v_cvt_pk_bf16_f32 v70, v212, v213
    v_cvt_pk_bf16_f32 v71, v214, v215
    v_mfma_f32_16x16x32_bf16 a[108:111], a[220:223], v[92:95], a[108:111]
    v_exp_f32 v209, v17
    v_mfma_f32_16x16x32_bf16 a[112:115], a[224:227], v[88:91], a[112:115]
    v_exp_f32 v210, v18
    v_mfma_f32_16x16x32_bf16 a[112:115], a[228:231], v[92:95], a[112:115]
    v_exp_f32 v211, v19
    v_mfma_f32_16x16x32_bf16 a[116:119], a[232:235], v[88:91], a[116:119]
    v_mfma_f32_16x16x32_bf16 a[116:119], a[236:239], v[92:95], a[116:119]
    v_exp_f32 v212, v20
    v_mfma_f32_16x16x32_bf16 a[120:123], a[240:243], v[88:91], a[120:123]
    v_cvt_pk_bf16_f32 v72, v208, v209
    v_cvt_pk_bf16_f32 v73, v210, v211
    v_mfma_f32_16x16x32_bf16 a[120:123], a[244:247], v[92:95], a[120:123]
    v_exp_f32 v213, v21
    v_mfma_f32_16x16x32_bf16 a[124:127], a[248:251], v[88:91], a[124:127]
    v_exp_f32 v214, v22
    v_mfma_f32_16x16x32_bf16 a[124:127], a[252:255], v[92:95], a[124:127]
    v_exp_f32 v215, v23
    v_mfma_f32_16x16x32_bf16 v[32:35], a[128:131], v[160:163], v[104:107]
    s_waitcnt vmcnt(21)
    s_barrier
    v_mfma_f32_16x16x32_bf16 v[32:35], a[132:135], v[168:171], v[32:35]
    v_exp_f32 v208, v24
    v_mfma_f32_16x16x32_bf16 v[32:35], a[136:139], v[176:179], v[32:35]
    ds_read_b64_tr_b16 a[192:193], v234 offset:16384
    ds_read_b64_tr_b16 a[194:195], v234 offset:20480
    v_mfma_f32_16x16x32_bf16 v[32:35], a[140:143], v[184:187], v[32:35]
    v_cvt_pk_bf16_f32 v74, v212, v213
    v_cvt_pk_bf16_f32 v75, v214, v215
    v_smfmac_f32_16x16x64_bf16 v[192:195], v[226:229], v[64:71], v112
    ds_read_b64_tr_b16 a[196:197], v234 offset:24576
    ds_read_b64_tr_b16 a[198:199], v234 offset:28672
    v_mfma_f32_16x16x32_bf16 v[36:39], a[144:147], v[160:163], v[104:107]
    v_exp_f32 v209, v25
    v_mfma_f32_16x16x32_bf16 v[36:39], a[148:151], v[168:171], v[36:39]
    v_exp_f32 v210, v26
    v_mfma_f32_16x16x32_bf16 v[36:39], a[152:155], v[176:179], v[36:39]
    ds_read_b64_tr_b16 a[200:201], v235 offset:16384
    ds_read_b64_tr_b16 a[202:203], v235 offset:20480
    v_mfma_f32_16x16x32_bf16 v[36:39], a[156:159], v[184:187], v[36:39]
    ds_read_b64_tr_b16 a[204:205], v235 offset:24576
    v_cvt_pk_bf16_f32 v76, v208, v209
    v_mfma_f32_16x16x32_bf16 v[40:43], a[160:163], v[160:163], v[104:107]
    ds_read_b64_tr_b16 a[206:207], v235 offset:28672
    ds_read_b64_tr_b16 a[208:209], v236 offset:16384
    v_mfma_f32_16x16x32_bf16 v[40:43], a[164:167], v[168:171], v[40:43]
    v_exp_f32 v211, v27
    v_mfma_f32_16x16x32_bf16 v[40:43], a[168:171], v[176:179], v[40:43]
    v_exp_f32 v212, v28
    v_mfma_f32_16x16x32_bf16 v[40:43], a[172:175], v[184:187], v[40:43]
    ds_read_b64_tr_b16 a[210:211], v236 offset:20480
    ds_read_b64_tr_b16 a[212:213], v236 offset:24576
    v_mfma_f32_16x16x32_bf16 v[44:47], a[176:179], v[160:163], v[104:107]
    ds_read_b64_tr_b16 a[214:215], v236 offset:28672
    v_cvt_pk_bf16_f32 v77, v210, v211
    v_mfma_f32_16x16x32_bf16 v[44:47], a[180:183], v[168:171], v[44:47]
    ds_read_b64_tr_b16 a[216:217], v237 offset:16384
    ds_read_b64_tr_b16 a[218:219], v237 offset:20480
    v_mfma_f32_16x16x32_bf16 v[44:47], a[184:187], v[176:179], v[44:47]
    v_exp_f32 v213, v29
    v_mfma_f32_16x16x32_bf16 v[44:47], a[188:191], v[184:187], v[44:47]
    ds_read_b64_tr_b16 a[220:221], v237 offset:24576
    ds_read_b64_tr_b16 a[222:223], v237 offset:28672
    v_mfma_f32_16x16x32_bf16 v[48:51], a[128:131], v[164:167], v[108:111]
    v_exp_f32 v214, v30
    v_mfma_f32_16x16x32_bf16 v[48:51], a[132:135], v[172:175], v[48:51]
    ds_read_b64_tr_b16 a[224:225], v238 offset:16384
    v_cvt_pk_bf16_f32 v78, v212, v213
    v_mfma_f32_16x16x32_bf16 v[48:51], a[136:139], v[180:183], v[48:51]
    ds_read_b64_tr_b16 a[226:227], v238 offset:20480
    ds_read_b64_tr_b16 a[228:229], v238 offset:24576
    v_mfma_f32_16x16x32_bf16 v[48:51], a[140:143], v[188:191], v[48:51]
    v_exp_f32 v215, v31
    v_mfma_f32_16x16x32_bf16 v[52:55], a[144:147], v[164:167], v[108:111]
    ds_read_b64_tr_b16 a[230:231], v238 offset:28672
    ds_read_b64_tr_b16 a[232:233], v239 offset:16384
    v_mfma_f32_16x16x32_bf16 v[52:55], a[148:151], v[172:175], v[52:55]
    ds_read_b64_tr_b16 a[234:235], v239 offset:20480
    v_cvt_pk_bf16_f32 v79, v214, v215
    v_mfma_f32_16x16x32_bf16 v[52:55], a[152:155], v[180:183], v[52:55]
    ds_read_b64_tr_b16 a[236:237], v239 offset:24576
    ds_read_b64_tr_b16 a[238:239], v239 offset:28672
    v_mfma_f32_16x16x32_bf16 v[52:55], a[156:159], v[188:191], v[52:55]
    ds_read_b64_tr_b16 a[240:241], v240 offset:16384
    ds_read_b64_tr_b16 a[242:243], v240 offset:20480
    v_smfmac_f32_16x16x64_bf16 v[196:199], v[226:229], v[72:79], v112
    ds_read_b64_tr_b16 a[244:245], v240 offset:24576
    ds_read_b64_tr_b16 a[246:247], v240 offset:28672
    v_mfma_f32_16x16x32_bf16 v[56:59], a[160:163], v[164:167], v[108:111]
    ds_read_b64_tr_b16 a[248:249], v241 offset:16384
    ds_read_b64_tr_b16 a[250:251], v241 offset:20480
    v_mfma_f32_16x16x32_bf16 v[56:59], a[164:167], v[172:175], v[56:59]
    ds_read_b64_tr_b16 a[252:253], v241 offset:24576
    ds_read_b64_tr_b16 a[254:255], v241 offset:28672
    s_add_u32 s32, s3, 256
    s_add_u32 m0, s28, 0
    v_mfma_f32_16x16x32_bf16 v[56:59], a[168:171], v[180:183], v[56:59]
    buffer_load_dwordx4 v242, s[20:23], s32 offen offset:0  lds
    v_mfma_f32_16x16x32_bf16 v[56:59], a[172:175], v[188:191], v[56:59]
    buffer_load_dwordx4 v243, s[20:23], s32 offen offset:1024  lds
    v_mfma_f32_16x16x32_bf16 v[60:63], a[176:179], v[164:167], v[108:111]
    buffer_load_dwordx4 v244, s[20:23], s32 offen offset:2048  lds
    v_mfma_f32_16x16x32_bf16 v[60:63], a[180:183], v[172:175], v[60:63]
    v_max3_f32 v216, v192, v193, v196
    v_max_f32 v216, v216, v197
    v_mfma_f32_16x16x32_bf16 v[60:63], a[184:187], v[180:183], v[60:63]
    v_cmp_nge_f32 vcc, s34, v216
    v_mfma_f32_16x16x32_bf16 v[60:63], a[188:191], v[188:191], v[60:63]
    buffer_load_dwordx4 v245, s[20:23], s32 offen offset:3072  lds
    s_cbranch_vccnz RARE_T31_0
BACK_T31_0:
    s_waitcnt lgkmcnt(0)
    v_xor_b32 v230, s54, v230
    v_xor_b32 v231, s54, v231
    v_or_b32 v230, v230, v231
    v_cmp_ne_u32 vcc, 0, v230
    s_cbranch_vccz E_INIOK
    v_lshlrev_b32 v232, 1, v225
    s_mov_b32 s43, 9344
    s_mov_b32 s101, 200000
E_POLL8:
    buffer_load_dword v230, v232, s[24:27], s43 offen sc1
    buffer_load_dword v231, v232, s[24:27], s43 offen offset:256 sc1
    s_waitcnt vmcnt(0)
    v_xor_b32 v230, s54, v230
    v_xor_b32 v231, s54, v231
    v_or_b32 v230, v230, v231
    v_cmp_ne_u32 vcc, 0, v230
    s_sub_u32 s101, s101, 1
    s_cselect_b64 vcc, 0, vcc
    s_cbranch_vccnz E_POLL8
E_INIOK:
    v_mfma_f32_16x16x32_bf16 a[0:3], a[192:195], v[64:67], a[0:3]
    v_exp_f32 v208, v32
    v_mfma_f32_16x16x32_bf16 a[0:3], a[196:199], v[68:71], a[0:3]
    v_exp_f32 v209, v33
    v_mfma_f32_16x16x32_bf16 a[4:7], a[200:203], v[64:67], a[4:7]
    v_add_f32 v192, v192, v193
    v_mfma_f32_16x16x32_bf16 a[4:7], a[204:207], v[68:71], a[4:7]
    v_exp_f32 v210, v34
    s_add_u32 s33, s3, 147712
    s_add_u32 m0, s28, 65536
    v_mfma_f32_16x16x32_bf16 a[8:11], a[208:211], v[64:67], a[8:11]
    v_cvt_pk_bf16_f32 v80, v208, v209
    buffer_load_dwordx4 v242, s[20:23], s33 offen offset:0  lds
    v_rcp_f32 v192, v192
    v_mfma_f32_16x16x32_bf16 a[8:11], a[212:215], v[68:71], a[8:11]
    v_exp_f32 v211, v35
    v_mfma_f32_16x16x32_bf16 a[12:15], a[216:219], v[64:67], a[12:15]
    v_exp_f32 v212, v36
    v_add_f32 v196, v196, v197
    v_mfma_f32_16x16x32_bf16 a[12:15], a[220:223], v[68:71], a[12:15]
    v_cvt_pk_bf16_f32 v81, v210, v211
    v_mfma_f32_16x16x32_bf16 a[16:19], a[224:227], v[64:67], a[16:19]
    v_rcp_f32 v196, v196
    v_mfma_f32_16x16x32_bf16 a[16:19], a[228:231], v[68:71], a[16:19]
    v_exp_f32 v213, v37
    v_mfma_f32_16x16x32_bf16 a[20:23], a[232:235], v[64:67], a[20:23]
    v_exp_f32 v214, v38
    buffer_load_dwordx4 v243, s[20:23], s33 offen offset:1024  lds
    v_bfe_u32 v218, v225, 7, 1
    v_mfma_f32_16x16x32_bf16 a[20:23], a[236:239], v[68:71], a[20:23]
    v_cvt_pk_bf16_f32 v82, v212, v213
    v_mfma_f32_16x16x32_bf16 a[24:27], a[240:243], v[64:67], a[24:27]
    v_exp_f32 v215, v39
    v_mul_u32_u24 v218, 73728, v218
    v_mfma_f32_16x16x32_bf16 a[24:27], a[244:247], v[68:71], a[24:27]
    v_mfma_f32_16x16x32_bf16 a[28:31], a[248:251], v[64:67], a[28:31]
    v_exp_f32 v208, v40
    v_bfe_u32 v219, v225, 4, 3
    v_mfma_f32_16x16x32_bf16 a[28:31], a[252:255], v[68:71], a[28:31]
    v_cvt_pk_bf16_f32 v83, v214, v215
    v_mfma_f32_16x16x32_bf16 a[32:35], a[192:195], v[72:75], a[32:35]
    v_exp_f32 v209, v41
    v_lshl_add_u32 v218, v219, 6, v218
    v_mfma_f32_16x16x32_bf16 a[32:35], a[196:199], v[76:79], a[32:35]
    v_exp_f32 v210, v42
    v_mfma_f32_16x16x32_bf16 a[36:39], a[200:203], v[72:75], a[36:39]
    buffer_load_dwordx4 v244, s[20:23], s33 offen offset:2048  lds
    v_bfe_u32 v219, v225, 8, 2
    v_mfma_f32_16x16x32_bf16 a[36:39], a[204:207], v[76:79], a[36:39]
    v_cvt_pk_bf16_f32 v84, v208, v209
    v_mfma_f32_16x16x32_bf16 a[40:43], a[208:211], v[72:75], a[40:43]
    v_exp_f32 v211, v43
    v_lshl_add_u32 v254, v219, 4, v218
    v_mfma_f32_16x16x32_bf16 a[40:43], a[212:215], v[76:79], a[40:43]
    v_exp_f32 v212, v44
    v_mfma_f32_16x16x32_bf16 a[44:47], a[216:219], v[72:75], a[44:47]
    v_cvt_pk_bf16_f32 v85, v210, v211
    v_add_u32 v255, 147456, v254
    v_mfma_f32_16x16x32_bf16 a[44:47], a[220:223], v[76:79], a[44:47]
    v_exp_f32 v213, v45
    v_mfma_f32_16x16x32_bf16 a[48:51], a[224:227], v[72:75], a[48:51]
    v_mfma_f32_16x16x32_bf16 a[48:51], a[228:231], v[76:79], a[48:51]
    v_exp_f32 v214, v46
    v_mfma_f32_16x16x32_bf16 a[52:55], a[232:235], v[72:75], a[52:55]
    v_cvt_pk_bf16_f32 v86, v212, v213
    buffer_load_dwordx4 v245, s[20:23], s33 offen offset:3072  lds
    v_mfma_f32_16x16x32_bf16 a[52:55], a[236:239], v[76:79], a[52:55]
    v_exp_f32 v215, v47
    v_mfma_f32_16x16x32_bf16 a[56:59], a[240:243], v[72:75], a[56:59]
    v_exp_f32 v208, v48
    v_mfma_f32_16x16x32_bf16 a[56:59], a[244:247], v[76:79], a[56:59]
    v_mfma_f32_16x16x32_bf16 a[60:63], a[248:251], v[72:75], a[60:63]
    v_cvt_pk_bf16_f32 v87, v214, v215
    v_mfma_f32_16x16x32_bf16 a[60:63], a[252:255], v[76:79], a[60:63]
    v_exp_f32 v209, v49
    s_waitcnt lgkmcnt(0)
    s_waitcnt vmcnt(16)
    s_barrier
    s_add_u32 s32, s3, 384
    s_add_u32 m0, s28, 16384
    s_nop 0
    buffer_load_dwordx4 v242, s[20:23], s32 offen offset:0  lds
    buffer_load_dwordx4 v243, s[20:23], s32 offen offset:1024  lds
    buffer_load_dwordx4 v244, s[20:23], s32 offen offset:2048  lds
    buffer_load_dwordx4 v245, s[20:23], s32 offen offset:3072  lds
    s_add_u32 s33, s3, 147840
    s_add_u32 m0, s28, 81920
    s_nop 0
    buffer_load_dwordx4 v242, s[20:23], s33 offen offset:0  lds
    buffer_load_dwordx4 v243, s[20:23], s33 offen offset:1024  lds
    buffer_load_dwordx4 v244, s[20:23], s33 offen offset:2048  lds
    buffer_load_dwordx4 v245, s[20:23], s33 offen offset:3072  lds
    s_bitcmp1_b32 s41, 0
    s_cselect_b32 s48, 0, 5120
    s_add_u32 s48, s48, s39
    v_accvgpr_read_b32 v0, a0
    v_accvgpr_read_b32 v1, a1
    v_accvgpr_read_b32 v2, a2
    v_accvgpr_read_b32 v3, a3
    v_accvgpr_read_b32 v4, a4
    v_accvgpr_read_b32 v5, a5
    v_accvgpr_read_b32 v6, a6
    v_accvgpr_read_b32 v7, a7
    v_mul_f32 v0, v0, v192
    v_mul_f32 v1, v1, v192
    v_mul_f32 v2, v2, v192
    v_mul_f32 v3, v3, v192
    v_mul_f32 v4, v4, v192
    v_mul_f32 v5, v5, v192
    v_mul_f32 v6, v6, v192
    v_mul_f32 v7, v7, v192
    v_cvt_pk_bf16_f32 v128, v0, v1
    v_cvt_pk_bf16_f32 v129, v2, v3
    v_cvt_pk_bf16_f32 v130, v4, v5
    v_cvt_pk_bf16_f32 v131, v6, v7
    buffer_store_dwordx4 v[128:131], v254, s[24:27], s48 offen offset:0 sc1
    v_accvgpr_read_b32 v8, a8
    v_accvgpr_read_b32 v9, a9
    v_accvgpr_read_b32 v10, a10
    v_accvgpr_read_b32 v11, a11
    v_accvgpr_read_b32 v12, a12
    v_accvgpr_read_b32 v13, a13
    v_accvgpr_read_b32 v14, a14
    v_accvgpr_read_b32 v15, a15
    v_mul_f32 v8, v8, v192
    v_mul_f32 v9, v9, v192
    v_mul_f32 v10, v10, v192
    v_mul_f32 v11, v11, v192
    v_mul_f32 v12, v12, v192
    v_mul_f32 v13, v13, v192
    v_mul_f32 v14, v14, v192
    v_mul_f32 v15, v15, v192
    v_cvt_pk_bf16_f32 v132, v8, v9
    v_cvt_pk_bf16_f32 v133, v10, v11
    v_cvt_pk_bf16_f32 v134, v12, v13
    v_cvt_pk_bf16_f32 v135, v14, v15
    buffer_store_dwordx4 v[132:135], v254, s[24:27], s48 offen offset:512 sc1
    v_accvgpr_read_b32 v0, a16
    v_accvgpr_read_b32 v1, a17
    v_accvgpr_read_b32 v2, a18
    v_accvgpr_read_b32 v3, a19
    v_accvgpr_read_b32 v4, a20
    v_accvgpr_read_b32 v5, a21
    v_accvgpr_read_b32 v6, a22
    v_accvgpr_read_b32 v7, a23
    v_mul_f32 v0, v0, v192
    v_mul_f32 v1, v1, v192
    v_mul_f32 v2, v2, v192
    v_mul_f32 v3, v3, v192
    v_mul_f32 v4, v4, v192
    v_mul_f32 v5, v5, v192
    v_mul_f32 v6, v6, v192
    v_mul_f32 v7, v7, v192
    v_cvt_pk_bf16_f32 v136, v0, v1
    v_cvt_pk_bf16_f32 v137, v2, v3
    v_cvt_pk_bf16_f32 v138, v4, v5
    v_cvt_pk_bf16_f32 v139, v6, v7
    buffer_store_dwordx4 v[136:139], v254, s[24:27], s48 offen offset:1024 sc1
    v_accvgpr_read_b32 v8, a24
    v_accvgpr_read_b32 v9, a25
    v_accvgpr_read_b32 v10, a26
    v_accvgpr_read_b32 v11, a27
    v_accvgpr_read_b32 v12, a28
    v_accvgpr_read_b32 v13, a29
    v_accvgpr_read_b32 v14, a30
    v_accvgpr_read_b32 v15, a31
    v_mul_f32 v8, v8, v192
    v_mul_f32 v9, v9, v192
    v_mul_f32 v10, v10, v192
    v_mul_f32 v11, v11, v192
    v_mul_f32 v12, v12, v192
    v_mul_f32 v13, v13, v192
    v_mul_f32 v14, v14, v192
    v_mul_f32 v15, v15, v192
    v_cvt_pk_bf16_f32 v140, v8, v9
    v_cvt_pk_bf16_f32 v141, v10, v11
    v_cvt_pk_bf16_f32 v142, v12, v13
    v_cvt_pk_bf16_f32 v143, v14, v15
    buffer_store_dwordx4 v[140:143], v254, s[24:27], s48 offen offset:1536 sc1
    v_accvgpr_read_b32 v0, a32
    v_accvgpr_read_b32 v1, a33
    v_accvgpr_read_b32 v2, a34
    v_accvgpr_read_b32 v3, a35
    v_accvgpr_read_b32 v4, a36
    v_accvgpr_read_b32 v5, a37
    v_accvgpr_read_b32 v6, a38
    v_accvgpr_read_b32 v7, a39
    v_mul_f32 v0, v0, v196
    v_mul_f32 v1, v1, v196
    v_mul_f32 v2, v2, v196
    v_mul_f32 v3, v3, v196
    v_mul_f32 v4, v4, v196
    v_mul_f32 v5, v5, v196
    v_mul_f32 v6, v6, v196
    v_mul_f32 v7, v7, v196
    v_cvt_pk_bf16_f32 v160, v0, v1
    v_cvt_pk_bf16_f32 v161, v2, v3
    v_cvt_pk_bf16_f32 v162, v4, v5
    v_cvt_pk_bf16_f32 v163, v6, v7
    buffer_store_dwordx4 v[160:163], v255, s[24:27], s48 offen offset:0 sc1
    v_accvgpr_read_b32 v8, a40
    v_accvgpr_read_b32 v9, a41
    v_accvgpr_read_b32 v10, a42
    v_accvgpr_read_b32 v11, a43
    v_accvgpr_read_b32 v12, a44
    v_accvgpr_read_b32 v13, a45
    v_accvgpr_read_b32 v14, a46
    v_accvgpr_read_b32 v15, a47
    v_mul_f32 v8, v8, v196
    v_mul_f32 v9, v9, v196
    v_mul_f32 v10, v10, v196
    v_mul_f32 v11, v11, v196
    v_mul_f32 v12, v12, v196
    v_mul_f32 v13, v13, v196
    v_mul_f32 v14, v14, v196
    v_mul_f32 v15, v15, v196
    v_cvt_pk_bf16_f32 v164, v8, v9
    v_cvt_pk_bf16_f32 v165, v10, v11
    v_cvt_pk_bf16_f32 v166, v12, v13
    v_cvt_pk_bf16_f32 v167, v14, v15
    buffer_store_dwordx4 v[164:167], v255, s[24:27], s48 offen offset:512 sc1
    v_accvgpr_read_b32 v0, a48
    v_accvgpr_read_b32 v1, a49
    v_accvgpr_read_b32 v2, a50
    v_accvgpr_read_b32 v3, a51
    v_accvgpr_read_b32 v4, a52
    v_accvgpr_read_b32 v5, a53
    v_accvgpr_read_b32 v6, a54
    v_accvgpr_read_b32 v7, a55
    v_mul_f32 v0, v0, v196
    v_mul_f32 v1, v1, v196
    v_mul_f32 v2, v2, v196
    v_mul_f32 v3, v3, v196
    v_mul_f32 v4, v4, v196
    v_mul_f32 v5, v5, v196
    v_mul_f32 v6, v6, v196
    v_mul_f32 v7, v7, v196
    v_cvt_pk_bf16_f32 v168, v0, v1
    v_cvt_pk_bf16_f32 v169, v2, v3
    v_cvt_pk_bf16_f32 v170, v4, v5
    v_cvt_pk_bf16_f32 v171, v6, v7
    buffer_store_dwordx4 v[168:171], v255, s[24:27], s48 offen offset:1024 sc1
    v_accvgpr_read_b32 v8, a56
    v_accvgpr_read_b32 v9, a57
    v_accvgpr_read_b32 v10, a58
    v_accvgpr_read_b32 v11, a59
    v_accvgpr_read_b32 v12, a60
    v_accvgpr_read_b32 v13, a61
    v_accvgpr_read_b32 v14, a62
    v_accvgpr_read_b32 v15, a63
    v_mul_f32 v8, v8, v196
    v_mul_f32 v9, v9, v196
    v_mul_f32 v10, v10, v196
    v_mul_f32 v11, v11, v196
    v_mul_f32 v12, v12, v196
    v_mul_f32 v13, v13, v196
    v_mul_f32 v14, v14, v196
    v_mul_f32 v15, v15, v196
    v_cvt_pk_bf16_f32 v172, v8, v9
    v_cvt_pk_bf16_f32 v173, v10, v11
    v_cvt_pk_bf16_f32 v174, v12, v13
    v_cvt_pk_bf16_f32 v175, v14, v15
    buffer_store_dwordx4 v[172:175], v255, s[24:27], s48 offen offset:1536 sc1
    v_exp_f32 v210, v50
    v_exp_f32 v211, v51
    v_exp_f32 v212, v52
    v_smfmac_f32_16x16x64_bf16 v[200:203], v[226:229], v[80:87], v112
    v_cvt_pk_bf16_f32 v88, v208, v209
    v_cvt_pk_bf16_f32 v89, v210, v211
    v_exp_f32 v213, v53
    v_exp_f32 v214, v54
    v_exp_f32 v215, v55
    v_exp_f32 v208, v56
    v_cvt_pk_bf16_f32 v90, v212, v213
    v_cvt_pk_bf16_f32 v91, v214, v215
    v_exp_f32 v209, v57
    v_exp_f32 v210, v58
    v_exp_f32 v211, v59
    v_exp_f32 v212, v60
    v_cvt_pk_bf16_f32 v92, v208, v209
    v_cvt_pk_bf16_f32 v93, v210, v211
    v_exp_f32 v213, v61
    v_exp_f32 v214, v62
    v_exp_f32 v215, v63
    v_cvt_pk_bf16_f32 v94, v212, v213
    v_cvt_pk_bf16_f32 v95, v214, v215
    s_nop 1
    v_smfmac_f32_16x16x64_bf16 v[204:207], v[226:229], v[88:95], v112
    s_nop 7
    v_max3_f32 v216, v200, v201, v204
    v_max_f32 v216, v216, v205
    v_cmp_nge_f32 vcc, s34, v216
    s_cbranch_vccnz RARE_T31_1
BACK_T31_1:
    v_mfma_f32_16x16x32_bf16 a[64:67], a[192:195], v[80:83], a[64:67]
    v_and_b32 v226, 0xffff, v234
    v_and_b32 v227, 0xffff, v235
    v_mfma_f32_16x16x32_bf16 a[64:67], a[196:199], v[84:87], a[64:67]
    v_and_b32 v228, 0xffff, v236
    v_and_b32 v229, 0xffff, v237
    v_mfma_f32_16x16x32_bf16 a[68:71], a[200:203], v[80:83], a[68:71]
    v_and_b32 v230, 0xffff, v238
    v_mfma_f32_16x16x32_bf16 a[68:71], a[204:207], v[84:87], a[68:71]
    v_and_b32 v231, 0xffff, v239
    v_and_b32 v232, 0xffff, v240
    v_mfma_f32_16x16x32_bf16 a[72:75], a[208:211], v[80:83], a[72:75]
    v_and_b32 v233, 0xffff, v241
    v_mfma_f32_16x16x32_bf16 a[72:75], a[212:215], v[84:87], a[72:75]
    v_add_f32 v200, v200, v201
    v_rcp_f32 v200, v200
    v_mfma_f32_16x16x32_bf16 a[76:79], a[216:219], v[80:83], a[76:79]
    v_add_f32 v204, v204, v205
    v_mfma_f32_16x16x32_bf16 a[76:79], a[220:223], v[84:87], a[76:79]
    v_rcp_f32 v204, v204
    s_and_b32 s17, s17, 0xffff
    v_mfma_f32_16x16x32_bf16 a[80:83], a[224:227], v[80:83], a[80:83]
    s_mov_b32 s18, 0x240000
    v_mfma_f32_16x16x32_bf16 a[80:83], a[228:231], v[84:87], a[80:83]
    s_mov_b32 s19, 0x00020000
    v_and_b32 v252, 3, v246
    v_mfma_f32_16x16x32_bf16 a[84:87], a[232:235], v[80:83], a[84:87]
    v_lshlrev_b32 v252, 2, v252
    v_mfma_f32_16x16x32_bf16 a[84:87], a[236:239], v[84:87], a[84:87]
    s_lshr_b32 s30, s31, 2
    s_lshl_b32 s30, s30, 7
    v_mfma_f32_16x16x32_bf16 a[88:91], a[240:243], v[80:83], a[88:91]
    s_lshl_b32 s35, s40, 4
    v_mfma_f32_16x16x32_bf16 a[88:91], a[244:247], v[84:87], a[88:91]
    s_add_u32 s30, s30, s35
    s_add_u32 s30, s30, 2621440
    v_mfma_f32_16x16x32_bf16 a[92:95], a[248:251], v[80:83], a[92:95]
    s_mul_i32 s34, s31, 73728
    v_mfma_f32_16x16x32_bf16 a[92:95], a[252:255], v[84:87], a[92:95]
    s_mul_i32 s35, s40, 18432
    s_add_u32 s34, s34, s35
    v_mfma_f32_16x16x32_bf16 a[96:99], a[192:195], v[88:91], a[96:99]
    s_add_u32 s34, s34, 12582912
    s_lshl_b32 s31, s42, 2
    v_mfma_f32_16x16x32_bf16 a[96:99], a[196:199], v[92:95], a[96:99]
    s_add_u32 s31, s31, s40
    v_mfma_f32_16x16x32_bf16 a[100:103], a[200:203], v[88:91], a[100:103]
    s_lshl_b32 s31, s31, 7
    s_lshl_b32 s35, s41, 2
    v_mfma_f32_16x16x32_bf16 a[100:103], a[204:207], v[92:95], a[100:103]
    s_add_u32 s31, s31, s35
    v_mfma_f32_16x16x32_bf16 a[104:107], a[208:211], v[88:91], a[104:107]
    s_add_u32 s31, s31, 2621440
    v_mov_b32 v221, s54
    v_mfma_f32_16x16x32_bf16 a[104:107], a[212:215], v[92:95], a[104:107]
    v_mov_b32 v222, 0
    v_mfma_f32_16x16x32_bf16 a[108:111], a[216:219], v[88:91], a[108:111]
    s_and_b32 s43, s41, 1
    s_mul_i32 s50, s43, -576
    v_mfma_f32_16x16x32_bf16 a[108:111], a[220:223], v[92:95], a[108:111]
    s_add_u32 s50, s50, 512
    v_mfma_f32_16x16x32_bf16 a[112:115], a[224:227], v[88:91], a[112:115]
    s_lshl_b32 s53, s43, 9
    s_add_u32 s53, s53, s39
    v_mfma_f32_16x16x32_bf16 a[112:115], a[228:231], v[92:95], a[112:115]
    s_add_u32 s53, s53, 4096
    v_mfma_f32_16x16x32_bf16 a[116:119], a[232:235], v[88:91], a[116:119]
    s_mul_i32 s43, s43, 5120
    s_add_u32 s39, s39, s43
    v_mfma_f32_16x16x32_bf16 a[116:119], a[236:239], v[92:95], a[116:119]
    s_lshl_b32 s44, s42, 4
    v_mfma_f32_16x16x32_bf16 a[120:123], a[240:243], v[88:91], a[120:123]
    s_add_u32 s44, s44, s41
    s_lshl_b32 s44, s44, 2
    v_mfma_f32_16x16x32_bf16 a[120:123], a[244:247], v[92:95], a[120:123]
    s_add_u32 s44, s44, s40
    v_mfma_f32_16x16x32_bf16 a[124:127], a[248:251], v[88:91], a[124:127]
    s_lshl_b32 s44, s44, 5
    s_add_u32 s44, s44, 2883584
    v_mfma_f32_16x16x32_bf16 a[124:127], a[252:255], v[92:95], a[124:127]
    s_xor_b32 s45, s44, 128
    ds_read_b64_tr_b16 a[192:193], v226 offset:32768
    ds_read_b64_tr_b16 a[194:195], v226 offset:36864
    ds_read_b64_tr_b16 a[196:197], v226 offset:40960
    ds_read_b64_tr_b16 a[198:199], v226 offset:45056
    ds_read_b64_tr_b16 a[200:201], v230 offset:32768
    ds_read_b64_tr_b16 a[202:203], v230 offset:36864
    ds_read_b64_tr_b16 a[204:205], v230 offset:40960
    ds_read_b64_tr_b16 a[206:207], v230 offset:45056
    ds_read_b64_tr_b16 a[208:209], v234 offset:32768
    ds_read_b64_tr_b16 a[210:211], v234 offset:36864
    ds_read_b64_tr_b16 a[212:213], v234 offset:40960
    ds_read_b64_tr_b16 a[214:215], v234 offset:45056
    ds_read_b64_tr_b16 a[216:217], v238 offset:32768
    ds_read_b64_tr_b16 a[218:219], v238 offset:36864
    ds_read_b64_tr_b16 a[220:221], v238 offset:40960
    ds_read_b64_tr_b16 a[222:223], v238 offset:45056
    v_accvgpr_read_b32 v0, a64
    v_accvgpr_read_b32 v1, a65
    v_accvgpr_read_b32 v2, a66
    v_accvgpr_read_b32 v3, a67
    v_accvgpr_read_b32 v4, a68
    v_accvgpr_read_b32 v5, a69
    v_accvgpr_read_b32 v6, a70
    v_accvgpr_read_b32 v7, a71
    v_mul_f32 v0, v0, v200
    v_mul_f32 v1, v1, v200
    v_mul_f32 v2, v2, v200
    v_mul_f32 v3, v3, v200
    v_mul_f32 v4, v4, v200
    v_mul_f32 v5, v5, v200
    v_mul_f32 v6, v6, v200
    v_mul_f32 v7, v7, v200
    v_cvt_pk_bf16_f32 v144, v0, v1
    v_cvt_pk_bf16_f32 v145, v2, v3
    v_cvt_pk_bf16_f32 v146, v4, v5
    v_cvt_pk_bf16_f32 v147, v6, v7
    buffer_store_dwordx4 v[144:147], v254, s[24:27], s48 offen offset:2048 sc1
    v_accvgpr_read_b32 v8, a72
    v_accvgpr_read_b32 v9, a73
    v_accvgpr_read_b32 v10, a74
    v_accvgpr_read_b32 v11, a75
    v_accvgpr_read_b32 v12, a76
    v_accvgpr_read_b32 v13, a77
    v_accvgpr_read_b32 v14, a78
    v_accvgpr_read_b32 v15, a79
    v_mul_f32 v8, v8, v200
    v_mul_f32 v9, v9, v200
    v_mul_f32 v10, v10, v200
    v_mul_f32 v11, v11, v200
    v_mul_f32 v12, v12, v200
    v_mul_f32 v13, v13, v200
    v_mul_f32 v14, v14, v200
    v_mul_f32 v15, v15, v200
    v_cvt_pk_bf16_f32 v148, v8, v9
    v_cvt_pk_bf16_f32 v149, v10, v11
    v_cvt_pk_bf16_f32 v150, v12, v13
    v_cvt_pk_bf16_f32 v151, v14, v15
    buffer_store_dwordx4 v[148:151], v254, s[24:27], s48 offen offset:2560 sc1
    v_accvgpr_read_b32 v0, a80
    v_accvgpr_read_b32 v1, a81
    v_accvgpr_read_b32 v2, a82
    v_accvgpr_read_b32 v3, a83
    v_accvgpr_read_b32 v4, a84
    v_accvgpr_read_b32 v5, a85
    v_accvgpr_read_b32 v6, a86
    v_accvgpr_read_b32 v7, a87
    v_mul_f32 v0, v0, v200
    v_mul_f32 v1, v1, v200
    v_mul_f32 v2, v2, v200
    v_mul_f32 v3, v3, v200
    v_mul_f32 v4, v4, v200
    v_mul_f32 v5, v5, v200
    v_mul_f32 v6, v6, v200
    v_mul_f32 v7, v7, v200
    v_cvt_pk_bf16_f32 v152, v0, v1
    v_cvt_pk_bf16_f32 v153, v2, v3
    v_cvt_pk_bf16_f32 v154, v4, v5
    v_cvt_pk_bf16_f32 v155, v6, v7
    buffer_store_dwordx4 v[152:155], v254, s[24:27], s48 offen offset:3072 sc1
    v_accvgpr_read_b32 v8, a88
    v_accvgpr_read_b32 v9, a89
    v_accvgpr_read_b32 v10, a90
    v_accvgpr_read_b32 v11, a91
    v_accvgpr_read_b32 v12, a92
    v_accvgpr_read_b32 v13, a93
    v_accvgpr_read_b32 v14, a94
    v_accvgpr_read_b32 v15, a95
    v_mul_f32 v8, v8, v200
    v_mul_f32 v9, v9, v200
    v_mul_f32 v10, v10, v200
    v_mul_f32 v11, v11, v200
    v_mul_f32 v12, v12, v200
    v_mul_f32 v13, v13, v200
    v_mul_f32 v14, v14, v200
    v_mul_f32 v15, v15, v200
    v_cvt_pk_bf16_f32 v156, v8, v9
    v_cvt_pk_bf16_f32 v157, v10, v11
    v_cvt_pk_bf16_f32 v158, v12, v13
    v_cvt_pk_bf16_f32 v159, v14, v15
    buffer_store_dwordx4 v[156:159], v254, s[24:27], s48 offen offset:3584 sc1
    v_accvgpr_read_b32 v0, a96
    v_accvgpr_read_b32 v1, a97
    v_accvgpr_read_b32 v2, a98
    v_accvgpr_read_b32 v3, a99
    v_accvgpr_read_b32 v4, a100
    v_accvgpr_read_b32 v5, a101
    v_accvgpr_read_b32 v6, a102
    v_accvgpr_read_b32 v7, a103
    v_mul_f32 v0, v0, v204
    v_mul_f32 v1, v1, v204
    v_mul_f32 v2, v2, v204
    v_mul_f32 v3, v3, v204
    v_mul_f32 v4, v4, v204
    v_mul_f32 v5, v5, v204
    v_mul_f32 v6, v6, v204
    v_mul_f32 v7, v7, v204
    v_cvt_pk_bf16_f32 v176, v0, v1
    v_cvt_pk_bf16_f32 v177, v2, v3
    v_cvt_pk_bf16_f32 v178, v4, v5
    v_cvt_pk_bf16_f32 v179, v6, v7
    buffer_store_dwordx4 v[176:179], v255, s[24:27], s48 offen offset:2048 sc1
    v_accvgpr_read_b32 v8, a104
    v_accvgpr_read_b32 v9, a105
    v_accvgpr_read_b32 v10, a106
    v_accvgpr_read_b32 v11, a107
    v_accvgpr_read_b32 v12, a108
    v_accvgpr_read_b32 v13, a109
    v_accvgpr_read_b32 v14, a110
    v_accvgpr_read_b32 v15, a111
    v_mul_f32 v8, v8, v204
    v_mul_f32 v9, v9, v204
    v_mul_f32 v10, v10, v204
    v_mul_f32 v11, v11, v204
    v_mul_f32 v12, v12, v204
    v_mul_f32 v13, v13, v204
    v_mul_f32 v14, v14, v204
    v_mul_f32 v15, v15, v204
    v_cvt_pk_bf16_f32 v180, v8, v9
    v_cvt_pk_bf16_f32 v181, v10, v11
    v_cvt_pk_bf16_f32 v182, v12, v13
    v_cvt_pk_bf16_f32 v183, v14, v15
    buffer_store_dwordx4 v[180:183], v255, s[24:27], s48 offen offset:2560 sc1
    v_accvgpr_read_b32 v0, a112
    v_accvgpr_read_b32 v1, a113
    v_accvgpr_read_b32 v2, a114
    v_accvgpr_read_b32 v3, a115
    v_accvgpr_read_b32 v4, a116
    v_accvgpr_read_b32 v5, a117
    v_accvgpr_read_b32 v6, a118
    v_accvgpr_read_b32 v7, a119
    v_mul_f32 v0, v0, v204
    v_mul_f32 v1, v1, v204
    v_mul_f32 v2, v2, v204
    v_mul_f32 v3, v3, v204
    v_mul_f32 v4, v4, v204
    v_mul_f32 v5, v5, v204
    v_mul_f32 v6, v6, v204
    v_mul_f32 v7, v7, v204
    v_cvt_pk_bf16_f32 v184, v0, v1
    v_cvt_pk_bf16_f32 v185, v2, v3
    v_cvt_pk_bf16_f32 v186, v4, v5
    v_cvt_pk_bf16_f32 v187, v6, v7
    buffer_store_dwordx4 v[184:187], v255, s[24:27], s48 offen offset:3072 sc1
    v_accvgpr_read_b32 v8, a120
    v_accvgpr_read_b32 v9, a121
    v_accvgpr_read_b32 v10, a122
    v_accvgpr_read_b32 v11, a123
    v_accvgpr_read_b32 v12, a124
    v_accvgpr_read_b32 v13, a125
    v_accvgpr_read_b32 v14, a126
    v_accvgpr_read_b32 v15, a127
    v_mul_f32 v8, v8, v204
    v_mul_f32 v9, v9, v204
    v_mul_f32 v10, v10, v204
    v_mul_f32 v11, v11, v204
    v_mul_f32 v12, v12, v204
    v_mul_f32 v13, v13, v204
    v_mul_f32 v14, v14, v204
    v_mul_f32 v15, v15, v204
    v_cvt_pk_bf16_f32 v188, v8, v9
    v_cvt_pk_bf16_f32 v189, v10, v11
    v_cvt_pk_bf16_f32 v190, v12, v13
    v_cvt_pk_bf16_f32 v191, v14, v15
    buffer_store_dwordx4 v[188:191], v255, s[24:27], s48 offen offset:3584 sc1
    s_waitcnt vmcnt(8)
    buffer_store_dword v221, v222, s[24:27], s44 offen offset:4 sc1
    s_waitcnt lgkmcnt(0)
    s_nop 0
    s_waitcnt lgkmcnt(8)
    v_mfma_f32_16x16x32_bf16 v[0:3], a[192:195], v[128:131], 0
    ds_read_b64_tr_b16 a[224:225], v227 offset:32768
    v_mfma_f32_16x16x32_bf16 v[0:3], a[196:199], v[132:135], v[0:3]
    ds_read_b64_tr_b16 a[226:227], v227 offset:36864
    buffer_load_dwordx2 a[168:169], v250, s[8:11], s29 offen offset:0
    v_mfma_f32_16x16x32_bf16 v[0:3], a[200:203], v[136:139], v[0:3]
    ds_read_b64_tr_b16 a[228:229], v227 offset:40960
    v_mfma_f32_16x16x32_bf16 v[0:3], a[204:207], v[140:143], v[0:3]
    ds_read_b64_tr_b16 a[230:231], v227 offset:45056
    buffer_load_dwordx4 a[68:71], v217, s[56:59], s49 offen
    v_mfma_f32_16x16x32_bf16 v[4:7], a[192:195], v[160:163], 0
    ds_read_b64_tr_b16 a[232:233], v231 offset:32768
    v_mfma_f32_16x16x32_bf16 v[4:7], a[196:199], v[164:167], v[4:7]
    ds_read_b64_tr_b16 a[234:235], v231 offset:36864
    buffer_load_dwordx4 a[128:131], v251, s[24:27], s46 offen offset:0 sc1
    v_mfma_f32_16x16x32_bf16 v[4:7], a[200:203], v[168:171], v[4:7]
    ds_read_b64_tr_b16 a[236:237], v231 offset:40960
    v_mfma_f32_16x16x32_bf16 v[4:7], a[204:207], v[172:175], v[4:7]
    ds_read_b64_tr_b16 a[238:239], v231 offset:45056
    s_waitcnt lgkmcnt(8)
    v_mfma_f32_16x16x32_bf16 v[0:3], a[208:211], v[144:147], v[0:3]
    ds_read_b64_tr_b16 a[240:241], v235 offset:32768
    v_mfma_f32_16x16x32_bf16 v[0:3], a[212:215], v[148:151], v[0:3]
    ds_read_b64_tr_b16 a[242:243], v235 offset:36864
    buffer_load_dwordx4 a[132:135], v251, s[24:27], s46 offen offset:16 sc1
    v_mfma_f32_16x16x32_bf16 v[0:3], a[216:219], v[152:155], v[0:3]
    ds_read_b64_tr_b16 a[244:245], v235 offset:40960
    v_mfma_f32_16x16x32_bf16 v[0:3], a[220:223], v[156:159], v[0:3]
    ds_read_b64_tr_b16 a[246:247], v235 offset:45056
    buffer_load_dwordx4 a[72:75], v217, s[60:63], s51 offen
    v_mfma_f32_16x16x32_bf16 v[4:7], a[208:211], v[176:179], v[4:7]
    ds_read_b64_tr_b16 a[248:249], v239 offset:32768
    s_add_u32 s51, s51, 147456
    v_mfma_f32_16x16x32_bf16 v[4:7], a[212:215], v[180:183], v[4:7]
    ds_read_b64_tr_b16 a[250:251], v239 offset:36864
    buffer_load_dwordx2 a[178:179], v253, s[12:15], 0 offen offset:0
    v_mfma_f32_16x16x32_bf16 v[4:7], a[216:219], v[184:187], v[4:7]
    ds_read_b64_tr_b16 a[252:253], v239 offset:40960
    v_mfma_f32_16x16x32_bf16 v[4:7], a[220:223], v[188:191], v[4:7]
    ds_read_b64_tr_b16 a[254:255], v239 offset:45056
    s_waitcnt lgkmcnt(8)
    v_mfma_f32_16x16x32_bf16 v[8:11], a[224:227], v[128:131], 0
    ds_read_b64_tr_b16 a[192:193], v228 offset:32768
    v_mfma_f32_16x16x32_bf16 v[8:11], a[228:231], v[132:135], v[8:11]
    ds_read_b64_tr_b16 a[194:195], v228 offset:36864
    buffer_load_dwordx2 a[170:171], v250, s[8:11], s29 offen offset:256
    v_mfma_f32_16x16x32_bf16 v[8:11], a[232:235], v[136:139], v[8:11]
    ds_read_b64_tr_b16 a[196:197], v228 offset:40960
    v_mfma_f32_16x16x32_bf16 v[8:11], a[236:239], v[140:143], v[8:11]
    ds_read_b64_tr_b16 a[198:199], v228 offset:45056
    buffer_load_dwordx4 a[76:79], v217, s[60:63], s51 offen
    v_mfma_f32_16x16x32_bf16 v[12:15], a[224:227], v[160:163], 0
    ds_read_b64_tr_b16 a[200:201], v232 offset:32768
    s_add_u32 s51, s51, 147456
    v_mfma_f32_16x16x32_bf16 v[12:15], a[228:231], v[164:167], v[12:15]
    ds_read_b64_tr_b16 a[202:203], v232 offset:36864
    buffer_load_dwordx4 a[136:139], v251, s[24:27], s46 offen offset:1024 sc1
    v_mfma_f32_16x16x32_bf16 v[12:15], a[232:235], v[168:171], v[12:15]
    ds_read_b64_tr_b16 a[204:205], v232 offset:40960
    v_mfma_f32_16x16x32_bf16 v[12:15], a[236:239], v[172:175], v[12:15]
    ds_read_b64_tr_b16 a[206:207], v232 offset:45056
    s_waitcnt lgkmcnt(8)
    v_mfma_f32_16x16x32_bf16 v[8:11], a[240:243], v[144:147], v[8:11]
    ds_read_b64_tr_b16 a[208:209], v236 offset:32768
    v_mfma_f32_16x16x32_bf16 v[8:11], a[244:247], v[148:151], v[8:11]
    ds_read_b64_tr_b16 a[210:211], v236 offset:36864
    buffer_load_dwordx4 a[140:143], v251, s[24:27], s46 offen offset:1040 sc1
    v_mfma_f32_16x16x32_bf16 v[8:11], a[248:251], v[152:155], v[8:11]
    ds_read_b64_tr_b16 a[212:213], v236 offset:40960
    v_mfma_f32_16x16x32_bf16 v[8:11], a[252:255], v[156:159], v[8:11]
    ds_read_b64_tr_b16 a[214:215], v236 offset:45056
    buffer_load_dwordx4 a[80:83], v217, s[60:63], s51 offen
    v_mfma_f32_16x16x32_bf16 v[12:15], a[240:243], v[176:179], v[12:15]
    ds_read_b64_tr_b16 a[216:217], v240 offset:32768
    s_add_u32 s51, s51, 147456
    v_mfma_f32_16x16x32_bf16 v[12:15], a[244:247], v[180:183], v[12:15]
    ds_read_b64_tr_b16 a[218:219], v240 offset:36864
    buffer_load_dwordx2 a[180:181], v253, s[12:15], 0 offen offset:256
    v_mfma_f32_16x16x32_bf16 v[12:15], a[248:251], v[184:187], v[12:15]
    ds_read_b64_tr_b16 a[220:221], v240 offset:40960
    v_mfma_f32_16x16x32_bf16 v[12:15], a[252:255], v[188:191], v[12:15]
    ds_read_b64_tr_b16 a[222:223], v240 offset:45056
    s_waitcnt lgkmcnt(8)
    v_mfma_f32_16x16x32_bf16 v[16:19], a[192:195], v[128:131], 0
    ds_read_b64_tr_b16 a[224:225], v229 offset:32768
    v_mfma_f32_16x16x32_bf16 v[16:19], a[196:199], v[132:135], v[16:19]
    ds_read_b64_tr_b16 a[226:227], v229 offset:36864
    buffer_load_dwordx2 a[172:173], v250, s[8:11], s29 offen offset:512
    v_mfma_f32_16x16x32_bf16 v[16:19], a[200:203], v[136:139], v[16:19]
    ds_read_b64_tr_b16 a[228:229], v229 offset:40960
    v_mfma_f32_16x16x32_bf16 v[16:19], a[204:207], v[140:143], v[16:19]
    ds_read_b64_tr_b16 a[230:231], v229 offset:45056
    buffer_load_dwordx4 a[84:87], v217, s[60:63], s51 offen
    v_mfma_f32_16x16x32_bf16 v[20:23], a[192:195], v[160:163], 0
    ds_read_b64_tr_b16 a[232:233], v233 offset:32768
    s_add_u32 s51, s51, 147456
    v_mfma_f32_16x16x32_bf16 v[20:23], a[196:199], v[164:167], v[20:23]
    ds_read_b64_tr_b16 a[234:235], v233 offset:36864
    buffer_load_dwordx4 a[144:147], v251, s[24:27], s46 offen offset:2048 sc1
    v_mfma_f32_16x16x32_bf16 v[20:23], a[200:203], v[168:171], v[20:23]
    ds_read_b64_tr_b16 a[236:237], v233 offset:40960
    v_mfma_f32_16x16x32_bf16 v[20:23], a[204:207], v[172:175], v[20:23]
    ds_read_b64_tr_b16 a[238:239], v233 offset:45056
    s_waitcnt lgkmcnt(8)
    v_mfma_f32_16x16x32_bf16 v[16:19], a[208:211], v[144:147], v[16:19]
    ds_read_b64_tr_b16 a[240:241], v237 offset:32768
    v_mfma_f32_16x16x32_bf16 v[16:19], a[212:215], v[148:151], v[16:19]
    ds_read_b64_tr_b16 a[242:243], v237 offset:36864
    buffer_load_dwordx4 a[148:151], v251, s[24:27], s46 offen offset:2064 sc1
    v_mfma_f32_16x16x32_bf16 v[16:19], a[216:219], v[152:155], v[16:19]
    ds_read_b64_tr_b16 a[244:245], v237 offset:40960
    v_mfma_f32_16x16x32_bf16 v[16:19], a[220:223], v[156:159], v[16:19]
    ds_read_b64_tr_b16 a[246:247], v237 offset:45056
    buffer_load_dwordx4 a[88:91], v217, s[60:63], s51 offen
    v_mfma_f32_16x16x32_bf16 v[20:23], a[208:211], v[176:179], v[20:23]
    ds_read_b64_tr_b16 a[248:249], v241 offset:32768
    s_add_u32 s51, s51, 147456
    v_mfma_f32_16x16x32_bf16 v[20:23], a[212:215], v[180:183], v[20:23]
    ds_read_b64_tr_b16 a[250:251], v241 offset:36864
    buffer_load_dwordx2 a[182:183], v253, s[12:15], 0 offen offset:512
    v_mfma_f32_16x16x32_bf16 v[20:23], a[216:219], v[184:187], v[20:23]
    ds_read_b64_tr_b16 a[252:253], v241 offset:40960
    v_mfma_f32_16x16x32_bf16 v[20:23], a[220:223], v[188:191], v[20:23]
    ds_read_b64_tr_b16 a[254:255], v241 offset:45056
    s_waitcnt lgkmcnt(8)
    v_mfma_f32_16x16x32_bf16 v[24:27], a[224:227], v[128:131], 0
    s_barrier
    ds_read_b64_tr_b16 a[192:193], v226 offset:49152
    v_mfma_f32_16x16x32_bf16 v[24:27], a[228:231], v[132:135], v[24:27]
    ds_read_b64_tr_b16 a[194:195], v226 offset:53248
    buffer_load_dwordx2 a[174:175], v250, s[8:11], s29 offen offset:768
    v_mfma_f32_16x16x32_bf16 v[24:27], a[232:235], v[136:139], v[24:27]
    ds_read_b64_tr_b16 a[196:197], v226 offset:57344
    v_mfma_f32_16x16x32_bf16 v[24:27], a[236:239], v[140:143], v[24:27]
    ds_read_b64_tr_b16 a[198:199], v226 offset:61440
    buffer_load_dwordx4 a[92:95], v217, s[60:63], s51 offen
    v_mfma_f32_16x16x32_bf16 v[28:31], a[224:227], v[160:163], 0
    ds_read_b64_tr_b16 a[200:201], v230 offset:49152
    s_add_u32 s51, s51, 147456
    v_mfma_f32_16x16x32_bf16 v[28:31], a[228:231], v[164:167], v[28:31]
    ds_read_b64_tr_b16 a[202:203], v230 offset:53248
    buffer_load_dwordx4 a[152:155], v251, s[24:27], s46 offen offset:3072 sc1
    v_mfma_f32_16x16x32_bf16 v[28:31], a[232:235], v[168:171], v[28:31]
    ds_read_b64_tr_b16 a[204:205], v230 offset:57344
    v_mfma_f32_16x16x32_bf16 v[28:31], a[236:239], v[172:175], v[28:31]
    ds_read_b64_tr_b16 a[206:207], v230 offset:61440
    s_waitcnt lgkmcnt(8)
    v_mfma_f32_16x16x32_bf16 v[24:27], a[240:243], v[144:147], v[24:27]
    ds_read_b64_tr_b16 a[208:209], v234 offset:49152
    v_mfma_f32_16x16x32_bf16 v[24:27], a[244:247], v[148:151], v[24:27]
    ds_read_b64_tr_b16 a[210:211], v234 offset:53248
    buffer_load_dwordx4 a[156:159], v251, s[24:27], s46 offen offset:3088 sc1
    v_mfma_f32_16x16x32_bf16 v[24:27], a[248:251], v[152:155], v[24:27]
    ds_read_b64_tr_b16 a[212:213], v234 offset:57344
    v_mfma_f32_16x16x32_bf16 v[24:27], a[252:255], v[156:159], v[24:27]
    ds_read_b64_tr_b16 a[214:215], v234 offset:61440
    buffer_load_dwordx4 a[96:99], v217, s[60:63], s51 offen
    v_mfma_f32_16x16x32_bf16 v[28:31], a[240:243], v[176:179], v[28:31]
    ds_read_b64_tr_b16 a[216:217], v238 offset:49152
    s_add_u32 s51, s51, 147456
    v_mfma_f32_16x16x32_bf16 v[28:31], a[244:247], v[180:183], v[28:31]
    ds_read_b64_tr_b16 a[218:219], v238 offset:53248
    buffer_load_dwordx2 a[184:185], v253, s[12:15], 0 offen offset:768
    v_mfma_f32_16x16x32_bf16 v[28:31], a[248:251], v[184:187], v[28:31]
    ds_read_b64_tr_b16 a[220:221], v238 offset:57344
    v_mfma_f32_16x16x32_bf16 v[28:31], a[252:255], v[188:191], v[28:31]
    ds_read_b64_tr_b16 a[222:223], v238 offset:61440
    s_waitcnt vmcnt(25)
    buffer_store_dword v221, v222, s[24:27], s44 offen sc1
    s_waitcnt lgkmcnt(8)
    v_mfma_f32_16x16x32_bf16 v[32:35], a[192:195], v[128:131], 0
    ds_read_b64_tr_b16 a[224:225], v227 offset:49152
    v_mfma_f32_16x16x32_bf16 v[32:35], a[196:199], v[132:135], v[32:35]
    ds_read_b64_tr_b16 a[226:227], v227 offset:53248
    buffer_load_dwordx2 a[176:177], v250, s[8:11], s29 offen offset:1024
    v_mfma_f32_16x16x32_bf16 v[32:35], a[200:203], v[136:139], v[32:35]
    ds_read_b64_tr_b16 a[228:229], v227 offset:57344
    v_mfma_f32_16x16x32_bf16 v[32:35], a[204:207], v[140:143], v[32:35]
    ds_read_b64_tr_b16 a[230:231], v227 offset:61440
    buffer_load_dwordx4 a[100:103], v217, s[60:63], s51 offen
    v_mfma_f32_16x16x32_bf16 v[36:39], a[192:195], v[160:163], 0
    ds_read_b64_tr_b16 a[232:233], v231 offset:49152
    s_add_u32 s51, s51, 147456
    v_mfma_f32_16x16x32_bf16 v[36:39], a[196:199], v[164:167], v[36:39]
    ds_read_b64_tr_b16 a[234:235], v231 offset:53248
    buffer_load_dwordx4 a[160:163], v251, s[24:27], s47 offen offset:0 sc1
    v_mfma_f32_16x16x32_bf16 v[36:39], a[200:203], v[168:171], v[36:39]
    ds_read_b64_tr_b16 a[236:237], v231 offset:57344
    v_mfma_f32_16x16x32_bf16 v[36:39], a[204:207], v[172:175], v[36:39]
    ds_read_b64_tr_b16 a[238:239], v231 offset:61440
    s_waitcnt lgkmcnt(8)
    v_mfma_f32_16x16x32_bf16 v[32:35], a[208:211], v[144:147], v[32:35]
    ds_read_b64_tr_b16 a[240:241], v235 offset:49152
    buffer_load_dword v220, v222, s[24:27], s45 offen offset:4 sc1
    v_mfma_f32_16x16x32_bf16 v[32:35], a[212:215], v[148:151], v[32:35]
    ds_read_b64_tr_b16 a[242:243], v235 offset:53248
    buffer_load_dwordx4 a[164:167], v251, s[24:27], s47 offen offset:16 sc1
    v_mfma_f32_16x16x32_bf16 v[32:35], a[216:219], v[152:155], v[32:35]
    ds_read_b64_tr_b16 a[244:245], v235 offset:57344
    v_mfma_f32_16x16x32_bf16 v[32:35], a[220:223], v[156:159], v[32:35]
    ds_read_b64_tr_b16 a[246:247], v235 offset:61440
    buffer_load_dwordx4 a[104:107], v217, s[60:63], s51 offen
    v_mfma_f32_16x16x32_bf16 v[36:39], a[208:211], v[176:179], v[36:39]
    ds_read_b64_tr_b16 a[248:249], v239 offset:49152
    s_add_u32 s51, s51, 147456
    v_mfma_f32_16x16x32_bf16 v[36:39], a[212:215], v[180:183], v[36:39]
    ds_read_b64_tr_b16 a[250:251], v239 offset:53248
    buffer_load_dwordx2 a[186:187], v253, s[12:15], 0 offen offset:1024
    v_mfma_f32_16x16x32_bf16 v[36:39], a[216:219], v[184:187], v[36:39]
    ds_read_b64_tr_b16 a[252:253], v239 offset:57344
    v_mfma_f32_16x16x32_bf16 v[36:39], a[220:223], v[188:191], v[36:39]
    ds_read_b64_tr_b16 a[254:255], v239 offset:61440
    s_waitcnt lgkmcnt(8)
    v_mfma_f32_16x16x32_bf16 v[40:43], a[224:227], v[128:131], 0
    ds_read_b64_tr_b16 a[192:193], v228 offset:49152
    v_mfma_f32_16x16x32_bf16 v[40:43], a[228:231], v[132:135], v[40:43]
    ds_read_b64_tr_b16 a[194:195], v228 offset:53248
    v_mfma_f32_16x16x32_bf16 v[40:43], a[232:235], v[136:139], v[40:43]
    ds_read_b64_tr_b16 a[196:197], v228 offset:57344
    v_mfma_f32_16x16x32_bf16 v[40:43], a[236:239], v[140:143], v[40:43]
    ds_read_b64_tr_b16 a[198:199], v228 offset:61440
    buffer_load_dwordx4 a[108:111], v225, s[4:7], s52 offen offset:0
    v_mfma_f32_16x16x32_bf16 v[44:47], a[224:227], v[160:163], 0
    ds_read_b64_tr_b16 a[200:201], v232 offset:49152
    v_mfma_f32_16x16x32_bf16 v[44:47], a[228:231], v[164:167], v[44:47]
    ds_read_b64_tr_b16 a[202:203], v232 offset:53248
    v_mfma_f32_16x16x32_bf16 v[44:47], a[232:235], v[168:171], v[44:47]
    ds_read_b64_tr_b16 a[204:205], v232 offset:57344
    v_mfma_f32_16x16x32_bf16 v[44:47], a[236:239], v[172:175], v[44:47]
    ds_read_b64_tr_b16 a[206:207], v232 offset:61440
    s_waitcnt lgkmcnt(8)
    v_mfma_f32_16x16x32_bf16 v[40:43], a[240:243], v[144:147], v[40:43]
    ds_read_b64_tr_b16 a[208:209], v236 offset:49152
    v_mfma_f32_16x16x32_bf16 v[40:43], a[244:247], v[148:151], v[40:43]
    ds_read_b64_tr_b16 a[210:211], v236 offset:53248
    v_mfma_f32_16x16x32_bf16 v[40:43], a[248:251], v[152:155], v[40:43]
    ds_read_b64_tr_b16 a[212:213], v236 offset:57344
    v_mfma_f32_16x16x32_bf16 v[40:43], a[252:255], v[156:159], v[40:43]
    ds_read_b64_tr_b16 a[214:215], v236 offset:61440
    buffer_load_dwordx4 a[112:115], v225, s[4:7], s52 offen offset:1024
    v_mfma_f32_16x16x32_bf16 v[44:47], a[240:243], v[176:179], v[44:47]
    ds_read_b64_tr_b16 a[216:217], v240 offset:49152
    v_mfma_f32_16x16x32_bf16 v[44:47], a[244:247], v[180:183], v[44:47]
    ds_read_b64_tr_b16 a[218:219], v240 offset:53248
    v_mfma_f32_16x16x32_bf16 v[44:47], a[248:251], v[184:187], v[44:47]
    ds_read_b64_tr_b16 a[220:221], v240 offset:57344
    v_mfma_f32_16x16x32_bf16 v[44:47], a[252:255], v[188:191], v[44:47]
    ds_read_b64_tr_b16 a[222:223], v240 offset:61440
    s_waitcnt vmcnt(5)
    v_cmp_ne_u32 vcc, s54, v220
    s_cbranch_vccnz E_WAITA
E_WAITAX:
    s_waitcnt lgkmcnt(8)
    v_mfma_f32_16x16x32_bf16 v[48:51], a[192:195], v[128:131], 0
    ds_read_b64_tr_b16 a[224:225], v229 offset:49152
    v_mfma_f32_16x16x32_bf16 v[48:51], a[196:199], v[132:135], v[48:51]
    buffer_load_dwordx4 a[0:3], v254, s[24:27], s39 offen offset:0 sc1
    ds_read_b64_tr_b16 a[226:227], v229 offset:53248
    v_mfma_f32_16x16x32_bf16 v[48:51], a[200:203], v[136:139], v[48:51]
    ds_read_b64_tr_b16 a[228:229], v229 offset:57344
    v_mfma_f32_16x16x32_bf16 v[48:51], a[204:207], v[140:143], v[48:51]
    ds_read_b64_tr_b16 a[230:231], v229 offset:61440
    buffer_load_dwordx4 a[116:119], v225, s[4:7], s52 offen offset:2048
    v_mfma_f32_16x16x32_bf16 v[52:55], a[192:195], v[160:163], 0
    ds_read_b64_tr_b16 a[232:233], v233 offset:49152
    v_mfma_f32_16x16x32_bf16 v[52:55], a[196:199], v[164:167], v[52:55]
    buffer_load_dwordx4 a[32:35], v255, s[24:27], s39 offen offset:0 sc1
    ds_read_b64_tr_b16 a[234:235], v233 offset:53248
    v_mfma_f32_16x16x32_bf16 v[52:55], a[200:203], v[168:171], v[52:55]
    ds_read_b64_tr_b16 a[236:237], v233 offset:57344
    v_mfma_f32_16x16x32_bf16 v[52:55], a[204:207], v[172:175], v[52:55]
    ds_read_b64_tr_b16 a[238:239], v233 offset:61440
    s_waitcnt lgkmcnt(8)
    v_mfma_f32_16x16x32_bf16 v[48:51], a[208:211], v[144:147], v[48:51]
    ds_read_b64_tr_b16 a[240:241], v237 offset:49152
    v_mfma_f32_16x16x32_bf16 v[48:51], a[212:215], v[148:151], v[48:51]
    buffer_load_dwordx4 a[4:7], v254, s[24:27], s39 offen offset:512 sc1
    ds_read_b64_tr_b16 a[242:243], v237 offset:53248
    v_mfma_f32_16x16x32_bf16 v[48:51], a[216:219], v[152:155], v[48:51]
    ds_read_b64_tr_b16 a[244:245], v237 offset:57344
    v_mfma_f32_16x16x32_bf16 v[48:51], a[220:223], v[156:159], v[48:51]
    ds_read_b64_tr_b16 a[246:247], v237 offset:61440
    buffer_load_dwordx4 a[120:123], v225, s[4:7], s52 offen offset:3072
    v_mfma_f32_16x16x32_bf16 v[52:55], a[208:211], v[176:179], v[52:55]
    ds_read_b64_tr_b16 a[248:249], v241 offset:49152
    v_mfma_f32_16x16x32_bf16 v[52:55], a[212:215], v[180:183], v[52:55]
    buffer_load_dwordx4 a[36:39], v255, s[24:27], s39 offen offset:512 sc1
    ds_read_b64_tr_b16 a[250:251], v241 offset:53248
    v_mfma_f32_16x16x32_bf16 v[52:55], a[216:219], v[184:187], v[52:55]
    ds_read_b64_tr_b16 a[252:253], v241 offset:57344
    v_mfma_f32_16x16x32_bf16 v[52:55], a[220:223], v[188:191], v[52:55]
    ds_read_b64_tr_b16 a[254:255], v241 offset:61440
    s_waitcnt lgkmcnt(8)
    v_mfma_f32_16x16x32_bf16 v[56:59], a[224:227], v[128:131], 0
    s_barrier
    ds_read_b64_tr_b16 a[192:193], v226 offset:0
    v_mfma_f32_16x16x32_bf16 v[56:59], a[228:231], v[132:135], v[56:59]
    buffer_load_dwordx4 a[8:11], v254, s[24:27], s39 offen offset:1024 sc1
    ds_read_b64_tr_b16 a[194:195], v226 offset:4096
    v_mfma_f32_16x16x32_bf16 v[56:59], a[232:235], v[136:139], v[56:59]
    ds_read_b64_tr_b16 a[196:197], v226 offset:8192
    v_mfma_f32_16x16x32_bf16 v[56:59], a[236:239], v[140:143], v[56:59]
    ds_read_b64_tr_b16 a[198:199], v226 offset:12288
    v_mfma_f32_16x16x32_bf16 v[60:63], a[224:227], v[160:163], 0
    ds_read_b64_tr_b16 a[200:201], v230 offset:0
    v_mfma_f32_16x16x32_bf16 v[60:63], a[228:231], v[164:167], v[60:63]
    buffer_load_dwordx4 a[40:43], v255, s[24:27], s39 offen offset:1024 sc1
    ds_read_b64_tr_b16 a[202:203], v230 offset:4096
    v_mfma_f32_16x16x32_bf16 v[60:63], a[232:235], v[168:171], v[60:63]
    ds_read_b64_tr_b16 a[204:205], v230 offset:8192
    v_mfma_f32_16x16x32_bf16 v[60:63], a[236:239], v[172:175], v[60:63]
    ds_read_b64_tr_b16 a[206:207], v230 offset:12288
    s_add_u32 s32, s55, 0
    s_waitcnt lgkmcnt(8)
    v_mfma_f32_16x16x32_bf16 v[56:59], a[240:243], v[144:147], v[56:59]
    ds_read_b64_tr_b16 a[208:209], v234 offset:0
    s_add_u32 m0, s28, 32768
    v_mfma_f32_16x16x32_bf16 v[56:59], a[244:247], v[148:151], v[56:59]
    buffer_load_dwordx4 a[12:15], v254, s[24:27], s39 offen offset:1536 sc1
    ds_read_b64_tr_b16 a[210:211], v234 offset:4096
    v_mfma_f32_16x16x32_bf16 v[56:59], a[248:251], v[152:155], v[56:59]
    ds_read_b64_tr_b16 a[212:213], v234 offset:8192
    buffer_load_dwordx4 v242, s[20:23], s32 offen offset:0  lds
    v_mfma_f32_16x16x32_bf16 v[56:59], a[252:255], v[156:159], v[56:59]
    ds_read_b64_tr_b16 a[214:215], v234 offset:12288
    v_mfma_f32_16x16x32_bf16 v[60:63], a[240:243], v[176:179], v[60:63]
    ds_read_b64_tr_b16 a[216:217], v238 offset:0
    buffer_load_dwordx4 v243, s[20:23], s32 offen offset:1024  lds
    v_mfma_f32_16x16x32_bf16 v[60:63], a[244:247], v[180:183], v[60:63]
    buffer_load_dwordx4 a[44:47], v255, s[24:27], s39 offen offset:1536 sc1
    ds_read_b64_tr_b16 a[218:219], v238 offset:4096
    v_mfma_f32_16x16x32_bf16 v[60:63], a[248:251], v[184:187], v[60:63]
    ds_read_b64_tr_b16 a[220:221], v238 offset:8192
    v_mfma_f32_16x16x32_bf16 v[60:63], a[252:255], v[188:191], v[60:63]
    ds_read_b64_tr_b16 a[222:223], v238 offset:12288
    s_waitcnt lgkmcnt(8)
    v_mfma_f32_16x16x32_bf16 v[64:67], a[192:195], v[128:131], 0
    ds_read_b64_tr_b16 a[224:225], v227 offset:0
    v_mfma_f32_16x16x32_bf16 v[64:67], a[196:199], v[132:135], v[64:67]
    ds_read_b64_tr_b16 a[226:227], v227 offset:4096
    v_mfma_f32_16x16x32_bf16 v[64:67], a[200:203], v[136:139], v[64:67]
    ds_read_b64_tr_b16 a[228:229], v227 offset:8192
    v_mfma_f32_16x16x32_bf16 v[64:67], a[204:207], v[140:143], v[64:67]
    ds_read_b64_tr_b16 a[230:231], v227 offset:12288
    v_mfma_f32_16x16x32_bf16 v[68:71], a[192:195], v[160:163], 0
    ds_read_b64_tr_b16 a[232:233], v231 offset:0
    v_mfma_f32_16x16x32_bf16 v[68:71], a[196:199], v[164:167], v[68:71]
    ds_read_b64_tr_b16 a[234:235], v231 offset:4096
    v_mfma_f32_16x16x32_bf16 v[68:71], a[200:203], v[168:171], v[68:71]
    ds_read_b64_tr_b16 a[236:237], v231 offset:8192
    v_mfma_f32_16x16x32_bf16 v[68:71], a[204:207], v[172:175], v[68:71]
    ds_read_b64_tr_b16 a[238:239], v231 offset:12288
    s_waitcnt lgkmcnt(8)
    v_mfma_f32_16x16x32_bf16 v[64:67], a[208:211], v[144:147], v[64:67]
    ds_read_b64_tr_b16 a[240:241], v235 offset:0
    v_mfma_f32_16x16x32_bf16 v[64:67], a[212:215], v[148:151], v[64:67]
    ds_read_b64_tr_b16 a[242:243], v235 offset:4096
    v_mfma_f32_16x16x32_bf16 v[64:67], a[216:219], v[152:155], v[64:67]
    ds_read_b64_tr_b16 a[244:245], v235 offset:8192
    buffer_load_dwordx4 v244, s[20:23], s32 offen offset:2048  lds
    v_mfma_f32_16x16x32_bf16 v[64:67], a[220:223], v[156:159], v[64:67]
    ds_read_b64_tr_b16 a[246:247], v235 offset:12288
    v_mfma_f32_16x16x32_bf16 v[68:71], a[208:211], v[176:179], v[68:71]
    ds_read_b64_tr_b16 a[248:249], v239 offset:0
    buffer_load_dwordx4 v245, s[20:23], s32 offen offset:3072  lds
    v_mfma_f32_16x16x32_bf16 v[68:71], a[212:215], v[180:183], v[68:71]
    ds_read_b64_tr_b16 a[250:251], v239 offset:4096
    v_mfma_f32_16x16x32_bf16 v[68:71], a[216:219], v[184:187], v[68:71]
    ds_read_b64_tr_b16 a[252:253], v239 offset:8192
    v_mfma_f32_16x16x32_bf16 v[68:71], a[220:223], v[188:191], v[68:71]
    ds_read_b64_tr_b16 a[254:255], v239 offset:12288
    s_waitcnt lgkmcnt(8)
    v_mfma_f32_16x16x32_bf16 v[72:75], a[224:227], v[128:131], 0
    ds_read_b64_tr_b16 a[192:193], v228 offset:0
    v_mfma_f32_16x16x32_bf16 v[72:75], a[228:231], v[132:135], v[72:75]
    ds_read_b64_tr_b16 a[194:195], v228 offset:4096
    v_mfma_f32_16x16x32_bf16 v[72:75], a[232:235], v[136:139], v[72:75]
    ds_read_b64_tr_b16 a[196:197], v228 offset:8192
    v_mfma_f32_16x16x32_bf16 v[72:75], a[236:239], v[140:143], v[72:75]
    ds_read_b64_tr_b16 a[198:199], v228 offset:12288
    v_mfma_f32_16x16x32_bf16 v[76:79], a[224:227], v[160:163], 0
    ds_read_b64_tr_b16 a[200:201], v232 offset:0
    v_mfma_f32_16x16x32_bf16 v[76:79], a[228:231], v[164:167], v[76:79]
    ds_read_b64_tr_b16 a[202:203], v232 offset:4096
    v_mfma_f32_16x16x32_bf16 v[76:79], a[232:235], v[168:171], v[76:79]
    ds_read_b64_tr_b16 a[204:205], v232 offset:8192
    v_mfma_f32_16x16x32_bf16 v[76:79], a[236:239], v[172:175], v[76:79]
    ds_read_b64_tr_b16 a[206:207], v232 offset:12288
    s_add_u32 s33, s55, 147456
    s_waitcnt lgkmcnt(8)
    v_mfma_f32_16x16x32_bf16 v[72:75], a[240:243], v[144:147], v[72:75]
    ds_read_b64_tr_b16 a[208:209], v236 offset:0
    buffer_load_dword v220, v222, s[24:27], s45 offen sc1
    s_add_u32 m0, s28, 98304
    v_mfma_f32_16x16x32_bf16 v[72:75], a[244:247], v[148:151], v[72:75]
    ds_read_b64_tr_b16 a[210:211], v236 offset:4096
    v_mfma_f32_16x16x32_bf16 v[72:75], a[248:251], v[152:155], v[72:75]
    ds_read_b64_tr_b16 a[212:213], v236 offset:8192
    buffer_load_dwordx4 v242, s[20:23], s33 offen offset:0  lds
    v_mfma_f32_16x16x32_bf16 v[72:75], a[252:255], v[156:159], v[72:75]
    ds_read_b64_tr_b16 a[214:215], v236 offset:12288
    v_mfma_f32_16x16x32_bf16 v[76:79], a[240:243], v[176:179], v[76:79]
    ds_read_b64_tr_b16 a[216:217], v240 offset:0
    buffer_load_dwordx4 v243, s[20:23], s33 offen offset:1024  lds
    v_mfma_f32_16x16x32_bf16 v[76:79], a[244:247], v[180:183], v[76:79]
    ds_read_b64_tr_b16 a[218:219], v240 offset:4096
    v_mfma_f32_16x16x32_bf16 v[76:79], a[248:251], v[184:187], v[76:79]
    ds_read_b64_tr_b16 a[220:221], v240 offset:8192
    v_mfma_f32_16x16x32_bf16 v[76:79], a[252:255], v[188:191], v[76:79]
    ds_read_b64_tr_b16 a[222:223], v240 offset:12288
    s_waitcnt lgkmcnt(8)
    v_mfma_f32_16x16x32_bf16 v[80:83], a[192:195], v[128:131], 0
    ds_read_b64_tr_b16 a[224:225], v229 offset:0
    v_mfma_f32_16x16x32_bf16 v[80:83], a[196:199], v[132:135], v[80:83]
    ds_read_b64_tr_b16 a[226:227], v229 offset:4096
    v_mfma_f32_16x16x32_bf16 v[80:83], a[200:203], v[136:139], v[80:83]
    ds_read_b64_tr_b16 a[228:229], v229 offset:8192
    v_mfma_f32_16x16x32_bf16 v[80:83], a[204:207], v[140:143], v[80:83]
    ds_read_b64_tr_b16 a[230:231], v229 offset:12288
    v_mfma_f32_16x16x32_bf16 v[84:87], a[192:195], v[160:163], 0
    ds_read_b64_tr_b16 a[232:233], v233 offset:0
    v_mfma_f32_16x16x32_bf16 v[84:87], a[196:199], v[164:167], v[84:87]
    ds_read_b64_tr_b16 a[234:235], v233 offset:4096
    v_mfma_f32_16x16x32_bf16 v[84:87], a[200:203], v[168:171], v[84:87]
    ds_read_b64_tr_b16 a[236:237], v233 offset:8192
    v_mfma_f32_16x16x32_bf16 v[84:87], a[204:207], v[172:175], v[84:87]
    ds_read_b64_tr_b16 a[238:239], v233 offset:12288
    s_waitcnt lgkmcnt(8)
    v_mfma_f32_16x16x32_bf16 v[80:83], a[208:211], v[144:147], v[80:83]
    ds_read_b64_tr_b16 a[240:241], v237 offset:0
    v_mfma_f32_16x16x32_bf16 v[80:83], a[212:215], v[148:151], v[80:83]
    ds_read_b64_tr_b16 a[242:243], v237 offset:4096
    v_mfma_f32_16x16x32_bf16 v[80:83], a[216:219], v[152:155], v[80:83]
    ds_read_b64_tr_b16 a[244:245], v237 offset:8192
    buffer_load_dwordx4 v244, s[20:23], s33 offen offset:2048  lds
    v_mfma_f32_16x16x32_bf16 v[80:83], a[220:223], v[156:159], v[80:83]
    ds_read_b64_tr_b16 a[246:247], v237 offset:12288
    v_mfma_f32_16x16x32_bf16 v[84:87], a[208:211], v[176:179], v[84:87]
    ds_read_b64_tr_b16 a[248:249], v241 offset:0
    buffer_load_dwordx4 v245, s[20:23], s33 offen offset:3072  lds
    v_mfma_f32_16x16x32_bf16 v[84:87], a[212:215], v[180:183], v[84:87]
    ds_read_b64_tr_b16 a[250:251], v241 offset:4096
    v_mfma_f32_16x16x32_bf16 v[84:87], a[216:219], v[184:187], v[84:87]
    ds_read_b64_tr_b16 a[252:253], v241 offset:8192
    v_mfma_f32_16x16x32_bf16 v[84:87], a[220:223], v[188:191], v[84:87]
    ds_read_b64_tr_b16 a[254:255], v241 offset:12288
    s_waitcnt vmcnt(4)
    v_cmp_ne_u32 vcc, s54, v220
    s_cbranch_vccnz E_WAITP
E_WAITX:
    s_waitcnt lgkmcnt(8)
    v_mfma_f32_16x16x32_bf16 v[88:91], a[224:227], v[128:131], 0
    s_barrier
    ds_read_b64_tr_b16 a[192:193], v226 offset:16384
    v_mfma_f32_16x16x32_bf16 v[88:91], a[228:231], v[132:135], v[88:91]
    buffer_load_dwordx4 a[16:19], v254, s[24:27], s39 offen offset:2048 sc1
    ds_read_b64_tr_b16 a[194:195], v226 offset:20480
    v_mfma_f32_16x16x32_bf16 v[88:91], a[232:235], v[136:139], v[88:91]
    ds_read_b64_tr_b16 a[196:197], v226 offset:24576
    v_mfma_f32_16x16x32_bf16 v[88:91], a[236:239], v[140:143], v[88:91]
    ds_read_b64_tr_b16 a[198:199], v226 offset:28672
    v_mfma_f32_16x16x32_bf16 v[92:95], a[224:227], v[160:163], 0
    ds_read_b64_tr_b16 a[200:201], v230 offset:16384
    v_mfma_f32_16x16x32_bf16 v[92:95], a[228:231], v[164:167], v[92:95]
    buffer_load_dwordx4 a[48:51], v255, s[24:27], s39 offen offset:2048 sc1
    ds_read_b64_tr_b16 a[202:203], v230 offset:20480
    v_mfma_f32_16x16x32_bf16 v[92:95], a[232:235], v[168:171], v[92:95]
    ds_read_b64_tr_b16 a[204:205], v230 offset:24576
    v_mfma_f32_16x16x32_bf16 v[92:95], a[236:239], v[172:175], v[92:95]
    ds_read_b64_tr_b16 a[206:207], v230 offset:28672
    s_add_u32 s32, s55, 128
    s_waitcnt lgkmcnt(8)
    v_mfma_f32_16x16x32_bf16 v[88:91], a[240:243], v[144:147], v[88:91]
    ds_read_b64_tr_b16 a[208:209], v234 offset:16384
    s_add_u32 m0, s28, 49152
    v_mfma_f32_16x16x32_bf16 v[88:91], a[244:247], v[148:151], v[88:91]
    buffer_load_dwordx4 a[20:23], v254, s[24:27], s39 offen offset:2560 sc1
    ds_read_b64_tr_b16 a[210:211], v234 offset:20480
    v_mfma_f32_16x16x32_bf16 v[88:91], a[248:251], v[152:155], v[88:91]
    ds_read_b64_tr_b16 a[212:213], v234 offset:24576
    buffer_load_dwordx4 v242, s[20:23], s32 offen offset:0  lds
    v_mfma_f32_16x16x32_bf16 v[88:91], a[252:255], v[156:159], v[88:91]
    ds_read_b64_tr_b16 a[214:215], v234 offset:28672
    v_mfma_f32_16x16x32_bf16 v[92:95], a[240:243], v[176:179], v[92:95]
    ds_read_b64_tr_b16 a[216:217], v238 offset:16384
    buffer_load_dwordx4 v243, s[20:23], s32 offen offset:1024  lds
    v_mfma_f32_16x16x32_bf16 v[92:95], a[244:247], v[180:183], v[92:95]
    buffer_load_dwordx4 a[52:55], v255, s[24:27], s39 offen offset:2560 sc1
    ds_read_b64_tr_b16 a[218:219], v238 offset:20480
    v_mfma_f32_16x16x32_bf16 v[92:95], a[248:251], v[184:187], v[92:95]
    ds_read_b64_tr_b16 a[220:221], v238 offset:24576
    v_mfma_f32_16x16x32_bf16 v[92:95], a[252:255], v[188:191], v[92:95]
    ds_read_b64_tr_b16 a[222:223], v238 offset:28672
    s_waitcnt lgkmcnt(8)
    v_mfma_f32_16x16x32_bf16 v[96:99], a[192:195], v[128:131], 0
    ds_read_b64_tr_b16 a[224:225], v227 offset:16384
    v_mfma_f32_16x16x32_bf16 v[96:99], a[196:199], v[132:135], v[96:99]
    buffer_load_dwordx4 a[24:27], v254, s[24:27], s39 offen offset:3072 sc1
    ds_read_b64_tr_b16 a[226:227], v227 offset:20480
    v_mfma_f32_16x16x32_bf16 v[96:99], a[200:203], v[136:139], v[96:99]
    ds_read_b64_tr_b16 a[228:229], v227 offset:24576
    v_mfma_f32_16x16x32_bf16 v[96:99], a[204:207], v[140:143], v[96:99]
    ds_read_b64_tr_b16 a[230:231], v227 offset:28672
    v_mfma_f32_16x16x32_bf16 v[100:103], a[192:195], v[160:163], 0
    ds_read_b64_tr_b16 a[232:233], v231 offset:16384
    v_mfma_f32_16x16x32_bf16 v[100:103], a[196:199], v[164:167], v[100:103]
    buffer_load_dwordx4 a[56:59], v255, s[24:27], s39 offen offset:3072 sc1
    ds_read_b64_tr_b16 a[234:235], v231 offset:20480
    v_mfma_f32_16x16x32_bf16 v[100:103], a[200:203], v[168:171], v[100:103]
    ds_read_b64_tr_b16 a[236:237], v231 offset:24576
    v_mfma_f32_16x16x32_bf16 v[100:103], a[204:207], v[172:175], v[100:103]
    ds_read_b64_tr_b16 a[238:239], v231 offset:28672
    s_waitcnt lgkmcnt(8)
    v_mfma_f32_16x16x32_bf16 v[96:99], a[208:211], v[144:147], v[96:99]
    ds_read_b64_tr_b16 a[240:241], v235 offset:16384
    v_mfma_f32_16x16x32_bf16 v[96:99], a[212:215], v[148:151], v[96:99]
    buffer_load_dwordx4 a[28:31], v254, s[24:27], s39 offen offset:3584 sc1
    ds_read_b64_tr_b16 a[242:243], v235 offset:20480
    v_mfma_f32_16x16x32_bf16 v[96:99], a[216:219], v[152:155], v[96:99]
    ds_read_b64_tr_b16 a[244:245], v235 offset:24576
    buffer_load_dwordx4 v244, s[20:23], s32 offen offset:2048  lds
    v_mfma_f32_16x16x32_bf16 v[96:99], a[220:223], v[156:159], v[96:99]
    ds_read_b64_tr_b16 a[246:247], v235 offset:28672
    v_mfma_f32_16x16x32_bf16 v[100:103], a[208:211], v[176:179], v[100:103]
    ds_read_b64_tr_b16 a[248:249], v239 offset:16384
    buffer_load_dwordx4 v245, s[20:23], s32 offen offset:3072  lds
    v_mfma_f32_16x16x32_bf16 v[100:103], a[212:215], v[180:183], v[100:103]
    buffer_load_dwordx4 a[60:63], v255, s[24:27], s39 offen offset:3584 sc1
    ds_read_b64_tr_b16 a[250:251], v239 offset:20480
    v_mfma_f32_16x16x32_bf16 v[100:103], a[216:219], v[184:187], v[100:103]
    ds_read_b64_tr_b16 a[252:253], v239 offset:24576
    v_mfma_f32_16x16x32_bf16 v[100:103], a[220:223], v[188:191], v[100:103]
    ds_read_b64_tr_b16 a[254:255], v239 offset:28672
    s_waitcnt lgkmcnt(8)
    v_mfma_f32_16x16x32_bf16 v[104:107], a[224:227], v[128:131], 0
    ds_read_b64_tr_b16 a[192:193], v228 offset:16384
    v_mfma_f32_16x16x32_bf16 v[104:107], a[228:231], v[132:135], v[104:107]
    ds_read_b64_tr_b16 a[194:195], v228 offset:20480
    v_mfma_f32_16x16x32_bf16 v[104:107], a[232:235], v[136:139], v[104:107]
    ds_read_b64_tr_b16 a[196:197], v228 offset:24576
    v_mfma_f32_16x16x32_bf16 v[104:107], a[236:239], v[140:143], v[104:107]
    ds_read_b64_tr_b16 a[198:199], v228 offset:28672
    v_mfma_f32_16x16x32_bf16 v[108:111], a[224:227], v[160:163], 0
    ds_read_b64_tr_b16 a[200:201], v232 offset:16384
    v_mfma_f32_16x16x32_bf16 v[108:111], a[228:231], v[164:167], v[108:111]
    ds_read_b64_tr_b16 a[202:203], v232 offset:20480
    v_mfma_f32_16x16x32_bf16 v[108:111], a[232:235], v[168:171], v[108:111]
    ds_read_b64_tr_b16 a[204:205], v232 offset:24576
    v_mfma_f32_16x16x32_bf16 v[108:111], a[236:239], v[172:175], v[108:111]
    ds_read_b64_tr_b16 a[206:207], v232 offset:28672
    s_add_u32 s33, s55, 147584
    s_waitcnt lgkmcnt(8)
    v_mfma_f32_16x16x32_bf16 v[104:107], a[240:243], v[144:147], v[104:107]
    ds_read_b64_tr_b16 a[208:209], v236 offset:16384
    s_add_u32 m0, s28, 114688
    v_mfma_f32_16x16x32_bf16 v[104:107], a[244:247], v[148:151], v[104:107]
    ds_read_b64_tr_b16 a[210:211], v236 offset:20480
    v_mfma_f32_16x16x32_bf16 v[104:107], a[248:251], v[152:155], v[104:107]
    ds_read_b64_tr_b16 a[212:213], v236 offset:24576
    buffer_load_dwordx4 v242, s[20:23], s33 offen offset:0  lds
    v_mfma_f32_16x16x32_bf16 v[104:107], a[252:255], v[156:159], v[104:107]
    ds_read_b64_tr_b16 a[214:215], v236 offset:28672
    v_mfma_f32_16x16x32_bf16 v[108:111], a[240:243], v[176:179], v[108:111]
    ds_read_b64_tr_b16 a[216:217], v240 offset:16384
    buffer_load_dwordx4 v243, s[20:23], s33 offen offset:1024  lds
    v_mfma_f32_16x16x32_bf16 v[108:111], a[244:247], v[180:183], v[108:111]
    ds_read_b64_tr_b16 a[218:219], v240 offset:20480
    v_mfma_f32_16x16x32_bf16 v[108:111], a[248:251], v[184:187], v[108:111]
    ds_read_b64_tr_b16 a[220:221], v240 offset:24576
    v_mfma_f32_16x16x32_bf16 v[108:111], a[252:255], v[188:191], v[108:111]
    ds_read_b64_tr_b16 a[222:223], v240 offset:28672
    s_waitcnt lgkmcnt(8)
    v_mfma_f32_16x16x32_bf16 v[112:115], a[192:195], v[128:131], 0
    ds_read_b64_tr_b16 a[224:225], v229 offset:16384
    v_mfma_f32_16x16x32_bf16 v[112:115], a[196:199], v[132:135], v[112:115]
    ds_read_b64_tr_b16 a[226:227], v229 offset:20480
    v_mfma_f32_16x16x32_bf16 v[112:115], a[200:203], v[136:139], v[112:115]
    ds_read_b64_tr_b16 a[228:229], v229 offset:24576
    v_mfma_f32_16x16x32_bf16 v[112:115], a[204:207], v[140:143], v[112:115]
    ds_read_b64_tr_b16 a[230:231], v229 offset:28672
    v_mfma_f32_16x16x32_bf16 v[116:119], a[192:195], v[160:163], 0
    ds_read_b64_tr_b16 a[232:233], v233 offset:16384
    v_mfma_f32_16x16x32_bf16 v[116:119], a[196:199], v[164:167], v[116:119]
    ds_read_b64_tr_b16 a[234:235], v233 offset:20480
    v_mfma_f32_16x16x32_bf16 v[116:119], a[200:203], v[168:171], v[116:119]
    ds_read_b64_tr_b16 a[236:237], v233 offset:24576
    v_mfma_f32_16x16x32_bf16 v[116:119], a[204:207], v[172:175], v[116:119]
    ds_read_b64_tr_b16 a[238:239], v233 offset:28672
    s_waitcnt lgkmcnt(8)
    v_mfma_f32_16x16x32_bf16 v[112:115], a[208:211], v[144:147], v[112:115]
    ds_read_b64_tr_b16 a[240:241], v237 offset:16384
    v_mfma_f32_16x16x32_bf16 v[112:115], a[212:215], v[148:151], v[112:115]
    ds_read_b64_tr_b16 a[242:243], v237 offset:20480
    v_mfma_f32_16x16x32_bf16 v[112:115], a[216:219], v[152:155], v[112:115]
    ds_read_b64_tr_b16 a[244:245], v237 offset:24576
    buffer_load_dwordx4 v244, s[20:23], s33 offen offset:2048  lds
    v_mfma_f32_16x16x32_bf16 v[112:115], a[220:223], v[156:159], v[112:115]
    ds_read_b64_tr_b16 a[246:247], v237 offset:28672
    v_mfma_f32_16x16x32_bf16 v[116:119], a[208:211], v[176:179], v[116:119]
    ds_read_b64_tr_b16 a[248:249], v241 offset:16384
    buffer_load_dwordx4 v245, s[20:23], s33 offen offset:3072  lds
    v_mfma_f32_16x16x32_bf16 v[116:119], a[212:215], v[180:183], v[116:119]
    ds_read_b64_tr_b16 a[250:251], v241 offset:20480
    v_mfma_f32_16x16x32_bf16 v[116:119], a[216:219], v[184:187], v[116:119]
    ds_read_b64_tr_b16 a[252:253], v241 offset:24576
    v_mfma_f32_16x16x32_bf16 v[116:119], a[220:223], v[188:191], v[116:119]
    ds_read_b64_tr_b16 a[254:255], v241 offset:28672
    s_waitcnt lgkmcnt(8)
    v_mfma_f32_16x16x32_bf16 v[120:123], a[224:227], v[128:131], 0
    s_waitcnt vmcnt(16)
    s_barrier
    ds_read_b64_tr_b16 a[192:193], v226 offset:32768
    v_mfma_f32_16x16x32_bf16 v[120:123], a[228:231], v[132:135], v[120:123]
    ds_read_b64_tr_b16 a[194:195], v226 offset:36864
    v_mfma_f32_16x16x32_bf16 v[120:123], a[232:235], v[136:139], v[120:123]
    ds_read_b64_tr_b16 a[196:197], v226 offset:40960
    v_mfma_f32_16x16x32_bf16 v[120:123], a[236:239], v[140:143], v[120:123]
    ds_read_b64_tr_b16 a[198:199], v226 offset:45056
    v_mfma_f32_16x16x32_bf16 v[124:127], a[224:227], v[160:163], 0
    ds_read_b64_tr_b16 a[200:201], v230 offset:32768
    v_mfma_f32_16x16x32_bf16 v[124:127], a[228:231], v[164:167], v[124:127]
    ds_read_b64_tr_b16 a[202:203], v230 offset:36864
    v_mfma_f32_16x16x32_bf16 v[124:127], a[232:235], v[168:171], v[124:127]
    ds_read_b64_tr_b16 a[204:205], v230 offset:40960
    v_mfma_f32_16x16x32_bf16 v[124:127], a[236:239], v[172:175], v[124:127]
    ds_read_b64_tr_b16 a[206:207], v230 offset:45056
    s_add_u32 s32, s55, 256
    s_waitcnt lgkmcnt(8)
    v_mfma_f32_16x16x32_bf16 v[120:123], a[240:243], v[144:147], v[120:123]
    ds_read_b64_tr_b16 a[208:209], v234 offset:32768
    s_add_u32 m0, s28, 0
    v_mfma_f32_16x16x32_bf16 v[120:123], a[244:247], v[148:151], v[120:123]
    ds_read_b64_tr_b16 a[210:211], v234 offset:36864
    v_mfma_f32_16x16x32_bf16 v[120:123], a[248:251], v[152:155], v[120:123]
    ds_read_b64_tr_b16 a[212:213], v234 offset:40960
    buffer_load_dwordx4 v242, s[20:23], s32 offen offset:0  lds
    v_mfma_f32_16x16x32_bf16 v[120:123], a[252:255], v[156:159], v[120:123]
    ds_read_b64_tr_b16 a[214:215], v234 offset:45056
    v_mfma_f32_16x16x32_bf16 v[124:127], a[240:243], v[176:179], v[124:127]
    ds_read_b64_tr_b16 a[216:217], v238 offset:32768
    buffer_load_dwordx4 v243, s[20:23], s32 offen offset:1024  lds
    v_mfma_f32_16x16x32_bf16 v[124:127], a[244:247], v[180:183], v[124:127]
    ds_read_b64_tr_b16 a[218:219], v238 offset:36864
    v_mfma_f32_16x16x32_bf16 v[124:127], a[248:251], v[184:187], v[124:127]
    ds_read_b64_tr_b16 a[220:221], v238 offset:40960
    v_mfma_f32_16x16x32_bf16 v[124:127], a[252:255], v[188:191], v[124:127]
    ds_read_b64_tr_b16 a[222:223], v238 offset:45056
    s_waitcnt vmcnt(6)
    s_waitcnt lgkmcnt(8)
    v_mfma_f32_16x16x32_bf16 v[0:3], a[192:195], a[0:3], v[0:3]
    ds_read_b64_tr_b16 a[224:225], v227 offset:32768
    v_mfma_f32_16x16x32_bf16 v[0:3], a[196:199], a[4:7], v[0:3]
    ds_read_b64_tr_b16 a[226:227], v227 offset:36864
    v_mfma_f32_16x16x32_bf16 v[0:3], a[200:203], a[8:11], v[0:3]
    ds_read_b64_tr_b16 a[228:229], v227 offset:40960
    v_mfma_f32_16x16x32_bf16 v[0:3], a[204:207], a[12:15], v[0:3]
    ds_read_b64_tr_b16 a[230:231], v227 offset:45056
    v_mfma_f32_16x16x32_bf16 v[4:7], a[192:195], a[32:35], v[4:7]
    ds_read_b64_tr_b16 a[232:233], v231 offset:32768
    v_mfma_f32_16x16x32_bf16 v[4:7], a[196:199], a[36:39], v[4:7]
    ds_read_b64_tr_b16 a[234:235], v231 offset:36864
    v_mfma_f32_16x16x32_bf16 v[4:7], a[200:203], a[40:43], v[4:7]
    ds_read_b64_tr_b16 a[236:237], v231 offset:40960
    v_mfma_f32_16x16x32_bf16 v[4:7], a[204:207], a[44:47], v[4:7]
    ds_read_b64_tr_b16 a[238:239], v231 offset:45056
    s_waitcnt lgkmcnt(8)
    v_mfma_f32_16x16x32_bf16 v[0:3], a[208:211], a[16:19], v[0:3]
    ds_read_b64_tr_b16 a[240:241], v235 offset:32768
    v_mfma_f32_16x16x32_bf16 v[0:3], a[212:215], a[20:23], v[0:3]
    ds_read_b64_tr_b16 a[242:243], v235 offset:36864
    v_mfma_f32_16x16x32_bf16 v[0:3], a[216:219], a[24:27], v[0:3]
    ds_read_b64_tr_b16 a[244:245], v235 offset:40960
    buffer_load_dwordx4 v244, s[20:23], s32 offen offset:2048  lds
    v_mfma_f32_16x16x32_bf16 v[0:3], a[220:223], a[28:31], v[0:3]
    ds_read_b64_tr_b16 a[246:247], v235 offset:45056
    v_mfma_f32_16x16x32_bf16 v[4:7], a[208:211], a[48:51], v[4:7]
    ds_read_b64_tr_b16 a[248:249], v239 offset:32768
    buffer_load_dwordx4 v245, s[20:23], s32 offen offset:3072  lds
    v_mfma_f32_16x16x32_bf16 v[4:7], a[212:215], a[52:55], v[4:7]
    ds_read_b64_tr_b16 a[250:251], v239 offset:36864
    v_mfma_f32_16x16x32_bf16 v[4:7], a[216:219], a[56:59], v[4:7]
    ds_read_b64_tr_b16 a[252:253], v239 offset:40960
    v_mfma_f32_16x16x32_bf16 v[4:7], a[220:223], a[60:63], v[4:7]
    ds_read_b64_tr_b16 a[254:255], v239 offset:45056
    s_waitcnt lgkmcnt(8)
    v_mfma_f32_16x16x32_bf16 v[8:11], a[224:227], a[0:3], v[8:11]
    ds_read_b64_tr_b16 a[192:193], v228 offset:32768
    v_mfma_f32_16x16x32_bf16 v[8:11], a[228:231], a[4:7], v[8:11]
    ds_read_b64_tr_b16 a[194:195], v228 offset:36864
    v_mfma_f32_16x16x32_bf16 v[8:11], a[232:235], a[8:11], v[8:11]
    ds_read_b64_tr_b16 a[196:197], v228 offset:40960
    v_mfma_f32_16x16x32_bf16 v[8:11], a[236:239], a[12:15], v[8:11]
    ds_read_b64_tr_b16 a[198:199], v228 offset:45056
    v_mfma_f32_16x16x32_bf16 v[12:15], a[224:227], a[32:35], v[12:15]
    ds_read_b64_tr_b16 a[200:201], v232 offset:32768
    v_mfma_f32_16x16x32_bf16 v[12:15], a[228:231], a[36:39], v[12:15]
    ds_read_b64_tr_b16 a[202:203], v232 offset:36864
    v_mfma_f32_16x16x32_bf16 v[12:15], a[232:235], a[40:43], v[12:15]
    ds_read_b64_tr_b16 a[204:205], v232 offset:40960
    v_mfma_f32_16x16x32_bf16 v[12:15], a[236:239], a[44:47], v[12:15]
    ds_read_b64_tr_b16 a[206:207], v232 offset:45056
    s_add_u32 s33, s55, 147712
    s_waitcnt lgkmcnt(8)
    v_mfma_f32_16x16x32_bf16 v[8:11], a[240:243], a[16:19], v[8:11]
    ds_read_b64_tr_b16 a[208:209], v236 offset:32768
    s_add_u32 m0, s28, 65536
    v_mfma_f32_16x16x32_bf16 v[8:11], a[244:247], a[20:23], v[8:11]
    ds_read_b64_tr_b16 a[210:211], v236 offset:36864
    v_mfma_f32_16x16x32_bf16 v[8:11], a[248:251], a[24:27], v[8:11]
    ds_read_b64_tr_b16 a[212:213], v236 offset:40960
    buffer_load_dwordx4 v242, s[20:23], s33 offen offset:0  lds
    v_mfma_f32_16x16x32_bf16 v[8:11], a[252:255], a[28:31], v[8:11]
    ds_read_b64_tr_b16 a[214:215], v236 offset:45056
    v_mfma_f32_16x16x32_bf16 v[12:15], a[240:243], a[48:51], v[12:15]
    ds_read_b64_tr_b16 a[216:217], v240 offset:32768
    buffer_load_dwordx4 v243, s[20:23], s33 offen offset:1024  lds
    v_mfma_f32_16x16x32_bf16 v[12:15], a[244:247], a[52:55], v[12:15]
    ds_read_b64_tr_b16 a[218:219], v240 offset:36864
    v_mfma_f32_16x16x32_bf16 v[12:15], a[248:251], a[56:59], v[12:15]
    ds_read_b64_tr_b16 a[220:221], v240 offset:40960
    v_mfma_f32_16x16x32_bf16 v[12:15], a[252:255], a[60:63], v[12:15]
    ds_read_b64_tr_b16 a[222:223], v240 offset:45056
    s_waitcnt lgkmcnt(8)
    v_mfma_f32_16x16x32_bf16 v[16:19], a[192:195], a[0:3], v[16:19]
    ds_read_b64_tr_b16 a[224:225], v229 offset:32768
    v_mfma_f32_16x16x32_bf16 v[16:19], a[196:199], a[4:7], v[16:19]
    ds_read_b64_tr_b16 a[226:227], v229 offset:36864
    v_mfma_f32_16x16x32_bf16 v[16:19], a[200:203], a[8:11], v[16:19]
    ds_read_b64_tr_b16 a[228:229], v229 offset:40960
    v_mfma_f32_16x16x32_bf16 v[16:19], a[204:207], a[12:15], v[16:19]
    ds_read_b64_tr_b16 a[230:231], v229 offset:45056
    v_cvt_pk_bf16_f32 v192, v0, v1
    v_mfma_f32_16x16x32_bf16 v[20:23], a[192:195], a[32:35], v[20:23]
    ds_read_b64_tr_b16 a[232:233], v233 offset:32768
    v_cvt_pk_bf16_f32 v193, v2, v3
    v_mfma_f32_16x16x32_bf16 v[20:23], a[196:199], a[36:39], v[20:23]
    ds_read_b64_tr_b16 a[234:235], v233 offset:36864
    v_cvt_pk_bf16_f32 v194, v8, v9
    v_mfma_f32_16x16x32_bf16 v[20:23], a[200:203], a[40:43], v[20:23]
    ds_read_b64_tr_b16 a[236:237], v233 offset:40960
    v_cvt_pk_bf16_f32 v195, v10, v11
    v_mfma_f32_16x16x32_bf16 v[20:23], a[204:207], a[44:47], v[20:23]
    ds_read_b64_tr_b16 a[238:239], v233 offset:45056
    buffer_store_dwordx4 v[192:195], v254, s[24:27], s39 offen offset:0 sc1
    s_waitcnt lgkmcnt(8)
    v_mfma_f32_16x16x32_bf16 v[16:19], a[208:211], a[16:19], v[16:19]
    ds_read_b64_tr_b16 a[240:241], v237 offset:32768
    v_mfma_f32_16x16x32_bf16 v[16:19], a[212:215], a[20:23], v[16:19]
    ds_read_b64_tr_b16 a[242:243], v237 offset:36864
    v_mfma_f32_16x16x32_bf16 v[16:19], a[216:219], a[24:27], v[16:19]
    ds_read_b64_tr_b16 a[244:245], v237 offset:40960
    buffer_load_dwordx4 v244, s[20:23], s33 offen offset:2048  lds
    v_mfma_f32_16x16x32_bf16 v[16:19], a[220:223], a[28:31], v[16:19]
    ds_read_b64_tr_b16 a[246:247], v237 offset:45056
    v_mfma_f32_16x16x32_bf16 v[20:23], a[208:211], a[48:51], v[20:23]
    ds_read_b64_tr_b16 a[248:249], v241 offset:32768
    buffer_load_dwordx4 v245, s[20:23], s33 offen offset:3072  lds
    v_mfma_f32_16x16x32_bf16 v[20:23], a[212:215], a[52:55], v[20:23]
    ds_read_b64_tr_b16 a[250:251], v241 offset:36864
    v_mfma_f32_16x16x32_bf16 v[20:23], a[216:219], a[56:59], v[20:23]
    ds_read_b64_tr_b16 a[252:253], v241 offset:40960
    v_mfma_f32_16x16x32_bf16 v[20:23], a[220:223], a[60:63], v[20:23]
    ds_read_b64_tr_b16 a[254:255], v241 offset:45056
    s_waitcnt lgkmcnt(8)
    v_mfma_f32_16x16x32_bf16 v[24:27], a[224:227], a[0:3], v[24:27]
    s_waitcnt vmcnt(9)
    s_barrier
    ds_read_b64_tr_b16 a[192:193], v226 offset:49152
    v_bfe_u32 v218, v225, 8, 2
    v_bfe_u32 v219, v225, 4, 4
    v_mfma_f32_16x16x32_bf16 v[24:27], a[228:231], a[4:7], v[24:27]
    ds_read_b64_tr_b16 a[194:195], v226 offset:53248
    v_lshlrev_b32 v220, 1, v218
    v_mfma_f32_16x16x32_bf16 v[24:27], a[232:235], a[8:11], v[24:27]
    ds_read_b64_tr_b16 a[196:197], v226 offset:57344
    v_xor_b32 v219, v219, v220
    v_mfma_f32_16x16x32_bf16 v[24:27], a[236:239], a[12:15], v[24:27]
    ds_read_b64_tr_b16 a[198:199], v226 offset:61440
    s_lshl_b32 s43, s40, 4
    v_cvt_pk_bf16_f32 v196, v4, v5
    v_mfma_f32_16x16x32_bf16 v[28:31], a[224:227], a[32:35], v[28:31]
    ds_read_b64_tr_b16 a[200:201], v230 offset:49152
    v_add_u32 v218, s43, v218
    v_cvt_pk_bf16_f32 v197, v6, v7
    v_mfma_f32_16x16x32_bf16 v[28:31], a[228:231], a[36:39], v[28:31]
    ds_read_b64_tr_b16 a[202:203], v230 offset:53248
    v_mul_u32_u24 v218, 1152, v218
    v_lshrrev_b32 v220, 2, v219
    v_cvt_pk_bf16_f32 v198, v12, v13
    v_mfma_f32_16x16x32_bf16 v[28:31], a[232:235], a[40:43], v[28:31]
    ds_read_b64_tr_b16 a[204:205], v230 offset:57344
    v_mul_u32_u24 v220, 73664, v220
    v_cvt_pk_bf16_f32 v199, v14, v15
    v_mfma_f32_16x16x32_bf16 v[28:31], a[236:239], a[44:47], v[28:31]
    ds_read_b64_tr_b16 a[206:207], v230 offset:61440
    v_add_u32 v220, v220, v218
    s_add_u32 s32, s55, 384
    buffer_store_dwordx4 v[196:199], v255, s[24:27], s39 offen offset:0 sc1
    s_waitcnt lgkmcnt(8)
    v_mfma_f32_16x16x32_bf16 v[24:27], a[240:243], a[16:19], v[24:27]
    ds_read_b64_tr_b16 a[208:209], v234 offset:49152
    v_lshl_add_u32 v208, v219, 4, v220
    s_add_u32 m0, s28, 16384
    v_mfma_f32_16x16x32_bf16 v[24:27], a[244:247], a[20:23], v[24:27]
    ds_read_b64_tr_b16 a[210:211], v234 offset:53248
    v_add_u32 v210, 7168, v208
    v_mfma_f32_16x16x32_bf16 v[24:27], a[248:251], a[24:27], v[24:27]
    ds_read_b64_tr_b16 a[212:213], v234 offset:57344
    v_xor_b32 v219, 8, v219
    v_lshrrev_b32 v220, 2, v219
    buffer_load_dwordx4 v242, s[20:23], s32 offen offset:0  lds
    v_mfma_f32_16x16x32_bf16 v[24:27], a[252:255], a[28:31], v[24:27]
    ds_read_b64_tr_b16 a[214:215], v234 offset:61440
    v_mul_u32_u24 v220, 73664, v220
    v_mfma_f32_16x16x32_bf16 v[28:31], a[240:243], a[48:51], v[28:31]
    ds_read_b64_tr_b16 a[216:217], v238 offset:49152
    v_add_u32 v220, v220, v218
    buffer_load_dwordx4 v243, s[20:23], s32 offen offset:1024  lds
    v_mfma_f32_16x16x32_bf16 v[28:31], a[244:247], a[52:55], v[28:31]
    ds_read_b64_tr_b16 a[218:219], v238 offset:53248
    v_lshl_add_u32 v209, v219, 4, v220
    v_mfma_f32_16x16x32_bf16 v[28:31], a[248:251], a[56:59], v[28:31]
    ds_read_b64_tr_b16 a[220:221], v238 offset:57344
    v_add_u32 v209, 3584, v209
    v_mfma_f32_16x16x32_bf16 v[28:31], a[252:255], a[60:63], v[28:31]
    ds_read_b64_tr_b16 a[222:223], v238 offset:61440
    v_add_u32 v211, 7168, v209
    s_waitcnt lgkmcnt(8)
    v_mfma_f32_16x16x32_bf16 v[32:35], a[192:195], a[0:3], v[32:35]
    ds_read_b64_tr_b16 a[224:225], v227 offset:49152
    v_mfma_f32_16x16x32_bf16 v[32:35], a[196:199], a[4:7], v[32:35]
    ds_read_b64_tr_b16 a[226:227], v227 offset:53248
    v_mfma_f32_16x16x32_bf16 v[32:35], a[200:203], a[8:11], v[32:35]
    ds_read_b64_tr_b16 a[228:229], v227 offset:57344
    v_mfma_f32_16x16x32_bf16 v[32:35], a[204:207], a[12:15], v[32:35]
    ds_read_b64_tr_b16 a[230:231], v227 offset:61440
    v_cvt_pk_bf16_f32 v200, v16, v17
    v_mfma_f32_16x16x32_bf16 v[36:39], a[192:195], a[32:35], v[36:39]
    ds_read_b64_tr_b16 a[232:233], v231 offset:49152
    v_cvt_pk_bf16_f32 v201, v18, v19
    v_mfma_f32_16x16x32_bf16 v[36:39], a[196:199], a[36:39], v[36:39]
    ds_read_b64_tr_b16 a[234:235], v231 offset:53248
    v_cvt_pk_bf16_f32 v202, v24, v25
    v_mfma_f32_16x16x32_bf16 v[36:39], a[200:203], a[40:43], v[36:39]
    ds_read_b64_tr_b16 a[236:237], v231 offset:57344
    v_cvt_pk_bf16_f32 v203, v26, v27
    v_mfma_f32_16x16x32_bf16 v[36:39], a[204:207], a[44:47], v[36:39]
    ds_read_b64_tr_b16 a[238:239], v231 offset:61440
    buffer_store_dwordx4 v[200:203], v254, s[24:27], s39 offen offset:512 sc1
    s_waitcnt lgkmcnt(8)
    v_mfma_f32_16x16x32_bf16 v[32:35], a[208:211], a[16:19], v[32:35]
    ds_read_b64_tr_b16 a[240:241], v235 offset:49152
    v_mfma_f32_16x16x32_bf16 v[32:35], a[212:215], a[20:23], v[32:35]
    ds_read_b64_tr_b16 a[242:243], v235 offset:53248
    v_mfma_f32_16x16x32_bf16 v[32:35], a[216:219], a[24:27], v[32:35]
    ds_read_b64_tr_b16 a[244:245], v235 offset:57344
    buffer_load_dwordx4 v244, s[20:23], s32 offen offset:2048  lds
    v_mfma_f32_16x16x32_bf16 v[32:35], a[220:223], a[28:31], v[32:35]
    ds_read_b64_tr_b16 a[246:247], v235 offset:61440
    v_mfma_f32_16x16x32_bf16 v[36:39], a[208:211], a[48:51], v[36:39]
    ds_read_b64_tr_b16 a[248:249], v239 offset:49152
    buffer_load_dwordx4 v245, s[20:23], s32 offen offset:3072  lds
    v_mfma_f32_16x16x32_bf16 v[36:39], a[212:215], a[52:55], v[36:39]
    ds_read_b64_tr_b16 a[250:251], v239 offset:53248
    v_mfma_f32_16x16x32_bf16 v[36:39], a[216:219], a[56:59], v[36:39]
    ds_read_b64_tr_b16 a[252:253], v239 offset:57344
    v_mfma_f32_16x16x32_bf16 v[36:39], a[220:223], a[60:63], v[36:39]
    ds_read_b64_tr_b16 a[254:255], v239 offset:61440
    s_waitcnt lgkmcnt(8)
    v_mfma_f32_16x16x32_bf16 v[40:43], a[224:227], a[0:3], v[40:43]
    ds_read_b64_tr_b16 a[192:193], v228 offset:49152
    v_mfma_f32_16x16x32_bf16 v[40:43], a[228:231], a[4:7], v[40:43]
    ds_read_b64_tr_b16 a[194:195], v228 offset:53248
    v_mfma_f32_16x16x32_bf16 v[40:43], a[232:235], a[8:11], v[40:43]
    ds_read_b64_tr_b16 a[196:197], v228 offset:57344
    v_mfma_f32_16x16x32_bf16 v[40:43], a[236:239], a[12:15], v[40:43]
    ds_read_b64_tr_b16 a[198:199], v228 offset:61440
    v_cvt_pk_bf16_f32 v204, v20, v21
    v_mfma_f32_16x16x32_bf16 v[44:47], a[224:227], a[32:35], v[44:47]
    ds_read_b64_tr_b16 a[200:201], v232 offset:49152
    v_cvt_pk_bf16_f32 v205, v22, v23
    v_mfma_f32_16x16x32_bf16 v[44:47], a[228:231], a[36:39], v[44:47]
    ds_read_b64_tr_b16 a[202:203], v232 offset:53248
    v_cvt_pk_bf16_f32 v206, v28, v29
    v_mfma_f32_16x16x32_bf16 v[44:47], a[232:235], a[40:43], v[44:47]
    ds_read_b64_tr_b16 a[204:205], v232 offset:57344
    v_cvt_pk_bf16_f32 v207, v30, v31
    v_mfma_f32_16x16x32_bf16 v[44:47], a[236:239], a[44:47], v[44:47]
    ds_read_b64_tr_b16 a[206:207], v232 offset:61440
    s_add_u32 s33, s55, 147840
    buffer_store_dwordx4 v[204:207], v255, s[24:27], s39 offen offset:512 sc1
    s_waitcnt lgkmcnt(8)
    v_mfma_f32_16x16x32_bf16 v[40:43], a[240:243], a[16:19], v[40:43]
    ds_read_b64_tr_b16 a[208:209], v236 offset:49152
    s_add_u32 m0, s28, 81920
    v_mfma_f32_16x16x32_bf16 v[40:43], a[244:247], a[20:23], v[40:43]
    ds_read_b64_tr_b16 a[210:211], v236 offset:53248
    v_mfma_f32_16x16x32_bf16 v[40:43], a[248:251], a[24:27], v[40:43]
    ds_read_b64_tr_b16 a[212:213], v236 offset:57344
    buffer_load_dwordx4 v242, s[20:23], s33 offen offset:0  lds
    v_mfma_f32_16x16x32_bf16 v[40:43], a[252:255], a[28:31], v[40:43]
    ds_read_b64_tr_b16 a[214:215], v236 offset:61440
    v_mfma_f32_16x16x32_bf16 v[44:47], a[240:243], a[48:51], v[44:47]
    ds_read_b64_tr_b16 a[216:217], v240 offset:49152
    buffer_load_dwordx4 v243, s[20:23], s33 offen offset:1024  lds
    v_mfma_f32_16x16x32_bf16 v[44:47], a[244:247], a[52:55], v[44:47]
    ds_read_b64_tr_b16 a[218:219], v240 offset:53248
    v_mfma_f32_16x16x32_bf16 v[44:47], a[248:251], a[56:59], v[44:47]
    ds_read_b64_tr_b16 a[220:221], v240 offset:57344
    v_mfma_f32_16x16x32_bf16 v[44:47], a[252:255], a[60:63], v[44:47]
    ds_read_b64_tr_b16 a[222:223], v240 offset:61440
    s_waitcnt lgkmcnt(8)
    v_mfma_f32_16x16x32_bf16 v[48:51], a[192:195], a[0:3], v[48:51]
    ds_read_b64_tr_b16 a[224:225], v229 offset:49152
    v_mfma_f32_16x16x32_bf16 v[48:51], a[196:199], a[4:7], v[48:51]
    ds_read_b64_tr_b16 a[226:227], v229 offset:53248
    v_mfma_f32_16x16x32_bf16 v[48:51], a[200:203], a[8:11], v[48:51]
    ds_read_b64_tr_b16 a[228:229], v229 offset:57344
    v_mfma_f32_16x16x32_bf16 v[48:51], a[204:207], a[12:15], v[48:51]
    ds_read_b64_tr_b16 a[230:231], v229 offset:61440
    v_cvt_pk_bf16_f32 v192, v32, v33
    v_mfma_f32_16x16x32_bf16 v[52:55], a[192:195], a[32:35], v[52:55]
    ds_read_b64_tr_b16 a[232:233], v233 offset:49152
    v_cvt_pk_bf16_f32 v193, v34, v35
    v_mfma_f32_16x16x32_bf16 v[52:55], a[196:199], a[36:39], v[52:55]
    ds_read_b64_tr_b16 a[234:235], v233 offset:53248
    v_cvt_pk_bf16_f32 v194, v40, v41
    v_mfma_f32_16x16x32_bf16 v[52:55], a[200:203], a[40:43], v[52:55]
    ds_read_b64_tr_b16 a[236:237], v233 offset:57344
    v_cvt_pk_bf16_f32 v195, v42, v43
    v_mfma_f32_16x16x32_bf16 v[52:55], a[204:207], a[44:47], v[52:55]
    ds_read_b64_tr_b16 a[238:239], v233 offset:61440
    buffer_store_dwordx4 v[192:195], v254, s[24:27], s39 offen offset:1024 sc1
    s_waitcnt lgkmcnt(8)
    v_mfma_f32_16x16x32_bf16 v[48:51], a[208:211], a[16:19], v[48:51]
    ds_read_b64_tr_b16 a[240:241], v237 offset:49152
    v_mfma_f32_16x16x32_bf16 v[48:51], a[212:215], a[20:23], v[48:51]
    ds_read_b64_tr_b16 a[242:243], v237 offset:53248
    v_mfma_f32_16x16x32_bf16 v[48:51], a[216:219], a[24:27], v[48:51]
    ds_read_b64_tr_b16 a[244:245], v237 offset:57344
    buffer_load_dwordx4 v244, s[20:23], s33 offen offset:2048  lds
    v_mfma_f32_16x16x32_bf16 v[48:51], a[220:223], a[28:31], v[48:51]
    ds_read_b64_tr_b16 a[246:247], v237 offset:61440
    v_mfma_f32_16x16x32_bf16 v[52:55], a[208:211], a[48:51], v[52:55]
    ds_read_b64_tr_b16 a[248:249], v241 offset:49152
    buffer_load_dwordx4 v245, s[20:23], s33 offen offset:3072  lds
    v_mfma_f32_16x16x32_bf16 v[52:55], a[212:215], a[52:55], v[52:55]
    ds_read_b64_tr_b16 a[250:251], v241 offset:53248
    v_mfma_f32_16x16x32_bf16 v[52:55], a[216:219], a[56:59], v[52:55]
    ds_read_b64_tr_b16 a[252:253], v241 offset:57344
    v_mfma_f32_16x16x32_bf16 v[52:55], a[220:223], a[60:63], v[52:55]
    ds_read_b64_tr_b16 a[254:255], v241 offset:61440
    s_waitcnt lgkmcnt(8)
    v_mfma_f32_16x16x32_bf16 v[56:59], a[224:227], a[0:3], v[56:59]
    s_waitcnt vmcnt(12)
    s_barrier
    ds_read_b64_tr_b16 a[192:193], v226 offset:0
    v_mfma_f32_16x16x32_bf16 v[56:59], a[228:231], a[4:7], v[56:59]
    ds_read_b64_tr_b16 a[194:195], v226 offset:4096
    v_mfma_f32_16x16x32_bf16 v[56:59], a[232:235], a[8:11], v[56:59]
    ds_read_b64_tr_b16 a[196:197], v226 offset:8192
    v_mfma_f32_16x16x32_bf16 v[56:59], a[236:239], a[12:15], v[56:59]
    ds_read_b64_tr_b16 a[198:199], v226 offset:12288
    v_cvt_pk_bf16_f32 v196, v36, v37
    v_mfma_f32_16x16x32_bf16 v[60:63], a[224:227], a[32:35], v[60:63]
    ds_read_b64_tr_b16 a[200:201], v230 offset:0
    v_cvt_pk_bf16_f32 v197, v38, v39
    v_mfma_f32_16x16x32_bf16 v[60:63], a[228:231], a[36:39], v[60:63]
    ds_read_b64_tr_b16 a[202:203], v230 offset:4096
    v_cvt_pk_bf16_f32 v198, v44, v45
    v_mfma_f32_16x16x32_bf16 v[60:63], a[232:235], a[40:43], v[60:63]
    ds_read_b64_tr_b16 a[204:205], v230 offset:8192
    v_cvt_pk_bf16_f32 v199, v46, v47
    v_mfma_f32_16x16x32_bf16 v[60:63], a[236:239], a[44:47], v[60:63]
    ds_read_b64_tr_b16 a[206:207], v230 offset:12288
    s_add_u32 s32, s3, s50
    buffer_store_dwordx4 v[196:199], v255, s[24:27], s39 offen offset:1024 sc1
    s_waitcnt lgkmcnt(8)
    v_mfma_f32_16x16x32_bf16 v[56:59], a[240:243], a[16:19], v[56:59]
    ds_read_b64_tr_b16 a[208:209], v234 offset:0
    s_add_u32 m0, s28, 32768
    v_mfma_f32_16x16x32_bf16 v[56:59], a[244:247], a[20:23], v[56:59]
    ds_read_b64_tr_b16 a[210:211], v234 offset:4096
    v_mfma_f32_16x16x32_bf16 v[56:59], a[248:251], a[24:27], v[56:59]
    ds_read_b64_tr_b16 a[212:213], v234 offset:8192
    buffer_load_dwordx4 v208, s[20:23], s32 offen offset:0  lds
    v_mfma_f32_16x16x32_bf16 v[56:59], a[252:255], a[28:31], v[56:59]
    ds_read_b64_tr_b16 a[214:215], v234 offset:12288
    v_mfma_f32_16x16x32_bf16 v[60:63], a[240:243], a[48:51], v[60:63]
    ds_read_b64_tr_b16 a[216:217], v238 offset:0
    buffer_load_dwordx4 v209, s[20:23], s32 offen offset:1024  lds
    v_mfma_f32_16x16x32_bf16 v[60:63], a[244:247], a[52:55], v[60:63]
    ds_read_b64_tr_b16 a[218:219], v238 offset:4096
    v_mfma_f32_16x16x32_bf16 v[60:63], a[248:251], a[56:59], v[60:63]
    ds_read_b64_tr_b16 a[220:221], v238 offset:8192
    v_mfma_f32_16x16x32_bf16 v[60:63], a[252:255], a[60:63], v[60:63]
    ds_read_b64_tr_b16 a[222:223], v238 offset:12288
    s_waitcnt lgkmcnt(8)
    s_lshl_b32 s43, s40, 6
    v_add_u32 v212, s43, v246
    s_getpc_b64 s[46:47]
TC7612_T_BEGIN:
    s_add_u32 s46, s46, T_BEGIN-TC7612_T_BEGIN
    s_addc_u32 s47, s47, 0
    v_min_u32 v213, (K2_END-T_BEGIN-1)/128, v212
    v_lshlrev_b32 v213, 7, v213
    global_load_dword a188, v213, s[46:47]
    v_mfma_f32_16x16x32_bf16 v[64:67], a[192:195], a[0:3], v[64:67]
    ds_read_b64_tr_b16 a[224:225], v227 offset:0
    v_mfma_f32_16x16x32_bf16 v[64:67], a[196:199], a[4:7], v[64:67]
    ds_read_b64_tr_b16 a[226:227], v227 offset:4096
    v_mfma_f32_16x16x32_bf16 v[64:67], a[200:203], a[8:11], v[64:67]
    ds_read_b64_tr_b16 a[228:229], v227 offset:8192
    v_mfma_f32_16x16x32_bf16 v[64:67], a[204:207], a[12:15], v[64:67]
    ds_read_b64_tr_b16 a[230:231], v227 offset:12288
    v_cvt_pk_bf16_f32 v200, v48, v49
    v_mfma_f32_16x16x32_bf16 v[68:71], a[192:195], a[32:35], v[68:71]
    ds_read_b64_tr_b16 a[232:233], v231 offset:0
    v_cvt_pk_bf16_f32 v201, v50, v51
    v_mfma_f32_16x16x32_bf16 v[68:71], a[196:199], a[36:39], v[68:71]
    ds_read_b64_tr_b16 a[234:235], v231 offset:4096
    v_cvt_pk_bf16_f32 v202, v56, v57
    v_mfma_f32_16x16x32_bf16 v[68:71], a[200:203], a[40:43], v[68:71]
    ds_read_b64_tr_b16 a[236:237], v231 offset:8192
    v_cvt_pk_bf16_f32 v203, v58, v59
    v_mfma_f32_16x16x32_bf16 v[68:71], a[204:207], a[44:47], v[68:71]
    ds_read_b64_tr_b16 a[238:239], v231 offset:12288
    buffer_store_dwordx4 v[200:203], v254, s[24:27], s39 offen offset:1536 sc1
    s_waitcnt lgkmcnt(8)
    v_mfma_f32_16x16x32_bf16 v[64:67], a[208:211], a[16:19], v[64:67]
    ds_read_b64_tr_b16 a[240:241], v235 offset:0
    v_mfma_f32_16x16x32_bf16 v[64:67], a[212:215], a[20:23], v[64:67]
    ds_read_b64_tr_b16 a[242:243], v235 offset:4096
    v_mfma_f32_16x16x32_bf16 v[64:67], a[216:219], a[24:27], v[64:67]
    ds_read_b64_tr_b16 a[244:245], v235 offset:8192
    buffer_load_dwordx4 v210, s[20:23], s32 offen offset:2048  lds
    v_mfma_f32_16x16x32_bf16 v[64:67], a[220:223], a[28:31], v[64:67]
    ds_read_b64_tr_b16 a[246:247], v235 offset:12288
    v_mfma_f32_16x16x32_bf16 v[68:71], a[208:211], a[48:51], v[68:71]
    ds_read_b64_tr_b16 a[248:249], v239 offset:0
    buffer_load_dwordx4 v211, s[20:23], s32 offen offset:3072  lds
    v_mfma_f32_16x16x32_bf16 v[68:71], a[212:215], a[52:55], v[68:71]
    ds_read_b64_tr_b16 a[250:251], v239 offset:4096
    v_mfma_f32_16x16x32_bf16 v[68:71], a[216:219], a[56:59], v[68:71]
    ds_read_b64_tr_b16 a[252:253], v239 offset:8192
    v_mfma_f32_16x16x32_bf16 v[68:71], a[220:223], a[60:63], v[68:71]
    ds_read_b64_tr_b16 a[254:255], v239 offset:12288
    s_waitcnt lgkmcnt(8)
    v_mfma_f32_16x16x32_bf16 v[72:75], a[224:227], a[0:3], v[72:75]
    ds_read_b64_tr_b16 a[192:193], v228 offset:0
    v_mfma_f32_16x16x32_bf16 v[72:75], a[228:231], a[4:7], v[72:75]
    ds_read_b64_tr_b16 a[194:195], v228 offset:4096
    v_mfma_f32_16x16x32_bf16 v[72:75], a[232:235], a[8:11], v[72:75]
    ds_read_b64_tr_b16 a[196:197], v228 offset:8192
    v_mfma_f32_16x16x32_bf16 v[72:75], a[236:239], a[12:15], v[72:75]
    ds_read_b64_tr_b16 a[198:199], v228 offset:12288
    v_cvt_pk_bf16_f32 v204, v52, v53
    v_mfma_f32_16x16x32_bf16 v[76:79], a[224:227], a[32:35], v[76:79]
    ds_read_b64_tr_b16 a[200:201], v232 offset:0
    v_cvt_pk_bf16_f32 v205, v54, v55
    v_mfma_f32_16x16x32_bf16 v[76:79], a[228:231], a[36:39], v[76:79]
    ds_read_b64_tr_b16 a[202:203], v232 offset:4096
    v_cvt_pk_bf16_f32 v206, v60, v61
    v_mfma_f32_16x16x32_bf16 v[76:79], a[232:235], a[40:43], v[76:79]
    ds_read_b64_tr_b16 a[204:205], v232 offset:8192
    v_cvt_pk_bf16_f32 v207, v62, v63
    v_mfma_f32_16x16x32_bf16 v[76:79], a[236:239], a[44:47], v[76:79]
    ds_read_b64_tr_b16 a[206:207], v232 offset:12288
    s_add_u32 s33, s55, s50
    buffer_store_dwordx4 v[204:207], v255, s[24:27], s39 offen offset:1536 sc1
    s_waitcnt lgkmcnt(8)
    v_mfma_f32_16x16x32_bf16 v[72:75], a[240:243], a[16:19], v[72:75]
    ds_read_b64_tr_b16 a[208:209], v236 offset:0
    s_add_u32 m0, s28, 98304
    v_mfma_f32_16x16x32_bf16 v[72:75], a[244:247], a[20:23], v[72:75]
    ds_read_b64_tr_b16 a[210:211], v236 offset:4096
    v_mfma_f32_16x16x32_bf16 v[72:75], a[248:251], a[24:27], v[72:75]
    ds_read_b64_tr_b16 a[212:213], v236 offset:8192
    buffer_load_dwordx4 v208, s[20:23], s33 offen offset:0  lds
    v_mfma_f32_16x16x32_bf16 v[72:75], a[252:255], a[28:31], v[72:75]
    ds_read_b64_tr_b16 a[214:215], v236 offset:12288
    v_mfma_f32_16x16x32_bf16 v[76:79], a[240:243], a[48:51], v[76:79]
    ds_read_b64_tr_b16 a[216:217], v240 offset:0
    buffer_load_dwordx4 v209, s[20:23], s33 offen offset:1024  lds
    v_mfma_f32_16x16x32_bf16 v[76:79], a[244:247], a[52:55], v[76:79]
    ds_read_b64_tr_b16 a[218:219], v240 offset:4096
    v_mfma_f32_16x16x32_bf16 v[76:79], a[248:251], a[56:59], v[76:79]
    ds_read_b64_tr_b16 a[220:221], v240 offset:8192
    v_mfma_f32_16x16x32_bf16 v[76:79], a[252:255], a[60:63], v[76:79]
    ds_read_b64_tr_b16 a[222:223], v240 offset:12288
    s_waitcnt lgkmcnt(8)
    v_mfma_f32_16x16x32_bf16 v[80:83], a[192:195], a[0:3], v[80:83]
    ds_read_b64_tr_b16 a[224:225], v229 offset:0
    v_mfma_f32_16x16x32_bf16 v[80:83], a[196:199], a[4:7], v[80:83]
    ds_read_b64_tr_b16 a[226:227], v229 offset:4096
    v_mfma_f32_16x16x32_bf16 v[80:83], a[200:203], a[8:11], v[80:83]
    ds_read_b64_tr_b16 a[228:229], v229 offset:8192
    v_mfma_f32_16x16x32_bf16 v[80:83], a[204:207], a[12:15], v[80:83]
    ds_read_b64_tr_b16 a[230:231], v229 offset:12288
    v_cvt_pk_bf16_f32 v192, v64, v65
    v_mfma_f32_16x16x32_bf16 v[84:87], a[192:195], a[32:35], v[84:87]
    ds_read_b64_tr_b16 a[232:233], v233 offset:0
    v_cvt_pk_bf16_f32 v193, v66, v67
    v_mfma_f32_16x16x32_bf16 v[84:87], a[196:199], a[36:39], v[84:87]
    ds_read_b64_tr_b16 a[234:235], v233 offset:4096
    v_cvt_pk_bf16_f32 v194, v72, v73
    v_mfma_f32_16x16x32_bf16 v[84:87], a[200:203], a[40:43], v[84:87]
    ds_read_b64_tr_b16 a[236:237], v233 offset:8192
    v_cvt_pk_bf16_f32 v195, v74, v75
    v_mfma_f32_16x16x32_bf16 v[84:87], a[204:207], a[44:47], v[84:87]
    ds_read_b64_tr_b16 a[238:239], v233 offset:12288
    buffer_store_dwordx4 v[192:195], v254, s[24:27], s39 offen offset:2048 sc1
    s_waitcnt lgkmcnt(8)
    v_mfma_f32_16x16x32_bf16 v[80:83], a[208:211], a[16:19], v[80:83]
    ds_read_b64_tr_b16 a[240:241], v237 offset:0
    v_mfma_f32_16x16x32_bf16 v[80:83], a[212:215], a[20:23], v[80:83]
    ds_read_b64_tr_b16 a[242:243], v237 offset:4096
    v_mfma_f32_16x16x32_bf16 v[80:83], a[216:219], a[24:27], v[80:83]
    ds_read_b64_tr_b16 a[244:245], v237 offset:8192
    buffer_load_dwordx4 v210, s[20:23], s33 offen offset:2048  lds
    v_mfma_f32_16x16x32_bf16 v[80:83], a[220:223], a[28:31], v[80:83]
    ds_read_b64_tr_b16 a[246:247], v237 offset:12288
    v_mfma_f32_16x16x32_bf16 v[84:87], a[208:211], a[48:51], v[84:87]
    ds_read_b64_tr_b16 a[248:249], v241 offset:0
    buffer_load_dwordx4 v211, s[20:23], s33 offen offset:3072  lds
    v_mfma_f32_16x16x32_bf16 v[84:87], a[212:215], a[52:55], v[84:87]
    ds_read_b64_tr_b16 a[250:251], v241 offset:4096
    v_mfma_f32_16x16x32_bf16 v[84:87], a[216:219], a[56:59], v[84:87]
    ds_read_b64_tr_b16 a[252:253], v241 offset:8192
    v_mfma_f32_16x16x32_bf16 v[84:87], a[220:223], a[60:63], v[84:87]
    ds_read_b64_tr_b16 a[254:255], v241 offset:12288
    s_waitcnt lgkmcnt(8)
    v_mfma_f32_16x16x32_bf16 v[88:91], a[224:227], a[0:3], v[88:91]
    s_waitcnt vmcnt(13)
    s_barrier
    ds_read_b64_tr_b16 a[192:193], v226 offset:16384
    v_mfma_f32_16x16x32_bf16 v[88:91], a[228:231], a[4:7], v[88:91]
    ds_read_b64_tr_b16 a[194:195], v226 offset:20480
    v_mfma_f32_16x16x32_bf16 v[88:91], a[232:235], a[8:11], v[88:91]
    ds_read_b64_tr_b16 a[196:197], v226 offset:24576
    v_mfma_f32_16x16x32_bf16 v[88:91], a[236:239], a[12:15], v[88:91]
    ds_read_b64_tr_b16 a[198:199], v226 offset:28672
    v_cvt_pk_bf16_f32 v196, v68, v69
    v_mfma_f32_16x16x32_bf16 v[92:95], a[224:227], a[32:35], v[92:95]
    ds_read_b64_tr_b16 a[200:201], v230 offset:16384
    v_cvt_pk_bf16_f32 v197, v70, v71
    v_mfma_f32_16x16x32_bf16 v[92:95], a[228:231], a[36:39], v[92:95]
    ds_read_b64_tr_b16 a[202:203], v230 offset:20480
    v_cvt_pk_bf16_f32 v198, v76, v77
    v_mfma_f32_16x16x32_bf16 v[92:95], a[232:235], a[40:43], v[92:95]
    ds_read_b64_tr_b16 a[204:205], v230 offset:24576
    v_cvt_pk_bf16_f32 v199, v78, v79
    v_mfma_f32_16x16x32_bf16 v[92:95], a[236:239], a[44:47], v[92:95]
    ds_read_b64_tr_b16 a[206:207], v230 offset:28672
    buffer_store_dwordx4 v[196:199], v255, s[24:27], s39 offen offset:2048 sc1
    s_waitcnt lgkmcnt(8)
    v_mfma_f32_16x16x32_bf16 v[88:91], a[240:243], a[16:19], v[88:91]
    ds_read_b64_tr_b16 a[208:209], v234 offset:16384
    v_mfma_f32_16x16x32_bf16 v[88:91], a[244:247], a[20:23], v[88:91]
    ds_read_b64_tr_b16 a[210:211], v234 offset:20480
    v_mfma_f32_16x16x32_bf16 v[88:91], a[248:251], a[24:27], v[88:91]
    ds_read_b64_tr_b16 a[212:213], v234 offset:24576
    v_mfma_f32_16x16x32_bf16 v[88:91], a[252:255], a[28:31], v[88:91]
    ds_read_b64_tr_b16 a[214:215], v234 offset:28672
    v_mfma_f32_16x16x32_bf16 v[92:95], a[240:243], a[48:51], v[92:95]
    ds_read_b64_tr_b16 a[216:217], v238 offset:16384
    v_mfma_f32_16x16x32_bf16 v[92:95], a[244:247], a[52:55], v[92:95]
    ds_read_b64_tr_b16 a[218:219], v238 offset:20480
    v_mfma_f32_16x16x32_bf16 v[92:95], a[248:251], a[56:59], v[92:95]
    ds_read_b64_tr_b16 a[220:221], v238 offset:24576
    v_mfma_f32_16x16x32_bf16 v[92:95], a[252:255], a[60:63], v[92:95]
    ds_read_b64_tr_b16 a[222:223], v238 offset:28672
    s_waitcnt lgkmcnt(8)
    v_mfma_f32_16x16x32_bf16 v[96:99], a[192:195], a[0:3], v[96:99]
    ds_read_b64_tr_b16 a[224:225], v227 offset:16384
    v_mfma_f32_16x16x32_bf16 v[96:99], a[196:199], a[4:7], v[96:99]
    ds_read_b64_tr_b16 a[226:227], v227 offset:20480
    v_mfma_f32_16x16x32_bf16 v[96:99], a[200:203], a[8:11], v[96:99]
    ds_read_b64_tr_b16 a[228:229], v227 offset:24576
    v_mfma_f32_16x16x32_bf16 v[96:99], a[204:207], a[12:15], v[96:99]
    ds_read_b64_tr_b16 a[230:231], v227 offset:28672
    v_cvt_pk_bf16_f32 v200, v80, v81
    v_mfma_f32_16x16x32_bf16 v[100:103], a[192:195], a[32:35], v[100:103]
    ds_read_b64_tr_b16 a[232:233], v231 offset:16384
    v_cvt_pk_bf16_f32 v201, v82, v83
    v_mfma_f32_16x16x32_bf16 v[100:103], a[196:199], a[36:39], v[100:103]
    ds_read_b64_tr_b16 a[234:235], v231 offset:20480
    v_cvt_pk_bf16_f32 v202, v88, v89
    v_mfma_f32_16x16x32_bf16 v[100:103], a[200:203], a[40:43], v[100:103]
    ds_read_b64_tr_b16 a[236:237], v231 offset:24576
    v_cvt_pk_bf16_f32 v203, v90, v91
    v_mfma_f32_16x16x32_bf16 v[100:103], a[204:207], a[44:47], v[100:103]
    ds_read_b64_tr_b16 a[238:239], v231 offset:28672
    buffer_store_dwordx4 v[200:203], v254, s[24:27], s39 offen offset:2560 sc1
    s_waitcnt lgkmcnt(8)
    v_mfma_f32_16x16x32_bf16 v[96:99], a[208:211], a[16:19], v[96:99]
    ds_read_b64_tr_b16 a[240:241], v235 offset:16384
    v_mfma_f32_16x16x32_bf16 v[96:99], a[212:215], a[20:23], v[96:99]
    ds_read_b64_tr_b16 a[242:243], v235 offset:20480
    v_mfma_f32_16x16x32_bf16 v[96:99], a[216:219], a[24:27], v[96:99]
    ds_read_b64_tr_b16 a[244:245], v235 offset:24576
    v_mfma_f32_16x16x32_bf16 v[96:99], a[220:223], a[28:31], v[96:99]
    ds_read_b64_tr_b16 a[246:247], v235 offset:28672
    v_mfma_f32_16x16x32_bf16 v[100:103], a[208:211], a[48:51], v[100:103]
    ds_read_b64_tr_b16 a[248:249], v239 offset:16384
    v_mfma_f32_16x16x32_bf16 v[100:103], a[212:215], a[52:55], v[100:103]
    ds_read_b64_tr_b16 a[250:251], v239 offset:20480
    v_mfma_f32_16x16x32_bf16 v[100:103], a[216:219], a[56:59], v[100:103]
    ds_read_b64_tr_b16 a[252:253], v239 offset:24576
    v_mfma_f32_16x16x32_bf16 v[100:103], a[220:223], a[60:63], v[100:103]
    ds_read_b64_tr_b16 a[254:255], v239 offset:28672
    s_waitcnt lgkmcnt(8)
    v_mfma_f32_16x16x32_bf16 v[104:107], a[224:227], a[0:3], v[104:107]
    ds_read_b64_tr_b16 a[192:193], v228 offset:16384
    v_mfma_f32_16x16x32_bf16 v[104:107], a[228:231], a[4:7], v[104:107]
    ds_read_b64_tr_b16 a[194:195], v228 offset:20480
    v_mfma_f32_16x16x32_bf16 v[104:107], a[232:235], a[8:11], v[104:107]
    ds_read_b64_tr_b16 a[196:197], v228 offset:24576
    v_mfma_f32_16x16x32_bf16 v[104:107], a[236:239], a[12:15], v[104:107]
    ds_read_b64_tr_b16 a[198:199], v228 offset:28672
    v_cvt_pk_bf16_f32 v204, v84, v85
    v_mfma_f32_16x16x32_bf16 v[108:111], a[224:227], a[32:35], v[108:111]
    ds_read_b64_tr_b16 a[200:201], v232 offset:16384
    v_cvt_pk_bf16_f32 v205, v86, v87
    v_mfma_f32_16x16x32_bf16 v[108:111], a[228:231], a[36:39], v[108:111]
    ds_read_b64_tr_b16 a[202:203], v232 offset:20480
    v_cvt_pk_bf16_f32 v206, v92, v93
    v_mfma_f32_16x16x32_bf16 v[108:111], a[232:235], a[40:43], v[108:111]
    ds_read_b64_tr_b16 a[204:205], v232 offset:24576
    v_cvt_pk_bf16_f32 v207, v94, v95
    v_mfma_f32_16x16x32_bf16 v[108:111], a[236:239], a[44:47], v[108:111]
    ds_read_b64_tr_b16 a[206:207], v232 offset:28672
    buffer_store_dwordx4 v[204:207], v255, s[24:27], s39 offen offset:2560 sc1
    s_waitcnt lgkmcnt(8)
    v_mfma_f32_16x16x32_bf16 v[104:107], a[240:243], a[16:19], v[104:107]
    ds_read_b64_tr_b16 a[208:209], v236 offset:16384
    v_mfma_f32_16x16x32_bf16 v[104:107], a[244:247], a[20:23], v[104:107]
    ds_read_b64_tr_b16 a[210:211], v236 offset:20480
    v_mfma_f32_16x16x32_bf16 v[104:107], a[248:251], a[24:27], v[104:107]
    ds_read_b64_tr_b16 a[212:213], v236 offset:24576
    v_mfma_f32_16x16x32_bf16 v[104:107], a[252:255], a[28:31], v[104:107]
    ds_read_b64_tr_b16 a[214:215], v236 offset:28672
    v_mfma_f32_16x16x32_bf16 v[108:111], a[240:243], a[48:51], v[108:111]
    ds_read_b64_tr_b16 a[216:217], v240 offset:16384
    v_mfma_f32_16x16x32_bf16 v[108:111], a[244:247], a[52:55], v[108:111]
    ds_read_b64_tr_b16 a[218:219], v240 offset:20480
    v_mfma_f32_16x16x32_bf16 v[108:111], a[248:251], a[56:59], v[108:111]
    ds_read_b64_tr_b16 a[220:221], v240 offset:24576
    v_mfma_f32_16x16x32_bf16 v[108:111], a[252:255], a[60:63], v[108:111]
    ds_read_b64_tr_b16 a[222:223], v240 offset:28672
    s_waitcnt lgkmcnt(8)
    v_mfma_f32_16x16x32_bf16 v[112:115], a[192:195], a[0:3], v[112:115]
    ds_read_b64_tr_b16 a[224:225], v229 offset:16384
    v_mfma_f32_16x16x32_bf16 v[112:115], a[196:199], a[4:7], v[112:115]
    ds_read_b64_tr_b16 a[226:227], v229 offset:20480
    v_mfma_f32_16x16x32_bf16 v[112:115], a[200:203], a[8:11], v[112:115]
    ds_read_b64_tr_b16 a[228:229], v229 offset:24576
    v_mfma_f32_16x16x32_bf16 v[112:115], a[204:207], a[12:15], v[112:115]
    ds_read_b64_tr_b16 a[230:231], v229 offset:28672
    v_cvt_pk_bf16_f32 v192, v96, v97
    v_mfma_f32_16x16x32_bf16 v[116:119], a[192:195], a[32:35], v[116:119]
    ds_read_b64_tr_b16 a[232:233], v233 offset:16384
    v_cvt_pk_bf16_f32 v193, v98, v99
    v_mfma_f32_16x16x32_bf16 v[116:119], a[196:199], a[36:39], v[116:119]
    ds_read_b64_tr_b16 a[234:235], v233 offset:20480
    v_cvt_pk_bf16_f32 v194, v104, v105
    v_mfma_f32_16x16x32_bf16 v[116:119], a[200:203], a[40:43], v[116:119]
    ds_read_b64_tr_b16 a[236:237], v233 offset:24576
    v_cvt_pk_bf16_f32 v195, v106, v107
    v_mfma_f32_16x16x32_bf16 v[116:119], a[204:207], a[44:47], v[116:119]
    ds_read_b64_tr_b16 a[238:239], v233 offset:28672
    buffer_store_dwordx4 v[192:195], v254, s[24:27], s39 offen offset:3072 sc1
    s_waitcnt lgkmcnt(8)
    v_mfma_f32_16x16x32_bf16 v[112:115], a[208:211], a[16:19], v[112:115]
    ds_read_b64_tr_b16 a[240:241], v237 offset:16384
    v_mfma_f32_16x16x32_bf16 v[112:115], a[212:215], a[20:23], v[112:115]
    ds_read_b64_tr_b16 a[242:243], v237 offset:20480
    v_mfma_f32_16x16x32_bf16 v[112:115], a[216:219], a[24:27], v[112:115]
    ds_read_b64_tr_b16 a[244:245], v237 offset:24576
    v_mfma_f32_16x16x32_bf16 v[112:115], a[220:223], a[28:31], v[112:115]
    ds_read_b64_tr_b16 a[246:247], v237 offset:28672
    v_mfma_f32_16x16x32_bf16 v[116:119], a[208:211], a[48:51], v[116:119]
    ds_read_b64_tr_b16 a[248:249], v241 offset:16384
    v_mfma_f32_16x16x32_bf16 v[116:119], a[212:215], a[52:55], v[116:119]
    ds_read_b64_tr_b16 a[250:251], v241 offset:20480
    v_mfma_f32_16x16x32_bf16 v[116:119], a[216:219], a[56:59], v[116:119]
    ds_read_b64_tr_b16 a[252:253], v241 offset:24576
    v_mfma_f32_16x16x32_bf16 v[116:119], a[220:223], a[60:63], v[116:119]
    ds_read_b64_tr_b16 a[254:255], v241 offset:28672
    s_waitcnt lgkmcnt(8)
    v_mfma_f32_16x16x32_bf16 v[120:123], a[224:227], a[0:3], v[120:123]
    s_waitcnt vmcnt(4)
    s_barrier
    ds_read_b64_tr_b16 a[192:193], v226 offset:32768
    v_mfma_f32_16x16x32_bf16 v[120:123], a[228:231], a[4:7], v[120:123]
    ds_read_b64_tr_b16 a[194:195], v226 offset:36864
    v_mfma_f32_16x16x32_bf16 v[120:123], a[232:235], a[8:11], v[120:123]
    ds_read_b64_tr_b16 a[196:197], v226 offset:40960
    v_mfma_f32_16x16x32_bf16 v[120:123], a[236:239], a[12:15], v[120:123]
    ds_read_b64_tr_b16 a[198:199], v226 offset:45056
    v_cvt_pk_bf16_f32 v196, v100, v101
    v_mfma_f32_16x16x32_bf16 v[124:127], a[224:227], a[32:35], v[124:127]
    ds_read_b64_tr_b16 a[200:201], v228 offset:32768
    v_cvt_pk_bf16_f32 v197, v102, v103
    v_mfma_f32_16x16x32_bf16 v[124:127], a[228:231], a[36:39], v[124:127]
    ds_read_b64_tr_b16 a[202:203], v228 offset:36864
    v_cvt_pk_bf16_f32 v198, v108, v109
    v_mfma_f32_16x16x32_bf16 v[124:127], a[232:235], a[40:43], v[124:127]
    ds_read_b64_tr_b16 a[204:205], v228 offset:40960
    v_cvt_pk_bf16_f32 v199, v110, v111
    v_mfma_f32_16x16x32_bf16 v[124:127], a[236:239], a[44:47], v[124:127]
    ds_read_b64_tr_b16 a[206:207], v228 offset:45056
    buffer_store_dwordx4 v[196:199], v255, s[24:27], s39 offen offset:3072 sc1
    s_waitcnt lgkmcnt(8)
    v_mfma_f32_16x16x32_bf16 v[120:123], a[240:243], a[16:19], v[120:123]
    ds_read_b64_tr_b16 a[208:209], v230 offset:32768
    v_mfma_f32_16x16x32_bf16 v[120:123], a[244:247], a[20:23], v[120:123]
    ds_read_b64_tr_b16 a[210:211], v230 offset:36864
    v_mfma_f32_16x16x32_bf16 v[120:123], a[248:251], a[24:27], v[120:123]
    ds_read_b64_tr_b16 a[212:213], v230 offset:40960
    v_mfma_f32_16x16x32_bf16 v[120:123], a[252:255], a[28:31], v[120:123]
    ds_read_b64_tr_b16 a[214:215], v230 offset:45056
    v_mfma_f32_16x16x32_bf16 v[124:127], a[240:243], a[48:51], v[124:127]
    ds_read_b64_tr_b16 a[216:217], v232 offset:32768
    v_mfma_f32_16x16x32_bf16 v[124:127], a[244:247], a[52:55], v[124:127]
    ds_read_b64_tr_b16 a[218:219], v232 offset:36864
    v_mfma_f32_16x16x32_bf16 v[124:127], a[248:251], a[56:59], v[124:127]
    ds_read_b64_tr_b16 a[220:221], v232 offset:40960
    v_mfma_f32_16x16x32_bf16 v[124:127], a[252:255], a[60:63], v[124:127]
    ds_read_b64_tr_b16 a[222:223], v232 offset:45056
    s_waitcnt lgkmcnt(8)
    v_mfma_f32_16x16x32_bf16 v[0:3], a[192:195], v[128:131], 0
    ds_read_b64_tr_b16 a[224:225], v227 offset:32768
    v_mfma_f32_16x16x32_bf16 v[0:3], a[196:199], v[132:135], v[0:3]
    ds_read_b64_tr_b16 a[226:227], v227 offset:36864
    v_mfma_f32_16x16x32_bf16 v[0:3], a[200:203], v[136:139], v[0:3]
    ds_read_b64_tr_b16 a[228:229], v227 offset:40960
    v_mfma_f32_16x16x32_bf16 v[0:3], a[204:207], v[140:143], v[0:3]
    ds_read_b64_tr_b16 a[230:231], v227 offset:45056
    v_cvt_pk_bf16_f32 v200, v112, v113
    v_mfma_f32_16x16x32_bf16 v[4:7], a[192:195], v[160:163], 0
    ds_read_b64_tr_b16 a[232:233], v229 offset:32768
    v_cvt_pk_bf16_f32 v201, v114, v115
    v_mfma_f32_16x16x32_bf16 v[4:7], a[196:199], v[164:167], v[4:7]
    ds_read_b64_tr_b16 a[234:235], v229 offset:36864
    v_cvt_pk_bf16_f32 v202, v120, v121
    v_mfma_f32_16x16x32_bf16 v[4:7], a[200:203], v[168:171], v[4:7]
    ds_read_b64_tr_b16 a[236:237], v229 offset:40960
    v_cvt_pk_bf16_f32 v203, v122, v123
    v_mfma_f32_16x16x32_bf16 v[4:7], a[204:207], v[172:175], v[4:7]
    ds_read_b64_tr_b16 a[238:239], v229 offset:45056
    buffer_store_dwordx4 v[200:203], v254, s[24:27], s39 offen offset:3584 sc1
    s_waitcnt lgkmcnt(8)
    v_mfma_f32_16x16x32_bf16 v[0:3], a[208:211], v[144:147], v[0:3]
    ds_read_b64_tr_b16 a[240:241], v231 offset:32768
    buffer_load_dword v220, v252, s[24:27], s30 offen sc1
    v_mfma_f32_16x16x32_bf16 v[0:3], a[212:215], v[148:151], v[0:3]
    ds_read_b64_tr_b16 a[242:243], v231 offset:36864
    v_mfma_f32_16x16x32_bf16 v[0:3], a[216:219], v[152:155], v[0:3]
    ds_read_b64_tr_b16 a[244:245], v231 offset:40960
    v_mfma_f32_16x16x32_bf16 v[0:3], a[220:223], v[156:159], v[0:3]
    ds_read_b64_tr_b16 a[246:247], v231 offset:45056
    v_mfma_f32_16x16x32_bf16 v[4:7], a[208:211], v[176:179], v[4:7]
    ds_read_b64_tr_b16 a[248:249], v233 offset:32768
    v_mfma_f32_16x16x32_bf16 v[4:7], a[212:215], v[180:183], v[4:7]
    ds_read_b64_tr_b16 a[250:251], v233 offset:36864
    v_mfma_f32_16x16x32_bf16 v[4:7], a[216:219], v[184:187], v[4:7]
    ds_read_b64_tr_b16 a[252:253], v233 offset:40960
    v_mfma_f32_16x16x32_bf16 v[4:7], a[220:223], v[188:191], v[4:7]
    ds_read_b64_tr_b16 a[254:255], v233 offset:45056
    s_waitcnt lgkmcnt(8)
    v_mfma_f32_16x16x32_bf16 v[8:11], a[224:227], v[128:131], 0
    ds_read_b64_tr_b16 a[192:193], v234 offset:32768
    v_mfma_f32_16x16x32_bf16 v[8:11], a[228:231], v[132:135], v[8:11]
    ds_read_b64_tr_b16 a[194:195], v234 offset:36864
    v_mfma_f32_16x16x32_bf16 v[8:11], a[232:235], v[136:139], v[8:11]
    ds_read_b64_tr_b16 a[196:197], v234 offset:40960
    v_mfma_f32_16x16x32_bf16 v[8:11], a[236:239], v[140:143], v[8:11]
    ds_read_b64_tr_b16 a[198:199], v234 offset:45056
    v_cvt_pk_bf16_f32 v204, v116, v117
    v_mfma_f32_16x16x32_bf16 v[12:15], a[224:227], v[160:163], 0
    ds_read_b64_tr_b16 a[200:201], v236 offset:32768
    v_cvt_pk_bf16_f32 v205, v118, v119
    v_mfma_f32_16x16x32_bf16 v[12:15], a[228:231], v[164:167], v[12:15]
    ds_read_b64_tr_b16 a[202:203], v236 offset:36864
    v_cvt_pk_bf16_f32 v206, v124, v125
    v_mfma_f32_16x16x32_bf16 v[12:15], a[232:235], v[168:171], v[12:15]
    ds_read_b64_tr_b16 a[204:205], v236 offset:40960
    v_cvt_pk_bf16_f32 v207, v126, v127
    v_mfma_f32_16x16x32_bf16 v[12:15], a[236:239], v[172:175], v[12:15]
    ds_read_b64_tr_b16 a[206:207], v236 offset:45056
    buffer_store_dwordx4 v[204:207], v255, s[24:27], s39 offen offset:3584 sc1
    s_waitcnt lgkmcnt(8)
    v_mfma_f32_16x16x32_bf16 v[8:11], a[240:243], v[144:147], v[8:11]
    ds_read_b64_tr_b16 a[208:209], v238 offset:32768
    v_mfma_f32_16x16x32_bf16 v[8:11], a[244:247], v[148:151], v[8:11]
    ds_read_b64_tr_b16 a[210:211], v238 offset:36864
    v_mfma_f32_16x16x32_bf16 v[8:11], a[248:251], v[152:155], v[8:11]
    ds_read_b64_tr_b16 a[212:213], v238 offset:40960
    v_mfma_f32_16x16x32_bf16 v[8:11], a[252:255], v[156:159], v[8:11]
    ds_read_b64_tr_b16 a[214:215], v238 offset:45056
    v_mfma_f32_16x16x32_bf16 v[12:15], a[240:243], v[176:179], v[12:15]
    ds_read_b64_tr_b16 a[216:217], v240 offset:32768
    v_mfma_f32_16x16x32_bf16 v[12:15], a[244:247], v[180:183], v[12:15]
    ds_read_b64_tr_b16 a[218:219], v240 offset:36864
    v_mfma_f32_16x16x32_bf16 v[12:15], a[248:251], v[184:187], v[12:15]
    ds_read_b64_tr_b16 a[220:221], v240 offset:40960
    v_mfma_f32_16x16x32_bf16 v[12:15], a[252:255], v[188:191], v[12:15]
    ds_read_b64_tr_b16 a[222:223], v240 offset:45056
    s_waitcnt lgkmcnt(8)
    v_mfma_f32_16x16x32_bf16 v[0:3], a[192:195], a[0:3], v[0:3]
    ds_read_b64_tr_b16 a[224:225], v235 offset:32768
    v_mfma_f32_16x16x32_bf16 v[0:3], a[196:199], a[4:7], v[0:3]
    ds_read_b64_tr_b16 a[226:227], v235 offset:36864
    v_mfma_f32_16x16x32_bf16 v[0:3], a[200:203], a[8:11], v[0:3]
    ds_read_b64_tr_b16 a[228:229], v235 offset:40960
    v_mfma_f32_16x16x32_bf16 v[0:3], a[204:207], a[12:15], v[0:3]
    ds_read_b64_tr_b16 a[230:231], v235 offset:45056
    v_mfma_f32_16x16x32_bf16 v[4:7], a[192:195], a[32:35], v[4:7]
    ds_read_b64_tr_b16 a[232:233], v237 offset:32768
    v_mfma_f32_16x16x32_bf16 v[4:7], a[196:199], a[36:39], v[4:7]
    ds_read_b64_tr_b16 a[234:235], v237 offset:36864
    v_mfma_f32_16x16x32_bf16 v[4:7], a[200:203], a[40:43], v[4:7]
    ds_read_b64_tr_b16 a[236:237], v237 offset:40960
    v_mfma_f32_16x16x32_bf16 v[4:7], a[204:207], a[44:47], v[4:7]
    ds_read_b64_tr_b16 a[238:239], v237 offset:45056
    s_waitcnt lgkmcnt(8)
    v_mfma_f32_16x16x32_bf16 v[0:3], a[208:211], a[16:19], v[0:3]
    ds_read_b64_tr_b16 a[240:241], v239 offset:32768
    v_mfma_f32_16x16x32_bf16 v[0:3], a[212:215], a[20:23], v[0:3]
    ds_read_b64_tr_b16 a[242:243], v239 offset:36864
    v_mfma_f32_16x16x32_bf16 v[0:3], a[216:219], a[24:27], v[0:3]
    ds_read_b64_tr_b16 a[244:245], v239 offset:40960
    v_mfma_f32_16x16x32_bf16 v[0:3], a[220:223], a[28:31], v[0:3]
    ds_read_b64_tr_b16 a[246:247], v239 offset:45056
    v_mfma_f32_16x16x32_bf16 v[4:7], a[208:211], a[48:51], v[4:7]
    ds_read_b64_tr_b16 a[248:249], v241 offset:32768
    v_mfma_f32_16x16x32_bf16 v[4:7], a[212:215], a[52:55], v[4:7]
    ds_read_b64_tr_b16 a[250:251], v241 offset:36864
    v_mfma_f32_16x16x32_bf16 v[4:7], a[216:219], a[56:59], v[4:7]
    ds_read_b64_tr_b16 a[252:253], v241 offset:40960
    v_mfma_f32_16x16x32_bf16 v[4:7], a[220:223], a[60:63], v[4:7]
    ds_read_b64_tr_b16 a[254:255], v241 offset:45056
    s_waitcnt lgkmcnt(0)
    v_mfma_f32_16x16x32_bf16 v[8:11], a[224:227], a[0:3], v[8:11]
    s_barrier
    v_mfma_f32_16x16x32_bf16 v[8:11], a[228:231], a[4:7], v[8:11]
    v_mfma_f32_16x16x32_bf16 v[8:11], a[232:235], a[8:11], v[8:11]
    v_mfma_f32_16x16x32_bf16 v[8:11], a[236:239], a[12:15], v[8:11]
    v_mfma_f32_16x16x32_bf16 v[12:15], a[224:227], a[32:35], v[12:15]
    v_mfma_f32_16x16x32_bf16 v[12:15], a[228:231], a[36:39], v[12:15]
    v_mfma_f32_16x16x32_bf16 v[12:15], a[232:235], a[40:43], v[12:15]
    v_mfma_f32_16x16x32_bf16 v[12:15], a[236:239], a[44:47], v[12:15]
    v_mfma_f32_16x16x32_bf16 v[8:11], a[240:243], a[16:19], v[8:11]
    v_mfma_f32_16x16x32_bf16 v[8:11], a[244:247], a[20:23], v[8:11]
    v_mfma_f32_16x16x32_bf16 v[8:11], a[248:251], a[24:27], v[8:11]
    v_mfma_f32_16x16x32_bf16 v[8:11], a[252:255], a[28:31], v[8:11]
    v_mfma_f32_16x16x32_bf16 v[12:15], a[240:243], a[48:51], v[12:15]
    v_mfma_f32_16x16x32_bf16 v[12:15], a[244:247], a[52:55], v[12:15]
    v_mfma_f32_16x16x32_bf16 v[12:15], a[248:251], a[56:59], v[12:15]
    v_mfma_f32_16x16x32_bf16 v[12:15], a[252:255], a[60:63], v[12:15]
    s_nop 7
    v_cvt_pk_bf16_f32 v192, v0, v1
    v_cvt_pk_bf16_f32 v193, v2, v3
    v_cvt_pk_bf16_f32 v194, v8, v9
    v_cvt_pk_bf16_f32 v195, v10, v11
    buffer_store_dwordx4 v[192:195], v254, s[24:27], s53 offen offset:0 sc1
    v_cvt_pk_bf16_f32 v196, v4, v5
    v_cvt_pk_bf16_f32 v197, v6, v7
    v_cvt_pk_bf16_f32 v198, v12, v13
    v_cvt_pk_bf16_f32 v199, v14, v15
    buffer_store_dwordx4 v[196:199], v255, s[24:27], s53 offen offset:0 sc1
T_BEGIN:
    s_mov_b32 s101, 200000
    s_waitcnt vmcnt(3)
    v_cmp_ne_u32 vcc, s54, v220
    s_mov_b32 s32, 0
    s_cbranch_vccnz T_SLOW
    buffer_load_dwordx4 a[0:3], v249, s[24:27], s34 offen offset:0 sc1
    buffer_load_dwordx4 a[4:7], v249, s[24:27], s34 offen offset:512 sc1
    buffer_load_dwordx4 a[8:11], v249, s[24:27], s34 offen offset:1024 sc1
    buffer_load_dwordx4 a[12:15], v249, s[24:27], s34 offen offset:1536 sc1
    buffer_load_dwordx4 a[16:19], v249, s[24:27], s34 offen offset:2048 sc1
    buffer_load_dwordx4 a[20:23], v249, s[24:27], s34 offen offset:2560 sc1
    buffer_load_dwordx4 a[24:27], v249, s[24:27], s34 offen offset:3072 sc1
    buffer_load_dwordx4 a[28:31], v249, s[24:27], s34 offen offset:3584 sc1
    s_waitcnt vmcnt(8)
    s_mov_b64 exec, 1
    buffer_store_dword v221, v222, s[24:27], s31 offen sc1
    s_mov_b64 exec, -1
    s_add_u32 s34, s34, 4096
    buffer_load_dwordx4 a[32:35], v249, s[24:27], s34 offen offset:0 sc1
    buffer_load_dwordx4 a[36:39], v249, s[24:27], s34 offen offset:512 sc1
    buffer_load_dwordx4 a[40:43], v249, s[24:27], s34 offen offset:1024 sc1
    buffer_load_dwordx4 a[44:47], v249, s[24:27], s34 offen offset:1536 sc1
    buffer_load_dwordx4 a[48:51], v249, s[24:27], s34 offen offset:2048 sc1
    buffer_load_dwordx4 a[52:55], v249, s[24:27], s34 offen offset:2560 sc1
    buffer_load_dwordx4 a[56:59], v249, s[24:27], s34 offen offset:3072 sc1
    buffer_load_dwordx4 a[60:63], v249, s[24:27], s34 offen offset:3584 sc1
    s_add_u32 s34, s34, 4096
    buffer_load_dwordx4 a[64:67], v249, s[24:27], s34 offen offset:0 sc1
    buffer_load_dwordx4 a[212:215], v249, s[24:27], s34 offen offset:512 sc1
    s_mov_b32 s32, 1
    s_branch T_SETUP
T_SLOW:
    s_waitcnt vmcnt(0)
    s_mov_b64 exec, 1
    buffer_store_dword v221, v222, s[24:27], s31 offen sc1
    s_mov_b64 exec, -1
T_SETUP:
    s_add_u32 s52, s52, 4096
    buffer_load_dwordx4 a[192:195], v225, s[4:7], s52 offen offset:0
    buffer_load_dwordx4 a[196:199], v225, s[4:7], s52 offen offset:1024
    buffer_load_dwordx4 a[200:203], v225, s[4:7], s52 offen offset:2048
    buffer_load_dwordx4 a[204:207], v225, s[4:7], s52 offen offset:3072
    s_add_u32 s52, s52, 4096
    buffer_load_dwordx4 a[208:211], v225, s[4:7], s52 offen
    s_lshl_b32 s35, s40, 6
    v_add_u32 v210, s35, v246
    s_getpc_b64 s[44:45]
TC8131_T_LN:
    s_add_u32 s44, s44, T_LN-TC8131_T_LN
    s_addc_u32 s45, s45, 0
    v_min_u32 v211, (K2_END-T_LN-1)/128, v210
    v_lshlrev_b32 v211, 7, v211
    global_load_dword a216, v211, s[44:45]
    s_mul_i32 s53, s40, 9216
    v_add_u32 v223, s53, v225
    s_lshl_b32 s35, s40, 10
    s_add_u32 s35, s35, 126976
    v_add_u32 v217, s35, v225
    ds_write_b128 v217, a[68:71]
    ds_write_b128 v223, a[72:75] offset:0
    ds_write_b128 v223, a[76:79] offset:1024
    ds_write_b128 v223, a[80:83] offset:2048
    ds_write_b128 v223, a[84:87] offset:3072
    ds_write_b128 v223, a[88:91] offset:4096
    ds_write_b128 v223, a[92:95] offset:5120
    ds_write_b128 v223, a[96:99] offset:6144
    ds_write_b128 v223, a[100:103] offset:7168
    ds_write_b128 v223, a[104:107] offset:8192
    v_and_b32 v210, 1, v247
    v_lshlrev_b32 v210, 4, v210
    v_mov_b32 v211, 0x3f80
    v_lshlrev_b32 v210, v210, v211
    v_lshrrev_b32 v211, 1, v247
    v_and_b32 v212, 2, v248
    v_lshlrev_b32 v212, 1, v212
    v_sub_u32 v211, v211, v212
    v_cmp_eq_u32 vcc, 0, v211
    s_nop 1
    v_cndmask_b32 v128, 0, v210, vcc
    v_cmp_eq_u32 vcc, 1, v211
    s_nop 1
    v_cndmask_b32 v129, 0, v210, vcc
    v_cmp_eq_u32 vcc, 2, v211
    s_nop 1
    v_cndmask_b32 v130, 0, v210, vcc
    v_cmp_eq_u32 vcc, 3, v211
    s_nop 1
    v_cndmask_b32 v131, 0, v210, vcc
    v_accvgpr_read_b32 v64, a128
    v_accvgpr_read_b32 v65, a129
    v_accvgpr_read_b32 v66, a130
    v_accvgpr_read_b32 v67, a131
    v_accvgpr_read_b32 v68, a132
    v_accvgpr_read_b32 v69, a133
    v_accvgpr_read_b32 v70, a134
    v_accvgpr_read_b32 v71, a135
    v_accvgpr_read_b32 v72, a136
    v_accvgpr_read_b32 v73, a137
    v_accvgpr_read_b32 v74, a138
    v_accvgpr_read_b32 v75, a139
    v_accvgpr_read_b32 v76, a140
    v_accvgpr_read_b32 v77, a141
    v_accvgpr_read_b32 v78, a142
    v_accvgpr_read_b32 v79, a143
    v_accvgpr_read_b32 v80, a144
    v_accvgpr_read_b32 v81, a145
    v_accvgpr_read_b32 v82, a146
    v_accvgpr_read_b32 v83, a147
    v_accvgpr_read_b32 v84, a148
    v_accvgpr_read_b32 v85, a149
    v_accvgpr_read_b32 v86, a150
    v_accvgpr_read_b32 v87, a151
    v_accvgpr_read_b32 v88, a152
    v_accvgpr_read_b32 v89, a153
    v_accvgpr_read_b32 v90, a154
    v_accvgpr_read_b32 v91, a155
    v_accvgpr_read_b32 v92, a156
    v_accvgpr_read_b32 v93, a157
    v_accvgpr_read_b32 v94, a158
    v_accvgpr_read_b32 v95, a159
    v_accvgpr_read_b32 v96, a160
    v_accvgpr_read_b32 v97, a161
    buffer_load_dword v220, v252, s[24:27], s30 offen sc1
    v_accvgpr_read_b32 v98, a162
    v_accvgpr_read_b32 v99, a163
    v_accvgpr_read_b32 v100, a164
    v_accvgpr_read_b32 v101, a165
    v_accvgpr_read_b32 v102, a166
    v_accvgpr_read_b32 v103, a167
    v_accvgpr_read_b32 v104, a168
    v_accvgpr_read_b32 v105, a169
    v_accvgpr_read_b32 v106, a170
    v_accvgpr_read_b32 v107, a171
    v_accvgpr_read_b32 v108, a172
    v_accvgpr_read_b32 v109, a173
    v_accvgpr_read_b32 v110, a174
    v_accvgpr_read_b32 v111, a175
    v_accvgpr_read_b32 v112, a176
    v_accvgpr_read_b32 v113, a177
    v_accvgpr_read_b32 v114, a178
    v_accvgpr_read_b32 v115, a179
    v_accvgpr_read_b32 v116, a180
    v_accvgpr_read_b32 v117, a181
    v_accvgpr_read_b32 v118, a182
    v_accvgpr_read_b32 v119, a183
    v_accvgpr_read_b32 v120, a184
    v_accvgpr_read_b32 v121, a185
    v_accvgpr_read_b32 v122, a186
    v_accvgpr_read_b32 v123, a187
    s_mov_b32 exec_lo, 0
    v_mov_b32 v96, 0
    v_mov_b32 v97, 0
    v_mov_b32 v98, 0
    v_mov_b32 v99, 0
    v_mov_b32 v100, 0
    v_mov_b32 v101, 0
    v_mov_b32 v102, 0
    v_mov_b32 v103, 0
    s_mov_b32 exec_lo, -1
    v_lshlrev_b32 v160, 16, v64
    v_and_b32 v161, 0xffff0000, v64
    v_lshlrev_b32 v162, 16, v65
    v_and_b32 v163, 0xffff0000, v65
    v_lshlrev_b32 v180, 16, v66
    v_and_b32 v181, 0xffff0000, v66
    v_lshlrev_b32 v182, 16, v67
    v_and_b32 v183, 0xffff0000, v67
    v_lshlrev_b32 v20, 16, v68
    v_and_b32 v21, 0xffff0000, v68
    v_lshlrev_b32 v22, 16, v69
    v_and_b32 v23, 0xffff0000, v69
    v_lshlrev_b32 v40, 16, v70
    v_and_b32 v41, 0xffff0000, v70
    v_lshlrev_b32 v42, 16, v71
    v_and_b32 v43, 0xffff0000, v71
    v_lshlrev_b32 v164, 16, v72
    v_and_b32 v165, 0xffff0000, v72
    v_lshlrev_b32 v166, 16, v73
    v_and_b32 v167, 0xffff0000, v73
    v_lshlrev_b32 v184, 16, v74
    v_and_b32 v185, 0xffff0000, v74
    v_lshlrev_b32 v186, 16, v75
    v_and_b32 v187, 0xffff0000, v75
    v_lshlrev_b32 v24, 16, v76
    v_and_b32 v25, 0xffff0000, v76
    v_lshlrev_b32 v26, 16, v77
    v_and_b32 v27, 0xffff0000, v77
    v_lshlrev_b32 v44, 16, v78
    v_and_b32 v45, 0xffff0000, v78
    v_lshlrev_b32 v46, 16, v79
    v_and_b32 v47, 0xffff0000, v79
    v_lshlrev_b32 v168, 16, v80
    v_and_b32 v169, 0xffff0000, v80
    v_lshlrev_b32 v170, 16, v81
    v_and_b32 v171, 0xffff0000, v81
    v_lshlrev_b32 v188, 16, v82
    v_and_b32 v189, 0xffff0000, v82
    v_lshlrev_b32 v190, 16, v83
    v_and_b32 v191, 0xffff0000, v83
    v_lshlrev_b32 v28, 16, v84
    v_and_b32 v29, 0xffff0000, v84
    v_lshlrev_b32 v30, 16, v85
    v_and_b32 v31, 0xffff0000, v85
    v_lshlrev_b32 v48, 16, v86
    v_and_b32 v49, 0xffff0000, v86
    v_lshlrev_b32 v50, 16, v87
    v_and_b32 v51, 0xffff0000, v87
    v_lshlrev_b32 v172, 16, v88
    v_and_b32 v173, 0xffff0000, v88
    v_lshlrev_b32 v174, 16, v89
    v_and_b32 v175, 0xffff0000, v89
    v_lshlrev_b32 v192, 16, v90
    v_and_b32 v193, 0xffff0000, v90
    v_lshlrev_b32 v194, 16, v91
    v_and_b32 v195, 0xffff0000, v91
    v_lshlrev_b32 v32, 16, v92
    v_and_b32 v33, 0xffff0000, v92
    v_lshlrev_b32 v34, 16, v93
    v_and_b32 v35, 0xffff0000, v93
    v_lshlrev_b32 v52, 16, v94
    v_and_b32 v53, 0xffff0000, v94
    v_lshlrev_b32 v54, 16, v95
    v_and_b32 v55, 0xffff0000, v95
    v_lshlrev_b32 v176, 16, v96
    v_and_b32 v177, 0xffff0000, v96
    v_lshlrev_b32 v178, 16, v97
    v_and_b32 v179, 0xffff0000, v97
    v_lshlrev_b32 v196, 16, v98
    v_and_b32 v197, 0xffff0000, v98
    s_cmp_eq_u32 s32, 1
    s_cbranch_scc1 T_SUM
    s_branch T_POLL1C
T_POLL1:
    buffer_load_dword v220, v252, s[24:27], s30 offen sc1
T_POLL1C:
    s_waitcnt vmcnt(0)
    v_cmp_ne_u32 vcc, s54, v220
    s_sub_u32 s101, s101, 1
    s_cselect_b64 vcc, 0, vcc
    s_cbranch_vccnz T_POLL1
    buffer_load_dwordx4 a[0:3], v249, s[24:27], s34 offen offset:0 sc1
    buffer_load_dwordx4 a[4:7], v249, s[24:27], s34 offen offset:512 sc1
    buffer_load_dwordx4 a[8:11], v249, s[24:27], s34 offen offset:1024 sc1
    buffer_load_dwordx4 a[12:15], v249, s[24:27], s34 offen offset:1536 sc1
    buffer_load_dwordx4 a[16:19], v249, s[24:27], s34 offen offset:2048 sc1
    buffer_load_dwordx4 a[20:23], v249, s[24:27], s34 offen offset:2560 sc1
    buffer_load_dwordx4 a[24:27], v249, s[24:27], s34 offen offset:3072 sc1
    buffer_load_dwordx4 a[28:31], v249, s[24:27], s34 offen offset:3584 sc1
    s_add_u32 s34, s34, 4096
    buffer_load_dwordx4 a[32:35], v249, s[24:27], s34 offen offset:0 sc1
    buffer_load_dwordx4 a[36:39], v249, s[24:27], s34 offen offset:512 sc1
    buffer_load_dwordx4 a[40:43], v249, s[24:27], s34 offen offset:1024 sc1
    buffer_load_dwordx4 a[44:47], v249, s[24:27], s34 offen offset:1536 sc1
    buffer_load_dwordx4 a[48:51], v249, s[24:27], s34 offen offset:2048 sc1
    buffer_load_dwordx4 a[52:55], v249, s[24:27], s34 offen offset:2560 sc1
    buffer_load_dwordx4 a[56:59], v249, s[24:27], s34 offen offset:3072 sc1
    buffer_load_dwordx4 a[60:63], v249, s[24:27], s34 offen offset:3584 sc1
    s_add_u32 s34, s34, 4096
    buffer_load_dwordx4 a[64:67], v249, s[24:27], s34 offen offset:0 sc1
    buffer_load_dwordx4 a[212:215], v249, s[24:27], s34 offen offset:512 sc1
T_SUM:
    v_lshlrev_b32 v198, 16, v99
    v_and_b32 v199, 0xffff0000, v99
    v_lshlrev_b32 v36, 16, v100
    v_and_b32 v37, 0xffff0000, v100
    v_lshlrev_b32 v38, 16, v101
    v_and_b32 v39, 0xffff0000, v101
    v_lshlrev_b32 v56, 16, v102
    v_and_b32 v57, 0xffff0000, v102
    v_lshlrev_b32 v58, 16, v103
    v_and_b32 v59, 0xffff0000, v103
    v_lshlrev_b32 v226, 16, v104
    v_and_b32 v227, 0xffff0000, v104
    v_lshlrev_b32 v228, 16, v105
    v_and_b32 v229, 0xffff0000, v105
    v_lshlrev_b32 v230, 16, v106
    v_and_b32 v231, 0xffff0000, v106
    v_lshlrev_b32 v232, 16, v107
    v_and_b32 v233, 0xffff0000, v107
    v_lshlrev_b32 v234, 16, v108
    v_and_b32 v235, 0xffff0000, v108
    v_lshlrev_b32 v236, 16, v109
    v_and_b32 v237, 0xffff0000, v109
    v_lshlrev_b32 v238, 16, v110
    v_and_b32 v239, 0xffff0000, v110
    v_lshlrev_b32 v240, 16, v111
    v_and_b32 v241, 0xffff0000, v111
    v_lshlrev_b32 v242, 16, v112
    v_and_b32 v243, 0xffff0000, v112
    v_lshlrev_b32 v244, 16, v113
    v_and_b32 v245, 0xffff0000, v113
    v_lshlrev_b32 v84, 16, v114
    v_and_b32 v85, 0xffff0000, v114
    v_lshlrev_b32 v86, 16, v115
    v_and_b32 v87, 0xffff0000, v115
    v_lshlrev_b32 v88, 16, v116
    v_and_b32 v89, 0xffff0000, v116
    v_lshlrev_b32 v90, 16, v117
    v_and_b32 v91, 0xffff0000, v117
    v_lshlrev_b32 v92, 16, v118
    v_and_b32 v93, 0xffff0000, v118
    v_lshlrev_b32 v94, 16, v119
    v_and_b32 v95, 0xffff0000, v119
    v_lshlrev_b32 v96, 16, v120
    v_and_b32 v97, 0xffff0000, v120
    v_lshlrev_b32 v98, 16, v121
    v_and_b32 v99, 0xffff0000, v121
    v_lshlrev_b32 v100, 16, v122
    v_and_b32 v101, 0xffff0000, v122
    v_lshlrev_b32 v102, 16, v123
    v_and_b32 v103, 0xffff0000, v123
    v_mul_f32 v125, v180, v84
    v_fmac_f32 v125, v181, v85
    v_fmac_f32 v125, v182, v86
    v_fmac_f32 v125, v183, v87
    v_fmac_f32 v125, v184, v88
    v_fmac_f32 v125, v185, v89
    v_fmac_f32 v125, v186, v90
    v_fmac_f32 v125, v187, v91
    v_fmac_f32 v125, v188, v92
    v_fmac_f32 v125, v189, v93
    v_fmac_f32 v125, v190, v94
    v_fmac_f32 v125, v191, v95
    v_fmac_f32 v125, v192, v96
    v_fmac_f32 v125, v193, v97
    v_fmac_f32 v125, v194, v98
    v_fmac_f32 v125, v195, v99
    v_fmac_f32 v125, v196, v100
    v_fmac_f32 v125, v197, v101
    v_fmac_f32 v125, v198, v102
    v_fmac_f32 v125, v199, v103
    v_mul_f32 v84, v84, v20
    v_mul_f32 v85, v85, v21
    v_mul_f32 v86, v86, v22
    v_mul_f32 v87, v87, v23
    v_mul_f32 v88, v88, v24
    v_mul_f32 v89, v89, v25
    v_mul_f32 v90, v90, v26
    v_mul_f32 v91, v91, v27
    v_mul_f32 v92, v92, v28
    v_mul_f32 v93, v93, v29
    v_mul_f32 v94, v94, v30
    v_mul_f32 v95, v95, v31
    v_mul_f32 v96, v96, v32
    v_mul_f32 v97, v97, v33
    v_mul_f32 v98, v98, v34
    v_mul_f32 v99, v99, v35
    v_mul_f32 v100, v100, v36
    v_mul_f32 v101, v101, v37
    v_mul_f32 v102, v102, v38
    v_mul_f32 v103, v103, v39
    v_add_f32 v124, v84, v85
    v_add_f32 v124, v124, v86
    v_add_f32 v124, v124, v87
    v_add_f32 v124, v124, v88
    v_add_f32 v124, v124, v89
    v_add_f32 v124, v124, v90
    v_add_f32 v124, v124, v91
    v_add_f32 v124, v124, v92
    v_add_f32 v124, v124, v93
    v_add_f32 v124, v124, v94
    v_add_f32 v124, v124, v95
    v_add_f32 v124, v124, v96
    v_add_f32 v124, v124, v97
    v_add_f32 v124, v124, v98
    v_add_f32 v124, v124, v99
    v_add_f32 v124, v124, v100
    v_add_f32 v124, v124, v101
    v_add_f32 v124, v124, v102
    v_add_f32 v124, v124, v103
    s_nop 1
    v_add_f32_dpp v124, v124, v124 quad_perm:[1,0,3,2] row_mask:0xf bank_mask:0xf
    v_add_f32_dpp v125, v125, v125 quad_perm:[1,0,3,2] row_mask:0xf bank_mask:0xf
    s_nop 1
    v_add_f32_dpp v124, v124, v124 quad_perm:[2,3,0,1] row_mask:0xf bank_mask:0xf
    v_add_f32_dpp v125, v125, v125 quad_perm:[2,3,0,1] row_mask:0xf bank_mask:0xf
    s_nop 1
    v_add_f32_dpp v124, v124, v124 row_ror:8 row_mask:0xf bank_mask:0xf
    v_add_f32_dpp v125, v125, v125 row_ror:8 row_mask:0xf bank_mask:0xf
    v_mov_b32 v210, v124
    v_mov_b32 v211, v125
    s_nop 0
    v_permlane16_swap_b32 v210, v124
    v_permlane16_swap_b32 v211, v125
    v_add_f32 v124, v124, v210
    v_add_f32 v125, v125, v211
    v_mov_b32 v210, v124
    v_mov_b32 v211, v125
    s_nop 0
    v_permlane32_swap_b32 v210, v124
    v_permlane32_swap_b32 v211, v125
    v_add_f32 v124, v124, v210
    v_add_f32 v125, v125, v211
    v_lshrrev_b32 v210, 1, v248
    v_lshrrev_b32 v211, 2, v247
    v_lshl_add_u32 v210, v210, 2, v211
    v_mul_u32_u24 v210, 2368, v210
    v_and_b32 v212, 1, v248
    v_lshl_add_u32 v210, v212, 6, v210
    v_and_b32 v212, 3, v247
    v_lshl_add_u32 v210, v212, 4, v210
    s_mul_i32 s35, s40, 18944
    s_add_u32 s35, s35, 36864
    v_add_u32 v210, s35, v210
    v_and_b32 v218, 1, v211
    v_mul_u32_u24 v211, 2368, v218
    v_lshl_add_u32 v211, v253, 1, v211
    s_mul_i32 s35, s40, 4736
    s_add_u32 s35, s35, 36864
    v_add_u32 v211, s35, v211
    s_sub_u32 s33, 2047, s38
    v_sub_u32 v254, s33, v218
    v_mov_b32 v255, s54
    v_lshlrev_b32 v218, 3, v218
    s_lshl_b32 s35, s40, 4
    s_add_u32 s35, s35, 120960
    v_add_u32 v219, s35, v218
    s_lshl_b32 s33, s38, 3
    s_add_u32 s33, s33, 2424832
    s_mul_i32 s63, s40, 9
    s_add_u32 s63, s63, 1
    s_lshr_b32 s63, s63, 1
    s_lshl_b32 s35, s63, 11
    v_lshrrev_b32 v224, 2, v247
    v_lshl_add_u32 v224, v248, 3, v224
    v_lshlrev_b32 v224, 6, v224
    v_lshl_add_u32 v224, v212, 3, v224
    v_add_u32 v224, s35, v224
    v_add_u32 v251, 126976, v224
    s_lshl_b32 s63, s63, 6
    s_add_u32 s62, s63, 4784128
    s_bitcmp1_b32 s40, 0
    s_cselect_b32 s55, 0, 64
    s_add_u32 s55, s55, s62
    s_waitcnt vmcnt(16)
    v_mfma_f32_16x16x32_bf16 v[136:139], v[128:131], a[0:3], 0
    v_mfma_f32_16x16x32_bf16 v[140:143], v[128:131], a[4:7], 0
    s_waitcnt vmcnt(14)
    v_mfma_f32_16x16x32_bf16 v[144:147], v[128:131], a[8:11], 0
    v_mfma_f32_16x16x32_bf16 v[148:151], v[128:131], a[12:15], 0
    s_waitcnt vmcnt(12)
    v_mfma_f32_16x16x32_bf16 v[152:155], v[128:131], a[16:19], 0
    v_mfma_f32_16x16x32_bf16 v[156:159], v[128:131], a[20:23], 0
    s_nop 0
    ds_write_b128 v210, v[136:139] offset:0
    s_waitcnt vmcnt(10)
    v_mfma_f32_16x16x32_bf16 v[136:139], v[128:131], a[24:27], 0
    ds_write_b128 v210, v[140:143] offset:128
    v_mfma_f32_16x16x32_bf16 v[140:143], v[128:131], a[28:31], 0
    ds_write_b128 v210, v[144:147] offset:256
    s_waitcnt vmcnt(8)
    v_mfma_f32_16x16x32_bf16 v[144:147], v[128:131], a[32:35], 0
    ds_write_b128 v210, v[148:151] offset:384
    v_mfma_f32_16x16x32_bf16 v[148:151], v[128:131], a[36:39], 0
    ds_write_b128 v210, v[152:155] offset:512
    s_waitcnt vmcnt(6)
    v_mfma_f32_16x16x32_bf16 v[152:155], v[128:131], a[40:43], 0
    ds_write_b128 v210, v[156:159] offset:640
    v_mfma_f32_16x16x32_bf16 v[156:159], v[128:131], a[44:47], 0
    ds_write_b128 v210, v[136:139] offset:768
    s_waitcnt vmcnt(4)
    v_mfma_f32_16x16x32_bf16 v[136:139], v[128:131], a[48:51], 0
    ds_write_b128 v210, v[140:143] offset:896
    v_mfma_f32_16x16x32_bf16 v[140:143], v[128:131], a[52:55], 0
    ds_write_b128 v210, v[144:147] offset:1024
    s_waitcnt vmcnt(2)
    v_mfma_f32_16x16x32_bf16 v[144:147], v[128:131], a[56:59], 0
    ds_write_b128 v210, v[148:151] offset:1152
    v_mfma_f32_16x16x32_bf16 v[148:151], v[128:131], a[60:63], 0
    ds_write_b128 v210, v[152:155] offset:1280
    s_waitcnt vmcnt(0)
    v_mfma_f32_16x16x32_bf16 v[152:155], v[128:131], a[64:67], 0
    ds_write_b128 v210, v[156:159] offset:1408
    v_mfma_f32_16x16x32_bf16 v[156:159], v[128:131], a[212:215], 0
    ds_write_b128 v210, v[136:139] offset:1536
    ds_write_b128 v210, v[140:143] offset:1664
    ds_write_b128 v210, v[144:147] offset:1792
    ds_write_b128 v210, v[148:151] offset:1920
    s_nop 1
    ds_write_b128 v210, v[152:155] offset:2048
    s_nop 0
    ds_write_b128 v210, v[156:159] offset:2176
    s_waitcnt lgkmcnt(0)
    s_barrier
T_LN:
    ds_read_b128 v[0:3], v211 offset:0
    ds_read_b128 v[104:107], v211 offset:18944
    ds_read_b128 v[136:139], v211 offset:37888
    ds_read_b128 v[60:63], v211 offset:56832
    ds_read_b128 v[4:7], v211 offset:512
    ds_read_b128 v[108:111], v211 offset:19456
    ds_read_b128 v[140:143], v211 offset:38400
    ds_read_b128 v[64:67], v211 offset:57344
    ds_read_b128 v[8:11], v211 offset:1024
    ds_read_b128 v[112:115], v211 offset:19968
    ds_read_b128 v[144:147], v211 offset:38912
    ds_read_b128 v[68:71], v211 offset:57856
    ds_read_b128 v[12:15], v211 offset:1536
    ds_read_b128 v[116:119], v211 offset:20480
    ds_read_b128 v[148:151], v211 offset:39424
    ds_read_b128 v[72:75], v211 offset:58368
    ds_read_b128 v[16:19], v211 offset:2048
    ds_read_b128 v[120:123], v211 offset:20992
    ds_read_b128 v[152:155], v211 offset:39936
    ds_read_b128 v[76:79], v211 offset:58880
    s_waitcnt lgkmcnt(15)
    v_add_f32 v0, v0, v104
    v_add_f32 v136, v136, v60
    v_add_f32 v1, v1, v105
    v_add_f32 v137, v137, v61
    v_add_f32 v2, v2, v106
    v_add_f32 v138, v138, v62
    v_add_f32 v3, v3, v107
    v_add_f32 v139, v139, v63
    v_add_f32 v0, v0, v136
    v_add_f32 v1, v1, v137
    v_add_f32 v2, v2, v138
    v_add_f32 v3, v3, v139
    v_fmac_f32 v226, v0, v160
    v_fmac_f32 v227, v1, v161
    v_fmac_f32 v228, v2, v162
    v_fmac_f32 v229, v3, v163
    v_cvt_pk_bf16_f32 v200, v226, v227
    v_lshlrev_b32 v226, 16, v200
    v_and_b32 v227, 0xffff0000, v200
    v_cvt_pk_bf16_f32 v201, v228, v229
    v_lshlrev_b32 v228, 16, v201
    v_and_b32 v229, 0xffff0000, v201
    v_mul_f32 v211, v226, v226
    v_mul_f32 v212, v226, v84
    v_add_f32 v210, v226, v227
    v_fmac_f32 v211, v227, v227
    v_fmac_f32 v212, v227, v85
    v_add_f32 v210, v210, v228
    v_fmac_f32 v211, v228, v228
    v_fmac_f32 v212, v228, v86
    v_add_f32 v210, v210, v229
    v_fmac_f32 v211, v229, v229
    v_fmac_f32 v212, v229, v87
    s_waitcnt lgkmcnt(12)
    v_add_f32 v4, v4, v108
    v_add_f32 v140, v140, v64
    v_add_f32 v5, v5, v109
    v_add_f32 v141, v141, v65
    v_add_f32 v6, v6, v110
    v_add_f32 v142, v142, v66
    v_add_f32 v7, v7, v111
    v_add_f32 v143, v143, v67
    v_add_f32 v4, v4, v140
    v_add_f32 v5, v5, v141
    v_add_f32 v6, v6, v142
    v_add_f32 v7, v7, v143
    v_fmac_f32 v230, v4, v164
    v_fmac_f32 v231, v5, v165
    v_fmac_f32 v232, v6, v166
    v_fmac_f32 v233, v7, v167
    v_cvt_pk_bf16_f32 v202, v230, v231
    v_lshlrev_b32 v230, 16, v202
    v_and_b32 v231, 0xffff0000, v202
    v_cvt_pk_bf16_f32 v203, v232, v233
    v_lshlrev_b32 v232, 16, v203
    v_and_b32 v233, 0xffff0000, v203
    v_add_f32 v210, v210, v230
    v_fmac_f32 v211, v230, v230
    v_fmac_f32 v212, v230, v88
    v_add_f32 v210, v210, v231
    v_fmac_f32 v211, v231, v231
    v_fmac_f32 v212, v231, v89
    v_add_f32 v210, v210, v232
    v_fmac_f32 v211, v232, v232
    v_fmac_f32 v212, v232, v90
    v_add_f32 v210, v210, v233
    v_fmac_f32 v211, v233, v233
    v_fmac_f32 v212, v233, v91
    s_waitcnt lgkmcnt(8)
    v_add_f32 v8, v8, v112
    v_add_f32 v144, v144, v68
    v_add_f32 v9, v9, v113
    v_add_f32 v145, v145, v69
    v_add_f32 v10, v10, v114
    v_add_f32 v146, v146, v70
    v_add_f32 v11, v11, v115
    v_add_f32 v147, v147, v71
    v_add_f32 v8, v8, v144
    v_add_f32 v9, v9, v145
    v_add_f32 v10, v10, v146
    v_add_f32 v11, v11, v147
    v_fmac_f32 v234, v8, v168
    v_fmac_f32 v235, v9, v169
    v_fmac_f32 v236, v10, v170
    v_fmac_f32 v237, v11, v171
    v_cvt_pk_bf16_f32 v204, v234, v235
    v_lshlrev_b32 v234, 16, v204
    v_and_b32 v235, 0xffff0000, v204
    v_cvt_pk_bf16_f32 v205, v236, v237
    v_lshlrev_b32 v236, 16, v205
    v_and_b32 v237, 0xffff0000, v205
    v_add_f32 v210, v210, v234
    v_fmac_f32 v211, v234, v234
    v_fmac_f32 v212, v234, v92
    v_add_f32 v210, v210, v235
    v_fmac_f32 v211, v235, v235
    v_fmac_f32 v212, v235, v93
    v_add_f32 v210, v210, v236
    v_fmac_f32 v211, v236, v236
    v_fmac_f32 v212, v236, v94
    v_add_f32 v210, v210, v237
    v_fmac_f32 v211, v237, v237
    v_fmac_f32 v212, v237, v95
    s_waitcnt lgkmcnt(4)
    v_add_f32 v12, v12, v116
    v_add_f32 v148, v148, v72
    v_add_f32 v13, v13, v117
    v_add_f32 v149, v149, v73
    v_add_f32 v14, v14, v118
    v_add_f32 v150, v150, v74
    v_add_f32 v15, v15, v119
    v_add_f32 v151, v151, v75
    v_add_f32 v12, v12, v148
    v_add_f32 v13, v13, v149
    v_add_f32 v14, v14, v150
    v_add_f32 v15, v15, v151
    v_fmac_f32 v238, v12, v172
    v_fmac_f32 v239, v13, v173
    v_fmac_f32 v240, v14, v174
    v_fmac_f32 v241, v15, v175
    v_cvt_pk_bf16_f32 v206, v238, v239
    v_lshlrev_b32 v238, 16, v206
    v_and_b32 v239, 0xffff0000, v206
    v_cvt_pk_bf16_f32 v207, v240, v241
    v_lshlrev_b32 v240, 16, v207
    v_and_b32 v241, 0xffff0000, v207
    v_add_f32 v210, v210, v238
    v_fmac_f32 v211, v238, v238
    v_fmac_f32 v212, v238, v96
    v_add_f32 v210, v210, v239
    v_fmac_f32 v211, v239, v239
    v_fmac_f32 v212, v239, v97
    v_add_f32 v210, v210, v240
    v_fmac_f32 v211, v240, v240
    v_fmac_f32 v212, v240, v98
    v_add_f32 v210, v210, v241
    v_fmac_f32 v211, v241, v241
    v_fmac_f32 v212, v241, v99
    s_waitcnt lgkmcnt(0)
    s_mov_b32 exec_hi, 0
    v_add_f32 v16, v16, v120
    v_add_f32 v152, v152, v76
    v_add_f32 v17, v17, v121
    v_add_f32 v153, v153, v77
    v_add_f32 v18, v18, v122
    v_add_f32 v154, v154, v78
    v_add_f32 v19, v19, v123
    v_add_f32 v155, v155, v79
    v_add_f32 v16, v16, v152
    v_add_f32 v17, v17, v153
    v_add_f32 v18, v18, v154
    v_add_f32 v19, v19, v155
    v_fmac_f32 v242, v16, v176
    v_fmac_f32 v243, v17, v177
    v_fmac_f32 v244, v18, v178
    v_fmac_f32 v245, v19, v179
    v_cvt_pk_bf16_f32 v208, v242, v243
    v_lshlrev_b32 v242, 16, v208
    v_and_b32 v243, 0xffff0000, v208
    v_cvt_pk_bf16_f32 v209, v244, v245
    v_lshlrev_b32 v244, 16, v209
    v_and_b32 v245, 0xffff0000, v209
    v_add_f32 v210, v210, v242
    v_fmac_f32 v211, v242, v242
    v_fmac_f32 v212, v242, v100
    v_add_f32 v210, v210, v243
    v_fmac_f32 v211, v243, v243
    v_fmac_f32 v212, v243, v101
    v_add_f32 v210, v210, v244
    v_fmac_f32 v211, v244, v244
    v_fmac_f32 v212, v244, v102
    v_add_f32 v210, v210, v245
    v_fmac_f32 v211, v245, v245
    v_fmac_f32 v212, v245, v103
    s_mov_b32 exec_hi, -1
    s_nop 1
    v_add_f32_dpp v210, v210, v210 quad_perm:[1,0,3,2] row_mask:0xf bank_mask:0xf
    v_add_f32_dpp v211, v211, v211 quad_perm:[1,0,3,2] row_mask:0xf bank_mask:0xf
    v_add_f32_dpp v212, v212, v212 quad_perm:[1,0,3,2] row_mask:0xf bank_mask:0xf
    v_add_f32_dpp v210, v210, v210 quad_perm:[2,3,0,1] row_mask:0xf bank_mask:0xf
    v_add_f32_dpp v211, v211, v211 quad_perm:[2,3,0,1] row_mask:0xf bank_mask:0xf
    v_add_f32_dpp v212, v212, v212 quad_perm:[2,3,0,1] row_mask:0xf bank_mask:0xf
    v_add_f32_dpp v210, v210, v210 row_ror:8 row_mask:0xf bank_mask:0xf
    v_add_f32_dpp v211, v211, v211 row_ror:8 row_mask:0xf bank_mask:0xf
    v_add_f32_dpp v212, v212, v212 row_ror:8 row_mask:0xf bank_mask:0xf
    v_mov_b32 v213, v210
    v_mov_b32 v214, v211
    v_mov_b32 v215, v212
    v_permlane16_swap_b32 v213, v210
    v_permlane16_swap_b32 v214, v211
    v_permlane16_swap_b32 v215, v212
    v_add_f32 v210, v210, v213
    v_add_f32 v211, v211, v214
    v_add_f32 v212, v212, v215
    v_mov_b32 v213, v210
    v_mov_b32 v214, v211
    v_mov_b32 v215, v212
    v_permlane32_swap_b32 v213, v210
    v_permlane32_swap_b32 v214, v211
    v_permlane32_swap_b32 v215, v212
    v_add_f32 v210, v210, v213
    v_add_f32 v211, v211, v214
    v_add_f32 v212, v212, v215
    v_mul_f32 v210, 0x3ae38e39, v210
    v_mul_f32 v211, 0x3ae38e39, v211
    v_fma_f32 v211, -v210, v210, v211
    v_max_f32 v211, 0, v211
    v_cvt_pk_bf16_f32 v213, v210, v211
    v_lshlrev_b32 v210, 16, v213
    v_and_b32 v211, 0xffff0000, v213
    v_add_f32 v211, 0x3727c5ac, v211
    v_cvt_pk_bf16_f32 v211, v211, v211
    v_and_b32 v211, 0xffff0000, v211
    v_sqrt_f32 v211, v211
    v_fma_f32 v212, -v210, v124, v212
    v_cvt_pk_bf16_f32 v211, v211, v211
    v_and_b32 v211, 0xffff0000, v211
    v_rcp_f32 v211, v211
    s_nop 0
    v_fma_f32 v212, v212, v211, v125
    v_ashrrev_i32 v213, 31, v212
    v_or_b32 v213, 0x80000000, v213
    v_xor_b32 v212, v212, v213
    v_and_b32 v212, 0xfffff800, v212
    v_or_b32 v254, v254, v212
    ds_write_b64 v219, v[254:255]
    s_waitcnt lgkmcnt(0)
    s_barrier
    s_cmp_lg_u32 s40, 0
    s_cbranch_scc1 T_NOKEY
    s_mov_b64 exec, 0xf
    v_add_u32 v219, 120960, v225
    ds_read_b128 v[214:217], v219
    s_waitcnt lgkmcnt(0)
    buffer_store_dwordx4 v[214:217], v225, s[24:27], s33 offen sc1
    s_mov_b64 exec, -1
T_NOKEY:
    v_sub_f32 v0, v226, v210
    v_sub_f32 v1, v227, v210
    v_sub_f32 v2, v228, v210
    v_sub_f32 v3, v229, v210
    v_sub_f32 v4, v230, v210
    v_sub_f32 v5, v231, v210
    v_sub_f32 v6, v232, v210
    v_sub_f32 v7, v233, v210
    v_sub_f32 v8, v234, v210
    v_sub_f32 v9, v235, v210
    v_sub_f32 v10, v236, v210
    v_sub_f32 v11, v237, v210
    v_sub_f32 v12, v238, v210
    v_sub_f32 v13, v239, v210
    v_sub_f32 v14, v240, v210
    v_sub_f32 v15, v241, v210
    v_sub_f32 v16, v242, v210
    v_sub_f32 v17, v243, v210
    v_sub_f32 v18, v244, v210
    v_sub_f32 v19, v245, v210
    v_mul_f32 v0, v0, v211
    v_mul_f32 v1, v1, v211
    v_mul_f32 v2, v2, v211
    v_mul_f32 v3, v3, v211
    v_mul_f32 v4, v4, v211
    v_mul_f32 v5, v5, v211
    v_mul_f32 v6, v6, v211
    v_mul_f32 v7, v7, v211
    v_mul_f32 v8, v8, v211
    v_mul_f32 v9, v9, v211
    v_mul_f32 v10, v10, v211
    v_mul_f32 v11, v11, v211
    v_mul_f32 v12, v12, v211
    v_mul_f32 v13, v13, v211
    v_mul_f32 v14, v14, v211
    v_mul_f32 v15, v15, v211
    v_mul_f32 v16, v16, v211
    v_mul_f32 v17, v17, v211
    v_mul_f32 v18, v18, v211
    v_mul_f32 v19, v19, v211
    v_fma_f32 v0, v0, v20, v180
    v_fma_f32 v1, v1, v21, v181
    v_fma_f32 v2, v2, v22, v182
    v_fma_f32 v3, v3, v23, v183
    v_fma_f32 v4, v4, v24, v184
    v_fma_f32 v5, v5, v25, v185
    v_fma_f32 v6, v6, v26, v186
    v_fma_f32 v7, v7, v27, v187
    v_fma_f32 v8, v8, v28, v188
    v_fma_f32 v9, v9, v29, v189
    v_fma_f32 v10, v10, v30, v190
    v_fma_f32 v11, v11, v31, v191
    v_fma_f32 v12, v12, v32, v192
    v_fma_f32 v13, v13, v33, v193
    v_fma_f32 v14, v14, v34, v194
    v_fma_f32 v15, v15, v35, v195
    v_fma_f32 v16, v16, v36, v196
    v_fma_f32 v17, v17, v37, v197
    v_fma_f32 v18, v18, v38, v198
    v_fma_f32 v19, v19, v39, v199
    v_cvt_pk_bf16_f32 v64, v0, v1
    v_cvt_pk_bf16_f32 v65, v2, v3
    v_cvt_pk_bf16_f32 v66, v4, v5
    v_cvt_pk_bf16_f32 v67, v6, v7
    v_cvt_pk_bf16_f32 v68, v8, v9
    v_cvt_pk_bf16_f32 v69, v10, v11
    v_cvt_pk_bf16_f32 v70, v12, v13
    v_cvt_pk_bf16_f32 v71, v14, v15
    v_cvt_pk_bf16_f32 v72, v16, v17
    v_cvt_pk_bf16_f32 v73, v18, v19
    s_add_u32 s33, s29, 4784128
    buffer_store_dwordx2 v[64:65], v250, s[24:27], s33 offen offset:0 sc1
    buffer_store_dwordx2 v[66:67], v250, s[24:27], s33 offen offset:256 sc1
    buffer_store_dwordx2 v[68:69], v250, s[24:27], s33 offen offset:512 sc1
    buffer_store_dwordx2 v[70:71], v250, s[24:27], s33 offen offset:768 sc1
    s_mov_b32 exec_hi, 0
    buffer_store_dwordx2 v[72:73], v250, s[24:27], s33 offen offset:1024 sc1
    s_mov_b64 exec, -1
    s_lshl_b32 s30, s40, 12
    s_add_u32 s30, s30, 2424832
    s_add_u32 s34, s30, 4096
    v_and_b32 v219, 0x3c0, v225
    v_add_u32 v219, v219, v225
    buffer_load_dwordx4 v[104:107], v225, s[24:27], s30 offen offset:0 sc1
    buffer_load_dwordx4 v[108:111], v225, s[24:27], s30 offen offset:1024 sc1
    buffer_load_dwordx4 v[112:115], v225, s[24:27], s30 offen offset:2048 sc1
    buffer_load_dwordx4 v[116:119], v225, s[24:27], s30 offen offset:3072 sc1
    ds_read_b64_tr_b16 a[0:1], v251 offset:0
    ds_read_b64_tr_b16 a[2:3], v251 offset:256
    ds_read_b64_tr_b16 a[4:5], v251 offset:2048
    ds_read_b64_tr_b16 a[6:7], v251 offset:2304
    ds_read_b64_tr_b16 a[8:9], v251 offset:4096
    ds_read_b64_tr_b16 a[10:11], v251 offset:4352
    ds_read_b64_tr_b16 a[12:13], v251 offset:6144
    ds_read_b64_tr_b16 a[14:15], v251 offset:6400
    ds_read_b64_tr_b16 a[16:17], v251 offset:8192
    ds_read_b64_tr_b16 a[18:19], v251 offset:8448
    ds_read_b64_tr_b16 a[20:21], v251 offset:32
    ds_read_b64_tr_b16 a[22:23], v251 offset:288
    ds_read_b64_tr_b16 a[24:25], v251 offset:2080
    ds_read_b64_tr_b16 a[26:27], v251 offset:2336
    ds_read_b64_tr_b16 a[28:29], v251 offset:4128
    ds_read_b64_tr_b16 a[30:31], v251 offset:4384
    ds_read_b64_tr_b16 a[32:33], v251 offset:6176
    ds_read_b64_tr_b16 a[34:35], v251 offset:6432
    ds_read_b64_tr_b16 a[36:37], v251 offset:8224
    ds_read_b64_tr_b16 a[38:39], v251 offset:8480
    ds_read_b64_tr_b16 a[40:41], v224 offset:0
    ds_read_b64_tr_b16 a[42:43], v224 offset:256
    ds_read_b64_tr_b16 a[44:45], v224 offset:2048
    ds_read_b64_tr_b16 a[46:47], v224 offset:2304
    ds_read_b64_tr_b16 a[48:49], v224 offset:4096
    ds_read_b64_tr_b16 a[50:51], v224 offset:4352
    ds_read_b64_tr_b16 a[52:53], v224 offset:6144
    ds_read_b64_tr_b16 a[54:55], v224 offset:6400
    ds_read_b64_tr_b16 a[56:57], v224 offset:8192
    ds_read_b64_tr_b16 a[58:59], v224 offset:8448
    ds_read_b64_tr_b16 a[60:61], v224 offset:32
    ds_read_b64_tr_b16 a[62:63], v224 offset:288
    ds_read_b64_tr_b16 a[64:65], v224 offset:2080
    ds_read_b64_tr_b16 a[66:67], v224 offset:2336
    ds_read_b64_tr_b16 a[68:69], v224 offset:4128
    ds_read_b64_tr_b16 a[70:71], v224 offset:4384
    ds_read_b64_tr_b16 a[72:73], v224 offset:6176
    ds_read_b64_tr_b16 a[74:75], v224 offset:6432
    ds_read_b64_tr_b16 a[76:77], v224 offset:8224
    ds_read_b64_tr_b16 a[78:79], v224 offset:8480
    v_lshlrev_b32 v0, 16, v64
    v_and_b32 v1, 0xffff0000, v64
    v_lshlrev_b32 v2, 16, v65
    v_and_b32 v3, 0xffff0000, v65
    v_lshlrev_b32 v4, 16, v66
    v_and_b32 v5, 0xffff0000, v66
    v_lshlrev_b32 v6, 16, v67
    v_and_b32 v7, 0xffff0000, v67
    v_lshlrev_b32 v8, 16, v68
    v_and_b32 v9, 0xffff0000, v68
    v_lshlrev_b32 v10, 16, v69
    v_and_b32 v11, 0xffff0000, v69
    v_lshlrev_b32 v12, 16, v70
    v_and_b32 v13, 0xffff0000, v70
    v_lshlrev_b32 v14, 16, v71
    v_and_b32 v15, 0xffff0000, v71
    v_lshlrev_b32 v16, 16, v72
    v_and_b32 v17, 0xffff0000, v72
    v_lshlrev_b32 v18, 16, v73
    v_and_b32 v19, 0xffff0000, v73
    v_mul_f32 v0, v0, v40
    v_mul_f32 v1, v1, v41
    v_mul_f32 v2, v2, v42
    v_mul_f32 v3, v3, v43
    v_mul_f32 v4, v4, v44
    v_mul_f32 v5, v5, v45
    v_mul_f32 v6, v6, v46
    v_mul_f32 v7, v7, v47
    v_mul_f32 v8, v8, v48
    v_mul_f32 v9, v9, v49
    v_mul_f32 v10, v10, v50
    v_mul_f32 v11, v11, v51
    v_mul_f32 v12, v12, v52
    v_mul_f32 v13, v13, v53
    v_mul_f32 v14, v14, v54
    v_mul_f32 v15, v15, v55
    v_mul_f32 v16, v16, v56
    v_mul_f32 v17, v17, v57
    v_mul_f32 v18, v18, v58
    v_mul_f32 v19, v19, v59
    v_cvt_pk_bf16_f32 v213, v0, v1
    v_lshlrev_b32 v0, 16, v213
    v_and_b32 v1, 0xffff0000, v213
    v_cvt_pk_bf16_f32 v213, v2, v3
    v_lshlrev_b32 v2, 16, v213
    v_and_b32 v3, 0xffff0000, v213
    v_cvt_pk_bf16_f32 v213, v4, v5
    v_lshlrev_b32 v4, 16, v213
    v_and_b32 v5, 0xffff0000, v213
    v_cvt_pk_bf16_f32 v213, v6, v7
    v_lshlrev_b32 v6, 16, v213
    v_and_b32 v7, 0xffff0000, v213
    v_cvt_pk_bf16_f32 v213, v8, v9
    v_lshlrev_b32 v8, 16, v213
    v_and_b32 v9, 0xffff0000, v213
    v_cvt_pk_bf16_f32 v213, v10, v11
    v_lshlrev_b32 v10, 16, v213
    v_and_b32 v11, 0xffff0000, v213
    v_cvt_pk_bf16_f32 v213, v12, v13
    v_lshlrev_b32 v12, 16, v213
    v_and_b32 v13, 0xffff0000, v213
    v_cvt_pk_bf16_f32 v213, v14, v15
    v_lshlrev_b32 v14, 16, v213
    v_and_b32 v15, 0xffff0000, v213
    v_cvt_pk_bf16_f32 v213, v16, v17
    v_lshlrev_b32 v16, 16, v213
    v_and_b32 v17, 0xffff0000, v213
    v_cvt_pk_bf16_f32 v213, v18, v19
    v_lshlrev_b32 v18, 16, v213
    v_and_b32 v19, 0xffff0000, v213
    v_add_f32 v0, v0, v226
    v_add_f32 v1, v1, v227
    v_add_f32 v2, v2, v228
    v_add_f32 v3, v3, v229
    v_add_f32 v4, v4, v230
    v_add_f32 v5, v5, v231
    v_add_f32 v6, v6, v232
    v_add_f32 v7, v7, v233
    v_add_f32 v8, v8, v234
    v_add_f32 v9, v9, v235
    v_add_f32 v10, v10, v236
    v_add_f32 v11, v11, v237
    v_add_f32 v12, v12, v238
    v_add_f32 v13, v13, v239
    v_add_f32 v14, v14, v240
    v_add_f32 v15, v15, v241
    v_add_f32 v16, v16, v242
    v_add_f32 v17, v17, v243
    v_add_f32 v18, v18, v244
    v_add_f32 v19, v19, v245
    v_cvt_pk_bf16_f32 v190, v0, v1
    v_cvt_pk_bf16_f32 v191, v2, v3
    v_cvt_pk_bf16_f32 v192, v4, v5
    v_cvt_pk_bf16_f32 v193, v6, v7
    v_cvt_pk_bf16_f32 v194, v8, v9
    v_cvt_pk_bf16_f32 v195, v10, v11
    v_cvt_pk_bf16_f32 v196, v12, v13
    v_cvt_pk_bf16_f32 v197, v14, v15
    v_cvt_pk_bf16_f32 v198, v16, v17
    v_cvt_pk_bf16_f32 v199, v18, v19
    v_and_b32 v4, 7, v246
    v_lshlrev_b32 v97, 3, v4
    v_lshlrev_b32 v96, 4, v4
    v_lshl_add_u32 v93, v248, 7, v96
    s_lshl_b32 s35, s40, 9
    s_add_u32 s35, s35, 112640
    v_add_u32 v92, s35, v93
    v_bfe_u32 v4, v246, 3, 1
    v_lshl_add_u32 v93, v4, 11, v93
    v_add_u32 v93, 112640, v93
    v_lshrrev_b32 v94, 2, v246
    v_mul_u32_u24 v94, 1152, v94
    v_and_b32 v4, 3, v246
    v_lshl_add_u32 v94, v4, 3, v94
    s_lshl_b32 s35, s40, 6
    s_add_u32 s35, s35, 36864
    v_add_u32 v94, s35, v94
    v_mul_u32_u24 v95, 144, v96
    v_lshl_add_u32 v95, v248, 4, v95
    v_bfe_u32 v4, v246, 3, 1
    v_lshl_add_u32 v95, v4, 6, v95
    s_mul_i32 s32, s100, 18432
    s_lshl_b32 s31, s40, 7
    s_add_u32 s32, s32, s31
    s_add_u32 s32, s32, 7143424
    v_and_b32 v4, 1, v246
    v_cmp_ne_u32 s[56:57], 0, v4
    v_and_b32 v4, 2, v246
    v_cmp_ne_u32 s[58:59], 0, v4
    v_and_b32 v4, 4, v246
    v_cmp_ne_u32 s[60:61], 0, v4
    s_lshl_b32 s35, s40, 5
    s_add_u32 s35, s35, 120832
    v_mov_b32 v10, s35
    v_mov_b32 v11, 120832
    s_mov_b32 s101, 200000
T_POLL2:
    buffer_load_dwordx4 v[136:139], v225, s[24:27], s30 offen offset:0 sc1
    buffer_load_dwordx4 v[140:143], v225, s[24:27], s30 offen offset:1024 sc1
    buffer_load_dwordx4 v[144:147], v225, s[24:27], s30 offen offset:2048 sc1
    buffer_load_dwordx4 v[148:151], v225, s[24:27], s30 offen offset:3072 sc1
    s_waitcnt vmcnt(4)
    v_min3_u32 v4, v105, v107, v109
    v_max3_u32 v5, v105, v107, v109
    v_min3_u32 v4, v4, v111, v113
    v_max3_u32 v5, v5, v111, v113
    v_min3_u32 v4, v4, v115, v117
    v_max3_u32 v5, v5, v115, v117
    v_min_u32 v4, v4, v119
    v_max_u32 v5, v5, v119
    v_cmp_ne_u32 vcc, s54, v4
    v_cmp_ne_u32 s[44:45], s54, v5
    s_or_b64 vcc, vcc, s[44:45]
    s_cbranch_vccz T_K104
    buffer_load_dwordx4 v[104:107], v225, s[24:27], s30 offen offset:0 sc1
    buffer_load_dwordx4 v[108:111], v225, s[24:27], s30 offen offset:1024 sc1
    buffer_load_dwordx4 v[112:115], v225, s[24:27], s30 offen offset:2048 sc1
    buffer_load_dwordx4 v[116:119], v225, s[24:27], s30 offen offset:3072 sc1
    s_waitcnt vmcnt(4)
    v_min3_u32 v4, v137, v139, v141
    v_max3_u32 v5, v137, v139, v141
    v_min3_u32 v4, v4, v143, v145
    v_max3_u32 v5, v5, v143, v145
    v_min3_u32 v4, v4, v147, v149
    v_max3_u32 v5, v5, v147, v149
    v_min_u32 v4, v4, v151
    v_max_u32 v5, v5, v151
    v_cmp_ne_u32 vcc, s54, v4
    v_cmp_ne_u32 s[44:45], s54, v5
    s_or_b64 vcc, vcc, s[44:45]
    s_sub_u32 s101, s101, 1
    s_cselect_b64 vcc, 0, vcc
    s_cbranch_vccnz T_POLL2
    v_mov_b32 v168, v136
    v_mov_b32 v170, v138
    v_mov_b32 v172, v140
    v_mov_b32 v174, v142
    v_mov_b32 v176, v144
    v_mov_b32 v178, v146
    v_mov_b32 v180, v148
    v_mov_b32 v182, v150
    s_branch T_KDONE
T_K104:
    v_mov_b32 v168, v104
    v_mov_b32 v170, v106
    v_mov_b32 v172, v108
    v_mov_b32 v174, v110
    v_mov_b32 v176, v112
    v_mov_b32 v178, v114
    v_mov_b32 v180, v116
    v_mov_b32 v182, v118
T_KDONE:
    v_max_u32 v39, v168, v170
    v_min_u32 v170, v168, v170
    v_max_u32 v38, v172, v174
    v_min_u32 v174, v172, v174
    v_max_u32 v37, v176, v178
    v_min_u32 v178, v176, v178
    v_max_u32 v36, v180, v182
    v_min_u32 v182, v180, v182
    v_max_u32 v35, v39, v38
    v_min_u32 v38, v39, v38
    v_max_u32 v34, v170, v174
    v_min_u32 v174, v170, v174
    v_max_u32 v33, v37, v36
    v_min_u32 v36, v37, v36
    v_max_u32 v32, v178, v182
    v_min_u32 v182, v178, v182
    v_max_u32 v31, v34, v38
    v_min_u32 v38, v34, v38
    v_max_u32 v30, v32, v36
    v_min_u32 v36, v32, v36
    v_max_u32 v29, v35, v33
    v_min_u32 v33, v35, v33
    v_max_u32 v28, v174, v182
    v_min_u32 v182, v174, v182
    v_max_u32 v27, v31, v30
    v_min_u32 v30, v31, v30
    v_max_u32 v26, v38, v36
    v_min_u32 v36, v38, v36
    v_max_u32 v25, v27, v33
    v_min_u32 v33, v27, v33
    v_max_u32 v24, v28, v36
    v_min_u32 v36, v28, v36
    v_max_u32 v168, v26, v33
    v_min_u32 v33, v26, v33
    v_max_u32 v172, v24, v30
    v_min_u32 v30, v24, v30
    v_max_u32 v176, v172, v33
    v_min_u32 v33, v172, v33
    s_nop 1
    v_max_u32_dpp v180, v182, v29 quad_perm:[1,0,3,2] row_mask:0xf bank_mask:0xf
    v_max_u32_dpp v39, v36, v25 quad_perm:[1,0,3,2] row_mask:0xf bank_mask:0xf
    v_max_u32_dpp v170, v30, v168 quad_perm:[1,0,3,2] row_mask:0xf bank_mask:0xf
    v_max_u32_dpp v37, v33, v176 quad_perm:[1,0,3,2] row_mask:0xf bank_mask:0xf
    v_max_u32_dpp v178, v176, v33 quad_perm:[1,0,3,2] row_mask:0xf bank_mask:0xf
    v_max_u32_dpp v34, v168, v30 quad_perm:[1,0,3,2] row_mask:0xf bank_mask:0xf
    v_max_u32_dpp v32, v25, v36 quad_perm:[1,0,3,2] row_mask:0xf bank_mask:0xf
    v_max_u32_dpp v35, v29, v182 quad_perm:[1,0,3,2] row_mask:0xf bank_mask:0xf
    v_max_u32 v174, v180, v178
    v_min_u32 v178, v180, v178
    v_max_u32 v31, v39, v34
    v_min_u32 v34, v39, v34
    v_max_u32 v38, v170, v32
    v_min_u32 v32, v170, v32
    v_max_u32 v27, v37, v35
    v_min_u32 v35, v37, v35
    v_max_u32 v28, v174, v38
    v_min_u32 v38, v174, v38
    v_max_u32 v26, v31, v27
    v_min_u32 v27, v31, v27
    v_max_u32 v24, v178, v32
    v_min_u32 v32, v178, v32
    v_max_u32 v172, v34, v35
    v_min_u32 v35, v34, v35
    v_max_u32 v182, v28, v26
    v_min_u32 v26, v28, v26
    v_max_u32 v36, v38, v27
    v_min_u32 v27, v38, v27
    v_max_u32 v30, v24, v172
    v_min_u32 v172, v24, v172
    v_max_u32 v33, v32, v35
    v_min_u32 v35, v32, v35
    s_nop 1
    v_max_u32_dpp v176, v35, v182 quad_perm:[2,3,0,1] row_mask:0xf bank_mask:0xf
    v_max_u32_dpp v168, v33, v26 quad_perm:[2,3,0,1] row_mask:0xf bank_mask:0xf
    v_max_u32_dpp v25, v172, v36 quad_perm:[2,3,0,1] row_mask:0xf bank_mask:0xf
    v_max_u32_dpp v29, v30, v27 quad_perm:[2,3,0,1] row_mask:0xf bank_mask:0xf
    v_max_u32_dpp v180, v27, v30 quad_perm:[2,3,0,1] row_mask:0xf bank_mask:0xf
    v_max_u32_dpp v39, v36, v172 quad_perm:[2,3,0,1] row_mask:0xf bank_mask:0xf
    v_max_u32_dpp v170, v26, v33 quad_perm:[2,3,0,1] row_mask:0xf bank_mask:0xf
    v_max_u32_dpp v37, v182, v35 quad_perm:[2,3,0,1] row_mask:0xf bank_mask:0xf
    v_max_u32 v174, v176, v180
    v_min_u32 v180, v176, v180
    v_max_u32 v31, v168, v39
    v_min_u32 v39, v168, v39
    v_max_u32 v178, v25, v170
    v_min_u32 v170, v25, v170
    v_max_u32 v34, v29, v37
    v_min_u32 v37, v29, v37
    v_max_u32 v28, v174, v178
    v_min_u32 v178, v174, v178
    v_max_u32 v38, v31, v34
    v_min_u32 v34, v31, v34
    v_max_u32 v24, v180, v170
    v_min_u32 v170, v180, v170
    v_max_u32 v32, v39, v37
    v_min_u32 v37, v39, v37
    v_max_u32 v35, v28, v38
    v_min_u32 v38, v28, v38
    v_max_u32 v33, v178, v34
    v_min_u32 v34, v178, v34
    v_max_u32 v172, v24, v32
    v_min_u32 v32, v24, v32
    v_max_u32 v30, v170, v37
    v_min_u32 v37, v170, v37
    s_nop 1
    v_max_u32_dpp v27, v37, v35 row_half_mirror row_mask:0xf bank_mask:0xf
    v_max_u32_dpp v36, v30, v38 row_half_mirror row_mask:0xf bank_mask:0xf
    v_max_u32_dpp v26, v32, v33 row_half_mirror row_mask:0xf bank_mask:0xf
    v_max_u32_dpp v182, v172, v34 row_half_mirror row_mask:0xf bank_mask:0xf
    v_max_u32_dpp v176, v34, v172 row_half_mirror row_mask:0xf bank_mask:0xf
    v_max_u32_dpp v168, v33, v32 row_half_mirror row_mask:0xf bank_mask:0xf
    v_max_u32_dpp v25, v38, v30 row_half_mirror row_mask:0xf bank_mask:0xf
    v_max_u32_dpp v29, v35, v37 row_half_mirror row_mask:0xf bank_mask:0xf
    v_max_u32 v174, v27, v176
    v_min_u32 v176, v27, v176
    v_max_u32 v31, v36, v168
    v_min_u32 v168, v36, v168
    v_max_u32 v180, v26, v25
    v_min_u32 v25, v26, v25
    v_max_u32 v39, v182, v29
    v_min_u32 v29, v182, v29
    v_max_u32 v28, v174, v180
    v_min_u32 v180, v174, v180
    v_max_u32 v178, v31, v39
    v_min_u32 v39, v31, v39
    v_max_u32 v24, v176, v25
    v_min_u32 v25, v176, v25
    v_max_u32 v170, v168, v29
    v_min_u32 v29, v168, v29
    v_max_u32 v37, v28, v178
    v_min_u32 v178, v28, v178
    v_max_u32 v30, v180, v39
    v_min_u32 v39, v180, v39
    v_max_u32 v32, v24, v170
    v_min_u32 v170, v24, v170
    v_max_u32 v172, v25, v29
    v_min_u32 v29, v25, v29
    s_nop 1
    v_max_u32_dpp v34, v29, v37 row_mirror row_mask:0xf bank_mask:0xf
    v_max_u32_dpp v33, v172, v178 row_mirror row_mask:0xf bank_mask:0xf
    v_max_u32_dpp v38, v170, v30 row_mirror row_mask:0xf bank_mask:0xf
    v_max_u32_dpp v35, v32, v39 row_mirror row_mask:0xf bank_mask:0xf
    v_max_u32_dpp v27, v39, v32 row_mirror row_mask:0xf bank_mask:0xf
    v_max_u32_dpp v36, v30, v170 row_mirror row_mask:0xf bank_mask:0xf
    v_max_u32_dpp v26, v178, v172 row_mirror row_mask:0xf bank_mask:0xf
    v_max_u32_dpp v182, v37, v29 row_mirror row_mask:0xf bank_mask:0xf
    v_max_u32 v174, v34, v27
    v_min_u32 v27, v34, v27
    v_max_u32 v31, v33, v36
    v_min_u32 v36, v33, v36
    v_max_u32 v176, v38, v26
    v_min_u32 v26, v38, v26
    v_max_u32 v168, v35, v182
    v_min_u32 v182, v35, v182
    v_max_u32 v28, v174, v176
    v_min_u32 v176, v174, v176
    v_max_u32 v180, v31, v168
    v_min_u32 v168, v31, v168
    v_max_u32 v24, v27, v26
    v_min_u32 v26, v27, v26
    v_max_u32 v25, v36, v182
    v_min_u32 v182, v36, v182
    v_max_u32 v29, v28, v180
    v_min_u32 v180, v28, v180
    v_max_u32 v172, v176, v168
    v_min_u32 v168, v176, v168
    v_max_u32 v170, v24, v25
    v_min_u32 v25, v24, v25
    v_max_u32 v32, v26, v182
    v_min_u32 v182, v26, v182
    v_mov_b32 v39, v29
    v_mov_b32 v30, v180
    v_mov_b32 v178, v172
    v_mov_b32 v37, v168
    v_mov_b32 v34, v170
    v_mov_b32 v33, v25
    v_mov_b32 v38, v32
    v_mov_b32 v35, v182
    s_nop 0
    v_permlane16_swap_b32 v29, v39
    v_permlane16_swap_b32 v180, v30
    v_permlane16_swap_b32 v172, v178
    v_permlane16_swap_b32 v168, v37
    v_permlane16_swap_b32 v170, v34
    v_permlane16_swap_b32 v25, v33
    v_permlane16_swap_b32 v32, v38
    v_permlane16_swap_b32 v182, v35
    v_max_u32 v29, v29, v35
    v_max_u32 v180, v180, v38
    v_max_u32 v172, v172, v33
    v_max_u32 v168, v168, v34
    v_max_u32 v170, v170, v37
    v_max_u32 v25, v25, v178
    v_max_u32 v32, v32, v30
    v_max_u32 v182, v182, v39
    v_max_u32 v174, v29, v170
    v_min_u32 v170, v29, v170
    v_max_u32 v31, v180, v25
    v_min_u32 v25, v180, v25
    v_max_u32 v27, v172, v32
    v_min_u32 v32, v172, v32
    v_max_u32 v36, v168, v182
    v_min_u32 v182, v168, v182
    v_max_u32 v28, v174, v27
    v_min_u32 v27, v174, v27
    v_max_u32 v176, v31, v36
    v_min_u32 v36, v31, v36
    v_max_u32 v24, v170, v32
    v_min_u32 v32, v170, v32
    v_max_u32 v26, v25, v182
    v_min_u32 v182, v25, v182
    v_max_u32 v35, v28, v176
    v_min_u32 v176, v28, v176
    v_max_u32 v38, v27, v36
    v_min_u32 v36, v27, v36
    v_max_u32 v33, v24, v26
    v_min_u32 v26, v24, v26
    v_max_u32 v34, v32, v182
    v_min_u32 v182, v32, v182
    v_mov_b32 v37, v35
    v_mov_b32 v178, v176
    v_mov_b32 v30, v38
    v_mov_b32 v39, v36
    v_mov_b32 v29, v33
    v_mov_b32 v180, v26
    v_mov_b32 v172, v34
    v_mov_b32 v168, v182
    s_nop 0
    v_permlane32_swap_b32 v35, v37
    v_permlane32_swap_b32 v176, v178
    v_permlane32_swap_b32 v38, v30
    v_permlane32_swap_b32 v36, v39
    v_permlane32_swap_b32 v33, v29
    v_permlane32_swap_b32 v26, v180
    v_permlane32_swap_b32 v34, v172
    v_permlane32_swap_b32 v182, v168
    v_max_u32 v35, v35, v168
    v_max_u32 v176, v176, v172
    v_max_u32 v38, v38, v180
    v_max_u32 v36, v36, v29
    v_max_u32 v33, v33, v39
    v_max_u32 v26, v26, v30
    v_max_u32 v34, v34, v178
    v_max_u32 v182, v182, v37
    v_max_u32 v174, v35, v33
    v_min_u32 v33, v35, v33
    v_max_u32 v31, v176, v26
    v_min_u32 v26, v176, v26
    v_max_u32 v170, v38, v34
    v_min_u32 v34, v38, v34
    v_max_u32 v25, v36, v182
    v_min_u32 v182, v36, v182
    v_max_u32 v28, v174, v170
    v_min_u32 v170, v174, v170
    v_max_u32 v27, v31, v25
    v_min_u32 v25, v31, v25
    v_max_u32 v24, v33, v34
    v_min_u32 v34, v33, v34
    v_max_u32 v32, v26, v182
    v_min_u32 v182, v26, v182
    v_max_u32 v168, v28, v27
    v_min_u32 v27, v28, v27
    v_max_u32 v172, v170, v25
    v_min_u32 v25, v170, v25
    v_max_u32 v180, v24, v32
    v_min_u32 v32, v24, v32
    v_max_u32 v29, v34, v182
    v_min_u32 v182, v34, v182
    v_mov_b32 v40, v168
    v_mov_b32 v41, v27
    v_mov_b32 v42, v172
    v_mov_b32 v43, v25
    v_mov_b32 v44, v180
    v_mov_b32 v45, v32
    v_mov_b32 v46, v29
    v_mov_b32 v47, v182
    ds_write_b128 v10, v[40:43]
    ds_write_b128 v10, v[44:47] offset:16
    s_waitcnt lgkmcnt(0)
    s_barrier
    ds_read_b128 v[16:19], v11 offset:0
    ds_read_b128 v[20:23], v11 offset:16
    ds_read_b128 v[24:27], v11 offset:32
    ds_read_b128 v[28:31], v11 offset:48
    ds_read_b128 v[32:35], v11 offset:64
    ds_read_b128 v[36:39], v11 offset:80
    ds_read_b128 v[40:43], v11 offset:96
    ds_read_b128 v[44:47], v11 offset:112
    s_waitcnt lgkmcnt(0)
    v_max_u32 v16, v16, v31
    v_max_u32 v32, v32, v47
    v_max_u32 v17, v17, v30
    v_max_u32 v33, v33, v46
    v_max_u32 v18, v18, v29
    v_max_u32 v34, v34, v45
    v_max_u32 v19, v19, v28
    v_max_u32 v35, v35, v44
    v_max_u32 v20, v20, v27
    v_max_u32 v36, v36, v43
    v_max_u32 v21, v21, v26
    v_max_u32 v37, v37, v42
    v_max_u32 v22, v22, v25
    v_max_u32 v38, v38, v41
    v_max_u32 v23, v23, v24
    v_max_u32 v39, v39, v40
    v_max_u32 v31, v16, v20
    v_min_u32 v20, v16, v20
    v_max_u32 v30, v17, v21
    v_min_u32 v21, v17, v21
    v_max_u32 v29, v18, v22
    v_min_u32 v22, v18, v22
    v_max_u32 v28, v19, v23
    v_min_u32 v23, v19, v23
    v_max_u32 v27, v31, v29
    v_min_u32 v29, v31, v29
    v_max_u32 v26, v30, v28
    v_min_u32 v28, v30, v28
    v_max_u32 v25, v20, v22
    v_min_u32 v22, v20, v22
    v_max_u32 v24, v21, v23
    v_min_u32 v23, v21, v23
    v_max_u32 v16, v27, v26
    v_min_u32 v26, v27, v26
    v_max_u32 v17, v29, v28
    v_min_u32 v28, v29, v28
    v_max_u32 v18, v25, v24
    v_min_u32 v24, v25, v24
    v_max_u32 v19, v22, v23
    v_min_u32 v23, v22, v23
    v_max_u32 v47, v32, v36
    v_min_u32 v36, v32, v36
    v_max_u32 v46, v33, v37
    v_min_u32 v37, v33, v37
    v_max_u32 v45, v34, v38
    v_min_u32 v38, v34, v38
    v_max_u32 v44, v35, v39
    v_min_u32 v39, v35, v39
    v_max_u32 v43, v47, v45
    v_min_u32 v45, v47, v45
    v_max_u32 v42, v46, v44
    v_min_u32 v44, v46, v44
    v_max_u32 v41, v36, v38
    v_min_u32 v38, v36, v38
    v_max_u32 v40, v37, v39
    v_min_u32 v39, v37, v39
    v_max_u32 v32, v43, v42
    v_min_u32 v42, v43, v42
    v_max_u32 v33, v45, v44
    v_min_u32 v44, v45, v44
    v_max_u32 v34, v41, v40
    v_min_u32 v40, v41, v40
    v_max_u32 v35, v38, v39
    v_min_u32 v39, v38, v39
    v_max_u32 v48, v16, v39
    v_max_u32 v49, v26, v35
    v_max_u32 v50, v17, v40
    v_max_u32 v51, v28, v34
    v_max_u32 v52, v18, v44
    v_max_u32 v53, v24, v33
    v_max_u32 v54, v19, v42
    v_max_u32 v55, v23, v32
    v_cndmask_b32 v16, v48, v52, s[60:61]
    v_cndmask_b32 v17, v49, v53, s[60:61]
    v_cndmask_b32 v18, v50, v54, s[60:61]
    v_cndmask_b32 v19, v51, v55, s[60:61]
    v_cndmask_b32 v16, v16, v18, s[58:59]
    v_cndmask_b32 v17, v17, v19, s[58:59]
    v_cndmask_b32 v6, v16, v17, s[56:57]
    v_and_b32 v7, 0x7ff, v6
    v_sub_u32 v7, 2047, v7
    v_mul_u32_u24 v7, 1152, v7
    v_lshl_add_u32 v7, v248, 4, v7
    s_cmp_ge_u32 s2, 144
    s_cbranch_scc1 T_NOH
    buffer_load_dwordx4 v[112:115], v7, s[24:27], s62 offen offset:0 sc1
    buffer_load_dwordx4 v[116:119], v7, s[24:27], s62 offen offset:64 sc1
    buffer_load_dwordx4 v[120:123], v7, s[24:27], s62 offen offset:128 sc1
    buffer_load_dwordx4 v[124:127], v7, s[24:27], s62 offen offset:192 sc1
    buffer_load_dwordx4 v[128:131], v7, s[24:27], s55 offen offset:192 sc1
T_NOH:
    v_mov_b32 v4, -1
    v_cmp_eq_u32 s[44:45], v48, v254
    v_cmp_eq_u32 s[46:47], v49, v254
    v_cmp_eq_u32 s[48:49], v50, v254
    v_cmp_eq_u32 s[50:51], v51, v254
    v_cndmask_b32 v4, v4, 0, s[44:45]
    v_cndmask_b32 v4, v4, 1, s[46:47]
    v_cndmask_b32 v4, v4, 2, s[48:49]
    v_cndmask_b32 v4, v4, 3, s[50:51]
    v_cmp_eq_u32 s[44:45], v52, v254
    v_cmp_eq_u32 s[46:47], v53, v254
    v_cmp_eq_u32 s[48:49], v54, v254
    v_cmp_eq_u32 s[50:51], v55, v254
    v_cndmask_b32 v4, v4, 4, s[44:45]
    v_cndmask_b32 v4, v4, 5, s[46:47]
    v_cndmask_b32 v4, v4, 6, s[48:49]
    v_cndmask_b32 v4, v4, 7, s[50:51]
    v_cmp_ne_u32 s[36:37], -1, v4
    v_mul_u32_u24 v4, 1152, v4
    v_add_u32 v253, v4, v253
    s_cmp_lt_u32 s2, 144
    s_cbranch_scc1 T_MLP
    s_mov_b32 s30, 40960
    s_mov_b64 exec, s[36:37]
    s_cbranch_execz T_NOPUB9549
    buffer_store_dwordx2 v[200:201], v253, s[24:27], s30 offen offset:0 sc1
    buffer_store_dwordx2 v[202:203], v253, s[24:27], s30 offen offset:256 sc1
    buffer_store_dwordx2 v[204:205], v253, s[24:27], s30 offen offset:512 sc1
    buffer_store_dwordx2 v[206:207], v253, s[24:27], s30 offen offset:768 sc1
    s_mov_b32 exec_hi, 0
    buffer_store_dwordx2 v[208:209], v253, s[24:27], s30 offen offset:1024 sc1
    s_mov_b64 exec, -1
T_NOPUB9549:
    s_mov_b64 exec, -1
    s_not_b64 exec, s[36:37]
    s_cbranch_execz T_NOOUT9561
    buffer_store_dwordx2 v[190:191], v250, s[16:19], s29 offen offset:0
    buffer_store_dwordx2 v[192:193], v250, s[16:19], s29 offen offset:256
    buffer_store_dwordx2 v[194:195], v250, s[16:19], s29 offen offset:512
    buffer_store_dwordx2 v[196:197], v250, s[16:19], s29 offen offset:768
    s_mov_b32 exec_hi, 0
    buffer_store_dwordx2 v[198:199], v250, s[16:19], s29 offen offset:1024
    s_mov_b64 exec, -1
T_NOOUT9561:
    s_mov_b64 exec, -1
    s_branch K2_FIN
T_MLP:
    ds_write_b128 v223, a[108:111] offset:36864
    ds_write_b128 v223, a[112:115] offset:37888
    ds_write_b128 v223, a[116:119] offset:38912
    ds_write_b128 v223, a[120:123] offset:39936
    ds_write_b128 v223, a[192:195] offset:40960
    ds_write_b128 v223, a[196:199] offset:41984
    ds_write_b128 v223, a[200:203] offset:43008
    ds_write_b128 v223, a[204:207] offset:44032
    ds_write_b128 v223, a[208:211] offset:45056
    s_mul_i32 s28, s2, 3641
    s_lshr_b32 s28, s28, 16
    s_mul_i32 s34, s28, 18
    s_sub_u32 s34, s2, s34
    v_readlane_b32 s38, v6, s28
    s_lshl_b32 s33, s34, 6
    s_mul_i32 s43, s28, 1152
    s_add_u32 s43, s43, s33
    s_add_u32 s43, s43, 40960
    s_and_b32 s39, s38, 0x7ff
    s_sub_u32 s39, 2047, s39
    s_mul_i32 s39, s39, 1152
    s_add_u32 s39, s39, s33
    s_add_u32 s42, s39, 4784128
    s_lshl_b32 s41, s34, 8
    s_add_u32 s41, s41, 53272
    s_mov_b32 s101, 200000
    s_branch T_POLL4C
T_POLL4:
    buffer_load_dwordx4 v[112:115], v7, s[24:27], s62 offen offset:0 sc1
    buffer_load_dwordx4 v[116:119], v7, s[24:27], s62 offen offset:64 sc1
    buffer_load_dwordx4 v[120:123], v7, s[24:27], s62 offen offset:128 sc1
    buffer_load_dwordx4 v[124:127], v7, s[24:27], s62 offen offset:192 sc1
    buffer_load_dwordx4 v[128:131], v7, s[24:27], s55 offen offset:192 sc1
T_POLL4C:
    s_waitcnt vmcnt(0)
    v_max3_u32 v13, v112, v113, v114
    v_max3_u32 v14, v115, v116, v117
    v_max3_u32 v13, v13, v118, v119
    v_max3_u32 v14, v14, v120, v121
    v_max3_u32 v13, v13, v122, v123
    v_max3_u32 v14, v14, v124, v125
    v_max3_u32 v13, v13, v126, v127
    v_max3_u32 v14, v14, v128, v129
    v_max3_u32 v13, v13, v130, v131
    v_max_u32 v13, v13, v14
    v_cmp_eq_u32 vcc, -1, v13
    s_sub_u32 s101, s101, 1
    s_cselect_b64 vcc, 0, vcc
    s_cbranch_vccnz T_POLL4
    v_mfma_f32_16x16x32_bf16 v[16:19], a[0:3], v[112:115], 0
    v_mfma_f32_16x16x32_bf16 v[20:23], a[20:23], v[112:115], 0
    v_mfma_f32_16x16x32_bf16 v[24:27], a[40:43], v[112:115], 0
    v_mfma_f32_16x16x32_bf16 v[28:31], a[60:63], v[112:115], 0
    v_mfma_f32_16x16x32_bf16 v[16:19], a[4:7], v[116:119], v[16:19]
    v_mfma_f32_16x16x32_bf16 v[20:23], a[24:27], v[116:119], v[20:23]
    v_mfma_f32_16x16x32_bf16 v[24:27], a[44:47], v[116:119], v[24:27]
    v_mfma_f32_16x16x32_bf16 v[28:31], a[64:67], v[116:119], v[28:31]
    v_mfma_f32_16x16x32_bf16 v[16:19], a[8:11], v[120:123], v[16:19]
    v_mfma_f32_16x16x32_bf16 v[20:23], a[28:31], v[120:123], v[20:23]
    v_mfma_f32_16x16x32_bf16 v[24:27], a[48:51], v[120:123], v[24:27]
    v_mfma_f32_16x16x32_bf16 v[28:31], a[68:71], v[120:123], v[28:31]
    v_mfma_f32_16x16x32_bf16 v[16:19], a[12:15], v[124:127], v[16:19]
    v_mfma_f32_16x16x32_bf16 v[20:23], a[32:35], v[124:127], v[20:23]
    v_mfma_f32_16x16x32_bf16 v[24:27], a[52:55], v[124:127], v[24:27]
    v_mfma_f32_16x16x32_bf16 v[28:31], a[72:75], v[124:127], v[28:31]
    s_bitcmp1_b32 s40, 0
    s_cbranch_scc1 T_NO5
    v_mfma_f32_16x16x32_bf16 v[16:19], a[16:19], v[128:131], v[16:19]
    v_mfma_f32_16x16x32_bf16 v[20:23], a[36:39], v[128:131], v[20:23]
    v_mfma_f32_16x16x32_bf16 v[24:27], a[56:59], v[128:131], v[24:27]
    v_mfma_f32_16x16x32_bf16 v[28:31], a[76:79], v[128:131], v[28:31]
T_NO5:
    s_nop 4
    ds_write_b128 v92, v[16:19] offset:0
    ds_write_b128 v92, v[20:23] offset:2048
    ds_write_b128 v92, v[24:27] offset:4096
    ds_write_b128 v92, v[28:31] offset:6144
    s_waitcnt lgkmcnt(0)
    s_barrier
    ds_read_b128 v[16:19], v93 offset:0
    ds_read_b128 v[20:23], v93 offset:512
    ds_read_b128 v[24:27], v93 offset:1024
    ds_read_b128 v[28:31], v93 offset:1536
    ds_read_b128 v[32:35], v93 offset:4096
    ds_read_b128 v[36:39], v93 offset:4608
    ds_read_b128 v[40:43], v93 offset:5120
    ds_read_b128 v[44:47], v93 offset:5632
    ds_read_b64_tr_b16 a[80:81], v94 offset:0
    ds_read_b64_tr_b16 a[82:83], v94 offset:18432
    ds_read_b64_tr_b16 a[84:85], v94 offset:32
    ds_read_b64_tr_b16 a[86:87], v94 offset:18464
    ds_read_b64_tr_b16 a[88:89], v94 offset:256
    ds_read_b64_tr_b16 a[90:91], v94 offset:18688
    s_waitcnt lgkmcnt(10)
    v_add_f32 v16, v16, v20
    v_add_f32 v24, v24, v28
    v_add_f32 v17, v17, v21
    v_add_f32 v25, v25, v29
    v_add_f32 v18, v18, v22
    v_add_f32 v26, v26, v30
    v_add_f32 v19, v19, v23
    v_add_f32 v27, v27, v31
    v_add_f32 v16, v16, v24
    v_add_f32 v17, v17, v25
    v_add_f32 v18, v18, v26
    v_add_f32 v19, v19, v27
    v_cvt_pk_bf16_f32 v4, v16, v17
    v_lshlrev_b32 v16, 16, v4
    v_and_b32 v17, 0xffff0000, v4
    v_cvt_pk_bf16_f32 v5, v18, v19
    v_lshlrev_b32 v18, 16, v5
    v_and_b32 v19, 0xffff0000, v5
    v_mul_f32 v20, 0xbfb8aa3b, v16
    v_mul_f32 v21, 0xbfb8aa3b, v17
    v_mul_f32 v22, 0xbfb8aa3b, v18
    v_mul_f32 v23, 0xbfb8aa3b, v19
    v_exp_f32 v20, v20
    v_exp_f32 v21, v21
    v_exp_f32 v22, v22
    v_exp_f32 v23, v23
    s_waitcnt lgkmcnt(6)
    ds_read_b64_tr_b16 a[92:93], v94 offset:288
    ds_read_b64_tr_b16 a[94:95], v94 offset:18720
    ds_read_b64_tr_b16 a[96:97], v94 offset:512
    ds_read_b64_tr_b16 a[98:99], v94 offset:18944
    ds_read_b64_tr_b16 a[100:101], v94 offset:544
    ds_read_b64_tr_b16 a[102:103], v94 offset:18976
    ds_read_b64_tr_b16 a[104:105], v94 offset:768
    ds_read_b64_tr_b16 a[106:107], v94 offset:19200
    ds_read_b64_tr_b16 a[108:109], v94 offset:800
    ds_read_b64_tr_b16 a[110:111], v94 offset:19232
    ds_read_b64_tr_b16 a[112:113], v94 offset:1024
    ds_read_b64_tr_b16 a[114:115], v94 offset:19456
    ds_read_b64_tr_b16 a[116:117], v94 offset:1056
    ds_read_b64_tr_b16 a[118:119], v94 offset:19488
    v_add_f32 v20, 1.0, v20
    v_add_f32 v21, 1.0, v21
    v_add_f32 v22, 1.0, v22
    v_add_f32 v23, 1.0, v23
    v_rcp_f32 v20, v20
    v_rcp_f32 v21, v21
    v_rcp_f32 v22, v22
    v_rcp_f32 v23, v23
    v_add_f32 v32, v32, v36
    v_add_f32 v40, v40, v44
    v_add_f32 v33, v33, v37
    v_add_f32 v41, v41, v45
    v_add_f32 v34, v34, v38
    v_add_f32 v42, v42, v46
    v_add_f32 v35, v35, v39
    v_add_f32 v43, v43, v47
    v_add_f32 v32, v32, v40
    v_add_f32 v33, v33, v41
    v_add_f32 v34, v34, v42
    v_add_f32 v35, v35, v43
    v_mul_f32 v16, v16, v20
    v_mul_f32 v17, v17, v21
    v_mul_f32 v18, v18, v22
    v_mul_f32 v19, v19, v23
    v_cvt_pk_bf16_f32 v4, v16, v17
    v_lshlrev_b32 v16, 16, v4
    v_and_b32 v17, 0xffff0000, v4
    v_cvt_pk_bf16_f32 v5, v18, v19
    v_lshlrev_b32 v18, 16, v5
    v_and_b32 v19, 0xffff0000, v5
    v_cvt_pk_bf16_f32 v4, v32, v33
    v_lshlrev_b32 v32, 16, v4
    v_and_b32 v33, 0xffff0000, v4
    v_cvt_pk_bf16_f32 v5, v34, v35
    v_lshlrev_b32 v34, 16, v5
    v_and_b32 v35, 0xffff0000, v5
    v_mul_f32 v16, v16, v32
    v_mul_f32 v17, v17, v33
    v_mul_f32 v18, v18, v34
    v_mul_f32 v19, v19, v35
    v_cvt_pk_bf16_f32 v20, v16, v17
    v_cvt_pk_bf16_f32 v21, v18, v19
    s_nop 1
    v_mov_b32_dpp v22, v20 row_ror:8 row_mask:0xf bank_mask:0xf
    v_mov_b32_dpp v23, v21 row_ror:8 row_mask:0xf bank_mask:0xf
    s_waitcnt lgkmcnt(0)
    s_nop 0
    v_mfma_f32_16x16x32_bf16 v[24:27], a[80:83], v[20:23], 0
    v_mfma_f32_16x16x32_bf16 v[28:31], a[84:87], v[20:23], 0
    v_mfma_f32_16x16x32_bf16 v[32:35], a[88:91], v[20:23], 0
    v_mfma_f32_16x16x32_bf16 v[36:39], a[92:95], v[20:23], 0
    v_mfma_f32_16x16x32_bf16 v[40:43], a[96:99], v[20:23], 0
    v_mfma_f32_16x16x32_bf16 v[44:47], a[100:103], v[20:23], 0
    v_mfma_f32_16x16x32_bf16 v[48:51], a[104:107], v[20:23], 0
    v_mfma_f32_16x16x32_bf16 v[52:55], a[108:111], v[20:23], 0
    v_mfma_f32_16x16x32_bf16 v[56:59], a[112:115], v[20:23], 0
    v_mfma_f32_16x16x32_bf16 v[60:63], a[116:119], v[20:23], 0
    v_mov_b32_dpp v24, v28 row_ror:8 row_mask:0xf bank_mask:0xc
    v_mov_b32_dpp v25, v29 row_ror:8 row_mask:0xf bank_mask:0xc
    v_mov_b32_dpp v26, v30 row_ror:8 row_mask:0xf bank_mask:0xc
    v_mov_b32_dpp v27, v31 row_ror:8 row_mask:0xf bank_mask:0xc
    buffer_store_dwordx4 v[24:27], v95, s[24:27], s32 offen offset:0 sc1
    v_mov_b32_dpp v32, v36 row_ror:8 row_mask:0xf bank_mask:0xc
    v_mov_b32_dpp v33, v37 row_ror:8 row_mask:0xf bank_mask:0xc
    v_mov_b32_dpp v34, v38 row_ror:8 row_mask:0xf bank_mask:0xc
    v_mov_b32_dpp v35, v39 row_ror:8 row_mask:0xf bank_mask:0xc
    buffer_store_dwordx4 v[32:35], v95, s[24:27], s32 offen offset:512 sc1
    v_mov_b32_dpp v40, v44 row_ror:8 row_mask:0xf bank_mask:0xc
    v_mov_b32_dpp v41, v45 row_ror:8 row_mask:0xf bank_mask:0xc
    v_mov_b32_dpp v42, v46 row_ror:8 row_mask:0xf bank_mask:0xc
    v_mov_b32_dpp v43, v47 row_ror:8 row_mask:0xf bank_mask:0xc
    buffer_store_dwordx4 v[40:43], v95, s[24:27], s32 offen offset:1024 sc1
    v_mov_b32_dpp v48, v52 row_ror:8 row_mask:0xf bank_mask:0xc
    v_mov_b32_dpp v49, v53 row_ror:8 row_mask:0xf bank_mask:0xc
    v_mov_b32_dpp v50, v54 row_ror:8 row_mask:0xf bank_mask:0xc
    v_mov_b32_dpp v51, v55 row_ror:8 row_mask:0xf bank_mask:0xc
    buffer_store_dwordx4 v[48:51], v95, s[24:27], s32 offen offset:1536 sc1
    s_cmp_ge_u32 s40, 2
    s_cbranch_scc1 T_Y4
    v_mov_b32_dpp v56, v60 row_ror:8 row_mask:0xf bank_mask:0xc
    v_mov_b32_dpp v57, v61 row_ror:8 row_mask:0xf bank_mask:0xc
    v_mov_b32_dpp v58, v62 row_ror:8 row_mask:0xf bank_mask:0xc
    v_mov_b32_dpp v59, v63 row_ror:8 row_mask:0xf bank_mask:0xc
    buffer_store_dwordx4 v[56:59], v95, s[24:27], s32 offen offset:2048 sc1
T_Y4:
    s_mov_b32 s30, 40960
    s_mov_b64 exec, s[36:37]
    s_cbranch_execz T_NOPUB9794
    buffer_store_dwordx2 v[200:201], v253, s[24:27], s30 offen offset:0 sc1
    buffer_store_dwordx2 v[202:203], v253, s[24:27], s30 offen offset:256 sc1
    buffer_store_dwordx2 v[204:205], v253, s[24:27], s30 offen offset:512 sc1
    buffer_store_dwordx2 v[206:207], v253, s[24:27], s30 offen offset:768 sc1
    s_mov_b32 exec_hi, 0
    buffer_store_dwordx2 v[208:209], v253, s[24:27], s30 offen offset:1024 sc1
    s_mov_b64 exec, -1
T_NOPUB9794:
    s_mov_b64 exec, -1
    s_not_b64 exec, s[36:37]
    s_cbranch_execz T_NOOUT9806
    buffer_store_dwordx2 v[190:191], v250, s[16:19], s29 offen offset:0
    buffer_store_dwordx2 v[192:193], v250, s[16:19], s29 offen offset:256
    buffer_store_dwordx2 v[194:195], v250, s[16:19], s29 offen offset:512
    buffer_store_dwordx2 v[196:197], v250, s[16:19], s29 offen offset:768
    s_mov_b32 exec_hi, 0
    buffer_store_dwordx2 v[198:199], v250, s[16:19], s29 offen offset:1024
    s_mov_b64 exec, -1
T_NOOUT9806:
    s_mov_b64 exec, -1
    s_cmp_ge_u32 s40, 2
    s_cbranch_scc1 K2_END
    v_lshlrev_b32 v106, 1, v96
    buffer_load_dwordx2 v[106:107], v106, s[24:27], s41 offen sc1
    v_lshrrev_b32 v1, 3, v246
    s_lshl_b32 s31, s40, 3
    v_add_u32 v1, s31, v1
    v_mul_u32_u24 v3, 18432, v1
    v_add_u32 v3, v3, v96
    s_lshl_b32 s30, s2, 7
    s_add_u32 s30, s30, 7143424
    v_mov_b32 v8, s38
    v_ashrrev_i32 v9, 31, v8
    v_not_b32 v9, v9
    v_or_b32 v9, 0x80000000, v9
    v_xor_b32 v8, v8, v9
    v_and_b32 v8, 0xfffff800, v8
    v_or_b32 v8, 0x400, v8
    v_cvt_pk_bf16_f32 v8, v8, v8
    v_and_b32 v8, 0xffff0000, v8
    v_mul_f32 v8, 0xbfb8aa3b, v8
    v_exp_f32 v8, v8
    s_nop 0
    v_add_f32 v8, 1.0, v8
    v_rcp_f32 v8, v8
    s_nop 0
    v_cvt_pk_bf16_f32 v8, v8, v8
    v_and_b32 v8, 0xffff0000, v8
    s_lshl_b32 s31, s40, 7
    s_add_u32 s31, s31, 0
    v_add_u32 v10, s31, v96
    s_mov_b32 s101, 200000
T_POLL3:
    s_mov_b32 s31, s30
    buffer_load_dwordx4 v[112:115], v3, s[24:27], s31 offen sc1
    s_add_u32 s31, s31, 294912
    buffer_load_dwordx4 v[116:119], v3, s[24:27], s31 offen sc1
    s_add_u32 s31, s31, 294912
    buffer_load_dwordx4 v[120:123], v3, s[24:27], s31 offen sc1
    s_add_u32 s31, s31, 294912
    buffer_load_dwordx4 v[124:127], v3, s[24:27], s31 offen sc1
    s_add_u32 s31, s31, 294912
    buffer_load_dwordx4 v[128:131], v3, s[24:27], s31 offen sc1
    s_add_u32 s31, s31, 294912
    buffer_load_dwordx4 v[132:135], v3, s[24:27], s31 offen sc1
    s_add_u32 s31, s31, 294912
    buffer_load_dwordx4 v[136:139], v3, s[24:27], s31 offen sc1
    s_add_u32 s31, s31, 294912
    buffer_load_dwordx4 v[140:143], v3, s[24:27], s31 offen sc1
    s_add_u32 s31, s31, 294912
    buffer_load_dwordx4 v[144:147], v3, s[24:27], s31 offen sc1
    buffer_load_dwordx2 v[104:105], v97, s[24:27], s42 offen sc1
    buffer_load_dwordx2 v[102:103], v97, s[24:27], s43 offen sc1
    s_waitcnt vmcnt(0)
    v_max3_u32 v4, v102, v103, v104
    v_max3_u32 v5, v105, v112, v113
    v_max3_u32 v4, v4, v114, v115
    v_max3_u32 v5, v5, v116, v117
    v_max3_u32 v4, v4, v118, v119
    v_max3_u32 v5, v5, v120, v121
    v_max3_u32 v4, v4, v122, v123
    v_max3_u32 v5, v5, v124, v125
    v_max3_u32 v4, v4, v126, v127
    v_max3_u32 v5, v5, v128, v129
    v_max3_u32 v4, v4, v130, v131
    v_max3_u32 v5, v5, v132, v133
    v_max3_u32 v4, v4, v134, v135
    v_max3_u32 v5, v5, v136, v137
    v_max3_u32 v4, v4, v138, v139
    v_max3_u32 v5, v5, v140, v141
    v_max3_u32 v4, v4, v142, v143
    v_max3_u32 v5, v5, v144, v145
    v_max3_u32 v4, v4, v146, v147
    v_max_u32 v4, v4, v5
    v_cmp_eq_u32 vcc, -1, v4
    s_sub_u32 s101, s101, 1
    s_cselect_b64 vcc, 0, vcc
    s_cbranch_vccnz T_POLL3
    v_add_f32 v112, v112, v116
    v_add_f32 v113, v113, v117
    v_add_f32 v114, v114, v118
    v_add_f32 v115, v115, v119
    v_add_f32 v112, v112, v120
    v_add_f32 v113, v113, v121
    v_add_f32 v114, v114, v122
    v_add_f32 v115, v115, v123
    v_add_f32 v112, v112, v124
    v_add_f32 v113, v113, v125
    v_add_f32 v114, v114, v126
    v_add_f32 v115, v115, v127
    v_add_f32 v112, v112, v128
    v_add_f32 v113, v113, v129
    v_add_f32 v114, v114, v130
    v_add_f32 v115, v115, v131
    v_add_f32 v112, v112, v132
    v_add_f32 v113, v113, v133
    v_add_f32 v114, v114, v134
    v_add_f32 v115, v115, v135
    v_add_f32 v112, v112, v136
    v_add_f32 v113, v113, v137
    v_add_f32 v114, v114, v138
    v_add_f32 v115, v115, v139
    v_add_f32 v112, v112, v140
    v_add_f32 v113, v113, v141
    v_add_f32 v114, v114, v142
    v_add_f32 v115, v115, v143
    v_add_f32 v112, v112, v144
    v_add_f32 v113, v113, v145
    v_add_f32 v114, v114, v146
    v_add_f32 v115, v115, v147
    v_add_f32_dpp v112, v112, v112 row_ror:8 row_mask:0xf bank_mask:0xf
    v_add_f32_dpp v113, v113, v113 row_ror:8 row_mask:0xf bank_mask:0xf
    v_add_f32_dpp v114, v114, v114 row_ror:8 row_mask:0xf bank_mask:0xf
    v_add_f32_dpp v115, v115, v115 row_ror:8 row_mask:0xf bank_mask:0xf
    v_mov_b32 v16, v112
    v_mov_b32 v17, v113
    v_mov_b32 v18, v114
    v_mov_b32 v19, v115
    v_permlane16_swap_b32 v16, v112
    v_permlane16_swap_b32 v17, v113
    v_permlane16_swap_b32 v18, v114
    v_permlane16_swap_b32 v19, v115
    v_add_f32 v112, v112, v16
    v_add_f32 v113, v113, v17
    v_add_f32 v114, v114, v18
    v_add_f32 v115, v115, v19
    v_mov_b32 v16, v112
    v_mov_b32 v17, v113
    v_mov_b32 v18, v114
    v_mov_b32 v19, v115
    v_permlane32_swap_b32 v16, v112
    v_permlane32_swap_b32 v17, v113
    v_permlane32_swap_b32 v18, v114
    v_permlane32_swap_b32 v19, v115
    v_add_f32 v112, v112, v16
    v_add_f32 v113, v113, v17
    v_add_f32 v114, v114, v18
    v_add_f32 v115, v115, v19
    ds_write_b128 v10, v[112:115]
    v_lshlrev_b32 v108, 16, v106
    v_and_b32 v109, 0xffff0000, v106
    v_lshlrev_b32 v110, 16, v107
    v_and_b32 v111, 0xffff0000, v107
    v_lshlrev_b32 v20, 16, v104
    v_and_b32 v21, 0xffff0000, v104
    v_lshlrev_b32 v22, 16, v105
    v_and_b32 v23, 0xffff0000, v105
    v_lshlrev_b32 v24, 16, v102
    v_and_b32 v25, 0xffff0000, v102
    v_lshlrev_b32 v26, 16, v103
    v_and_b32 v27, 0xffff0000, v103
    s_waitcnt lgkmcnt(0)
    s_barrier
    s_cmp_lg_u32 s40, 0
    s_cbranch_scc1 K2_END
    ds_read_b128 v[16:19], v96 offset:128
    s_waitcnt lgkmcnt(0)
    v_add_f32 v16, v16, v112
    v_add_f32 v17, v17, v113
    v_add_f32 v18, v18, v114
    v_add_f32 v19, v19, v115
    v_cvt_pk_bf16_f32 v60, v16, v17
    v_lshlrev_b32 v16, 16, v60
    v_and_b32 v17, 0xffff0000, v60
    v_cvt_pk_bf16_f32 v61, v18, v19
    v_lshlrev_b32 v18, 16, v61
    v_and_b32 v19, 0xffff0000, v61
    v_mul_f32 v16, v16, v8
    v_mul_f32 v17, v17, v8
    v_mul_f32 v18, v18, v8
    v_mul_f32 v19, v19, v8
    v_cvt_pk_bf16_f32 v60, v16, v17
    v_lshlrev_b32 v16, 16, v60
    v_and_b32 v17, 0xffff0000, v60
    v_cvt_pk_bf16_f32 v61, v18, v19
    v_lshlrev_b32 v18, 16, v61
    v_and_b32 v19, 0xffff0000, v61
    v_add_f32 v16, v16, v20
    v_add_f32 v17, v17, v21
    v_add_f32 v18, v18, v22
    v_add_f32 v19, v19, v23
    v_cvt_pk_bf16_f32 v60, v16, v17
    v_lshlrev_b32 v16, 16, v60
    v_and_b32 v17, 0xffff0000, v60
    v_cvt_pk_bf16_f32 v61, v18, v19
    v_lshlrev_b32 v18, 16, v61
    v_and_b32 v19, 0xffff0000, v61
    v_mul_f32 v16, v16, v108
    v_mul_f32 v17, v17, v109
    v_mul_f32 v18, v18, v110
    v_mul_f32 v19, v19, v111
    v_cvt_pk_bf16_f32 v60, v16, v17
    v_lshlrev_b32 v16, 16, v60
    v_and_b32 v17, 0xffff0000, v60
    v_cvt_pk_bf16_f32 v61, v18, v19
    v_lshlrev_b32 v18, 16, v61
    v_and_b32 v19, 0xffff0000, v61
    v_add_f32 v16, v16, v24
    v_add_f32 v17, v17, v25
    v_add_f32 v18, v18, v26
    v_add_f32 v19, v19, v27
    v_cvt_pk_bf16_f32 v20, v16, v17
    v_cvt_pk_bf16_f32 v21, v18, v19
    s_mov_b64 exec, 0xff
    buffer_store_dwordx2 v[20:21], v97, s[16:19], s39 offen
K2_FIN:
K2_END:
    s_endpgm
E_WAITA:
    s_mov_b32 s101, 200000
E_POLLA9:
    buffer_load_dword v220, v222, s[24:27], s45 offen offset:4 sc1
    s_waitcnt vmcnt(0)
    v_cmp_ne_u32 vcc, s54, v220
    s_sub_u32 s101, s101, 1
    s_cselect_b64 vcc, 0, vcc
    s_cbranch_vccnz E_POLLA9
    s_branch E_WAITAX
E_WAITP:
    s_mov_b32 s101, 200000
E_POLL9:
    buffer_load_dword v220, v222, s[24:27], s45 offen sc1
    s_waitcnt vmcnt(0)
    v_cmp_ne_u32 vcc, s54, v220
    s_sub_u32 s101, s101, 1
    s_cselect_b64 vcc, 0, vcc
    s_cbranch_vccnz E_POLL9
    s_branch E_WAITX
RARE_L0_0:
    s_waitcnt lgkmcnt(0)
    s_call_b64 s[36:37], RARE_SUB_0
    s_branch BACK_L0_0
RARE_L0_1:
    s_waitcnt lgkmcnt(0)
    s_call_b64 s[36:37], RARE_SUB_1
    s_branch BACK_L0_1
RARE_L1_0:
    s_waitcnt lgkmcnt(0)
    s_call_b64 s[36:37], RARE_SUB_0
    s_branch BACK_L1_0
RARE_L1_1:
    s_waitcnt lgkmcnt(0)
    s_call_b64 s[36:37], RARE_SUB_1
    s_branch BACK_L1_1
RARE_L2_0:
    s_waitcnt lgkmcnt(0)
    s_call_b64 s[36:37], RARE_SUB_0
    s_branch BACK_L2_0
RARE_L2_1:
    s_waitcnt lgkmcnt(0)
    s_call_b64 s[36:37], RARE_SUB_1
    s_branch BACK_L2_1
RARE_L3_0:
    s_waitcnt lgkmcnt(0)
    s_call_b64 s[36:37], RARE_SUB_0
    s_branch BACK_L3_0
RARE_L3_1:
    s_waitcnt lgkmcnt(0)
    s_call_b64 s[36:37], RARE_SUB_1
    s_branch BACK_L3_1
RARE_T28_0:
    s_waitcnt lgkmcnt(0)
    s_call_b64 s[36:37], RARE_SUB_0
    s_branch BACK_T28_0
RARE_T28_1:
    s_waitcnt lgkmcnt(0)
    s_call_b64 s[36:37], RARE_SUB_1
    s_branch BACK_T28_1
RARE_T29_0:
    s_waitcnt lgkmcnt(0)
    s_call_b64 s[36:37], RARE_SUB_0
    s_branch BACK_T29_0
RARE_T29_1:
    s_waitcnt lgkmcnt(0)
    s_call_b64 s[36:37], RARE_SUB_1
    s_branch BACK_T29_1
RARE_T30_0:
    s_waitcnt lgkmcnt(0)
    s_call_b64 s[36:37], RARE_SUB_0
    s_branch BACK_T30_0
RARE_T30_1:
    s_waitcnt lgkmcnt(0)
    s_call_b64 s[36:37], RARE_SUB_1
    s_branch BACK_T30_1
RARE_T31_0:
    s_waitcnt lgkmcnt(0)
    s_call_b64 s[36:37], RARE_SUB_0
    s_branch BACK_T31_0
RARE_T31_1:
    s_waitcnt lgkmcnt(0)
    s_call_b64 s[36:37], RARE_SUB_1
    s_branch BACK_T31_1
LWAIT_L0:
    ds_read_b32 v244, v243
    s_waitcnt lgkmcnt(0)
    v_cmp_gt_u32 vcc, s30, v244
    s_cbranch_vccnz LWAIT_L0
    s_branch LBACK_L0
LWAIT_L1:
    ds_read_b32 v244, v243
    s_waitcnt lgkmcnt(0)
    v_cmp_gt_u32 vcc, s30, v244
    s_cbranch_vccnz LWAIT_L1
    s_branch LBACK_L1
LWAIT_L2:
    ds_read_b32 v244, v243
    s_waitcnt lgkmcnt(0)
    v_cmp_gt_u32 vcc, s30, v244
    s_cbranch_vccnz LWAIT_L2
    s_branch LBACK_L2
LWAIT_L3:
    ds_read_b32 v244, v243
    s_waitcnt lgkmcnt(0)
    v_cmp_gt_u32 vcc, s30, v244
    s_cbranch_vccnz LWAIT_L3
    s_branch LBACK_L3
RARE_SUB_0:
    s_nop 15
    v_max3_f32 v218, v0, v1, v2
    v_max3_f32 v219, v3, v4, v5
    v_max3_f32 v218, v218, v6, v7
    v_max3_f32 v219, v219, v8, v9
    v_max3_f32 v218, v218, v10, v11
    v_max3_f32 v219, v219, v12, v13
    v_max3_f32 v218, v218, v14, v15
    v_max_f32 v218, v218, v219
    v_mov_b32 v219, v218
    s_nop 1
    v_permlane16_swap_b32 v218, v219
    v_max_f32 v218, v218, v219
    v_mov_b32 v219, v218
    s_nop 1
    v_permlane32_swap_b32 v218, v219
    v_max_f32 v218, v218, v219
    v_log_f32 v219, s34
    v_add_f32 v218, 0x42980000, v218
    v_sub_f32 v218, v218, v219
    v_max_f32 v218, 0, v218
    v_ceil_f32 v218, v218
    v_mul_f32 v219, -0.5, v218
    v_floor_f32 v220, v219
    v_ceil_f32 v219, v219
    v_exp_f32 v220, v220
    v_exp_f32 v219, v219
    v_sub_f32 v96, v96, v218
    v_sub_f32 v97, v97, v218
    v_sub_f32 v98, v98, v218
    v_sub_f32 v99, v99, v218
    v_sub_f32 v0, v0, v218
    v_sub_f32 v1, v1, v218
    v_sub_f32 v2, v2, v218
    v_sub_f32 v3, v3, v218
    v_sub_f32 v4, v4, v218
    v_sub_f32 v5, v5, v218
    v_sub_f32 v6, v6, v218
    v_sub_f32 v7, v7, v218
    v_sub_f32 v8, v8, v218
    v_sub_f32 v9, v9, v218
    v_sub_f32 v10, v10, v218
    v_sub_f32 v11, v11, v218
    v_sub_f32 v12, v12, v218
    v_sub_f32 v13, v13, v218
    v_sub_f32 v14, v14, v218
    v_sub_f32 v15, v15, v218
    v_mul_f32 v192, v192, v219
    v_mul_f32 v192, v192, v220
    v_mul_f32 v193, v193, v219
    v_mul_f32 v193, v193, v220
    v_mul_f32 v194, v194, v219
    v_mul_f32 v194, v194, v220
    v_mul_f32 v195, v195, v219
    v_mul_f32 v195, v195, v220
    v_mul_f32 v219, v219, v220
    v_accvgpr_read_b32 v220, a0
    v_accvgpr_read_b32 v221, a1
    v_accvgpr_read_b32 v222, a2
    v_accvgpr_read_b32 v223, a3
    v_mul_f32 v220, v220, v219
    v_mul_f32 v221, v221, v219
    v_mul_f32 v222, v222, v219
    v_mul_f32 v223, v223, v219
    v_accvgpr_write_b32 a0, v220
    v_accvgpr_write_b32 a1, v221
    v_accvgpr_write_b32 a2, v222
    v_accvgpr_write_b32 a3, v223
    v_accvgpr_read_b32 v220, a4
    v_accvgpr_read_b32 v221, a5
    v_accvgpr_read_b32 v222, a6
    v_accvgpr_read_b32 v223, a7
    v_mul_f32 v220, v220, v219
    v_mul_f32 v221, v221, v219
    v_mul_f32 v222, v222, v219
    v_mul_f32 v223, v223, v219
    v_accvgpr_write_b32 a4, v220
    v_accvgpr_write_b32 a5, v221
    v_accvgpr_write_b32 a6, v222
    v_accvgpr_write_b32 a7, v223
    v_accvgpr_read_b32 v220, a8
    v_accvgpr_read_b32 v221, a9
    v_accvgpr_read_b32 v222, a10
    v_accvgpr_read_b32 v223, a11
    v_mul_f32 v220, v220, v219
    v_mul_f32 v221, v221, v219
    v_mul_f32 v222, v222, v219
    v_mul_f32 v223, v223, v219
    v_accvgpr_write_b32 a8, v220
    v_accvgpr_write_b32 a9, v221
    v_accvgpr_write_b32 a10, v222
    v_accvgpr_write_b32 a11, v223
    v_accvgpr_read_b32 v220, a12
    v_accvgpr_read_b32 v221, a13
    v_accvgpr_read_b32 v222, a14
    v_accvgpr_read_b32 v223, a15
    v_mul_f32 v220, v220, v219
    v_mul_f32 v221, v221, v219
    v_mul_f32 v222, v222, v219
    v_mul_f32 v223, v223, v219
    v_accvgpr_write_b32 a12, v220
    v_accvgpr_write_b32 a13, v221
    v_accvgpr_write_b32 a14, v222
    v_accvgpr_write_b32 a15, v223
    v_accvgpr_read_b32 v220, a16
    v_accvgpr_read_b32 v221, a17
    v_accvgpr_read_b32 v222, a18
    v_accvgpr_read_b32 v223, a19
    v_mul_f32 v220, v220, v219
    v_mul_f32 v221, v221, v219
    v_mul_f32 v222, v222, v219
    v_mul_f32 v223, v223, v219
    v_accvgpr_write_b32 a16, v220
    v_accvgpr_write_b32 a17, v221
    v_accvgpr_write_b32 a18, v222
    v_accvgpr_write_b32 a19, v223
    v_accvgpr_read_b32 v220, a20
    v_accvgpr_read_b32 v221, a21
    v_accvgpr_read_b32 v222, a22
    v_accvgpr_read_b32 v223, a23
    v_mul_f32 v220, v220, v219
    v_mul_f32 v221, v221, v219
    v_mul_f32 v222, v222, v219
    v_mul_f32 v223, v223, v219
    v_accvgpr_write_b32 a20, v220
    v_accvgpr_write_b32 a21, v221
    v_accvgpr_write_b32 a22, v222
    v_accvgpr_write_b32 a23, v223
    v_accvgpr_read_b32 v220, a24
    v_accvgpr_read_b32 v221, a25
    v_accvgpr_read_b32 v222, a26
    v_accvgpr_read_b32 v223, a27
    v_mul_f32 v220, v220, v219
    v_mul_f32 v221, v221, v219
    v_mul_f32 v222, v222, v219
    v_mul_f32 v223, v223, v219
    v_accvgpr_write_b32 a24, v220
    v_accvgpr_write_b32 a25, v221
    v_accvgpr_write_b32 a26, v222
    v_accvgpr_write_b32 a27, v223
    v_accvgpr_read_b32 v220, a28
    v_accvgpr_read_b32 v221, a29
    v_accvgpr_read_b32 v222, a30
    v_accvgpr_read_b32 v223, a31
    v_mul_f32 v220, v220, v219
    v_mul_f32 v221, v221, v219
    v_mul_f32 v222, v222, v219
    v_mul_f32 v223, v223, v219
    v_accvgpr_write_b32 a28, v220
    v_accvgpr_write_b32 a29, v221
    v_accvgpr_write_b32 a30, v222
    v_accvgpr_write_b32 a31, v223
    v_max3_f32 v218, v16, v17, v18
    v_max3_f32 v219, v19, v20, v21
    v_max3_f32 v218, v218, v22, v23
    v_max3_f32 v219, v219, v24, v25
    v_max3_f32 v218, v218, v26, v27
    v_max3_f32 v219, v219, v28, v29
    v_max3_f32 v218, v218, v30, v31
    v_max_f32 v218, v218, v219
    v_mov_b32 v219, v218
    s_nop 1
    v_permlane16_swap_b32 v218, v219
    v_max_f32 v218, v218, v219
    v_mov_b32 v219, v218
    s_nop 1
    v_permlane32_swap_b32 v218, v219
    v_max_f32 v218, v218, v219
    v_log_f32 v219, s34
    v_add_f32 v218, 0x42980000, v218
    v_sub_f32 v218, v218, v219
    v_max_f32 v218, 0, v218
    v_ceil_f32 v218, v218
    v_mul_f32 v219, -0.5, v218
    v_floor_f32 v220, v219
    v_ceil_f32 v219, v219
    v_exp_f32 v220, v220
    v_exp_f32 v219, v219
    v_sub_f32 v100, v100, v218
    v_sub_f32 v101, v101, v218
    v_sub_f32 v102, v102, v218
    v_sub_f32 v103, v103, v218
    v_sub_f32 v16, v16, v218
    v_sub_f32 v17, v17, v218
    v_sub_f32 v18, v18, v218
    v_sub_f32 v19, v19, v218
    v_sub_f32 v20, v20, v218
    v_sub_f32 v21, v21, v218
    v_sub_f32 v22, v22, v218
    v_sub_f32 v23, v23, v218
    v_sub_f32 v24, v24, v218
    v_sub_f32 v25, v25, v218
    v_sub_f32 v26, v26, v218
    v_sub_f32 v27, v27, v218
    v_sub_f32 v28, v28, v218
    v_sub_f32 v29, v29, v218
    v_sub_f32 v30, v30, v218
    v_sub_f32 v31, v31, v218
    v_mul_f32 v196, v196, v219
    v_mul_f32 v196, v196, v220
    v_mul_f32 v197, v197, v219
    v_mul_f32 v197, v197, v220
    v_mul_f32 v198, v198, v219
    v_mul_f32 v198, v198, v220
    v_mul_f32 v199, v199, v219
    v_mul_f32 v199, v199, v220
    v_mul_f32 v219, v219, v220
    v_accvgpr_read_b32 v220, a32
    v_accvgpr_read_b32 v221, a33
    v_accvgpr_read_b32 v222, a34
    v_accvgpr_read_b32 v223, a35
    v_mul_f32 v220, v220, v219
    v_mul_f32 v221, v221, v219
    v_mul_f32 v222, v222, v219
    v_mul_f32 v223, v223, v219
    v_accvgpr_write_b32 a32, v220
    v_accvgpr_write_b32 a33, v221
    v_accvgpr_write_b32 a34, v222
    v_accvgpr_write_b32 a35, v223
    v_accvgpr_read_b32 v220, a36
    v_accvgpr_read_b32 v221, a37
    v_accvgpr_read_b32 v222, a38
    v_accvgpr_read_b32 v223, a39
    v_mul_f32 v220, v220, v219
    v_mul_f32 v221, v221, v219
    v_mul_f32 v222, v222, v219
    v_mul_f32 v223, v223, v219
    v_accvgpr_write_b32 a36, v220
    v_accvgpr_write_b32 a37, v221
    v_accvgpr_write_b32 a38, v222
    v_accvgpr_write_b32 a39, v223
    v_accvgpr_read_b32 v220, a40
    v_accvgpr_read_b32 v221, a41
    v_accvgpr_read_b32 v222, a42
    v_accvgpr_read_b32 v223, a43
    v_mul_f32 v220, v220, v219
    v_mul_f32 v221, v221, v219
    v_mul_f32 v222, v222, v219
    v_mul_f32 v223, v223, v219
    v_accvgpr_write_b32 a40, v220
    v_accvgpr_write_b32 a41, v221
    v_accvgpr_write_b32 a42, v222
    v_accvgpr_write_b32 a43, v223
    v_accvgpr_read_b32 v220, a44
    v_accvgpr_read_b32 v221, a45
    v_accvgpr_read_b32 v222, a46
    v_accvgpr_read_b32 v223, a47
    v_mul_f32 v220, v220, v219
    v_mul_f32 v221, v221, v219
    v_mul_f32 v222, v222, v219
    v_mul_f32 v223, v223, v219
    v_accvgpr_write_b32 a44, v220
    v_accvgpr_write_b32 a45, v221
    v_accvgpr_write_b32 a46, v222
    v_accvgpr_write_b32 a47, v223
    v_accvgpr_read_b32 v220, a48
    v_accvgpr_read_b32 v221, a49
    v_accvgpr_read_b32 v222, a50
    v_accvgpr_read_b32 v223, a51
    v_mul_f32 v220, v220, v219
    v_mul_f32 v221, v221, v219
    v_mul_f32 v222, v222, v219
    v_mul_f32 v223, v223, v219
    v_accvgpr_write_b32 a48, v220
    v_accvgpr_write_b32 a49, v221
    v_accvgpr_write_b32 a50, v222
    v_accvgpr_write_b32 a51, v223
    v_accvgpr_read_b32 v220, a52
    v_accvgpr_read_b32 v221, a53
    v_accvgpr_read_b32 v222, a54
    v_accvgpr_read_b32 v223, a55
    v_mul_f32 v220, v220, v219
    v_mul_f32 v221, v221, v219
    v_mul_f32 v222, v222, v219
    v_mul_f32 v223, v223, v219
    v_accvgpr_write_b32 a52, v220
    v_accvgpr_write_b32 a53, v221
    v_accvgpr_write_b32 a54, v222
    v_accvgpr_write_b32 a55, v223
    v_accvgpr_read_b32 v220, a56
    v_accvgpr_read_b32 v221, a57
    v_accvgpr_read_b32 v222, a58
    v_accvgpr_read_b32 v223, a59
    v_mul_f32 v220, v220, v219
    v_mul_f32 v221, v221, v219
    v_mul_f32 v222, v222, v219
    v_mul_f32 v223, v223, v219
    v_accvgpr_write_b32 a56, v220
    v_accvgpr_write_b32 a57, v221
    v_accvgpr_write_b32 a58, v222
    v_accvgpr_write_b32 a59, v223
    v_accvgpr_read_b32 v220, a60
    v_accvgpr_read_b32 v221, a61
    v_accvgpr_read_b32 v222, a62
    v_accvgpr_read_b32 v223, a63
    v_mul_f32 v220, v220, v219
    v_mul_f32 v221, v221, v219
    v_mul_f32 v222, v222, v219
    v_mul_f32 v223, v223, v219
    v_accvgpr_write_b32 a60, v220
    v_accvgpr_write_b32 a61, v221
    v_accvgpr_write_b32 a62, v222
    v_accvgpr_write_b32 a63, v223
    v_exp_f32 v208, v0
    v_exp_f32 v209, v1
    v_exp_f32 v210, v2
    v_cvt_pk_bf16_f32 v64, v208, v209
    v_exp_f32 v211, v3
    v_exp_f32 v212, v4
    v_cvt_pk_bf16_f32 v65, v210, v211
    v_exp_f32 v213, v5
    v_exp_f32 v214, v6
    v_cvt_pk_bf16_f32 v66, v212, v213
    v_exp_f32 v215, v7
    v_exp_f32 v208, v8
    v_cvt_pk_bf16_f32 v67, v214, v215
    v_exp_f32 v209, v9
    v_exp_f32 v210, v10
    v_cvt_pk_bf16_f32 v68, v208, v209
    v_exp_f32 v211, v11
    v_exp_f32 v212, v12
    v_cvt_pk_bf16_f32 v69, v210, v211
    v_exp_f32 v213, v13
    v_exp_f32 v214, v14
    v_cvt_pk_bf16_f32 v70, v212, v213
    v_exp_f32 v215, v15
    v_exp_f32 v208, v16
    v_cvt_pk_bf16_f32 v71, v214, v215
    v_exp_f32 v209, v17
    v_exp_f32 v210, v18
    v_cvt_pk_bf16_f32 v72, v208, v209
    v_exp_f32 v211, v19
    v_exp_f32 v212, v20
    v_cvt_pk_bf16_f32 v73, v210, v211
    v_exp_f32 v213, v21
    v_exp_f32 v214, v22
    v_cvt_pk_bf16_f32 v74, v212, v213
    v_exp_f32 v215, v23
    v_exp_f32 v208, v24
    v_cvt_pk_bf16_f32 v75, v214, v215
    v_exp_f32 v209, v25
    v_exp_f32 v210, v26
    v_cvt_pk_bf16_f32 v76, v208, v209
    v_exp_f32 v211, v27
    v_exp_f32 v212, v28
    v_cvt_pk_bf16_f32 v77, v210, v211
    v_exp_f32 v213, v29
    v_exp_f32 v214, v30
    v_cvt_pk_bf16_f32 v78, v212, v213
    v_exp_f32 v215, v31
    s_nop 0
    v_cvt_pk_bf16_f32 v79, v214, v215
    v_mov_b32 v116, 0
    v_mov_b32 v117, 0
    v_mov_b32 v118, 0
    v_mov_b32 v119, 0
    v_mov_b32 v120, 0
    v_mov_b32 v121, 0
    v_mov_b32 v122, 0
    v_mov_b32 v123, 0
    v_smfmac_f32_16x16x64_bf16 v[116:119], v[226:229], v[64:71], v112
    s_nop 0
    v_smfmac_f32_16x16x64_bf16 v[120:123], v[226:229], v[72:79], v112
    v_mov_b32 v218, 0x7f800000
    v_cmp_lt_f32 vcc, v192, v218
    s_nop 3
    v_cndmask_b32 v192, v116, v192, vcc
    v_cmp_lt_f32 vcc, v193, v218
    s_nop 1
    v_cndmask_b32 v193, v117, v193, vcc
    v_cmp_lt_f32 vcc, v194, v218
    s_nop 1
    v_cndmask_b32 v194, v118, v194, vcc
    v_cmp_lt_f32 vcc, v195, v218
    s_nop 1
    v_cndmask_b32 v195, v119, v195, vcc
    v_cmp_lt_f32 vcc, v196, v218
    s_nop 1
    v_cndmask_b32 v196, v120, v196, vcc
    v_cmp_lt_f32 vcc, v197, v218
    s_nop 1
    v_cndmask_b32 v197, v121, v197, vcc
    v_cmp_lt_f32 vcc, v198, v218
    s_nop 1
    v_cndmask_b32 v198, v122, v198, vcc
    v_cmp_lt_f32 vcc, v199, v218
    s_nop 1
    v_cndmask_b32 v199, v123, v199, vcc
    s_nop 1
    s_setpc_b64 s[36:37]
RARE_SUB_1:
    s_nop 15
    v_max3_f32 v218, v32, v33, v34
    v_max3_f32 v219, v35, v36, v37
    v_max3_f32 v218, v218, v38, v39
    v_max3_f32 v219, v219, v40, v41
    v_max3_f32 v218, v218, v42, v43
    v_max3_f32 v219, v219, v44, v45
    v_max3_f32 v218, v218, v46, v47
    v_max_f32 v218, v218, v219
    v_mov_b32 v219, v218
    s_nop 1
    v_permlane16_swap_b32 v218, v219
    v_max_f32 v218, v218, v219
    v_mov_b32 v219, v218
    s_nop 1
    v_permlane32_swap_b32 v218, v219
    v_max_f32 v218, v218, v219
    v_log_f32 v219, s34
    v_add_f32 v218, 0x42980000, v218
    v_sub_f32 v218, v218, v219
    v_max_f32 v218, 0, v218
    v_ceil_f32 v218, v218
    v_mul_f32 v219, -0.5, v218
    v_floor_f32 v220, v219
    v_ceil_f32 v219, v219
    v_exp_f32 v220, v220
    v_exp_f32 v219, v219
    v_sub_f32 v104, v104, v218
    v_sub_f32 v105, v105, v218
    v_sub_f32 v106, v106, v218
    v_sub_f32 v107, v107, v218
    v_sub_f32 v32, v32, v218
    v_sub_f32 v33, v33, v218
    v_sub_f32 v34, v34, v218
    v_sub_f32 v35, v35, v218
    v_sub_f32 v36, v36, v218
    v_sub_f32 v37, v37, v218
    v_sub_f32 v38, v38, v218
    v_sub_f32 v39, v39, v218
    v_sub_f32 v40, v40, v218
    v_sub_f32 v41, v41, v218
    v_sub_f32 v42, v42, v218
    v_sub_f32 v43, v43, v218
    v_sub_f32 v44, v44, v218
    v_sub_f32 v45, v45, v218
    v_sub_f32 v46, v46, v218
    v_sub_f32 v47, v47, v218
    v_mul_f32 v200, v200, v219
    v_mul_f32 v200, v200, v220
    v_mul_f32 v201, v201, v219
    v_mul_f32 v201, v201, v220
    v_mul_f32 v202, v202, v219
    v_mul_f32 v202, v202, v220
    v_mul_f32 v203, v203, v219
    v_mul_f32 v203, v203, v220
    v_mul_f32 v219, v219, v220
    v_accvgpr_read_b32 v220, a64
    v_accvgpr_read_b32 v221, a65
    v_accvgpr_read_b32 v222, a66
    v_accvgpr_read_b32 v223, a67
    v_mul_f32 v220, v220, v219
    v_mul_f32 v221, v221, v219
    v_mul_f32 v222, v222, v219
    v_mul_f32 v223, v223, v219
    v_accvgpr_write_b32 a64, v220
    v_accvgpr_write_b32 a65, v221
    v_accvgpr_write_b32 a66, v222
    v_accvgpr_write_b32 a67, v223
    v_accvgpr_read_b32 v220, a68
    v_accvgpr_read_b32 v221, a69
    v_accvgpr_read_b32 v222, a70
    v_accvgpr_read_b32 v223, a71
    v_mul_f32 v220, v220, v219
    v_mul_f32 v221, v221, v219
    v_mul_f32 v222, v222, v219
    v_mul_f32 v223, v223, v219
    v_accvgpr_write_b32 a68, v220
    v_accvgpr_write_b32 a69, v221
    v_accvgpr_write_b32 a70, v222
    v_accvgpr_write_b32 a71, v223
    v_accvgpr_read_b32 v220, a72
    v_accvgpr_read_b32 v221, a73
    v_accvgpr_read_b32 v222, a74
    v_accvgpr_read_b32 v223, a75
    v_mul_f32 v220, v220, v219
    v_mul_f32 v221, v221, v219
    v_mul_f32 v222, v222, v219
    v_mul_f32 v223, v223, v219
    v_accvgpr_write_b32 a72, v220
    v_accvgpr_write_b32 a73, v221
    v_accvgpr_write_b32 a74, v222
    v_accvgpr_write_b32 a75, v223
    v_accvgpr_read_b32 v220, a76
    v_accvgpr_read_b32 v221, a77
    v_accvgpr_read_b32 v222, a78
    v_accvgpr_read_b32 v223, a79
    v_mul_f32 v220, v220, v219
    v_mul_f32 v221, v221, v219
    v_mul_f32 v222, v222, v219
    v_mul_f32 v223, v223, v219
    v_accvgpr_write_b32 a76, v220
    v_accvgpr_write_b32 a77, v221
    v_accvgpr_write_b32 a78, v222
    v_accvgpr_write_b32 a79, v223
    v_accvgpr_read_b32 v220, a80
    v_accvgpr_read_b32 v221, a81
    v_accvgpr_read_b32 v222, a82
    v_accvgpr_read_b32 v223, a83
    v_mul_f32 v220, v220, v219
    v_mul_f32 v221, v221, v219
    v_mul_f32 v222, v222, v219
    v_mul_f32 v223, v223, v219
    v_accvgpr_write_b32 a80, v220
    v_accvgpr_write_b32 a81, v221
    v_accvgpr_write_b32 a82, v222
    v_accvgpr_write_b32 a83, v223
    v_accvgpr_read_b32 v220, a84
    v_accvgpr_read_b32 v221, a85
    v_accvgpr_read_b32 v222, a86
    v_accvgpr_read_b32 v223, a87
    v_mul_f32 v220, v220, v219
    v_mul_f32 v221, v221, v219
    v_mul_f32 v222, v222, v219
    v_mul_f32 v223, v223, v219
    v_accvgpr_write_b32 a84, v220
    v_accvgpr_write_b32 a85, v221
    v_accvgpr_write_b32 a86, v222
    v_accvgpr_write_b32 a87, v223
    v_accvgpr_read_b32 v220, a88
    v_accvgpr_read_b32 v221, a89
    v_accvgpr_read_b32 v222, a90
    v_accvgpr_read_b32 v223, a91
    v_mul_f32 v220, v220, v219
    v_mul_f32 v221, v221, v219
    v_mul_f32 v222, v222, v219
    v_mul_f32 v223, v223, v219
    v_accvgpr_write_b32 a88, v220
    v_accvgpr_write_b32 a89, v221
    v_accvgpr_write_b32 a90, v222
    v_accvgpr_write_b32 a91, v223
    v_accvgpr_read_b32 v220, a92
    v_accvgpr_read_b32 v221, a93
    v_accvgpr_read_b32 v222, a94
    v_accvgpr_read_b32 v223, a95
    v_mul_f32 v220, v220, v219
    v_mul_f32 v221, v221, v219
    v_mul_f32 v222, v222, v219
    v_mul_f32 v223, v223, v219
    v_accvgpr_write_b32 a92, v220
    v_accvgpr_write_b32 a93, v221
    v_accvgpr_write_b32 a94, v222
    v_accvgpr_write_b32 a95, v223
    v_max3_f32 v218, v48, v49, v50
    v_max3_f32 v219, v51, v52, v53
    v_max3_f32 v218, v218, v54, v55
    v_max3_f32 v219, v219, v56, v57
    v_max3_f32 v218, v218, v58, v59
    v_max3_f32 v219, v219, v60, v61
    v_max3_f32 v218, v218, v62, v63
    v_max_f32 v218, v218, v219
    v_mov_b32 v219, v218
    s_nop 1
    v_permlane16_swap_b32 v218, v219
    v_max_f32 v218, v218, v219
    v_mov_b32 v219, v218
    s_nop 1
    v_permlane32_swap_b32 v218, v219
    v_max_f32 v218, v218, v219
    v_log_f32 v219, s34
    v_add_f32 v218, 0x42980000, v218
    v_sub_f32 v218, v218, v219
    v_max_f32 v218, 0, v218
    v_ceil_f32 v218, v218
    v_mul_f32 v219, -0.5, v218
    v_floor_f32 v220, v219
    v_ceil_f32 v219, v219
    v_exp_f32 v220, v220
    v_exp_f32 v219, v219
    v_sub_f32 v108, v108, v218
    v_sub_f32 v109, v109, v218
    v_sub_f32 v110, v110, v218
    v_sub_f32 v111, v111, v218
    v_sub_f32 v48, v48, v218
    v_sub_f32 v49, v49, v218
    v_sub_f32 v50, v50, v218
    v_sub_f32 v51, v51, v218
    v_sub_f32 v52, v52, v218
    v_sub_f32 v53, v53, v218
    v_sub_f32 v54, v54, v218
    v_sub_f32 v55, v55, v218
    v_sub_f32 v56, v56, v218
    v_sub_f32 v57, v57, v218
    v_sub_f32 v58, v58, v218
    v_sub_f32 v59, v59, v218
    v_sub_f32 v60, v60, v218
    v_sub_f32 v61, v61, v218
    v_sub_f32 v62, v62, v218
    v_sub_f32 v63, v63, v218
    v_mul_f32 v204, v204, v219
    v_mul_f32 v204, v204, v220
    v_mul_f32 v205, v205, v219
    v_mul_f32 v205, v205, v220
    v_mul_f32 v206, v206, v219
    v_mul_f32 v206, v206, v220
    v_mul_f32 v207, v207, v219
    v_mul_f32 v207, v207, v220
    v_mul_f32 v219, v219, v220
    v_accvgpr_read_b32 v220, a96
    v_accvgpr_read_b32 v221, a97
    v_accvgpr_read_b32 v222, a98
    v_accvgpr_read_b32 v223, a99
    v_mul_f32 v220, v220, v219
    v_mul_f32 v221, v221, v219
    v_mul_f32 v222, v222, v219
    v_mul_f32 v223, v223, v219
    v_accvgpr_write_b32 a96, v220
    v_accvgpr_write_b32 a97, v221
    v_accvgpr_write_b32 a98, v222
    v_accvgpr_write_b32 a99, v223
    v_accvgpr_read_b32 v220, a100
    v_accvgpr_read_b32 v221, a101
    v_accvgpr_read_b32 v222, a102
    v_accvgpr_read_b32 v223, a103
    v_mul_f32 v220, v220, v219
    v_mul_f32 v221, v221, v219
    v_mul_f32 v222, v222, v219
    v_mul_f32 v223, v223, v219
    v_accvgpr_write_b32 a100, v220
    v_accvgpr_write_b32 a101, v221
    v_accvgpr_write_b32 a102, v222
    v_accvgpr_write_b32 a103, v223
    v_accvgpr_read_b32 v220, a104
    v_accvgpr_read_b32 v221, a105
    v_accvgpr_read_b32 v222, a106
    v_accvgpr_read_b32 v223, a107
    v_mul_f32 v220, v220, v219
    v_mul_f32 v221, v221, v219
    v_mul_f32 v222, v222, v219
    v_mul_f32 v223, v223, v219
    v_accvgpr_write_b32 a104, v220
    v_accvgpr_write_b32 a105, v221
    v_accvgpr_write_b32 a106, v222
    v_accvgpr_write_b32 a107, v223
    v_accvgpr_read_b32 v220, a108
    v_accvgpr_read_b32 v221, a109
    v_accvgpr_read_b32 v222, a110
    v_accvgpr_read_b32 v223, a111
    v_mul_f32 v220, v220, v219
    v_mul_f32 v221, v221, v219
    v_mul_f32 v222, v222, v219
    v_mul_f32 v223, v223, v219
    v_accvgpr_write_b32 a108, v220
    v_accvgpr_write_b32 a109, v221
    v_accvgpr_write_b32 a110, v222
    v_accvgpr_write_b32 a111, v223
    v_accvgpr_read_b32 v220, a112
    v_accvgpr_read_b32 v221, a113
    v_accvgpr_read_b32 v222, a114
    v_accvgpr_read_b32 v223, a115
    v_mul_f32 v220, v220, v219
    v_mul_f32 v221, v221, v219
    v_mul_f32 v222, v222, v219
    v_mul_f32 v223, v223, v219
    v_accvgpr_write_b32 a112, v220
    v_accvgpr_write_b32 a113, v221
    v_accvgpr_write_b32 a114, v222
    v_accvgpr_write_b32 a115, v223
    v_accvgpr_read_b32 v220, a116
    v_accvgpr_read_b32 v221, a117
    v_accvgpr_read_b32 v222, a118
    v_accvgpr_read_b32 v223, a119
    v_mul_f32 v220, v220, v219
    v_mul_f32 v221, v221, v219
    v_mul_f32 v222, v222, v219
    v_mul_f32 v223, v223, v219
    v_accvgpr_write_b32 a116, v220
    v_accvgpr_write_b32 a117, v221
    v_accvgpr_write_b32 a118, v222
    v_accvgpr_write_b32 a119, v223
    v_accvgpr_read_b32 v220, a120
    v_accvgpr_read_b32 v221, a121
    v_accvgpr_read_b32 v222, a122
    v_accvgpr_read_b32 v223, a123
    v_mul_f32 v220, v220, v219
    v_mul_f32 v221, v221, v219
    v_mul_f32 v222, v222, v219
    v_mul_f32 v223, v223, v219
    v_accvgpr_write_b32 a120, v220
    v_accvgpr_write_b32 a121, v221
    v_accvgpr_write_b32 a122, v222
    v_accvgpr_write_b32 a123, v223
    v_accvgpr_read_b32 v220, a124
    v_accvgpr_read_b32 v221, a125
    v_accvgpr_read_b32 v222, a126
    v_accvgpr_read_b32 v223, a127
    v_mul_f32 v220, v220, v219
    v_mul_f32 v221, v221, v219
    v_mul_f32 v222, v222, v219
    v_mul_f32 v223, v223, v219
    v_accvgpr_write_b32 a124, v220
    v_accvgpr_write_b32 a125, v221
    v_accvgpr_write_b32 a126, v222
    v_accvgpr_write_b32 a127, v223
    v_exp_f32 v208, v32
    v_exp_f32 v209, v33
    v_exp_f32 v210, v34
    v_cvt_pk_bf16_f32 v80, v208, v209
    v_exp_f32 v211, v35
    v_exp_f32 v212, v36
    v_cvt_pk_bf16_f32 v81, v210, v211
    v_exp_f32 v213, v37
    v_exp_f32 v214, v38
    v_cvt_pk_bf16_f32 v82, v212, v213
    v_exp_f32 v215, v39
    v_exp_f32 v208, v40
    v_cvt_pk_bf16_f32 v83, v214, v215
    v_exp_f32 v209, v41
    v_exp_f32 v210, v42
    v_cvt_pk_bf16_f32 v84, v208, v209
    v_exp_f32 v211, v43
    v_exp_f32 v212, v44
    v_cvt_pk_bf16_f32 v85, v210, v211
    v_exp_f32 v213, v45
    v_exp_f32 v214, v46
    v_cvt_pk_bf16_f32 v86, v212, v213
    v_exp_f32 v215, v47
    v_exp_f32 v208, v48
    v_cvt_pk_bf16_f32 v87, v214, v215
    v_exp_f32 v209, v49
    v_exp_f32 v210, v50
    v_cvt_pk_bf16_f32 v88, v208, v209
    v_exp_f32 v211, v51
    v_exp_f32 v212, v52
    v_cvt_pk_bf16_f32 v89, v210, v211
    v_exp_f32 v213, v53
    v_exp_f32 v214, v54
    v_cvt_pk_bf16_f32 v90, v212, v213
    v_exp_f32 v215, v55
    v_exp_f32 v208, v56
    v_cvt_pk_bf16_f32 v91, v214, v215
    v_exp_f32 v209, v57
    v_exp_f32 v210, v58
    v_cvt_pk_bf16_f32 v92, v208, v209
    v_exp_f32 v211, v59
    v_exp_f32 v212, v60
    v_cvt_pk_bf16_f32 v93, v210, v211
    v_exp_f32 v213, v61
    v_exp_f32 v214, v62
    v_cvt_pk_bf16_f32 v94, v212, v213
    v_exp_f32 v215, v63
    s_nop 0
    v_cvt_pk_bf16_f32 v95, v214, v215
    v_mov_b32 v116, 0
    v_mov_b32 v117, 0
    v_mov_b32 v118, 0
    v_mov_b32 v119, 0
    v_mov_b32 v120, 0
    v_mov_b32 v121, 0
    v_mov_b32 v122, 0
    v_mov_b32 v123, 0
    v_smfmac_f32_16x16x64_bf16 v[116:119], v[226:229], v[80:87], v112
    s_nop 0
    v_smfmac_f32_16x16x64_bf16 v[120:123], v[226:229], v[88:95], v112
    v_mov_b32 v218, 0x7f800000
    v_cmp_lt_f32 vcc, v200, v218
    s_nop 3
    v_cndmask_b32 v200, v116, v200, vcc
    v_cmp_lt_f32 vcc, v201, v218
    s_nop 1
    v_cndmask_b32 v201, v117, v201, vcc
    v_cmp_lt_f32 vcc, v202, v218
    s_nop 1
    v_cndmask_b32 v202, v118, v202, vcc
    v_cmp_lt_f32 vcc, v203, v218
    s_nop 1
    v_cndmask_b32 v203, v119, v203, vcc
    v_cmp_lt_f32 vcc, v204, v218
    s_nop 1
    v_cndmask_b32 v204, v120, v204, vcc
    v_cmp_lt_f32 vcc, v205, v218
    s_nop 1
    v_cndmask_b32 v205, v121, v205, vcc
    v_cmp_lt_f32 vcc, v206, v218
    s_nop 1
    v_cndmask_b32 v206, v122, v206, vcc
    v_cmp_lt_f32 vcc, v207, v218
    s_nop 1
    v_cndmask_b32 v207, v123, v207, vcc
    s_nop 1
    s_setpc_b64 s[36:37]

CODE_END:
.section .rodata,"a"
.p2align 6
.amdhsa_kernel adaLN_cond__gqa_block_cached__moe_arch_mod__prompt_kernel
  .amdhsa_next_free_vgpr 512
  .amdhsa_next_free_sgpr 102
  .amdhsa_accum_offset 256
  .amdhsa_group_segment_fixed_size 0
  .amdhsa_kernarg_size 120
  .amdhsa_user_sgpr_count 2
  .amdhsa_user_sgpr_kernarg_segment_ptr 1
  .amdhsa_system_sgpr_workgroup_id_x 1
.end_amdhsa_kernel
```
